```python
import torch

def _softmax(x, axis=-1):
    return torch.softmax(x, dim=axis)
def _gelu(x):
    return torch.nn.functional.gelu(x, approximate="tanh")
def _silu(x):
    return torch.nn.functional.silu(x)
def _sigmoid(x):
    return torch.sigmoid(x)
def _layernorm(x, axis=-1, eps=1e-5):
    m = x.mean(dim=axis, keepdim=True)
    v = x.var(dim=axis, keepdim=True, unbiased=False)
    return (x - m) / torch.sqrt(v + eps)
def _scatter_add(tgt, idx, src, axis=0):
    return tgt.clone().index_add_(axis, idx, src)
def _segment_sum(src, seg, n):
    out = torch.zeros((n,) + src.shape[1:], dtype=src.dtype)
    return out.index_add_(0, seg, src)
def _pad(x, pw):
    flat = tuple(v for pair in reversed(pw) for v in pair)
    return torch.nn.functional.pad(x, flat)

kernel_name = 'recurrent_scan__ssm_conv_s5__dense_activation_silu__prompt'

def setup_inputs():

    _w = (lambda a: (lambda t: t.to(torch.bfloat16) if t.is_floating_point() else t)(torch.as_tensor(a)))
    def _A_setup():
        B, S, D = 1, 2048, 576
        P = D
        Lambda_re = -0.5 * (lambda _x: torch.exp(torch.as_tensor(_x)))((lambda *s: torch.randn(*s, dtype=torch.bfloat16) * 0.8)(P))
        Lambda_im = (lambda *s: torch.randn(*s, dtype=torch.bfloat16) * 0.8)(P) * 1.0
        B_re = (lambda *s: torch.randn(*s, dtype=torch.bfloat16) * 0.8)(P, D) * (D ** -0.5)
        B_im = (lambda *s: torch.randn(*s, dtype=torch.bfloat16) * 0.8)(P, D) * (D ** -0.5)
        C_re = (lambda *s: torch.randn(*s, dtype=torch.bfloat16) * 0.8)(D, P) * (P ** -0.5)
        C_im = (lambda *s: torch.randn(*s, dtype=torch.bfloat16) * 0.8)(D, P) * (P ** -0.5)
        log_dt = (lambda *s: torch.randn(*s, dtype=torch.bfloat16) * 0.8)(P) * 0.3 - 2.0
        Dskip = (lambda *s: torch.randn(*s, dtype=torch.bfloat16) * 0.4)(D)
        return {
            "x": _w((lambda *s: torch.randn(*s, dtype=torch.bfloat16) * 0.05)(B, S, D)),
            "Lambda_re": _w(Lambda_re),
            "Lambda_im": _w(Lambda_im),
            "B_re": _w(B_re),
            "B_im": _w(B_im),
            "C_re": _w(C_re),
            "C_im": _w(C_im),
            "log_dt": _w(log_dt),
            "Dskip": _w(Dskip),
        }
    _A_in = _A_setup()

    def _B_setup():
        B, S, D, F = 1, 2048, 576, 4608
        return {
            "x": _w((lambda *s: torch.randn(*s, dtype=torch.bfloat16) * 0.05)(B, S, D)),
            "w1": _w((lambda *s: torch.randn(*s, dtype=torch.bfloat16) * 0.8)(D, F) * (D ** -0.5)),
            "w2": _w((lambda *s: torch.randn(*s, dtype=torch.bfloat16) * 0.1)(F, D) * (F ** -0.5)),
        }
    _B_in = _B_setup()

    return {
        "A_x": _A_in["x"],
        "A_Lambda_re": _A_in["Lambda_re"],
        "A_Lambda_im": _A_in["Lambda_im"],
        "A_B_re": _A_in["B_re"],
        "A_B_im": _A_in["B_im"],
        "A_C_re": _A_in["C_re"],
        "A_C_im": _A_in["C_im"],
        "A_log_dt": _A_in["log_dt"],
        "A_Dskip": _A_in["Dskip"],
        "B_x": _B_in["x"],
        "B_w1": _B_in["w1"],
        "B_w2": _B_in["w2"],
    }

def reference(A_x, A_Lambda_re, A_Lambda_im, A_B_re, A_B_im, A_C_re, A_C_im, A_log_dt, A_Dskip, B_x, B_w1, B_w2):
    def _A_ref(x, Lambda_re, Lambda_im, B_re, B_im, C_re, C_im, log_dt, Dskip):
        Bsz, L, H = x.shape
        Lam = Lambda_re + 1j * Lambda_im
        Bmat = B_re + 1j * B_im
        Cmat = C_re + 1j * C_im
        dt = torch.exp(log_dt)
        Lam_bar = torch.exp(dt * Lam)
        B_bar = ((Lam_bar - 1.0) / Lam)[:, None] * Bmat
        Bu = torch.einsum("bld,pd->blp", x + 0j, B_bar)
        h = torch.zeros_like(Bu[:, 0, :])
        hs = []
        for t in range(L):
            h = Lam_bar[None, :] * h + Bu[:, t, :]
            hs.append(h)
        hseq = torch.stack(hs, 1)
        y = 2.0 * torch.einsum("blp,dp->bld", hseq, Cmat).real + x * Dskip[None, None, :]
        return y

    def _B_ref(x, w1, w2):
        h = torch.einsum("bsd,df->bsf", x, w1)
        h = _silu(h)
        out = torch.einsum("bsf,fd->bsd", h, w2)
        return out

    x = A_x
    xn = _layernorm(x, axis=-1)
    s = _A_ref(xn, A_Lambda_re, A_Lambda_im, A_B_re, A_B_im, A_C_re, A_C_im, A_log_dt, A_Dskip)
    g = _silu(_B_ref(xn, B_w1, B_w2))
    return x + s * g
```

```asm
; @launch grid=(256,1,1) block=(256,1,1) lds=158720
.amdgcn_target "amdgcn-amd-amdhsa--gfx950"
.text
.globl recurrent_scan__ssm_conv_s5__dense_activation_silu__prompt_kernel
.p2align 8
.type recurrent_scan__ssm_conv_s5__dense_activation_silu__prompt_kernel,@function
recurrent_scan__ssm_conv_s5__dense_activation_silu__prompt_kernel:
KSTART:
  s_cmp_ge_u32 s2, 256
  s_cbranch_scc1 KEND
  s_load_dwordx2 s[96:97], s[0:1], 0
  s_load_dwordx2 s[98:99], s[0:1], 112
  s_load_dwordx2 s[100:101], s[0:1], 80
  s_load_dwordx4 s[56:59], s[0:1], 24
  s_load_dwordx4 s[60:63], s[0:1], 8
  s_load_dwordx2 s[54:55], s[0:1], 56
  v_lshrrev_b32 v13, 6, v0
  s_nop 0
  v_readfirstlane_b32 s30, v13
  v_and_b32 v0, 63, v0
  s_nop 0
  s_cmp_lt_u32 s30, 2
  s_cbranch_scc1 DO_LN
  s_lshl_b32 s3, s2, 1
  s_add_u32 s3, s3, s30
  s_sub_u32 s3, s3, 2
  s_mul_i32 s4, s3, 1408
  v_min_u32 v252, 10, v0
  v_lshl_add_u32 v252, v252, 7, s4
  v_min_u32 v252, 663548, v252
  s_mul_i32 s4, s3, 45
  v_min_u32 v250, 44, v0
  v_add_u32 v250, s4, v250
  v_mul_u32_u24 v14, 52429, v250
  v_lshrrev_b32 v14, 18, v14
  v_mul_u32_u24 v15, 5, v14
  v_sub_u32 v15, v250, v15
  v_lshl_add_u32 v250, v14, 2, v250
  v_cmp_lt_u32 vcc, 1, v15
  s_nop 1
  v_cndmask_b32 v15, 0, 2, vcc
  v_add_lshl_u32 v250, v250, v15, 7
  v_min_u32 v250, 5308412, v250
  s_getpc_b64 s[4:5]
PFPC:
  s_sub_u32 s4, s4, PFPC-KSTART
  s_subb_u32 s5, s5, 0
  s_lshr_b32 s6, s2, 3
  s_and_b32 s6, s6, 15
  s_add_u32 s6, s6, 1
  s_mul_i32 s6, s6, 6144
  s_cmp_eq_u32 s30, 3
  s_cselect_b32 s6, 0, s6
  v_lshl_add_u32 v14, v0, 7, s6
  v_min_u32 v14, KLAST-KSTART, v14
  global_load_dword v253, v14, s[4:5]
  s_waitcnt lgkmcnt(0)
  s_add_u32 s8, s98, 0x0
  s_addc_u32 s9, s99, 0
  s_and_b32 s9, s9, 0xffff
  s_mov_b32 s10, 0x4000000
  s_mov_b32 s11, 0x00020000
  s_mov_b32 s12, s100
  s_and_b32 s13, s101, 0xffff
  s_mov_b32 s14, 0x510000
  s_mov_b32 s15, 0x00020000
  s_mov_b32 s16, s56
  s_and_b32 s17, s57, 0xffff
  s_mov_b32 s18, 0xa2000
  s_mov_b32 s19, 0x00020000
  s_mov_b32 s20, s58
  s_and_b32 s21, s59, 0xffff
  s_mov_b32 s22, 0xa2000
  s_mov_b32 s23, 0x00020000
  global_load_dword v253, v252, s[56:57]
  global_load_dword v253, v252, s[58:59]
  global_load_dword v253, v250, s[100:101]
  s_branch SKIP_LN
DO_LN:
  s_lshl_b32 s3, s2, 1
  s_add_u32 s3, s3, s30
  s_lshr_b32 s4, s3, 4
  s_lshl_b32 s4, s4, 6
  s_and_b32 s5, s3, 1
  s_lshl_b32 s5, s5, 5
  s_add_u32 s4, s4, s5
  s_bfe_u32 s5, s3, 0x10003
  s_lshl_b32 s5, s5, 4
  s_add_u32 s4, s4, s5
  s_bfe_u32 s5, s3, 0x20001
  s_lshl_b32 s5, s5, 2
  s_add_u32 s4, s4, s5
  v_and_b32 v112, 3, v0
  v_lshrrev_b32 v113, 2, v0
  v_add_u32 v114, s4, v112
  v_mul_u32_u24 v115, 1152, v114
  v_lshl_add_u32 v115, v113, 4, v115
  v_mov_b32 v64, 0
  v_mov_b32 v65, 0
  v_mov_b32 v66, 0
  v_mov_b32 v67, 0
  s_waitcnt lgkmcnt(0)
  global_load_dwordx4 v[48:51], v115, s[96:97] offset:0
  global_load_dwordx4 v[52:55], v115, s[96:97] offset:256
  global_load_dwordx4 v[56:59], v115, s[96:97] offset:512
  global_load_dwordx4 v[60:63], v115, s[96:97] offset:768
  s_mov_b32 exec_hi, 0
  global_load_dwordx4 v[64:67], v115, s[96:97] offset:1024
  s_mov_b32 exec_hi, -1
  s_mov_b32 s43, s3
  s_and_b32 s3, s2, 7
  s_lshr_b32 s4, s2, 3
  s_lshr_b32 s5, s3, 1
  s_mul_i32 s5, s5, 30
  s_add_u32 s5, s5, s4
  s_lshr_b32 s6, s5, 2
  s_min_u32 s6, s6, 29
  s_bfm_b32 s7, s6, 0
  s_and_b32 s7, s7, 0x3555eaab
  s_bcnt1_i32_b32 s7, s7
  s_sub_u32 s4, s6, s7
  s_add_u32 s4, s4, 18
  s_bitcmp1_b32 0x3555eaab, s6
  s_cselect_b32 s29, s7, s4
  s_and_b32 s5, s5, 3
  s_and_b32 s3, s3, 1
  s_lshl_b32 s3, s3, 2
  s_add_u32 s28, s3, s5
  s_lshl_b32 s33, s30, 10
  v_lshrrev_b32 v13, 3, v0
  v_and_b32 v14, 7, v0
  v_bfe_u32 v15, v0, 4, 1
  v_lshlrev_b32 v15, 2, v15
  v_xor_b32 v14, v14, v15
  s_lshl_b32 s3, s30, 3
  v_add_u32 v13, s3, v13
  v_mul_u32_u24 v3, 9216, v13
  v_lshl_add_u32 v3, v14, 4, v3
  s_lshr_b32 s3, s29, 2
  s_and_b32 s4, s29, 3
  s_mul_i32 s3, s3, 9
  s_add_u32 s3, s3, s4
  s_cmp_lt_u32 s4, 2
  s_cselect_b32 s4, 2, 5
  s_add_u32 s3, s3, s4
  s_lshl_b32 s36, s3, 7
  s_lshr_b32 s3, s29, 1
  s_mul_i32 s3, s3, 9
  s_and_b32 s34, s29, 1
  s_lshl_b32 s4, s34, 1
  s_sub_u32 s3, s3, s4
  s_add_u32 s3, s3, 6
  s_add_u32 s5, s29, 54
  s_cmp_lt_u32 s29, 16
  s_cselect_b32 s3, s3, s5
  s_lshl_b32 s35, s3, 7
  s_lshl_b32 s34, s34, 11
  s_mov_b32 s32, s34
  s_mov_b32 s42, s35
  s_lshl_b32 s7, s29, 1
  s_sub_u32 s7, s7, 36
  s_mul_i32 s3, s7, 86
  s_lshr_b32 s3, s3, 8
  s_mul_i32 s4, s3, 3
  s_sub_u32 s4, s7, s4
  s_cmp_lt_u32 s4, 2
  s_cselect_b32 s4, s4, 5
  s_mul_i32 s3, s3, 9
  s_add_u32 s3, s3, s4
  s_lshl_b32 s34, s3, 7
  s_add_u32 s7, s7, 1
  s_mul_i32 s3, s7, 86
  s_lshr_b32 s3, s3, 8
  s_mul_i32 s4, s3, 3
  s_sub_u32 s4, s7, s4
  s_cmp_lt_u32 s4, 2
  s_cselect_b32 s4, s4, 5
  s_mul_i32 s3, s3, 9
  s_add_u32 s3, s3, s4
  s_lshl_b32 s35, s3, 7
  s_cmp_lt_u32 s29, 18
  s_cselect_b32 s34, s32, s34
  s_cselect_b32 s35, s42, s35
  s_mov_b32 s3, s43
  s_mov_b32 s12, s100
  s_and_b32 s13, s101, 0xffff
  s_mov_b32 s14, 0x510000
  s_mov_b32 s15, 0x00020000
  s_add_u32 s8, s98, 0x0
  s_addc_u32 s9, s99, 0
  s_and_b32 s9, s9, 0xffff
  s_mov_b32 s10, 0x4000000
  s_mov_b32 s11, 0x00020000
  s_load_dword s45, s[8:9], 0
  s_lshr_b32 s5, s3, 3
  s_mul_i32 s5, s5, 36864
  s_and_b32 s6, s3, 7
  s_lshl_b32 s6, s6, 7
  s_add_u32 s5, s5, s6
  s_add_u32 s5, s5, 1048576
  v_lshrrev_b32 v116, 3, v0
  v_lshlrev_b32 v116, 10, v116
  v_and_b32 v117, 7, v0
  v_lshl_add_u32 v116, v117, 4, v116
  v_lshlrev_b32 v114, 3, v114
  s_mov_b32 s38, 0xffff0000
  s_mov_b32 s32, -1
  s_waitcnt vmcnt(0)
LN_BODY:
  v_lshlrev_b32 v72, 16, v48
  v_and_b32 v73, s38, v48
  v_lshlrev_b32 v74, 16, v49
  v_and_b32 v75, s38, v49
  v_lshlrev_b32 v76, 16, v50
  v_and_b32 v77, s38, v50
  v_lshlrev_b32 v78, 16, v51
  v_and_b32 v79, s38, v51
  v_lshlrev_b32 v80, 16, v52
  v_and_b32 v81, s38, v52
  v_lshlrev_b32 v82, 16, v53
  v_and_b32 v83, s38, v53
  v_pk_add_f32 v[124:125], v[72:73], v[80:81]
  v_lshlrev_b32 v84, 16, v54
  v_and_b32 v85, s38, v54
  v_pk_add_f32 v[126:127], v[74:75], v[82:83]
  v_lshlrev_b32 v86, 16, v55
  v_and_b32 v87, s38, v55
  v_pk_add_f32 v[128:129], v[76:77], v[84:85]
  v_lshlrev_b32 v88, 16, v56
  v_and_b32 v89, s38, v56
  v_pk_add_f32 v[130:131], v[78:79], v[86:87]
  v_lshlrev_b32 v90, 16, v57
  v_and_b32 v91, s38, v57
  v_pk_add_f32 v[124:125], v[124:125], v[88:89]
  v_lshlrev_b32 v92, 16, v58
  v_and_b32 v93, s38, v58
  v_pk_add_f32 v[126:127], v[126:127], v[90:91]
  v_lshlrev_b32 v94, 16, v59
  v_and_b32 v95, s38, v59
  v_pk_add_f32 v[128:129], v[128:129], v[92:93]
  v_lshlrev_b32 v96, 16, v60
  v_and_b32 v97, s38, v60
  v_pk_add_f32 v[130:131], v[130:131], v[94:95]
  v_lshlrev_b32 v98, 16, v61
  v_and_b32 v99, s38, v61
  v_pk_add_f32 v[124:125], v[124:125], v[96:97]
  v_lshlrev_b32 v100, 16, v62
  v_and_b32 v101, s38, v62
  v_pk_add_f32 v[126:127], v[126:127], v[98:99]
  v_lshlrev_b32 v102, 16, v63
  v_and_b32 v103, s38, v63
  v_pk_add_f32 v[128:129], v[128:129], v[100:101]
  v_lshlrev_b32 v104, 16, v64
  v_and_b32 v105, s38, v64
  v_pk_add_f32 v[130:131], v[130:131], v[102:103]
  v_lshlrev_b32 v106, 16, v65
  v_and_b32 v107, s38, v65
  v_pk_add_f32 v[124:125], v[124:125], v[104:105]
  v_lshlrev_b32 v108, 16, v66
  v_and_b32 v109, s38, v66
  v_pk_add_f32 v[126:127], v[126:127], v[106:107]
  v_lshlrev_b32 v110, 16, v67
  v_and_b32 v111, s38, v67
  v_pk_add_f32 v[128:129], v[128:129], v[108:109]
  v_pk_add_f32 v[130:131], v[130:131], v[110:111]
  v_pk_add_f32 v[124:125], v[124:125], v[126:127]
  v_pk_add_f32 v[128:129], v[128:129], v[130:131]
  v_pk_add_f32 v[124:125], v[124:125], v[128:129]
  v_add_f32 v122, v124, v125
  s_nop 1
  v_add_f32_dpp v122, v122, v122 row_ror:4 row_mask:0xf bank_mask:0xf
  s_nop 1
  v_add_f32_dpp v122, v122, v122 row_ror:8 row_mask:0xf bank_mask:0xf
  v_mov_b32 v118, v122
  s_nop 1
  v_permlane16_swap_b32 v122, v118
  v_add_f32 v122, v122, v118
  v_mov_b32 v118, v122
  s_nop 1
  v_permlane32_swap_b32 v122, v118
  v_add_f32 v122, v122, v118
  v_mul_f32 v122, 0x3ae38e39, v122
  v_cvt_pk_bf16_f32 v120, v122, v122
  v_lshlrev_b32 v120, 16, v120
  v_sub_f32 v122, v122, v120
  v_pk_add_f32 v[72:73], v[72:73], v[120:121] op_sel_hi:[1,0] neg_lo:[0,1] neg_hi:[0,1]
  v_pk_add_f32 v[74:75], v[74:75], v[120:121] op_sel_hi:[1,0] neg_lo:[0,1] neg_hi:[0,1]
  v_pk_add_f32 v[76:77], v[76:77], v[120:121] op_sel_hi:[1,0] neg_lo:[0,1] neg_hi:[0,1]
  v_pk_add_f32 v[78:79], v[78:79], v[120:121] op_sel_hi:[1,0] neg_lo:[0,1] neg_hi:[0,1]
  v_pk_mul_f32 v[124:125], v[72:73], v[72:73]
  v_pk_mul_f32 v[126:127], v[74:75], v[74:75]
  v_pk_mul_f32 v[128:129], v[76:77], v[76:77]
  v_pk_mul_f32 v[130:131], v[78:79], v[78:79]
  v_pk_add_f32 v[80:81], v[80:81], v[120:121] op_sel_hi:[1,0] neg_lo:[0,1] neg_hi:[0,1]
  v_pk_add_f32 v[82:83], v[82:83], v[120:121] op_sel_hi:[1,0] neg_lo:[0,1] neg_hi:[0,1]
  v_pk_add_f32 v[84:85], v[84:85], v[120:121] op_sel_hi:[1,0] neg_lo:[0,1] neg_hi:[0,1]
  v_pk_add_f32 v[86:87], v[86:87], v[120:121] op_sel_hi:[1,0] neg_lo:[0,1] neg_hi:[0,1]
  v_pk_fma_f32 v[124:125], v[80:81], v[80:81], v[124:125]
  v_pk_fma_f32 v[126:127], v[82:83], v[82:83], v[126:127]
  v_pk_fma_f32 v[128:129], v[84:85], v[84:85], v[128:129]
  v_pk_fma_f32 v[130:131], v[86:87], v[86:87], v[130:131]
  v_pk_add_f32 v[88:89], v[88:89], v[120:121] op_sel_hi:[1,0] neg_lo:[0,1] neg_hi:[0,1]
  v_pk_add_f32 v[90:91], v[90:91], v[120:121] op_sel_hi:[1,0] neg_lo:[0,1] neg_hi:[0,1]
  v_pk_add_f32 v[92:93], v[92:93], v[120:121] op_sel_hi:[1,0] neg_lo:[0,1] neg_hi:[0,1]
  v_pk_add_f32 v[94:95], v[94:95], v[120:121] op_sel_hi:[1,0] neg_lo:[0,1] neg_hi:[0,1]
  v_pk_fma_f32 v[124:125], v[88:89], v[88:89], v[124:125]
  v_pk_fma_f32 v[126:127], v[90:91], v[90:91], v[126:127]
  v_pk_fma_f32 v[128:129], v[92:93], v[92:93], v[128:129]
  v_pk_fma_f32 v[130:131], v[94:95], v[94:95], v[130:131]
  v_pk_add_f32 v[96:97], v[96:97], v[120:121] op_sel_hi:[1,0] neg_lo:[0,1] neg_hi:[0,1]
  v_pk_add_f32 v[98:99], v[98:99], v[120:121] op_sel_hi:[1,0] neg_lo:[0,1] neg_hi:[0,1]
  v_pk_add_f32 v[100:101], v[100:101], v[120:121] op_sel_hi:[1,0] neg_lo:[0,1] neg_hi:[0,1]
  v_pk_add_f32 v[102:103], v[102:103], v[120:121] op_sel_hi:[1,0] neg_lo:[0,1] neg_hi:[0,1]
  v_pk_fma_f32 v[124:125], v[96:97], v[96:97], v[124:125]
  v_pk_fma_f32 v[126:127], v[98:99], v[98:99], v[126:127]
  v_pk_fma_f32 v[128:129], v[100:101], v[100:101], v[128:129]
  v_pk_fma_f32 v[130:131], v[102:103], v[102:103], v[130:131]
  s_mov_b32 exec_hi, 0
  v_pk_add_f32 v[104:105], v[104:105], v[120:121] op_sel_hi:[1,0] neg_lo:[0,1] neg_hi:[0,1]
  v_pk_add_f32 v[106:107], v[106:107], v[120:121] op_sel_hi:[1,0] neg_lo:[0,1] neg_hi:[0,1]
  v_pk_add_f32 v[108:109], v[108:109], v[120:121] op_sel_hi:[1,0] neg_lo:[0,1] neg_hi:[0,1]
  v_pk_add_f32 v[110:111], v[110:111], v[120:121] op_sel_hi:[1,0] neg_lo:[0,1] neg_hi:[0,1]
  v_pk_fma_f32 v[124:125], v[104:105], v[104:105], v[124:125]
  v_pk_fma_f32 v[126:127], v[106:107], v[106:107], v[126:127]
  v_pk_fma_f32 v[128:129], v[108:109], v[108:109], v[128:129]
  v_pk_fma_f32 v[130:131], v[110:111], v[110:111], v[130:131]
  s_mov_b32 exec_hi, s32
  v_pk_add_f32 v[124:125], v[124:125], v[126:127]
  v_pk_add_f32 v[128:129], v[128:129], v[130:131]
  v_pk_add_f32 v[124:125], v[124:125], v[128:129]
  v_add_f32 v121, v124, v125
  s_nop 1
  v_add_f32_dpp v121, v121, v121 row_ror:4 row_mask:0xf bank_mask:0xf
  s_nop 1
  v_add_f32_dpp v121, v121, v121 row_ror:8 row_mask:0xf bank_mask:0xf
  v_mov_b32 v118, v121
  s_nop 1
  v_permlane16_swap_b32 v121, v118
  v_add_f32 v121, v121, v118
  v_mov_b32 v118, v121
  s_nop 1
  v_permlane32_swap_b32 v121, v118
  v_add_f32 v121, v121, v118
  v_mul_f32 v121, 0x3ae38e39, v121
  v_fma_f32 v121, -v122, v122, v121
  v_cvt_pk_bf16_f32 v121, v121, v121
  v_lshlrev_b32 v121, 16, v121
  v_add_f32 v121, 0x3727c5ac, v121
  v_cvt_pk_bf16_f32 v121, v121, v121
  v_lshlrev_b32 v121, 16, v121
  v_sqrt_f32 v121, v121
  s_nop 0
  v_cvt_pk_bf16_f32 v121, v121, v121
  v_lshlrev_b32 v121, 16, v121
  v_rcp_f32 v121, v121
  s_nop 0
  v_pk_mul_f32 v[72:73], v[72:73], v[120:121] op_sel:[0,1] op_sel_hi:[1,1]
  v_pk_mul_f32 v[74:75], v[74:75], v[120:121] op_sel:[0,1] op_sel_hi:[1,1]
  v_pk_mul_f32 v[76:77], v[76:77], v[120:121] op_sel:[0,1] op_sel_hi:[1,1]
  v_pk_mul_f32 v[78:79], v[78:79], v[120:121] op_sel:[0,1] op_sel_hi:[1,1]
  v_cvt_pk_bf16_f32 v48, v72, v73
  v_cvt_pk_bf16_f32 v49, v74, v75
  v_cvt_pk_bf16_f32 v50, v76, v77
  v_cvt_pk_bf16_f32 v51, v78, v79
  buffer_store_dwordx4 v[48:51], v116, s[8:11], s5 offen sc1
  s_add_u32 s5, s5, 8192
  v_pk_mul_f32 v[80:81], v[80:81], v[120:121] op_sel:[0,1] op_sel_hi:[1,1]
  v_pk_mul_f32 v[82:83], v[82:83], v[120:121] op_sel:[0,1] op_sel_hi:[1,1]
  v_pk_mul_f32 v[84:85], v[84:85], v[120:121] op_sel:[0,1] op_sel_hi:[1,1]
  v_pk_mul_f32 v[86:87], v[86:87], v[120:121] op_sel:[0,1] op_sel_hi:[1,1]
  v_cvt_pk_bf16_f32 v52, v80, v81
  v_cvt_pk_bf16_f32 v53, v82, v83
  v_cvt_pk_bf16_f32 v54, v84, v85
  v_cvt_pk_bf16_f32 v55, v86, v87
  buffer_store_dwordx4 v[52:55], v116, s[8:11], s5 offen sc1
  s_add_u32 s5, s5, 8192
  v_pk_mul_f32 v[88:89], v[88:89], v[120:121] op_sel:[0,1] op_sel_hi:[1,1]
  v_pk_mul_f32 v[90:91], v[90:91], v[120:121] op_sel:[0,1] op_sel_hi:[1,1]
  v_pk_mul_f32 v[92:93], v[92:93], v[120:121] op_sel:[0,1] op_sel_hi:[1,1]
  v_pk_mul_f32 v[94:95], v[94:95], v[120:121] op_sel:[0,1] op_sel_hi:[1,1]
  v_cvt_pk_bf16_f32 v56, v88, v89
  v_cvt_pk_bf16_f32 v57, v90, v91
  v_cvt_pk_bf16_f32 v58, v92, v93
  v_cvt_pk_bf16_f32 v59, v94, v95
  buffer_store_dwordx4 v[56:59], v116, s[8:11], s5 offen sc1
  s_add_u32 s5, s5, 8192
  v_pk_mul_f32 v[96:97], v[96:97], v[120:121] op_sel:[0,1] op_sel_hi:[1,1]
  v_pk_mul_f32 v[98:99], v[98:99], v[120:121] op_sel:[0,1] op_sel_hi:[1,1]
  v_pk_mul_f32 v[100:101], v[100:101], v[120:121] op_sel:[0,1] op_sel_hi:[1,1]
  v_pk_mul_f32 v[102:103], v[102:103], v[120:121] op_sel:[0,1] op_sel_hi:[1,1]
  v_cvt_pk_bf16_f32 v60, v96, v97
  v_cvt_pk_bf16_f32 v61, v98, v99
  v_cvt_pk_bf16_f32 v62, v100, v101
  v_cvt_pk_bf16_f32 v63, v102, v103
  buffer_store_dwordx4 v[60:63], v116, s[8:11], s5 offen sc1
  s_add_u32 s5, s5, 8192
  s_mov_b32 exec_hi, 0
  v_pk_mul_f32 v[104:105], v[104:105], v[120:121] op_sel:[0,1] op_sel_hi:[1,1]
  v_pk_mul_f32 v[106:107], v[106:107], v[120:121] op_sel:[0,1] op_sel_hi:[1,1]
  v_pk_mul_f32 v[108:109], v[108:109], v[120:121] op_sel:[0,1] op_sel_hi:[1,1]
  v_pk_mul_f32 v[110:111], v[110:111], v[120:121] op_sel:[0,1] op_sel_hi:[1,1]
  v_cvt_pk_bf16_f32 v64, v104, v105
  v_cvt_pk_bf16_f32 v65, v106, v107
  v_cvt_pk_bf16_f32 v66, v108, v109
  v_cvt_pk_bf16_f32 v67, v110, v111
  buffer_store_dwordx4 v[64:67], v116, s[8:11], s5 offen sc1
  s_mov_b32 exec_lo, 15
  s_mov_b32 s5, 16384
  buffer_store_dwordx2 v[120:121], v114, s[8:11], s5 offen sc1
  s_mov_b64 exec, -1
  s_barrier
  s_waitcnt lgkmcnt(0)
  s_mul_i32 s45, s45, 0x0019660d
  s_add_u32 s45, s45, 0x3c6ef35f
  s_lshl_b32 s3, s3, 7
  s_add_u32 s3, s3, 262144
  v_mov_b32 v112, 0
  v_mov_b32 v113, s45
  s_mov_b64 exec, 1
  s_waitcnt vmcnt(0)
  buffer_store_dword v113, v112, s[8:11], s3 offen sc1
  s_mov_b64 exec, -1
  s_branch LN_DONE
SKIP_LN:
  s_and_b32 s3, s2, 7
  s_lshr_b32 s4, s2, 3
  s_lshr_b32 s5, s3, 1
  s_mul_i32 s5, s5, 30
  s_add_u32 s5, s5, s4
  s_lshr_b32 s6, s5, 2
  s_min_u32 s6, s6, 29
  s_bfm_b32 s7, s6, 0
  s_and_b32 s7, s7, 0x3555eaab
  s_bcnt1_i32_b32 s7, s7
  s_sub_u32 s4, s6, s7
  s_add_u32 s4, s4, 18
  s_bitcmp1_b32 0x3555eaab, s6
  s_cselect_b32 s29, s7, s4
  s_and_b32 s5, s5, 3
  s_and_b32 s3, s3, 1
  s_lshl_b32 s3, s3, 2
  s_add_u32 s28, s3, s5
  s_lshl_b32 s33, s30, 10
  v_lshrrev_b32 v13, 3, v0
  v_and_b32 v14, 7, v0
  v_bfe_u32 v15, v0, 4, 1
  v_lshlrev_b32 v15, 2, v15
  v_xor_b32 v14, v14, v15
  s_lshl_b32 s3, s30, 3
  v_add_u32 v13, s3, v13
  v_mul_u32_u24 v3, 9216, v13
  v_lshl_add_u32 v3, v14, 4, v3
  s_lshr_b32 s3, s29, 2
  s_and_b32 s4, s29, 3
  s_mul_i32 s3, s3, 9
  s_add_u32 s3, s3, s4
  s_cmp_lt_u32 s4, 2
  s_cselect_b32 s4, 2, 5
  s_add_u32 s3, s3, s4
  s_lshl_b32 s36, s3, 7
  s_lshr_b32 s3, s29, 1
  s_mul_i32 s3, s3, 9
  s_and_b32 s34, s29, 1
  s_lshl_b32 s4, s34, 1
  s_sub_u32 s3, s3, s4
  s_add_u32 s3, s3, 6
  s_add_u32 s5, s29, 54
  s_cmp_lt_u32 s29, 16
  s_cselect_b32 s3, s3, s5
  s_lshl_b32 s35, s3, 7
  s_lshl_b32 s34, s34, 11
  s_mov_b32 s32, s34
  s_mov_b32 s42, s35
  s_lshl_b32 s7, s29, 1
  s_sub_u32 s7, s7, 36
  s_mul_i32 s3, s7, 86
  s_lshr_b32 s3, s3, 8
  s_mul_i32 s4, s3, 3
  s_sub_u32 s4, s7, s4
  s_cmp_lt_u32 s4, 2
  s_cselect_b32 s4, s4, 5
  s_mul_i32 s3, s3, 9
  s_add_u32 s3, s3, s4
  s_lshl_b32 s34, s3, 7
  s_add_u32 s7, s7, 1
  s_mul_i32 s3, s7, 86
  s_lshr_b32 s3, s3, 8
  s_mul_i32 s4, s3, 3
  s_sub_u32 s4, s7, s4
  s_cmp_lt_u32 s4, 2
  s_cselect_b32 s4, s4, 5
  s_mul_i32 s3, s3, 9
  s_add_u32 s3, s3, s4
  s_lshl_b32 s35, s3, 7
  s_cmp_lt_u32 s29, 18
  s_cselect_b32 s34, s32, s34
  s_cselect_b32 s35, s42, s35
  s_load_dword s45, s[8:9], 0
  v_bfe_u32 v15, v13, 1, 3
  v_and_b32 v14, 7, v0
  v_xor_b32 v14, v14, v15
  s_lshl_b32 s7, s29, 5
  v_add_u32 v13, s7, v13
  v_mul_u32_u24 v4, 1152, v13
  v_lshl_add_u32 v4, v14, 4, v4
  s_mov_b32 s3, 294912
  s_mov_b32 s4, 147456
  s_cmp_lt_u32 s29, 18
  s_cselect_b32 s46, 0, s3
  s_cselect_b32 s47, 128, s3
  s_cselect_b32 s48, 0, s34
  s_cselect_b32 s4, 18432, s4
  s_cselect_b32 s16, s16, s12
  s_cselect_b32 s17, s17, s13
  s_cselect_b32 s18, s18, s14
  s_cselect_b32 s20, s20, s12
  s_cselect_b32 s21, s21, s13
  s_cselect_b32 s22, s22, s14
  s_cselect_b64 vcc, -1, 0
  v_cndmask_b32 v4, v3, v4, vcc
  v_subrev_u32 v14, s4, v4
  s_add_u32 m0, s33, 0
  s_nop 0
  buffer_load_dwordx4 v4, s[16:19], s48 offen lds
  s_add_u32 m0, s33, -2048
  s_nop 0
  buffer_load_dwordx4 v14, s[16:19], s48 offen lds
  s_add_u32 s48, s48, s46
  s_add_u32 m0, s33, 4096
  s_nop 0
  buffer_load_dwordx4 v4, s[20:23], s48 offen lds
  s_add_u32 m0, s33, 2048
  s_nop 0
  buffer_load_dwordx4 v14, s[20:23], s48 offen lds
  s_add_u32 s48, s48, s47
  s_add_u32 m0, s33, 8192
  s_nop 0
  buffer_load_dwordx4 v4, s[16:19], s48 offen lds
  s_add_u32 m0, s33, 6144
  s_nop 0
  buffer_load_dwordx4 v14, s[16:19], s48 offen lds
  s_add_u32 s48, s48, s46
  s_add_u32 m0, s33, 12288
  s_nop 0
  buffer_load_dwordx4 v4, s[20:23], s48 offen lds
  s_add_u32 m0, s33, 10240
  s_nop 0
  buffer_load_dwordx4 v14, s[20:23], s48 offen lds
  s_add_u32 s48, s48, s47
  s_add_u32 m0, s33, 16384
  s_nop 0
  buffer_load_dwordx4 v4, s[16:19], s48 offen lds
  s_add_u32 m0, s33, 14336
  s_nop 0
  buffer_load_dwordx4 v14, s[16:19], s48 offen lds
  s_add_u32 s48, s48, s46
  s_add_u32 m0, s33, 20480
  s_nop 0
  buffer_load_dwordx4 v4, s[20:23], s48 offen lds
  s_add_u32 m0, s33, 18432
  s_nop 0
  buffer_load_dwordx4 v14, s[20:23], s48 offen lds
  s_add_u32 s48, s48, s47
  s_waitcnt lgkmcnt(0)
  s_mul_i32 s45, s45, 0x0019660d
  s_add_u32 s45, s45, 0x3c6ef35f
  s_barrier
  s_cmp_ge_u32 s2, 240
  s_cbranch_scc1 LIGHT
  s_add_u32 m0, s33, 24576
  s_nop 0
  buffer_load_dwordx4 v4, s[16:19], s48 offen lds
  s_add_u32 m0, s33, 22528
  s_nop 0
  buffer_load_dwordx4 v14, s[16:19], s48 offen lds
  s_add_u32 s48, s48, s46
  s_add_u32 m0, s33, 28672
  s_nop 0
  buffer_load_dwordx4 v4, s[20:23], s48 offen lds
  s_add_u32 m0, s33, 26624
  s_nop 0
  buffer_load_dwordx4 v14, s[20:23], s48 offen lds
  s_add_u32 s48, s48, s47
  s_add_u32 m0, s33, 32768
  s_nop 0
  buffer_load_dwordx4 v4, s[16:19], s48 offen lds
  s_add_u32 m0, s33, 30720
  s_nop 0
  buffer_load_dwordx4 v14, s[16:19], s48 offen lds
  s_add_u32 s48, s48, s46
  s_add_u32 m0, s33, 36864
  s_nop 0
  buffer_load_dwordx4 v4, s[20:23], s48 offen lds
  s_add_u32 m0, s33, 34816
  s_nop 0
  buffer_load_dwordx4 v14, s[20:23], s48 offen lds
  s_add_u32 s48, s48, s47
  s_add_u32 m0, s33, 40960
  s_nop 0
  buffer_load_dwordx4 v4, s[16:19], s48 offen lds
  s_add_u32 m0, s33, 38912
  s_nop 0
  buffer_load_dwordx4 v14, s[16:19], s48 offen lds
  s_add_u32 s48, s48, s46
  s_add_u32 m0, s33, 45056
  s_nop 0
  buffer_load_dwordx4 v4, s[20:23], s48 offen lds
  s_add_u32 m0, s33, 43008
  s_nop 0
  buffer_load_dwordx4 v14, s[20:23], s48 offen lds
  s_add_u32 s48, s48, s47
  s_add_u32 m0, s33, 49152
  s_nop 0
  buffer_load_dwordx4 v4, s[16:19], s48 offen lds
  s_add_u32 m0, s33, 47104
  s_nop 0
  buffer_load_dwordx4 v14, s[16:19], s48 offen lds
  s_add_u32 s48, s48, s46
  s_add_u32 m0, s33, 53248
  s_nop 0
  buffer_load_dwordx4 v4, s[20:23], s48 offen lds
  s_add_u32 m0, s33, 51200
  s_nop 0
  buffer_load_dwordx4 v14, s[20:23], s48 offen lds
  s_add_u32 s48, s48, s47
  s_add_u32 m0, s33, 57344
  s_nop 0
  buffer_load_dwordx4 v4, s[16:19], s48 offen lds
  s_add_u32 m0, s33, 55296
  s_nop 0
  buffer_load_dwordx4 v14, s[16:19], s48 offen lds
  s_add_u32 s48, s48, s46
  s_add_u32 m0, s33, 61440
  s_nop 0
  buffer_load_dwordx4 v4, s[20:23], s48 offen lds
  s_add_u32 m0, s33, 59392
  s_nop 0
  buffer_load_dwordx4 v14, s[20:23], s48 offen lds
  s_add_u32 s48, s48, s47
  s_add_u32 m0, s33, 65536
  s_nop 0
  buffer_load_dwordx4 v4, s[16:19], s48 offen lds
  s_add_u32 m0, s33, 63488
  s_nop 0
  buffer_load_dwordx4 v14, s[16:19], s48 offen lds
  s_add_u32 s48, s48, s46
  s_add_u32 m0, s33, 69632
  s_nop 0
  buffer_load_dwordx4 v4, s[20:23], s48 offen lds
  s_add_u32 m0, s33, 67584
  s_nop 0
  buffer_load_dwordx4 v14, s[20:23], s48 offen lds
  s_add_u32 s48, s48, s47
LN_DONE:
  s_cmp_ge_u32 s2, 240
  s_cbranch_scc1 LIGHT
  v_and_b32 v252, 15, v0
  v_lshlrev_b32 v252, 7, v252
  s_lshl_b32 s3, s28, 13
  s_lshl_b32 s4, s30, 11
  s_add_u32 s3, s3, s4
  s_add_u32 s52, s3, 262144
  s_add_u32 m0, s33, 73728
  s_add_u32 s32, s35, 0
  buffer_load_dwordx4 v3, s[12:15], s32 offen lds
  s_add_u32 m0, s33, 77824
  s_add_u32 s32, s35, 294912
  buffer_load_dwordx4 v3, s[12:15], s32 offen lds
  s_add_u32 m0, s33, 81920
  s_add_u32 s32, s35, 589824
  buffer_load_dwordx4 v3, s[12:15], s32 offen lds
  s_add_u32 m0, s33, 86016
  s_add_u32 s32, s35, 884736
  buffer_load_dwordx4 v3, s[12:15], s32 offen lds
  s_add_u32 m0, s33, 90112
  s_add_u32 s32, s35, 1179648
  buffer_load_dwordx4 v3, s[12:15], s32 offen lds
  s_add_u32 m0, s33, 94208
  s_add_u32 s32, s35, 1474560
  buffer_load_dwordx4 v3, s[12:15], s32 offen lds
  s_add_u32 m0, s33, 98304
  s_add_u32 s32, s35, 1769472
  buffer_load_dwordx4 v3, s[12:15], s32 offen lds
  s_add_u32 m0, s33, 102400
  s_add_u32 s32, s35, 2064384
  buffer_load_dwordx4 v3, s[12:15], s32 offen lds
  s_add_u32 m0, s33, 106496
  s_add_u32 s32, s35, 2359296
  buffer_load_dwordx4 v3, s[12:15], s32 offen lds
  s_add_u32 m0, s33, 110592
  s_add_u32 s32, s35, 2654208
  buffer_load_dwordx4 v3, s[12:15], s32 offen lds
  s_add_u32 m0, s33, 114688
  s_add_u32 s32, s35, 2949120
  buffer_load_dwordx4 v3, s[12:15], s32 offen lds
  s_add_u32 m0, s33, 118784
  s_add_u32 s32, s35, 3244032
  buffer_load_dwordx4 v3, s[12:15], s32 offen lds
  s_add_u32 m0, s33, 122880
  s_add_u32 s32, s35, 3538944
  buffer_load_dwordx4 v3, s[12:15], s32 offen lds
  s_add_u32 m0, s33, 126976
  s_add_u32 s32, s35, 3833856
  buffer_load_dwordx4 v3, s[12:15], s32 offen lds
  buffer_load_dword v250, v252, s[8:11], s52 offen sc1
  s_add_u32 m0, s33, 131072
  s_add_u32 s32, s35, 4128768
  buffer_load_dwordx4 v3, s[12:15], s32 offen lds
  s_add_u32 m0, s33, 135168
  s_add_u32 s32, s35, 4423680
  buffer_load_dwordx4 v3, s[12:15], s32 offen lds
  s_add_u32 m0, s33, 139264
  s_add_u32 s32, s35, 4718592
  buffer_load_dwordx4 v3, s[12:15], s32 offen lds
  s_add_u32 m0, s33, 143360
  s_add_u32 s32, s35, 5013504
  buffer_load_dwordx4 v3, s[12:15], s32 offen lds
  s_mov_b32 s40, 0xbfb8aa3b
  s_mul_i32 s31, s28, 294912
  s_add_u32 s31, s31, 1048576
  s_mul_i32 s37, s28, 2949120
  s_add_u32 s37, s37, 8388608
  s_mul_i32 s3, s30, 73728
  v_bfe_u32 v14, v0, 2, 3
  v_lshlrev_b32 v14, 7, v14
  v_lshrrev_b32 v15, 5, v0
  v_lshl_add_u32 v14, v15, 6, v14
  v_and_b32 v15, 3, v0
  v_lshl_add_u32 v14, v15, 4, v14
  v_add_u32 v1, s3, v14
  v_add_u32 v2, 36864, v1
  s_mul_i32 s3, s30, 737280
  v_lshl_add_u32 v11, v0, 4, s3
  v_add_u32 v12, 368640, v11
  v_lshrrev_b32 v14, 5, v0
  v_lshlrev_b32 v14, 10, v14
  v_bfe_u32 v15, v0, 2, 2
  v_lshl_add_u32 v14, v15, 7, v14
  v_bfe_u32 v15, v0, 4, 1
  v_lshl_add_u32 v14, v15, 5, v14
  v_and_b32 v15, 3, v0
  v_lshl_add_u32 v14, v15, 3, v14
  v_bfe_u32 v15, v0, 3, 1
  v_lshl_add_u32 v5, v15, 6, v14
  v_xor_b32 v6, 64, v5
  s_cmp_lt_u32 s29, 18
  s_cbranch_scc1 A_MIXED
  s_waitcnt vmcnt(4)
  v_cmp_ne_u32 vcc, s45, v250
  s_nop 1
  s_cmp_eq_u64 vcc, 0
  s_cbranch_scc0 POLL1
POLL1_OK:
  s_add_u32 s41, s31, 0
  buffer_load_dwordx4 a[0:3], v1, s[8:11], s41 offen offset:0 sc1
  buffer_load_dwordx4 a[8:11], v1, s[8:11], s41 offen offset:1024 sc1
  buffer_load_dwordx4 a[16:19], v1, s[8:11], s41 offen offset:2048 sc1
  buffer_load_dwordx4 a[24:27], v1, s[8:11], s41 offen offset:3072 sc1
  s_add_u32 s41, s31, 4096
  buffer_load_dwordx4 a[32:35], v1, s[8:11], s41 offen offset:0 sc1
  buffer_load_dwordx4 a[40:43], v1, s[8:11], s41 offen offset:1024 sc1
  buffer_load_dwordx4 a[48:51], v1, s[8:11], s41 offen offset:2048 sc1
  buffer_load_dwordx4 a[56:59], v1, s[8:11], s41 offen offset:3072 sc1
  s_add_u32 s41, s31, 8192
  buffer_load_dwordx4 a[64:67], v1, s[8:11], s41 offen offset:0 sc1
  buffer_load_dwordx4 a[72:75], v1, s[8:11], s41 offen offset:1024 sc1
  buffer_load_dwordx4 a[80:83], v1, s[8:11], s41 offen offset:2048 sc1
  buffer_load_dwordx4 a[88:91], v1, s[8:11], s41 offen offset:3072 sc1
  s_add_u32 s41, s31, 12288
  buffer_load_dwordx4 a[96:99], v1, s[8:11], s41 offen offset:0 sc1
  buffer_load_dwordx4 a[104:107], v1, s[8:11], s41 offen offset:1024 sc1
  buffer_load_dwordx4 a[112:115], v1, s[8:11], s41 offen offset:2048 sc1
  buffer_load_dwordx4 a[120:123], v1, s[8:11], s41 offen offset:3072 sc1
  s_waitcnt vmcnt(16)
  s_barrier
  ds_read_b64_tr_b16 v[176:177], v5 offset:0
  ds_read_b64_tr_b16 v[178:179], v5 offset:512
  ds_read_b64_tr_b16 v[180:181], v6 offset:0
  ds_read_b64_tr_b16 v[182:183], v6 offset:512
  ds_read_b64_tr_b16 v[184:185], v5 offset:2048
  ds_read_b64_tr_b16 v[186:187], v5 offset:2560
  ds_read_b64_tr_b16 v[188:189], v6 offset:2048
  ds_read_b64_tr_b16 v[190:191], v6 offset:2560
  ds_read_b64_tr_b16 v[192:193], v5 offset:4096
  ds_read_b64_tr_b16 v[194:195], v5 offset:4608
  ds_read_b64_tr_b16 v[196:197], v6 offset:4096
  ds_read_b64_tr_b16 v[198:199], v6 offset:4608
  s_waitcnt vmcnt(15)
  s_waitcnt lgkmcnt(8)
  v_mfma_f32_32x32x16_bf16 v[48:63], v[176:179], a[0:3], 0
  ds_read_b64_tr_b16 v[176:177], v5 offset:6144
  ds_read_b64_tr_b16 v[178:179], v5 offset:6656
  s_add_u32 s41, s31, 16384
  buffer_load_dwordx4 a[128:131], v1, s[8:11], s41 offen offset:0 sc1
  s_load_dwordx2 s[96:97], s[0:1], 88
  v_mfma_f32_32x32x16_bf16 v[80:95], v[180:183], a[0:3], 0
  ds_read_b64_tr_b16 v[180:181], v6 offset:6144
  ds_read_b64_tr_b16 v[182:183], v6 offset:6656
  s_and_b32 s3, s2, 7
  s_lshr_b32 s4, s2, 3
  s_waitcnt vmcnt(15)
  s_waitcnt lgkmcnt(8)
  v_mfma_f32_32x32x16_bf16 v[48:63], v[184:187], a[8:11], v[48:63]
  ds_read_b64_tr_b16 v[184:185], v5 offset:8192
  ds_read_b64_tr_b16 v[186:187], v5 offset:8704
  buffer_load_dwordx4 a[136:139], v1, s[8:11], s41 offen offset:1024 sc1
  s_mul_i32 s5, s4, 43
  s_lshr_b32 s5, s5, 8
  v_mfma_f32_32x32x16_bf16 v[80:95], v[188:191], a[8:11], v[80:95]
  ds_read_b64_tr_b16 v[188:189], v6 offset:8192
  ds_read_b64_tr_b16 v[190:191], v6 offset:8704
  s_mul_i32 s6, s5, 6
  s_sub_u32 s47, s4, s6
  s_waitcnt vmcnt(15)
  s_waitcnt lgkmcnt(8)
  v_mfma_f32_32x32x16_bf16 v[48:63], v[192:195], a[16:19], v[48:63]
  ds_read_b64_tr_b16 v[192:193], v5 offset:10240
  ds_read_b64_tr_b16 v[194:195], v5 offset:10752
  buffer_load_dwordx4 a[144:147], v1, s[8:11], s41 offen offset:2048 sc1
  s_lshr_b32 s48, s3, 1
  s_and_b32 s6, s3, 1
  v_mfma_f32_32x32x16_bf16 v[80:95], v[196:199], a[16:19], v[80:95]
  ds_read_b64_tr_b16 v[196:197], v6 offset:10240
  ds_read_b64_tr_b16 v[198:199], v6 offset:10752
  s_lshl_b32 s6, s6, 2
  s_add_u32 s46, s6, s5
  s_waitcnt vmcnt(15)
  s_waitcnt lgkmcnt(8)
  v_mfma_f32_32x32x16_bf16 v[48:63], v[176:179], a[24:27], v[48:63]
  ds_read_b64_tr_b16 v[176:177], v5 offset:12288
  ds_read_b64_tr_b16 v[178:179], v5 offset:12800
  buffer_load_dwordx4 a[152:155], v1, s[8:11], s41 offen offset:3072 sc1
  v_mfma_f32_32x32x16_bf16 v[80:95], v[180:183], a[24:27], v[80:95]
  ds_read_b64_tr_b16 v[180:181], v6 offset:12288
  ds_read_b64_tr_b16 v[182:183], v6 offset:12800
  s_waitcnt vmcnt(15)
  s_waitcnt lgkmcnt(8)
  v_mfma_f32_32x32x16_bf16 v[48:63], v[184:187], a[32:35], v[48:63]
  ds_read_b64_tr_b16 v[184:185], v5 offset:14336
  ds_read_b64_tr_b16 v[186:187], v5 offset:14848
  s_add_u32 s41, s31, 20480
  buffer_load_dwordx4 a[160:163], v1, s[8:11], s41 offen offset:0 sc1
  v_mfma_f32_32x32x16_bf16 v[80:95], v[188:191], a[32:35], v[80:95]
  ds_read_b64_tr_b16 v[188:189], v6 offset:14336
  ds_read_b64_tr_b16 v[190:191], v6 offset:14848
  s_waitcnt vmcnt(15)
  s_waitcnt lgkmcnt(8)
  v_mfma_f32_32x32x16_bf16 v[48:63], v[192:195], a[40:43], v[48:63]
  ds_read_b64_tr_b16 v[192:193], v5 offset:16384
  ds_read_b64_tr_b16 v[194:195], v5 offset:16896
  buffer_load_dwordx4 a[168:171], v1, s[8:11], s41 offen offset:1024 sc1
  v_mfma_f32_32x32x16_bf16 v[80:95], v[196:199], a[40:43], v[80:95]
  ds_read_b64_tr_b16 v[196:197], v6 offset:16384
  ds_read_b64_tr_b16 v[198:199], v6 offset:16896
  s_waitcnt vmcnt(15)
  s_waitcnt lgkmcnt(8)
  v_mfma_f32_32x32x16_bf16 v[48:63], v[176:179], a[48:51], v[48:63]
  ds_read_b64_tr_b16 v[176:177], v5 offset:18432
  ds_read_b64_tr_b16 v[178:179], v5 offset:18944
  buffer_load_dwordx4 a[176:179], v1, s[8:11], s41 offen offset:2048 sc1
  v_mfma_f32_32x32x16_bf16 v[80:95], v[180:183], a[48:51], v[80:95]
  ds_read_b64_tr_b16 v[180:181], v6 offset:18432
  ds_read_b64_tr_b16 v[182:183], v6 offset:18944
  s_waitcnt vmcnt(15)
  s_waitcnt lgkmcnt(8)
  v_mfma_f32_32x32x16_bf16 v[48:63], v[184:187], a[56:59], v[48:63]
  ds_read_b64_tr_b16 v[184:185], v5 offset:20480
  ds_read_b64_tr_b16 v[186:187], v5 offset:20992
  buffer_load_dwordx4 a[184:187], v1, s[8:11], s41 offen offset:3072 sc1
  v_mfma_f32_32x32x16_bf16 v[80:95], v[188:191], a[56:59], v[80:95]
  ds_read_b64_tr_b16 v[188:189], v6 offset:20480
  ds_read_b64_tr_b16 v[190:191], v6 offset:20992
  s_waitcnt vmcnt(15)
  s_waitcnt lgkmcnt(8)
  v_mfma_f32_32x32x16_bf16 v[48:63], v[192:195], a[64:67], v[48:63]
  ds_read_b64_tr_b16 v[192:193], v5 offset:22528
  ds_read_b64_tr_b16 v[194:195], v5 offset:23040
  s_add_u32 s41, s31, 24576
  buffer_load_dwordx4 a[192:195], v1, s[8:11], s41 offen offset:0 sc1
  v_mfma_f32_32x32x16_bf16 v[80:95], v[196:199], a[64:67], v[80:95]
  ds_read_b64_tr_b16 v[196:197], v6 offset:22528
  ds_read_b64_tr_b16 v[198:199], v6 offset:23040
  s_waitcnt vmcnt(15)
  s_waitcnt lgkmcnt(8)
  v_mfma_f32_32x32x16_bf16 v[48:63], v[176:179], a[72:75], v[48:63]
  ds_read_b64_tr_b16 v[176:177], v5 offset:24576
  ds_read_b64_tr_b16 v[178:179], v5 offset:25088
  buffer_load_dwordx4 a[200:203], v1, s[8:11], s41 offen offset:1024 sc1
  v_mfma_f32_32x32x16_bf16 v[80:95], v[180:183], a[72:75], v[80:95]
  ds_read_b64_tr_b16 v[180:181], v6 offset:24576
  ds_read_b64_tr_b16 v[182:183], v6 offset:25088
  s_waitcnt vmcnt(15)
  s_waitcnt lgkmcnt(8)
  v_mfma_f32_32x32x16_bf16 v[48:63], v[184:187], a[80:83], v[48:63]
  ds_read_b64_tr_b16 v[184:185], v5 offset:26624
  ds_read_b64_tr_b16 v[186:187], v5 offset:27136
  buffer_load_dwordx4 a[208:211], v1, s[8:11], s41 offen offset:2048 sc1
  v_mfma_f32_32x32x16_bf16 v[80:95], v[188:191], a[80:83], v[80:95]
  ds_read_b64_tr_b16 v[188:189], v6 offset:26624
  ds_read_b64_tr_b16 v[190:191], v6 offset:27136
  s_waitcnt vmcnt(15)
  s_waitcnt lgkmcnt(8)
  v_mfma_f32_32x32x16_bf16 v[48:63], v[192:195], a[88:91], v[48:63]
  ds_read_b64_tr_b16 v[192:193], v5 offset:28672
  ds_read_b64_tr_b16 v[194:195], v5 offset:29184
  buffer_load_dwordx4 a[216:219], v1, s[8:11], s41 offen offset:3072 sc1
  v_mfma_f32_32x32x16_bf16 v[80:95], v[196:199], a[88:91], v[80:95]
  ds_read_b64_tr_b16 v[196:197], v6 offset:28672
  ds_read_b64_tr_b16 v[198:199], v6 offset:29184
  s_waitcnt vmcnt(15)
  s_waitcnt lgkmcnt(8)
  v_mfma_f32_32x32x16_bf16 v[48:63], v[176:179], a[96:99], v[48:63]
  ds_read_b64_tr_b16 v[176:177], v5 offset:30720
  ds_read_b64_tr_b16 v[178:179], v5 offset:31232
  s_add_u32 s41, s31, 28672
  buffer_load_dwordx4 a[224:227], v1, s[8:11], s41 offen offset:0 sc1
  v_mfma_f32_32x32x16_bf16 v[80:95], v[180:183], a[96:99], v[80:95]
  ds_read_b64_tr_b16 v[180:181], v6 offset:30720
  ds_read_b64_tr_b16 v[182:183], v6 offset:31232
  s_waitcnt vmcnt(15)
  s_waitcnt lgkmcnt(8)
  v_mfma_f32_32x32x16_bf16 v[48:63], v[184:187], a[104:107], v[48:63]
  ds_read_b64_tr_b16 v[184:185], v5 offset:32768
  ds_read_b64_tr_b16 v[186:187], v5 offset:33280
  buffer_load_dwordx4 a[232:235], v1, s[8:11], s41 offen offset:1024 sc1
  v_mfma_f32_32x32x16_bf16 v[80:95], v[188:191], a[104:107], v[80:95]
  ds_read_b64_tr_b16 v[188:189], v6 offset:32768
  ds_read_b64_tr_b16 v[190:191], v6 offset:33280
  s_waitcnt vmcnt(15)
  s_waitcnt lgkmcnt(8)
  v_mfma_f32_32x32x16_bf16 v[48:63], v[192:195], a[112:115], v[48:63]
  ds_read_b64_tr_b16 v[192:193], v5 offset:34816
  ds_read_b64_tr_b16 v[194:195], v5 offset:35328
  buffer_load_dwordx4 a[240:243], v1, s[8:11], s41 offen offset:2048 sc1
  v_mfma_f32_32x32x16_bf16 v[80:95], v[196:199], a[112:115], v[80:95]
  ds_read_b64_tr_b16 v[196:197], v6 offset:34816
  ds_read_b64_tr_b16 v[198:199], v6 offset:35328
  s_waitcnt vmcnt(15)
  s_waitcnt lgkmcnt(8)
  v_mfma_f32_32x32x16_bf16 v[48:63], v[176:179], a[120:123], v[48:63]
  v_add_u32 v5, 0x9000, v5
  ds_read_b64_tr_b16 v[176:177], v5 offset:0
  ds_read_b64_tr_b16 v[178:179], v5 offset:512
  buffer_load_dwordx4 a[248:251], v1, s[8:11], s41 offen offset:3072 sc1
  v_mfma_f32_32x32x16_bf16 v[80:95], v[180:183], a[120:123], v[80:95]
  v_add_u32 v6, 0x9000, v6
  ds_read_b64_tr_b16 v[180:181], v6 offset:0
  ds_read_b64_tr_b16 v[182:183], v6 offset:512
  s_waitcnt vmcnt(15)
  s_waitcnt lgkmcnt(8)
  v_mfma_f32_32x32x16_bf16 v[48:63], v[184:187], a[128:131], v[48:63]
  ds_read_b64_tr_b16 v[184:185], v5 offset:2048
  ds_read_b64_tr_b16 v[186:187], v5 offset:2560
  s_add_u32 s41, s31, 32768
  buffer_load_dwordx4 v[16:19], v1, s[8:11], s41 offen offset:0 sc1
  v_mfma_f32_32x32x16_bf16 v[80:95], v[188:191], a[128:131], v[80:95]
  ds_read_b64_tr_b16 v[188:189], v6 offset:2048
  ds_read_b64_tr_b16 v[190:191], v6 offset:2560
  s_waitcnt vmcnt(15)
  s_waitcnt lgkmcnt(8)
  v_mfma_f32_32x32x16_bf16 v[48:63], v[192:195], a[136:139], v[48:63]
  ds_read_b64_tr_b16 v[192:193], v5 offset:4096
  ds_read_b64_tr_b16 v[194:195], v5 offset:4608
  buffer_load_dwordx4 v[24:27], v1, s[8:11], s41 offen offset:1024 sc1
  v_mfma_f32_32x32x16_bf16 v[80:95], v[196:199], a[136:139], v[80:95]
  ds_read_b64_tr_b16 v[196:197], v6 offset:4096
  ds_read_b64_tr_b16 v[198:199], v6 offset:4608
  s_waitcnt vmcnt(15)
  s_waitcnt lgkmcnt(8)
  v_mfma_f32_32x32x16_bf16 v[48:63], v[176:179], a[144:147], v[48:63]
  ds_read_b64_tr_b16 v[176:177], v5 offset:6144
  ds_read_b64_tr_b16 v[178:179], v5 offset:6656
  buffer_load_dwordx4 v[32:35], v1, s[8:11], s41 offen offset:2048 sc1
  v_mfma_f32_32x32x16_bf16 v[80:95], v[180:183], a[144:147], v[80:95]
  ds_read_b64_tr_b16 v[180:181], v6 offset:6144
  ds_read_b64_tr_b16 v[182:183], v6 offset:6656
  s_waitcnt vmcnt(15)
  s_waitcnt lgkmcnt(8)
  v_mfma_f32_32x32x16_bf16 v[48:63], v[184:187], a[152:155], v[48:63]
  ds_read_b64_tr_b16 v[184:185], v5 offset:8192
  ds_read_b64_tr_b16 v[186:187], v5 offset:8704
  buffer_load_dwordx4 v[40:43], v1, s[8:11], s41 offen offset:3072 sc1
  v_mfma_f32_32x32x16_bf16 v[80:95], v[188:191], a[152:155], v[80:95]
  ds_read_b64_tr_b16 v[188:189], v6 offset:8192
  ds_read_b64_tr_b16 v[190:191], v6 offset:8704
  s_waitcnt vmcnt(15)
  s_waitcnt lgkmcnt(8)
  v_mfma_f32_32x32x16_bf16 v[48:63], v[192:195], a[160:163], v[48:63]
  ds_read_b64_tr_b16 v[192:193], v5 offset:10240
  ds_read_b64_tr_b16 v[194:195], v5 offset:10752
  s_add_u32 s41, s31, 0
  buffer_load_dwordx4 a[4:7], v2, s[8:11], s41 offen offset:0 sc1
  v_mfma_f32_32x32x16_bf16 v[80:95], v[196:199], a[160:163], v[80:95]
  ds_read_b64_tr_b16 v[196:197], v6 offset:10240
  ds_read_b64_tr_b16 v[198:199], v6 offset:10752
  s_waitcnt vmcnt(15)
  s_waitcnt lgkmcnt(8)
  v_mfma_f32_32x32x16_bf16 v[48:63], v[176:179], a[168:171], v[48:63]
  ds_read_b64_tr_b16 v[176:177], v5 offset:12288
  ds_read_b64_tr_b16 v[178:179], v5 offset:12800
  buffer_load_dwordx4 a[12:15], v2, s[8:11], s41 offen offset:1024 sc1
  v_mfma_f32_32x32x16_bf16 v[80:95], v[180:183], a[168:171], v[80:95]
  ds_read_b64_tr_b16 v[180:181], v6 offset:12288
  ds_read_b64_tr_b16 v[182:183], v6 offset:12800
  s_waitcnt vmcnt(15)
  s_waitcnt lgkmcnt(8)
  v_mfma_f32_32x32x16_bf16 v[48:63], v[184:187], a[176:179], v[48:63]
  ds_read_b64_tr_b16 v[184:185], v5 offset:14336
  ds_read_b64_tr_b16 v[186:187], v5 offset:14848
  buffer_load_dwordx4 a[20:23], v2, s[8:11], s41 offen offset:2048 sc1
  v_mfma_f32_32x32x16_bf16 v[80:95], v[188:191], a[176:179], v[80:95]
  ds_read_b64_tr_b16 v[188:189], v6 offset:14336
  ds_read_b64_tr_b16 v[190:191], v6 offset:14848
  s_waitcnt vmcnt(15)
  s_waitcnt lgkmcnt(8)
  v_mfma_f32_32x32x16_bf16 v[48:63], v[192:195], a[184:187], v[48:63]
  ds_read_b64_tr_b16 v[192:193], v5 offset:16384
  ds_read_b64_tr_b16 v[194:195], v5 offset:16896
  buffer_load_dwordx4 a[28:31], v2, s[8:11], s41 offen offset:3072 sc1
  v_mfma_f32_32x32x16_bf16 v[80:95], v[196:199], a[184:187], v[80:95]
  ds_read_b64_tr_b16 v[196:197], v6 offset:16384
  ds_read_b64_tr_b16 v[198:199], v6 offset:16896
  s_waitcnt vmcnt(15)
  s_waitcnt lgkmcnt(8)
  v_mfma_f32_32x32x16_bf16 v[48:63], v[176:179], a[192:195], v[48:63]
  ds_read_b64_tr_b16 v[176:177], v5 offset:18432
  ds_read_b64_tr_b16 v[178:179], v5 offset:18944
  s_add_u32 s41, s31, 4096
  buffer_load_dwordx4 a[36:39], v2, s[8:11], s41 offen offset:0 sc1
  v_mfma_f32_32x32x16_bf16 v[80:95], v[180:183], a[192:195], v[80:95]
  ds_read_b64_tr_b16 v[180:181], v6 offset:18432
  ds_read_b64_tr_b16 v[182:183], v6 offset:18944
  s_waitcnt vmcnt(15)
  s_waitcnt lgkmcnt(8)
  v_mfma_f32_32x32x16_bf16 v[48:63], v[184:187], a[200:203], v[48:63]
  ds_read_b64_tr_b16 v[184:185], v5 offset:20480
  ds_read_b64_tr_b16 v[186:187], v5 offset:20992
  buffer_load_dwordx4 a[44:47], v2, s[8:11], s41 offen offset:1024 sc1
  v_mfma_f32_32x32x16_bf16 v[80:95], v[188:191], a[200:203], v[80:95]
  ds_read_b64_tr_b16 v[188:189], v6 offset:20480
  ds_read_b64_tr_b16 v[190:191], v6 offset:20992
  s_waitcnt vmcnt(15)
  s_waitcnt lgkmcnt(8)
  v_mfma_f32_32x32x16_bf16 v[48:63], v[192:195], a[208:211], v[48:63]
  ds_read_b64_tr_b16 v[192:193], v5 offset:22528
  ds_read_b64_tr_b16 v[194:195], v5 offset:23040
  buffer_load_dwordx4 a[52:55], v2, s[8:11], s41 offen offset:2048 sc1
  v_mfma_f32_32x32x16_bf16 v[80:95], v[196:199], a[208:211], v[80:95]
  ds_read_b64_tr_b16 v[196:197], v6 offset:22528
  ds_read_b64_tr_b16 v[198:199], v6 offset:23040
  s_waitcnt vmcnt(15)
  s_waitcnt lgkmcnt(8)
  v_mfma_f32_32x32x16_bf16 v[48:63], v[176:179], a[216:219], v[48:63]
  ds_read_b64_tr_b16 v[176:177], v5 offset:24576
  ds_read_b64_tr_b16 v[178:179], v5 offset:25088
  buffer_load_dwordx4 a[60:63], v2, s[8:11], s41 offen offset:3072 sc1
  v_mfma_f32_32x32x16_bf16 v[80:95], v[180:183], a[216:219], v[80:95]
  ds_read_b64_tr_b16 v[180:181], v6 offset:24576
  ds_read_b64_tr_b16 v[182:183], v6 offset:25088
  s_waitcnt vmcnt(15)
  s_waitcnt lgkmcnt(8)
  v_mfma_f32_32x32x16_bf16 v[48:63], v[184:187], a[224:227], v[48:63]
  ds_read_b64_tr_b16 v[184:185], v5 offset:26624
  ds_read_b64_tr_b16 v[186:187], v5 offset:27136
  s_add_u32 s41, s31, 8192
  buffer_load_dwordx4 a[68:71], v2, s[8:11], s41 offen offset:0 sc1
  v_mfma_f32_32x32x16_bf16 v[80:95], v[188:191], a[224:227], v[80:95]
  ds_read_b64_tr_b16 v[188:189], v6 offset:26624
  ds_read_b64_tr_b16 v[190:191], v6 offset:27136
  s_waitcnt vmcnt(15)
  s_waitcnt lgkmcnt(8)
  v_mfma_f32_32x32x16_bf16 v[48:63], v[192:195], a[232:235], v[48:63]
  ds_read_b64_tr_b16 v[192:193], v5 offset:28672
  ds_read_b64_tr_b16 v[194:195], v5 offset:29184
  buffer_load_dwordx4 a[76:79], v2, s[8:11], s41 offen offset:1024 sc1
  v_mfma_f32_32x32x16_bf16 v[80:95], v[196:199], a[232:235], v[80:95]
  ds_read_b64_tr_b16 v[196:197], v6 offset:28672
  ds_read_b64_tr_b16 v[198:199], v6 offset:29184
  s_waitcnt vmcnt(15)
  s_waitcnt lgkmcnt(8)
  v_mfma_f32_32x32x16_bf16 v[48:63], v[176:179], a[240:243], v[48:63]
  ds_read_b64_tr_b16 v[176:177], v5 offset:30720
  ds_read_b64_tr_b16 v[178:179], v5 offset:31232
  buffer_load_dwordx4 a[84:87], v2, s[8:11], s41 offen offset:2048 sc1
  v_mfma_f32_32x32x16_bf16 v[80:95], v[180:183], a[240:243], v[80:95]
  ds_read_b64_tr_b16 v[180:181], v6 offset:30720
  ds_read_b64_tr_b16 v[182:183], v6 offset:31232
  s_waitcnt vmcnt(15)
  s_waitcnt lgkmcnt(8)
  v_mfma_f32_32x32x16_bf16 v[48:63], v[184:187], a[248:251], v[48:63]
  ds_read_b64_tr_b16 v[184:185], v5 offset:32768
  ds_read_b64_tr_b16 v[186:187], v5 offset:33280
  buffer_load_dwordx4 a[92:95], v2, s[8:11], s41 offen offset:3072 sc1
  v_mfma_f32_32x32x16_bf16 v[80:95], v[188:191], a[248:251], v[80:95]
  ds_read_b64_tr_b16 v[188:189], v6 offset:32768
  ds_read_b64_tr_b16 v[190:191], v6 offset:33280
  s_waitcnt vmcnt(15)
  s_waitcnt lgkmcnt(8)
  v_mfma_f32_32x32x16_bf16 v[48:63], v[192:195], v[16:19], v[48:63]
  ds_read_b64_tr_b16 v[192:193], v5 offset:34816
  ds_read_b64_tr_b16 v[194:195], v5 offset:35328
  s_add_u32 s41, s31, 12288
  buffer_load_dwordx4 a[100:103], v2, s[8:11], s41 offen offset:0 sc1
  v_mfma_f32_32x32x16_bf16 v[80:95], v[196:199], v[16:19], v[80:95]
  ds_read_b64_tr_b16 v[196:197], v6 offset:34816
  ds_read_b64_tr_b16 v[198:199], v6 offset:35328
  s_waitcnt vmcnt(15)
  s_waitcnt lgkmcnt(8)
  v_mfma_f32_32x32x16_bf16 v[48:63], v[176:179], v[24:27], v[48:63]
  v_add_u32 v5, 0xffff7000, v5
  ds_read_b64_tr_b16 v[176:177], v5 offset:0
  ds_read_b64_tr_b16 v[178:179], v5 offset:512
  buffer_load_dwordx4 a[108:111], v2, s[8:11], s41 offen offset:1024 sc1
  v_mfma_f32_32x32x16_bf16 v[80:95], v[180:183], v[24:27], v[80:95]
  v_add_u32 v6, 0xffff7000, v6
  ds_read_b64_tr_b16 v[180:181], v6 offset:0
  ds_read_b64_tr_b16 v[182:183], v6 offset:512
  s_waitcnt vmcnt(15)
  s_waitcnt lgkmcnt(8)
  v_mfma_f32_32x32x16_bf16 v[48:63], v[184:187], v[32:35], v[48:63]
  ds_read_b64_tr_b16 v[184:185], v5 offset:2048
  ds_read_b64_tr_b16 v[186:187], v5 offset:2560
  buffer_load_dwordx4 a[116:119], v2, s[8:11], s41 offen offset:2048 sc1
  v_mfma_f32_32x32x16_bf16 v[80:95], v[188:191], v[32:35], v[80:95]
  ds_read_b64_tr_b16 v[188:189], v6 offset:2048
  ds_read_b64_tr_b16 v[190:191], v6 offset:2560
  s_waitcnt vmcnt(15)
  s_waitcnt lgkmcnt(8)
  v_mfma_f32_32x32x16_bf16 v[48:63], v[192:195], v[40:43], v[48:63]
  ds_read_b64_tr_b16 v[192:193], v5 offset:4096
  ds_read_b64_tr_b16 v[194:195], v5 offset:4608
  buffer_load_dwordx4 a[124:127], v2, s[8:11], s41 offen offset:3072 sc1
  v_mfma_f32_32x32x16_bf16 v[80:95], v[196:199], v[40:43], v[80:95]
  ds_read_b64_tr_b16 v[196:197], v6 offset:4096
  ds_read_b64_tr_b16 v[198:199], v6 offset:4608
  s_cmp_eq_u32 s5, 4
  s_cselect_b32 s48, 4, s48
  s_cselect_b32 s46, s3, s46
  s_mul_i32 s51, s30, 18432
  s_mul_i32 s3, s48, 1152
  s_mul_i32 s4, s30, 288
  s_add_u32 s3, s3, s4
  s_mul_i32 s3, s3, 1152
  s_mul_i32 s4, s47, 192
  s_add_u32 s3, s3, s4
  s_lshl_b32 s4, s47, 2
  s_add_u32 s4, s4, s30
  s_mul_i32 s4, s4, 55296
  s_add_u32 s4, s4, 4194304
  v_add_u32 v13, 0, v0
  v_mul_u32_u24 v14, 0x1556, v13
  v_lshrrev_b32 v14, 16, v14
  v_mul_u32_u24 v15, 960, v14
  v_lshl_add_u32 v253, v0, 4, v15
  v_add_u32 v13, 64, v0
  v_mul_u32_u24 v14, 0x1556, v13
  v_lshrrev_b32 v14, 16, v14
  v_mul_u32_u24 v15, 960, v14
  v_lshl_add_u32 v254, v0, 4, v15
  v_add_u32 v13, 128, v0
  v_mul_u32_u24 v14, 0x1556, v13
  v_lshrrev_b32 v14, 16, v14
  v_mul_u32_u24 v15, 960, v14
  v_lshl_add_u32 v255, v0, 4, v15
  v_lshrrev_b32 v14, 5, v0
  v_lshlrev_b32 v14, 2, v14
  v_bfe_u32 v15, v0, 2, 2
  v_add_u32 v14, v14, v15
  v_mul_u32_u24 v14, 192, v14
  v_bfe_u32 v15, v0, 4, 1
  v_lshl_add_u32 v14, v15, 5, v14
  v_and_b32 v15, 3, v0
  v_lshl_add_u32 v251, v15, 3, v14
  s_mov_b32 s50, 18432
  s_mov_b32 s26, 5308416
  s_mov_b32 s27, 0x00020000
  s_waitcnt lgkmcnt(0)
  s_cmp_eq_u32 s48, 4
  s_cselect_b32 s49, s4, s3
  s_cselect_b32 s50, 3072, s50
  s_cselect_b32 s24, s8, s96
  s_cselect_b32 s25, s9, s97
  s_cselect_b32 s26, s10, s26
  s_cselect_b64 vcc, -1, 0
  s_and_b32 s25, s25, 0xffff
  v_lshlrev_b32 v13, 4, v0
  v_cndmask_b32 v253, v253, v13, vcc
  v_cndmask_b32 v254, v254, v13, vcc
  v_cndmask_b32 v255, v255, v13, vcc
  v_cndmask_b32 v251, v251, v13, vcc
  s_add_u32 s3, s51, 73728
  v_add_u32 v251, s3, v251
  s_mov_b32 s16, s96
  s_and_b32 s17, s97, 0xffff
  s_mov_b32 s18, 0x510000
  s_mov_b32 s19, 0x00020000
  s_lshl_b32 s3, s28, 12
  s_lshl_b32 s4, s29, 7
  s_add_u32 s53, s3, s4
  v_or_b32 v252, s30, v0
  v_min_u32 v252, 1, v252
  v_lshlrev_b32 v252, 30, v252
  v_mov_b32 v250, s45
  s_waitcnt vmcnt(15)
  v_mfma_f32_32x32x16_bf16 v[64:79], v[176:179], a[4:7], 0
  ds_read_b64_tr_b16 v[176:177], v5 offset:6144
  ds_read_b64_tr_b16 v[178:179], v5 offset:6656
  s_add_u32 s41, s31, 16384
  buffer_load_dwordx4 a[132:135], v2, s[8:11], s41 offen offset:0 sc1
  v_mfma_f32_32x32x16_bf16 v[96:111], v[180:183], a[4:7], 0
  ds_read_b64_tr_b16 v[180:181], v6 offset:6144
  ds_read_b64_tr_b16 v[182:183], v6 offset:6656
  s_waitcnt vmcnt(15)
  v_mfma_f32_32x32x16_bf16 v[64:79], v[184:187], a[12:15], v[64:79]
  ds_read_b64_tr_b16 v[184:185], v5 offset:8192
  ds_read_b64_tr_b16 v[186:187], v5 offset:8704
  buffer_load_dwordx4 a[140:143], v2, s[8:11], s41 offen offset:1024 sc1
  s_lshl_b32 s38, s34, 5
  s_add_u32 s38, s38, s37
  v_mfma_f32_32x32x16_bf16 v[96:111], v[188:191], a[12:15], v[96:111]
  ds_read_b64_tr_b16 v[188:189], v6 offset:8192
  ds_read_b64_tr_b16 v[190:191], v6 offset:8704
  v_mul_f32 v200, s40, v48
  v_mul_f32 v201, s40, v49
  s_waitcnt vmcnt(15)
  v_mfma_f32_32x32x16_bf16 v[64:79], v[192:195], a[20:23], v[64:79]
  ds_read_b64_tr_b16 v[192:193], v5 offset:10240
  ds_read_b64_tr_b16 v[194:195], v5 offset:10752
  buffer_load_dwordx4 a[148:151], v2, s[8:11], s41 offen offset:2048 sc1
  v_exp_f32 v200, v200
  v_mfma_f32_32x32x16_bf16 v[96:111], v[196:199], a[20:23], v[96:111]
  ds_read_b64_tr_b16 v[196:197], v6 offset:10240
  ds_read_b64_tr_b16 v[198:199], v6 offset:10752
  v_mul_f32 v202, s40, v50
  s_waitcnt vmcnt(15)
  s_waitcnt lgkmcnt(8)
  v_mfma_f32_32x32x16_bf16 v[64:79], v[176:179], a[28:31], v[64:79]
  ds_read_b64_tr_b16 v[176:177], v5 offset:12288
  ds_read_b64_tr_b16 v[178:179], v5 offset:12800
  buffer_load_dwordx4 a[156:159], v2, s[8:11], s41 offen offset:3072 sc1
  v_exp_f32 v201, v201
  v_mfma_f32_32x32x16_bf16 v[96:111], v[180:183], a[28:31], v[96:111]
  ds_read_b64_tr_b16 v[180:181], v6 offset:12288
  ds_read_b64_tr_b16 v[182:183], v6 offset:12800
  v_add_f32 v200, 1.0, v200
  v_mul_f32 v203, s40, v51
  s_waitcnt vmcnt(15)
  s_waitcnt lgkmcnt(8)
  v_mfma_f32_32x32x16_bf16 v[64:79], v[184:187], a[36:39], v[64:79]
  ds_read_b64_tr_b16 v[184:185], v5 offset:14336
  ds_read_b64_tr_b16 v[186:187], v5 offset:14848
  s_add_u32 s41, s31, 20480
  buffer_load_dwordx4 a[164:167], v2, s[8:11], s41 offen offset:0 sc1
  v_mfma_f32_32x32x16_bf16 v[96:111], v[188:191], a[36:39], v[96:111]
  ds_read_b64_tr_b16 v[188:189], v6 offset:14336
  ds_read_b64_tr_b16 v[190:191], v6 offset:14848
  v_exp_f32 v202, v202
  s_waitcnt vmcnt(15)
  s_waitcnt lgkmcnt(8)
  v_mfma_f32_32x32x16_bf16 v[64:79], v[192:195], a[44:47], v[64:79]
  ds_read_b64_tr_b16 v[192:193], v5 offset:16384
  ds_read_b64_tr_b16 v[194:195], v5 offset:16896
  buffer_load_dwordx4 a[172:175], v2, s[8:11], s41 offen offset:1024 sc1
  v_add_f32 v201, 1.0, v201
  v_mfma_f32_32x32x16_bf16 v[96:111], v[196:199], a[44:47], v[96:111]
  ds_read_b64_tr_b16 v[196:197], v6 offset:16384
  ds_read_b64_tr_b16 v[198:199], v6 offset:16896
  v_rcp_f32 v200, v200
  s_waitcnt vmcnt(15)
  s_waitcnt lgkmcnt(8)
  v_mfma_f32_32x32x16_bf16 v[64:79], v[176:179], a[52:55], v[64:79]
  ds_read_b64_tr_b16 v[176:177], v5 offset:18432
  ds_read_b64_tr_b16 v[178:179], v5 offset:18944
  buffer_load_dwordx4 a[180:183], v2, s[8:11], s41 offen offset:2048 sc1
  v_mul_f32 v204, s40, v52
  v_mfma_f32_32x32x16_bf16 v[96:111], v[180:183], a[52:55], v[96:111]
  ds_read_b64_tr_b16 v[180:181], v6 offset:18432
  ds_read_b64_tr_b16 v[182:183], v6 offset:18944
  v_exp_f32 v203, v203
  s_waitcnt vmcnt(15)
  s_waitcnt lgkmcnt(8)
  v_mfma_f32_32x32x16_bf16 v[64:79], v[184:187], a[60:63], v[64:79]
  ds_read_b64_tr_b16 v[184:185], v5 offset:20480
  ds_read_b64_tr_b16 v[186:187], v5 offset:20992
  buffer_load_dwordx4 a[188:191], v2, s[8:11], s41 offen offset:3072 sc1
  v_add_f32 v202, 1.0, v202
  v_mfma_f32_32x32x16_bf16 v[96:111], v[188:191], a[60:63], v[96:111]
  ds_read_b64_tr_b16 v[188:189], v6 offset:20480
  ds_read_b64_tr_b16 v[190:191], v6 offset:20992
  v_rcp_f32 v201, v201
  s_waitcnt vmcnt(15)
  s_waitcnt lgkmcnt(8)
  v_mfma_f32_32x32x16_bf16 v[64:79], v[192:195], a[68:71], v[64:79]
  ds_read_b64_tr_b16 v[192:193], v5 offset:22528
  ds_read_b64_tr_b16 v[194:195], v5 offset:23040
  s_add_u32 s41, s31, 24576
  buffer_load_dwordx4 a[196:199], v2, s[8:11], s41 offen offset:0 sc1
  v_mul_f32 v200, v200, v48
  v_mfma_f32_32x32x16_bf16 v[96:111], v[196:199], a[68:71], v[96:111]
  ds_read_b64_tr_b16 v[196:197], v6 offset:22528
  ds_read_b64_tr_b16 v[198:199], v6 offset:23040
  v_mul_f32 v205, s40, v53
  s_waitcnt vmcnt(15)
  s_waitcnt lgkmcnt(8)
  v_mfma_f32_32x32x16_bf16 v[64:79], v[176:179], a[76:79], v[64:79]
  ds_read_b64_tr_b16 v[176:177], v5 offset:24576
  ds_read_b64_tr_b16 v[178:179], v5 offset:25088
  buffer_load_dwordx4 a[204:207], v2, s[8:11], s41 offen offset:1024 sc1
  v_exp_f32 v204, v204
  v_mfma_f32_32x32x16_bf16 v[96:111], v[180:183], a[76:79], v[96:111]
  ds_read_b64_tr_b16 v[180:181], v6 offset:24576
  ds_read_b64_tr_b16 v[182:183], v6 offset:25088
  v_add_f32 v203, 1.0, v203
  s_waitcnt vmcnt(15)
  s_waitcnt lgkmcnt(8)
  v_mfma_f32_32x32x16_bf16 v[64:79], v[184:187], a[84:87], v[64:79]
  ds_read_b64_tr_b16 v[184:185], v5 offset:26624
  ds_read_b64_tr_b16 v[186:187], v5 offset:27136
  buffer_load_dwordx4 a[212:215], v2, s[8:11], s41 offen offset:2048 sc1
  v_rcp_f32 v202, v202
  v_mfma_f32_32x32x16_bf16 v[96:111], v[188:191], a[84:87], v[96:111]
  ds_read_b64_tr_b16 v[188:189], v6 offset:26624
  ds_read_b64_tr_b16 v[190:191], v6 offset:27136
  v_mul_f32 v201, v201, v49
  v_mul_f32 v206, s40, v54
  s_waitcnt vmcnt(15)
  s_waitcnt lgkmcnt(8)
  v_mfma_f32_32x32x16_bf16 v[64:79], v[192:195], a[92:95], v[64:79]
  ds_read_b64_tr_b16 v[192:193], v5 offset:28672
  ds_read_b64_tr_b16 v[194:195], v5 offset:29184
  buffer_load_dwordx4 a[220:223], v2, s[8:11], s41 offen offset:3072 sc1
  v_exp_f32 v205, v205
  v_mfma_f32_32x32x16_bf16 v[96:111], v[196:199], a[92:95], v[96:111]
  ds_read_b64_tr_b16 v[196:197], v6 offset:28672
  ds_read_b64_tr_b16 v[198:199], v6 offset:29184
  v_add_f32 v204, 1.0, v204
  s_waitcnt vmcnt(15)
  s_waitcnt lgkmcnt(8)
  v_mfma_f32_32x32x16_bf16 v[64:79], v[176:179], a[100:103], v[64:79]
  ds_read_b64_tr_b16 v[176:177], v5 offset:30720
  ds_read_b64_tr_b16 v[178:179], v5 offset:31232
  s_add_u32 s41, s31, 28672
  buffer_load_dwordx4 a[228:231], v2, s[8:11], s41 offen offset:0 sc1
  v_mfma_f32_32x32x16_bf16 v[96:111], v[180:183], a[100:103], v[96:111]
  ds_read_b64_tr_b16 v[180:181], v6 offset:30720
  ds_read_b64_tr_b16 v[182:183], v6 offset:31232
  v_rcp_f32 v203, v203
  s_waitcnt vmcnt(15)
  s_waitcnt lgkmcnt(8)
  v_mfma_f32_32x32x16_bf16 v[64:79], v[184:187], a[108:111], v[64:79]
  ds_read_b64_tr_b16 v[184:185], v5 offset:32768
  ds_read_b64_tr_b16 v[186:187], v5 offset:33280
  buffer_load_dwordx4 a[236:239], v2, s[8:11], s41 offen offset:1024 sc1
  v_mul_f32 v202, v202, v50
  v_cvt_pk_bf16_f32 v48, v200, v201
  v_mfma_f32_32x32x16_bf16 v[96:111], v[188:191], a[108:111], v[96:111]
  ds_read_b64_tr_b16 v[188:189], v6 offset:32768
  ds_read_b64_tr_b16 v[190:191], v6 offset:33280
  v_mul_f32 v207, s40, v55
  s_waitcnt vmcnt(15)
  s_waitcnt lgkmcnt(8)
  v_mfma_f32_32x32x16_bf16 v[64:79], v[192:195], a[116:119], v[64:79]
  ds_read_b64_tr_b16 v[192:193], v5 offset:34816
  ds_read_b64_tr_b16 v[194:195], v5 offset:35328
  buffer_load_dwordx4 a[244:247], v2, s[8:11], s41 offen offset:2048 sc1
  v_exp_f32 v206, v206
  v_mfma_f32_32x32x16_bf16 v[96:111], v[196:199], a[116:119], v[96:111]
  ds_read_b64_tr_b16 v[196:197], v6 offset:34816
  ds_read_b64_tr_b16 v[198:199], v6 offset:35328
  v_add_f32 v205, 1.0, v205
  s_waitcnt vmcnt(15)
  s_waitcnt lgkmcnt(8)
  v_mfma_f32_32x32x16_bf16 v[64:79], v[176:179], a[124:127], v[64:79]
  v_add_u32 v5, 0x9000, v5
  ds_read_b64_tr_b16 v[176:177], v5 offset:0
  ds_read_b64_tr_b16 v[178:179], v5 offset:512
  buffer_load_dwordx4 a[252:255], v2, s[8:11], s41 offen offset:3072 sc1
  v_mfma_f32_32x32x16_bf16 v[96:111], v[180:183], a[124:127], v[96:111]
  v_add_u32 v6, 0x9000, v6
  ds_read_b64_tr_b16 v[180:181], v6 offset:0
  ds_read_b64_tr_b16 v[182:183], v6 offset:512
  s_waitcnt vmcnt(15)
  s_waitcnt lgkmcnt(8)
  v_mfma_f32_32x32x16_bf16 v[64:79], v[184:187], a[132:135], v[64:79]
  ds_read_b64_tr_b16 v[184:185], v5 offset:2048
  ds_read_b64_tr_b16 v[186:187], v5 offset:2560
  s_add_u32 s41, s31, 32768
  buffer_load_dwordx4 v[20:23], v2, s[8:11], s41 offen offset:0 sc1
  v_mfma_f32_32x32x16_bf16 v[96:111], v[188:191], a[132:135], v[96:111]
  ds_read_b64_tr_b16 v[188:189], v6 offset:2048
  ds_read_b64_tr_b16 v[190:191], v6 offset:2560
  v_rcp_f32 v204, v204
  s_waitcnt vmcnt(15)
  s_waitcnt lgkmcnt(8)
  v_mfma_f32_32x32x16_bf16 v[64:79], v[192:195], a[140:143], v[64:79]
  ds_read_b64_tr_b16 v[192:193], v5 offset:4096
  ds_read_b64_tr_b16 v[194:195], v5 offset:4608
  buffer_load_dwordx4 v[28:31], v2, s[8:11], s41 offen offset:1024 sc1
  v_mul_f32 v203, v203, v51
  v_mul_f32 v200, s40, v56
  v_mfma_f32_32x32x16_bf16 v[96:111], v[196:199], a[140:143], v[96:111]
  ds_read_b64_tr_b16 v[196:197], v6 offset:4096
  ds_read_b64_tr_b16 v[198:199], v6 offset:4608
  v_exp_f32 v207, v207
  s_waitcnt vmcnt(15)
  s_waitcnt lgkmcnt(8)
  v_mfma_f32_32x32x16_bf16 v[64:79], v[176:179], a[148:151], v[64:79]
  ds_read_b64_tr_b16 v[176:177], v5 offset:6144
  ds_read_b64_tr_b16 v[178:179], v5 offset:6656
  buffer_load_dwordx4 v[36:39], v2, s[8:11], s41 offen offset:2048 sc1
  v_add_f32 v206, 1.0, v206
  v_mfma_f32_32x32x16_bf16 v[96:111], v[180:183], a[148:151], v[96:111]
  ds_read_b64_tr_b16 v[180:181], v6 offset:6144
  ds_read_b64_tr_b16 v[182:183], v6 offset:6656
  v_rcp_f32 v205, v205
  s_waitcnt vmcnt(15)
  s_waitcnt lgkmcnt(8)
  v_mfma_f32_32x32x16_bf16 v[64:79], v[184:187], a[156:159], v[64:79]
  ds_read_b64_tr_b16 v[184:185], v5 offset:8192
  ds_read_b64_tr_b16 v[186:187], v5 offset:8704
  buffer_load_dwordx4 v[44:47], v2, s[8:11], s41 offen offset:3072 sc1
  v_mul_f32 v204, v204, v52
  v_cvt_pk_bf16_f32 v49, v202, v203
  v_mfma_f32_32x32x16_bf16 v[96:111], v[188:191], a[156:159], v[96:111]
  ds_read_b64_tr_b16 v[188:189], v6 offset:8192
  ds_read_b64_tr_b16 v[190:191], v6 offset:8704
  v_mul_f32 v201, s40, v57
  s_waitcnt vmcnt(15)
  s_waitcnt lgkmcnt(8)
  v_mfma_f32_32x32x16_bf16 v[64:79], v[192:195], a[164:167], v[64:79]
  ds_read_b64_tr_b16 v[192:193], v5 offset:10240
  ds_read_b64_tr_b16 v[194:195], v5 offset:10752
  v_exp_f32 v200, v200
  v_add_f32 v207, 1.0, v207
  v_mfma_f32_32x32x16_bf16 v[96:111], v[196:199], a[164:167], v[96:111]
  ds_read_b64_tr_b16 v[196:197], v6 offset:10240
  ds_read_b64_tr_b16 v[198:199], v6 offset:10752
  v_rcp_f32 v206, v206
  s_waitcnt vmcnt(14)
  s_waitcnt lgkmcnt(8)
  v_mfma_f32_32x32x16_bf16 v[64:79], v[176:179], a[172:175], v[64:79]
  ds_read_b64_tr_b16 v[176:177], v5 offset:12288
  ds_read_b64_tr_b16 v[178:179], v5 offset:12800
  v_mul_f32 v205, v205, v53
  v_mul_f32 v202, s40, v58
  v_exp_f32 v201, v201
  v_mfma_f32_32x32x16_bf16 v[96:111], v[180:183], a[172:175], v[96:111]
  ds_read_b64_tr_b16 v[180:181], v6 offset:12288
  ds_read_b64_tr_b16 v[182:183], v6 offset:12800
  s_lshl_b32 s3, s2, 2
  s_add_u32 s3, s3, s30
  s_waitcnt vmcnt(13)
  s_waitcnt lgkmcnt(8)
  v_mfma_f32_32x32x16_bf16 v[64:79], v[184:187], a[180:183], v[64:79]
  ds_read_b64_tr_b16 v[184:185], v5 offset:14336
  ds_read_b64_tr_b16 v[186:187], v5 offset:14848
  s_mul_i32 s3, s3, 5760
  s_add_u32 s3, s3, 256
  v_min_u32 v13, 19, v0
  v_lshrrev_b32 v15, 2, v13
  v_mfma_f32_32x32x16_bf16 v[96:111], v[188:191], a[180:183], v[96:111]
  ds_read_b64_tr_b16 v[188:189], v6 offset:14336
  ds_read_b64_tr_b16 v[190:191], v6 offset:14848
  v_mul_u32_u24 v15, 5, v15
  v_add_u32 v15, v15, v13
  s_waitcnt vmcnt(12)
  s_waitcnt lgkmcnt(8)
  v_mfma_f32_32x32x16_bf16 v[64:79], v[192:195], a[188:191], v[64:79]
  ds_read_b64_tr_b16 v[192:193], v5 offset:16384
  ds_read_b64_tr_b16 v[194:195], v5 offset:16896
  v_bfe_u32 v13, v13, 1, 1
  v_mul_u32_u24 v13, 3, v13
  v_add_u32 v15, v15, v13
  v_lshl_add_u32 v15, v15, 7, s3
  v_mfma_f32_32x32x16_bf16 v[96:111], v[196:199], a[188:191], v[96:111]
  ds_read_b64_tr_b16 v[196:197], v6 offset:16384
  ds_read_b64_tr_b16 v[198:199], v6 offset:16896
  buffer_load_dword v13, v15, s[12:15], 0 offen
  s_waitcnt vmcnt(12)
  s_waitcnt lgkmcnt(8)
  v_mfma_f32_32x32x16_bf16 v[64:79], v[176:179], a[196:199], v[64:79]
  ds_read_b64_tr_b16 v[176:177], v5 offset:18432
  ds_read_b64_tr_b16 v[178:179], v5 offset:18944
  s_lshl_b32 s3, s2, 2
  s_add_u32 s3, s3, s30
  s_mul_i32 s3, s3, 5632
  v_min_u32 v14, 10, v0
  v_mfma_f32_32x32x16_bf16 v[96:111], v[180:183], a[196:199], v[96:111]
  ds_read_b64_tr_b16 v[180:181], v6 offset:18432
  ds_read_b64_tr_b16 v[182:183], v6 offset:18944
  v_lshl_add_u32 v14, v14, 7, s3
  v_add_f32 v200, 1.0, v200
  s_waitcnt vmcnt(11)
  s_waitcnt lgkmcnt(8)
  v_mfma_f32_32x32x16_bf16 v[64:79], v[184:187], a[204:207], v[64:79]
  ds_read_b64_tr_b16 v[184:185], v5 offset:20480
  ds_read_b64_tr_b16 v[186:187], v5 offset:20992
  buffer_load_dword v13, v14, s[16:19], 0 offen
  v_add_u32 v14, 1408, v14
  v_mfma_f32_32x32x16_bf16 v[96:111], v[188:191], a[204:207], v[96:111]
  ds_read_b64_tr_b16 v[188:189], v6 offset:20480
  ds_read_b64_tr_b16 v[190:191], v6 offset:20992
  v_rcp_f32 v207, v207
  s_waitcnt vmcnt(11)
  s_waitcnt lgkmcnt(8)
  v_mfma_f32_32x32x16_bf16 v[64:79], v[192:195], a[212:215], v[64:79]
  ds_read_b64_tr_b16 v[192:193], v5 offset:22528
  ds_read_b64_tr_b16 v[194:195], v5 offset:23040
  v_mul_f32 v206, v206, v54
  v_cvt_pk_bf16_f32 v50, v204, v205
  v_mul_f32 v203, s40, v59
  v_mfma_f32_32x32x16_bf16 v[96:111], v[196:199], a[212:215], v[96:111]
  ds_read_b64_tr_b16 v[196:197], v6 offset:22528
  ds_read_b64_tr_b16 v[198:199], v6 offset:23040
  v_exp_f32 v202, v202
  s_waitcnt vmcnt(10)
  s_waitcnt lgkmcnt(8)
  v_mfma_f32_32x32x16_bf16 v[64:79], v[176:179], a[220:223], v[64:79]
  ds_read_b64_tr_b16 v[176:177], v5 offset:24576
  ds_read_b64_tr_b16 v[178:179], v5 offset:25088
  v_add_f32 v201, 1.0, v201
  v_rcp_f32 v200, v200
  v_mul_f32 v207, v207, v55
  v_mfma_f32_32x32x16_bf16 v[96:111], v[180:183], a[220:223], v[96:111]
  ds_read_b64_tr_b16 v[180:181], v6 offset:24576
  ds_read_b64_tr_b16 v[182:183], v6 offset:25088
  v_mul_f32 v204, s40, v60
  s_waitcnt vmcnt(9)
  s_waitcnt lgkmcnt(8)
  v_mfma_f32_32x32x16_bf16 v[64:79], v[184:187], a[228:231], v[64:79]
  ds_read_b64_tr_b16 v[184:185], v5 offset:26624
  ds_read_b64_tr_b16 v[186:187], v5 offset:27136
  v_exp_f32 v203, v203
  v_add_f32 v202, 1.0, v202
  v_mfma_f32_32x32x16_bf16 v[96:111], v[188:191], a[228:231], v[96:111]
  ds_read_b64_tr_b16 v[188:189], v6 offset:26624
  ds_read_b64_tr_b16 v[190:191], v6 offset:27136
  v_rcp_f32 v201, v201
  s_waitcnt vmcnt(8)
  s_waitcnt lgkmcnt(8)
  v_mfma_f32_32x32x16_bf16 v[64:79], v[192:195], a[236:239], v[64:79]
  ds_read_b64_tr_b16 v[192:193], v5 offset:28672
  ds_read_b64_tr_b16 v[194:195], v5 offset:29184
  v_mul_f32 v200, v200, v56
  v_cvt_pk_bf16_f32 v51, v206, v207
  v_mfma_f32_32x32x16_bf16 v[96:111], v[196:199], a[236:239], v[96:111]
  ds_read_b64_tr_b16 v[196:197], v6 offset:28672
  ds_read_b64_tr_b16 v[198:199], v6 offset:29184
  s_waitcnt vmcnt(7)
  s_waitcnt lgkmcnt(8)
  v_mfma_f32_32x32x16_bf16 v[64:79], v[176:179], a[244:247], v[64:79]
  ds_read_b64_tr_b16 v[176:177], v5 offset:30720
  ds_read_b64_tr_b16 v[178:179], v5 offset:31232
  buffer_load_dword v13, v14, s[16:19], 0 offen
  v_add_u32 v14, 1408, v14
  v_mfma_f32_32x32x16_bf16 v[96:111], v[180:183], a[244:247], v[96:111]
  ds_read_b64_tr_b16 v[180:181], v6 offset:30720
  ds_read_b64_tr_b16 v[182:183], v6 offset:31232
  s_waitcnt vmcnt(7)
  s_waitcnt lgkmcnt(8)
  v_mfma_f32_32x32x16_bf16 v[64:79], v[184:187], a[252:255], v[64:79]
  ds_read_b64_tr_b16 v[184:185], v5 offset:32768
  ds_read_b64_tr_b16 v[186:187], v5 offset:33280
  buffer_store_dwordx4 v[48:51], v11, s[8:11], s38 offen offset:0 sc1
  v_mul_f32 v205, s40, v61
  v_mfma_f32_32x32x16_bf16 v[96:111], v[188:191], a[252:255], v[96:111]
  ds_read_b64_tr_b16 v[188:189], v6 offset:32768
  ds_read_b64_tr_b16 v[190:191], v6 offset:33280
  v_exp_f32 v204, v204
  s_waitcnt vmcnt(7)
  s_waitcnt lgkmcnt(8)
  v_mfma_f32_32x32x16_bf16 v[64:79], v[192:195], v[20:23], v[64:79]
  ds_read_b64_tr_b16 v[192:193], v5 offset:34816
  ds_read_b64_tr_b16 v[194:195], v5 offset:35328
  v_add_f32 v203, 1.0, v203
  v_rcp_f32 v202, v202
  v_mul_f32 v201, v201, v57
  v_mfma_f32_32x32x16_bf16 v[96:111], v[196:199], v[20:23], v[96:111]
  ds_read_b64_tr_b16 v[196:197], v6 offset:34816
  ds_read_b64_tr_b16 v[198:199], v6 offset:35328
  v_mul_f32 v206, s40, v62
  s_waitcnt vmcnt(6)
  s_waitcnt lgkmcnt(8)
  v_mfma_f32_32x32x16_bf16 v[64:79], v[176:179], v[28:31], v[64:79]
  s_waitcnt lgkmcnt(0)
  s_barrier
  v_add_u32 v5, 0x9000, v5
  ds_read_b64_tr_b16 v[176:177], v5 offset:0
  ds_read_b64_tr_b16 v[178:179], v5 offset:512
  v_mfma_f32_32x32x16_bf16 v[96:111], v[180:183], v[28:31], v[96:111]
  ds_read_b64_tr_b16 v[180:181], v5 offset:2048
  ds_read_b64_tr_b16 v[182:183], v5 offset:2560
  v_exp_f32 v205, v205
  s_waitcnt vmcnt(5)
  v_add_f32 v204, 1.0, v204
  v_mfma_f32_32x32x16_bf16 v[64:79], v[184:187], v[36:39], v[64:79]
  ds_read_b64_tr_b16 v[184:185], v5 offset:4096
  ds_read_b64_tr_b16 v[186:187], v5 offset:4608
  v_rcp_f32 v203, v203
  v_mul_f32 v202, v202, v58
  v_cvt_pk_bf16_f32 v56, v200, v201
  v_mfma_f32_32x32x16_bf16 v[96:111], v[188:191], v[36:39], v[96:111]
  ds_read_b64_tr_b16 v[188:189], v5 offset:6144
  ds_read_b64_tr_b16 v[190:191], v5 offset:6656
  v_mul_f32 v207, s40, v63
  s_waitcnt vmcnt(4)
  v_exp_f32 v206, v206
  v_mfma_f32_32x32x16_bf16 v[64:79], v[192:195], v[44:47], v[64:79]
  ds_read_b64_tr_b16 v[192:193], v5 offset:8192
  ds_read_b64_tr_b16 v[194:195], v5 offset:8704
  buffer_load_dword v13, v14, s[16:19], 0 offen
  v_add_u32 v14, 1408, v14
  v_add_f32 v205, 1.0, v205
  v_mfma_f32_32x32x16_bf16 v[96:111], v[196:199], v[44:47], v[96:111]
  ds_read_b64_tr_b16 v[196:197], v5 offset:10240
  ds_read_b64_tr_b16 v[198:199], v5 offset:10752
  v_rcp_f32 v204, v204
  v_mul_f32 v203, v203, v59
  s_waitcnt lgkmcnt(8)
  v_mfma_f32_32x32x16_bf16 v[112:127], v[176:179], a[0:3], 0
  s_add_u32 m0, s33, 0
  s_add_u32 s32, s36, 0
  buffer_load_dwordx4 v3, s[12:15], s32 offen lds
  v_exp_f32 v207, v207
  v_mfma_f32_32x32x16_bf16 v[128:143], v[176:179], a[4:7], 0
  ds_read_b64_tr_b16 v[176:177], v5 offset:12288
  v_add_f32 v206, 1.0, v206
  v_rcp_f32 v205, v205
  v_mul_f32 v204, v204, v60
  v_cvt_pk_bf16_f32 v57, v202, v203
  v_mfma_f32_32x32x16_bf16 v[112:127], v[180:183], a[8:11], v[112:127]
  ds_read_b64_tr_b16 v[178:179], v5 offset:12800
  v_add_f32 v207, 1.0, v207
  v_rcp_f32 v206, v206
  v_mul_f32 v205, v205, v61
  v_mfma_f32_32x32x16_bf16 v[128:143], v[180:183], a[12:15], v[128:143]
  ds_read_b64_tr_b16 v[180:181], v5 offset:14336
  s_add_u32 m0, s33, 4096
  s_add_u32 s32, s36, 294912
  buffer_load_dwordx4 v3, s[12:15], s32 offen lds
  s_waitcnt lgkmcnt(7)
  v_mfma_f32_32x32x16_bf16 v[112:127], v[184:187], a[16:19], v[112:127]
  ds_read_b64_tr_b16 v[182:183], v5 offset:14848
  v_rcp_f32 v207, v207
  v_mul_f32 v206, v206, v62
  v_cvt_pk_bf16_f32 v58, v204, v205
  v_mul_f32 v207, v207, v63
  v_mfma_f32_32x32x16_bf16 v[128:143], v[184:187], a[20:23], v[128:143]
  ds_read_b64_tr_b16 v[184:185], v5 offset:16384
  v_cvt_pk_bf16_f32 v59, v206, v207
  buffer_store_dwordx4 v[56:59], v11, s[8:11], s38 offen offset:1024 sc1
  s_lshl_b32 s38, s34, 5
  v_mfma_f32_32x32x16_bf16 v[112:127], v[188:191], a[24:27], v[112:127]
  ds_read_b64_tr_b16 v[186:187], v5 offset:16896
  s_add_u32 m0, s33, 8192
  s_add_u32 s32, s36, 589824
  buffer_load_dwordx4 v3, s[12:15], s32 offen lds
  s_add_u32 s38, s38, s37
  v_mfma_f32_32x32x16_bf16 v[128:143], v[188:191], a[28:31], v[128:143]
  ds_read_b64_tr_b16 v[188:189], v5 offset:18432
  v_mul_f32 v200, s40, v80
  v_mul_f32 v201, s40, v81
  v_exp_f32 v200, v200
  s_waitcnt lgkmcnt(7)
  v_mfma_f32_32x32x16_bf16 v[112:127], v[192:195], a[32:35], v[112:127]
  ds_read_b64_tr_b16 v[190:191], v5 offset:18944
  buffer_load_dword v13, v14, s[16:19], 0 offen
  v_add_u32 v14, 1408, v14
  v_mul_f32 v202, s40, v82
  v_mfma_f32_32x32x16_bf16 v[128:143], v[192:195], a[36:39], v[128:143]
  ds_read_b64_tr_b16 v[192:193], v5 offset:20480
  s_add_u32 m0, s33, 12288
  s_add_u32 s32, s36, 884736
  buffer_load_dwordx4 v3, s[12:15], s32 offen lds
  v_mfma_f32_32x32x16_bf16 v[112:127], v[196:199], a[40:43], v[112:127]
  ds_read_b64_tr_b16 v[194:195], v5 offset:20992
  v_exp_f32 v201, v201
  v_add_f32 v200, 1.0, v200
  v_mul_f32 v203, s40, v83
  v_mfma_f32_32x32x16_bf16 v[128:143], v[196:199], a[44:47], v[128:143]
  ds_read_b64_tr_b16 v[196:197], v5 offset:22528
  v_exp_f32 v202, v202
  v_add_f32 v201, 1.0, v201
  s_waitcnt lgkmcnt(7)
  v_mfma_f32_32x32x16_bf16 v[112:127], v[176:179], a[48:51], v[112:127]
  ds_read_b64_tr_b16 v[198:199], v5 offset:23040
  s_add_u32 m0, s33, 16384
  s_add_u32 s32, s36, 1179648
  buffer_load_dwordx4 v3, s[12:15], s32 offen lds
  v_mfma_f32_32x32x16_bf16 v[128:143], v[176:179], a[52:55], v[128:143]
  ds_read_b64_tr_b16 v[176:177], v5 offset:24576
  v_rcp_f32 v200, v200
  v_mul_f32 v204, s40, v84
  v_exp_f32 v203, v203
  v_mfma_f32_32x32x16_bf16 v[112:127], v[180:183], a[56:59], v[112:127]
  ds_read_b64_tr_b16 v[178:179], v5 offset:25088
  v_add_f32 v202, 1.0, v202
  v_rcp_f32 v201, v201
  v_mul_f32 v200, v200, v80
  v_mul_f32 v205, s40, v85
  v_mfma_f32_32x32x16_bf16 v[128:143], v[180:183], a[60:63], v[128:143]
  ds_read_b64_tr_b16 v[180:181], v5 offset:26624
  s_add_u32 m0, s33, 20480
  s_add_u32 s32, s36, 1474560
  buffer_load_dwordx4 v3, s[12:15], s32 offen lds
  s_waitcnt lgkmcnt(7)
  v_mfma_f32_32x32x16_bf16 v[112:127], v[184:187], a[64:67], v[112:127]
  ds_read_b64_tr_b16 v[182:183], v5 offset:27136
  v_exp_f32 v204, v204
  v_add_f32 v203, 1.0, v203
  v_rcp_f32 v202, v202
  v_mfma_f32_32x32x16_bf16 v[128:143], v[184:187], a[68:71], v[128:143]
  ds_read_b64_tr_b16 v[184:185], v5 offset:28672
  v_mul_f32 v201, v201, v81
  v_mul_f32 v206, s40, v86
  v_exp_f32 v205, v205
  v_add_f32 v204, 1.0, v204
  v_mfma_f32_32x32x16_bf16 v[112:127], v[188:191], a[72:75], v[112:127]
  ds_read_b64_tr_b16 v[186:187], v5 offset:29184
  s_add_u32 m0, s33, 24576
  s_add_u32 s32, s36, 1769472
  buffer_load_dwordx4 v3, s[12:15], s32 offen lds
  v_mfma_f32_32x32x16_bf16 v[128:143], v[188:191], a[76:79], v[128:143]
  ds_read_b64_tr_b16 v[188:189], v5 offset:30720
  v_rcp_f32 v203, v203
  v_mul_f32 v202, v202, v82
  v_cvt_pk_bf16_f32 v80, v200, v201
  s_waitcnt lgkmcnt(7)
  v_mfma_f32_32x32x16_bf16 v[112:127], v[192:195], a[80:83], v[112:127]
  ds_read_b64_tr_b16 v[190:191], v5 offset:31232
  v_mul_f32 v207, s40, v87
  v_exp_f32 v206, v206
  v_add_f32 v205, 1.0, v205
  v_mfma_f32_32x32x16_bf16 v[128:143], v[192:195], a[84:87], v[128:143]
  ds_read_b64_tr_b16 v[192:193], v5 offset:32768
  s_add_u32 m0, s33, 28672
  s_add_u32 s32, s36, 2064384
  buffer_load_dwordx4 v3, s[12:15], s32 offen lds
  v_mfma_f32_32x32x16_bf16 v[112:127], v[196:199], a[88:91], v[112:127]
  ds_read_b64_tr_b16 v[194:195], v5 offset:33280
  v_rcp_f32 v204, v204
  v_mul_f32 v203, v203, v83
  v_mul_f32 v200, s40, v88
  v_mfma_f32_32x32x16_bf16 v[128:143], v[196:199], a[92:95], v[128:143]
  ds_read_b64_tr_b16 v[196:197], v5 offset:34816
  v_exp_f32 v207, v207
  v_add_f32 v206, 1.0, v206
  s_waitcnt lgkmcnt(7)
  v_mfma_f32_32x32x16_bf16 v[112:127], v[176:179], a[96:99], v[112:127]
  ds_read_b64_tr_b16 v[198:199], v5 offset:35328
  s_add_u32 m0, s33, 32768
  s_add_u32 s32, s36, 2359296
  buffer_load_dwordx4 v3, s[12:15], s32 offen lds
  v_mfma_f32_32x32x16_bf16 v[128:143], v[176:179], a[100:103], v[128:143]
  v_add_u32 v5, 0x9000, v5
  ds_read_b64_tr_b16 v[176:177], v5 offset:0
  v_rcp_f32 v205, v205
  v_mul_f32 v204, v204, v84
  v_cvt_pk_bf16_f32 v81, v202, v203
  v_mfma_f32_32x32x16_bf16 v[112:127], v[180:183], a[104:107], v[112:127]
  ds_read_b64_tr_b16 v[178:179], v5 offset:512
  v_mul_f32 v201, s40, v89
  v_exp_f32 v200, v200
  v_add_f32 v207, 1.0, v207
  v_mfma_f32_32x32x16_bf16 v[128:143], v[180:183], a[108:111], v[128:143]
  ds_read_b64_tr_b16 v[180:181], v5 offset:2048
  s_add_u32 m0, s33, 36864
  s_add_u32 s32, s36, 2654208
  buffer_load_dwordx4 v3, s[12:15], s32 offen lds
  s_waitcnt lgkmcnt(7)
  v_mfma_f32_32x32x16_bf16 v[112:127], v[184:187], a[112:115], v[112:127]
  ds_read_b64_tr_b16 v[182:183], v5 offset:2560
  v_rcp_f32 v206, v206
  v_mul_f32 v205, v205, v85
  v_mul_f32 v202, s40, v90
  v_mfma_f32_32x32x16_bf16 v[128:143], v[184:187], a[116:119], v[128:143]
  ds_read_b64_tr_b16 v[184:185], v5 offset:4096
  v_exp_f32 v201, v201
  v_add_f32 v200, 1.0, v200
  v_rcp_f32 v207, v207
  v_mfma_f32_32x32x16_bf16 v[112:127], v[188:191], a[120:123], v[112:127]
  ds_read_b64_tr_b16 v[186:187], v5 offset:4608
  s_add_u32 m0, s33, 40960
  s_add_u32 s32, s36, 2949120
  buffer_load_dwordx4 v3, s[12:15], s32 offen lds
  v_mul_f32 v206, v206, v86
  v_mfma_f32_32x32x16_bf16 v[128:143], v[188:191], a[124:127], v[128:143]
  ds_read_b64_tr_b16 v[188:189], v5 offset:6144
  v_cvt_pk_bf16_f32 v82, v204, v205
  v_mul_f32 v203, s40, v91
  v_exp_f32 v202, v202
  s_waitcnt lgkmcnt(7)
  v_mfma_f32_32x32x16_bf16 v[112:127], v[192:195], a[128:131], v[112:127]
  ds_read_b64_tr_b16 v[190:191], v5 offset:6656
  v_add_f32 v201, 1.0, v201
  v_rcp_f32 v200, v200
  v_mul_f32 v207, v207, v87
  v_mul_f32 v204, s40, v92
  v_mfma_f32_32x32x16_bf16 v[128:143], v[192:195], a[132:135], v[128:143]
  ds_read_b64_tr_b16 v[192:193], v5 offset:8192
  s_add_u32 m0, s33, 45056
  s_add_u32 s32, s36, 3244032
  buffer_load_dwordx4 v3, s[12:15], s32 offen lds
  v_mfma_f32_32x32x16_bf16 v[112:127], v[196:199], a[136:139], v[112:127]
  ds_read_b64_tr_b16 v[194:195], v5 offset:8704
  v_exp_f32 v203, v203
  v_add_f32 v202, 1.0, v202
  v_rcp_f32 v201, v201
  v_mfma_f32_32x32x16_bf16 v[128:143], v[196:199], a[140:143], v[128:143]
  ds_read_b64_tr_b16 v[196:197], v5 offset:10240
  v_mul_f32 v200, v200, v88
  v_cvt_pk_bf16_f32 v83, v206, v207
  s_waitcnt lgkmcnt(7)
  v_mfma_f32_32x32x16_bf16 v[112:127], v[176:179], a[144:147], v[112:127]
  ds_read_b64_tr_b16 v[198:199], v5 offset:10752
  s_add_u32 m0, s33, 49152
  s_add_u32 s32, s36, 3538944
  buffer_load_dwordx4 v3, s[12:15], s32 offen lds
  v_mfma_f32_32x32x16_bf16 v[128:143], v[176:179], a[148:151], v[128:143]
  ds_read_b64_tr_b16 v[176:177], v5 offset:12288
  buffer_store_dwordx4 v[80:83], v11, s[8:11], s38 offen offset:2048 sc1
  v_mul_f32 v205, s40, v93
  v_mfma_f32_32x32x16_bf16 v[112:127], v[180:183], a[152:155], v[112:127]
  ds_read_b64_tr_b16 v[178:179], v5 offset:12800
  v_exp_f32 v204, v204
  v_add_f32 v203, 1.0, v203
  v_rcp_f32 v202, v202
  v_mfma_f32_32x32x16_bf16 v[128:143], v[180:183], a[156:159], v[128:143]
  ds_read_b64_tr_b16 v[180:181], v5 offset:14336
  s_add_u32 m0, s33, 53248
  s_add_u32 s32, s36, 3833856
  buffer_load_dwordx4 v3, s[12:15], s32 offen lds
  s_waitcnt lgkmcnt(7)
  v_mfma_f32_32x32x16_bf16 v[112:127], v[184:187], a[160:163], v[112:127]
  ds_read_b64_tr_b16 v[182:183], v5 offset:14848
  v_mul_f32 v201, v201, v89
  v_mul_f32 v206, s40, v94
  v_exp_f32 v205, v205
  v_add_f32 v204, 1.0, v204
  v_mfma_f32_32x32x16_bf16 v[128:143], v[184:187], a[164:167], v[128:143]
  ds_read_b64_tr_b16 v[184:185], v5 offset:16384
  v_rcp_f32 v203, v203
  v_mul_f32 v202, v202, v90
  v_cvt_pk_bf16_f32 v88, v200, v201
  v_mul_f32 v207, s40, v95
  v_mfma_f32_32x32x16_bf16 v[112:127], v[188:191], a[168:171], v[112:127]
  ds_read_b64_tr_b16 v[186:187], v5 offset:16896
  s_add_u32 m0, s33, 57344
  s_add_u32 s32, s36, 4128768
  buffer_load_dwordx4 v3, s[12:15], s32 offen lds
  v_mfma_f32_32x32x16_bf16 v[128:143], v[188:191], a[172:175], v[128:143]
  ds_read_b64_tr_b16 v[188:189], v5 offset:18432
  v_exp_f32 v206, v206
  v_add_f32 v205, 1.0, v205
  s_waitcnt lgkmcnt(7)
  v_mfma_f32_32x32x16_bf16 v[112:127], v[192:195], a[176:179], v[112:127]
  ds_read_b64_tr_b16 v[190:191], v5 offset:18944
  v_rcp_f32 v204, v204
  v_mul_f32 v203, v203, v91
  v_exp_f32 v207, v207
  v_mfma_f32_32x32x16_bf16 v[128:143], v[192:195], a[180:183], v[128:143]
  ds_read_b64_tr_b16 v[192:193], v5 offset:20480
  s_add_u32 m0, s33, 61440
  s_add_u32 s32, s36, 4423680
  buffer_load_dwordx4 v3, s[12:15], s32 offen lds
  v_add_f32 v206, 1.0, v206
  v_mfma_f32_32x32x16_bf16 v[112:127], v[196:199], a[184:187], v[112:127]
  ds_read_b64_tr_b16 v[194:195], v5 offset:20992
  v_rcp_f32 v205, v205
  v_mul_f32 v204, v204, v92
  v_cvt_pk_bf16_f32 v89, v202, v203
  v_add_f32 v207, 1.0, v207
  v_mfma_f32_32x32x16_bf16 v[128:143], v[196:199], a[188:191], v[128:143]
  ds_read_b64_tr_b16 v[196:197], v5 offset:22528
  v_rcp_f32 v206, v206
  v_mul_f32 v205, v205, v93
  s_waitcnt lgkmcnt(7)
  v_mfma_f32_32x32x16_bf16 v[112:127], v[176:179], a[192:195], v[112:127]
  ds_read_b64_tr_b16 v[198:199], v5 offset:23040
  s_add_u32 m0, s33, 65536
  s_add_u32 s32, s36, 4718592
  buffer_load_dwordx4 v3, s[12:15], s32 offen lds
  v_mfma_f32_32x32x16_bf16 v[128:143], v[176:179], a[196:199], v[128:143]
  ds_read_b64_tr_b16 v[176:177], v5 offset:24576
  v_rcp_f32 v207, v207
  v_mul_f32 v206, v206, v94
  v_cvt_pk_bf16_f32 v90, v204, v205
  v_mul_f32 v207, v207, v95
  v_mfma_f32_32x32x16_bf16 v[112:127], v[180:183], a[200:203], v[112:127]
  ds_read_b64_tr_b16 v[178:179], v5 offset:25088
  v_cvt_pk_bf16_f32 v91, v206, v207
  buffer_store_dwordx4 v[88:91], v11, s[8:11], s38 offen offset:3072 sc1
  s_lshl_b32 s38, s34, 5
  v_mfma_f32_32x32x16_bf16 v[128:143], v[180:183], a[204:207], v[128:143]
  ds_read_b64_tr_b16 v[180:181], v5 offset:26624
  s_add_u32 m0, s33, 69632
  s_add_u32 s32, s36, 5013504
  buffer_load_dwordx4 v3, s[12:15], s32 offen lds
  s_waitcnt lgkmcnt(7)
  v_mfma_f32_32x32x16_bf16 v[112:127], v[184:187], a[208:211], v[112:127]
  ds_read_b64_tr_b16 v[182:183], v5 offset:27136
  s_add_u32 s38, s38, s37
  v_mul_f32 v200, s40, v64
  v_mul_f32 v201, s40, v65
  v_exp_f32 v200, v200
  v_mfma_f32_32x32x16_bf16 v[128:143], v[184:187], a[212:215], v[128:143]
  ds_read_b64_tr_b16 v[184:185], v5 offset:28672
  v_mul_f32 v202, s40, v66
  v_exp_f32 v201, v201
  v_add_f32 v200, 1.0, v200
  v_mul_f32 v203, s40, v67
  v_mfma_f32_32x32x16_bf16 v[112:127], v[188:191], a[216:219], v[112:127]
  ds_read_b64_tr_b16 v[186:187], v5 offset:29184
  v_exp_f32 v202, v202
  v_add_f32 v201, 1.0, v201
  v_rcp_f32 v200, v200
  v_mfma_f32_32x32x16_bf16 v[128:143], v[188:191], a[220:223], v[128:143]
  ds_read_b64_tr_b16 v[188:189], v5 offset:30720
  v_mul_f32 v204, s40, v68
  v_exp_f32 v203, v203
  v_add_f32 v202, 1.0, v202
  s_waitcnt lgkmcnt(7)
  v_mfma_f32_32x32x16_bf16 v[112:127], v[192:195], a[224:227], v[112:127]
  ds_read_b64_tr_b16 v[190:191], v5 offset:31232
  v_rcp_f32 v201, v201
  v_mul_f32 v200, v200, v64
  v_mul_f32 v205, s40, v69
  v_mfma_f32_32x32x16_bf16 v[128:143], v[192:195], a[228:231], v[128:143]
  ds_read_b64_tr_b16 v[192:193], v5 offset:32768
  v_exp_f32 v204, v204
  v_add_f32 v203, 1.0, v203
  v_rcp_f32 v202, v202
  v_mfma_f32_32x32x16_bf16 v[112:127], v[196:199], a[232:235], v[112:127]
  ds_read_b64_tr_b16 v[194:195], v5 offset:33280
  v_mul_f32 v201, v201, v65
  v_mul_f32 v206, s40, v70
  v_exp_f32 v205, v205
  v_add_f32 v204, 1.0, v204
  v_mfma_f32_32x32x16_bf16 v[128:143], v[196:199], a[236:239], v[128:143]
  ds_read_b64_tr_b16 v[196:197], v5 offset:34816
  v_rcp_f32 v203, v203
  v_mul_f32 v202, v202, v66
  v_cvt_pk_bf16_f32 v64, v200, v201
  s_waitcnt lgkmcnt(7)
  v_mfma_f32_32x32x16_bf16 v[112:127], v[176:179], a[240:243], v[112:127]
  ds_read_b64_tr_b16 v[198:199], v5 offset:35328
  v_mul_f32 v207, s40, v71
  v_exp_f32 v206, v206
  v_add_f32 v205, 1.0, v205
  v_mfma_f32_32x32x16_bf16 v[128:143], v[176:179], a[244:247], v[128:143]
  v_add_u32 v6, 0x9000, v6
  ds_read_b64_tr_b16 v[176:177], v6 offset:0
  v_rcp_f32 v204, v204
  v_mul_f32 v203, v203, v67
  v_mul_f32 v200, s40, v72
  v_mfma_f32_32x32x16_bf16 v[112:127], v[180:183], a[248:251], v[112:127]
  ds_read_b64_tr_b16 v[178:179], v6 offset:512
  v_exp_f32 v207, v207
  v_add_f32 v206, 1.0, v206
  v_rcp_f32 v205, v205
  v_mfma_f32_32x32x16_bf16 v[128:143], v[180:183], a[252:255], v[128:143]
  ds_read_b64_tr_b16 v[180:181], v6 offset:2048
  v_mul_f32 v204, v204, v68
  v_cvt_pk_bf16_f32 v65, v202, v203
  v_mul_f32 v201, s40, v73
  s_waitcnt lgkmcnt(7)
  v_mfma_f32_32x32x16_bf16 v[112:127], v[184:187], v[16:19], v[112:127]
  ds_read_b64_tr_b16 v[182:183], v6 offset:2560
  v_exp_f32 v200, v200
  v_add_f32 v207, 1.0, v207
  v_rcp_f32 v206, v206
  v_mfma_f32_32x32x16_bf16 v[128:143], v[184:187], v[20:23], v[128:143]
  ds_read_b64_tr_b16 v[184:185], v6 offset:4096
  v_mul_f32 v205, v205, v69
  v_mul_f32 v202, s40, v74
  v_exp_f32 v201, v201
  v_add_f32 v200, 1.0, v200
  v_mfma_f32_32x32x16_bf16 v[112:127], v[188:191], v[24:27], v[112:127]
  ds_read_b64_tr_b16 v[186:187], v6 offset:4608
  v_rcp_f32 v207, v207
  v_mul_f32 v206, v206, v70
  v_cvt_pk_bf16_f32 v66, v204, v205
  v_mul_f32 v203, s40, v75
  v_mfma_f32_32x32x16_bf16 v[128:143], v[188:191], v[28:31], v[128:143]
  ds_read_b64_tr_b16 v[188:189], v6 offset:6144
  v_exp_f32 v202, v202
  v_add_f32 v201, 1.0, v201
  s_waitcnt lgkmcnt(7)
  v_mfma_f32_32x32x16_bf16 v[112:127], v[192:195], v[32:35], v[112:127]
  ds_read_b64_tr_b16 v[190:191], v6 offset:6656
  v_rcp_f32 v200, v200
  v_mul_f32 v207, v207, v71
  v_mul_f32 v204, s40, v76
  v_mfma_f32_32x32x16_bf16 v[128:143], v[192:195], v[36:39], v[128:143]
  ds_read_b64_tr_b16 v[192:193], v6 offset:8192
  v_exp_f32 v203, v203
  v_add_f32 v202, 1.0, v202
  v_rcp_f32 v201, v201
  v_mfma_f32_32x32x16_bf16 v[112:127], v[196:199], v[40:43], v[112:127]
  ds_read_b64_tr_b16 v[194:195], v6 offset:8704
  v_mul_f32 v200, v200, v72
  v_cvt_pk_bf16_f32 v67, v206, v207
  buffer_store_dwordx4 v[64:67], v12, s[8:11], s38 offen offset:0 sc1
  v_mfma_f32_32x32x16_bf16 v[128:143], v[196:199], v[44:47], v[128:143]
  ds_read_b64_tr_b16 v[196:197], v6 offset:10240
  v_mul_f32 v205, s40, v77
  v_exp_f32 v204, v204
  v_add_f32 v203, 1.0, v203
  s_waitcnt lgkmcnt(7)
  v_mfma_f32_32x32x16_bf16 v[144:159], v[176:179], a[0:3], 0
  ds_read_b64_tr_b16 v[198:199], v6 offset:10752
  v_rcp_f32 v202, v202
  v_mul_f32 v201, v201, v73
  v_mul_f32 v206, s40, v78
  v_mfma_f32_32x32x16_bf16 v[160:175], v[176:179], a[4:7], 0
  ds_read_b64_tr_b16 v[176:177], v6 offset:12288
  v_exp_f32 v205, v205
  v_add_f32 v204, 1.0, v204
  v_rcp_f32 v203, v203
  v_mfma_f32_32x32x16_bf16 v[144:159], v[180:183], a[8:11], v[144:159]
  ds_read_b64_tr_b16 v[178:179], v6 offset:12800
  v_mul_f32 v202, v202, v74
  v_cvt_pk_bf16_f32 v72, v200, v201
  v_mul_f32 v207, s40, v79
  v_exp_f32 v206, v206
  v_mfma_f32_32x32x16_bf16 v[160:175], v[180:183], a[12:15], v[160:175]
  ds_read_b64_tr_b16 v[180:181], v6 offset:14336
  v_add_f32 v205, 1.0, v205
  v_rcp_f32 v204, v204
  v_mul_f32 v203, v203, v75
  s_waitcnt lgkmcnt(7)
  v_mfma_f32_32x32x16_bf16 v[144:159], v[184:187], a[16:19], v[144:159]
  ds_read_b64_tr_b16 v[182:183], v6 offset:14848
  v_exp_f32 v207, v207
  v_add_f32 v206, 1.0, v206
  v_rcp_f32 v205, v205
  v_mfma_f32_32x32x16_bf16 v[160:175], v[184:187], a[20:23], v[160:175]
  ds_read_b64_tr_b16 v[184:185], v6 offset:16384
  v_mul_f32 v204, v204, v76
  v_cvt_pk_bf16_f32 v73, v202, v203
  v_add_f32 v207, 1.0, v207
  v_rcp_f32 v206, v206
  v_mfma_f32_32x32x16_bf16 v[144:159], v[188:191], a[24:27], v[144:159]
  ds_read_b64_tr_b16 v[186:187], v6 offset:16896
  v_mul_f32 v205, v205, v77
  v_rcp_f32 v207, v207
  v_mul_f32 v206, v206, v78
  v_cvt_pk_bf16_f32 v74, v204, v205
  v_mfma_f32_32x32x16_bf16 v[160:175], v[188:191], a[28:31], v[160:175]
  ds_read_b64_tr_b16 v[188:189], v6 offset:18432
  v_mul_f32 v207, v207, v79
  v_cvt_pk_bf16_f32 v75, v206, v207
  s_waitcnt lgkmcnt(7)
  v_mfma_f32_32x32x16_bf16 v[144:159], v[192:195], a[32:35], v[144:159]
  ds_read_b64_tr_b16 v[190:191], v6 offset:18944
  buffer_store_dwordx4 v[72:75], v12, s[8:11], s38 offen offset:1024 sc1
  s_lshl_b32 s38, s34, 5
  s_add_u32 s38, s38, s37
  v_mfma_f32_32x32x16_bf16 v[160:175], v[192:195], a[36:39], v[160:175]
  ds_read_b64_tr_b16 v[192:193], v6 offset:20480
  v_mul_f32 v200, s40, v96
  v_mul_f32 v201, s40, v97
  v_exp_f32 v200, v200
  v_mul_f32 v202, s40, v98
  v_mfma_f32_32x32x16_bf16 v[144:159], v[196:199], a[40:43], v[144:159]
  ds_read_b64_tr_b16 v[194:195], v6 offset:20992
  v_exp_f32 v201, v201
  v_add_f32 v200, 1.0, v200
  v_mul_f32 v203, s40, v99
  v_mfma_f32_32x32x16_bf16 v[160:175], v[196:199], a[44:47], v[160:175]
  ds_read_b64_tr_b16 v[196:197], v6 offset:22528
  v_exp_f32 v202, v202
  v_add_f32 v201, 1.0, v201
  s_waitcnt lgkmcnt(7)
  v_mfma_f32_32x32x16_bf16 v[144:159], v[176:179], a[48:51], v[144:159]
  ds_read_b64_tr_b16 v[198:199], v6 offset:23040
  v_rcp_f32 v200, v200
  v_mul_f32 v204, s40, v100
  v_exp_f32 v203, v203
  v_mfma_f32_32x32x16_bf16 v[160:175], v[176:179], a[52:55], v[160:175]
  ds_read_b64_tr_b16 v[176:177], v6 offset:24576
  v_add_f32 v202, 1.0, v202
  v_rcp_f32 v201, v201
  v_mul_f32 v200, v200, v96
  v_mul_f32 v205, s40, v101
  v_mfma_f32_32x32x16_bf16 v[144:159], v[180:183], a[56:59], v[144:159]
  ds_read_b64_tr_b16 v[178:179], v6 offset:25088
  v_exp_f32 v204, v204
  v_add_f32 v203, 1.0, v203
  v_rcp_f32 v202, v202
  v_mfma_f32_32x32x16_bf16 v[160:175], v[180:183], a[60:63], v[160:175]
  ds_read_b64_tr_b16 v[180:181], v6 offset:26624
  v_mul_f32 v201, v201, v97
  v_mul_f32 v206, s40, v102
  v_exp_f32 v205, v205
  s_waitcnt lgkmcnt(7)
  v_mfma_f32_32x32x16_bf16 v[144:159], v[184:187], a[64:67], v[144:159]
  ds_read_b64_tr_b16 v[182:183], v6 offset:27136
  v_add_f32 v204, 1.0, v204
  v_rcp_f32 v203, v203
  v_mul_f32 v202, v202, v98
  v_cvt_pk_bf16_f32 v96, v200, v201
  v_mfma_f32_32x32x16_bf16 v[160:175], v[184:187], a[68:71], v[160:175]
  ds_read_b64_tr_b16 v[184:185], v6 offset:28672
  v_mul_f32 v207, s40, v103
  v_exp_f32 v206, v206
  v_add_f32 v205, 1.0, v205
  v_mfma_f32_32x32x16_bf16 v[144:159], v[188:191], a[72:75], v[144:159]
  ds_read_b64_tr_b16 v[186:187], v6 offset:29184
  v_rcp_f32 v204, v204
  v_mul_f32 v203, v203, v99
  v_mul_f32 v200, s40, v104
  v_mfma_f32_32x32x16_bf16 v[160:175], v[188:191], a[76:79], v[160:175]
  ds_read_b64_tr_b16 v[188:189], v6 offset:30720
  v_exp_f32 v207, v207
  v_add_f32 v206, 1.0, v206
  s_waitcnt lgkmcnt(7)
  v_mfma_f32_32x32x16_bf16 v[144:159], v[192:195], a[80:83], v[144:159]
  ds_read_b64_tr_b16 v[190:191], v6 offset:31232
  v_rcp_f32 v205, v205
  v_mul_f32 v204, v204, v100
  v_cvt_pk_bf16_f32 v97, v202, v203
  v_mul_f32 v201, s40, v105
  v_mfma_f32_32x32x16_bf16 v[160:175], v[192:195], a[84:87], v[160:175]
  ds_read_b64_tr_b16 v[192:193], v6 offset:32768
  v_exp_f32 v200, v200
  v_add_f32 v207, 1.0, v207
  v_rcp_f32 v206, v206
  v_mfma_f32_32x32x16_bf16 v[144:159], v[196:199], a[88:91], v[144:159]
  ds_read_b64_tr_b16 v[194:195], v6 offset:33280
  v_mul_f32 v205, v205, v101
  v_mul_f32 v202, s40, v106
  v_exp_f32 v201, v201
  v_add_f32 v200, 1.0, v200
  v_mfma_f32_32x32x16_bf16 v[160:175], v[196:199], a[92:95], v[160:175]
  ds_read_b64_tr_b16 v[196:197], v6 offset:34816
  v_rcp_f32 v207, v207
  v_mul_f32 v206, v206, v102
  v_cvt_pk_bf16_f32 v98, v204, v205
  s_waitcnt lgkmcnt(7)
  v_mfma_f32_32x32x16_bf16 v[144:159], v[176:179], a[96:99], v[144:159]
  ds_read_b64_tr_b16 v[198:199], v6 offset:35328
  v_mul_f32 v203, s40, v107
  v_exp_f32 v202, v202
  v_add_f32 v201, 1.0, v201
  v_mfma_f32_32x32x16_bf16 v[160:175], v[176:179], a[100:103], v[160:175]
  v_add_u32 v6, 0x9000, v6
  ds_read_b64_tr_b16 v[176:177], v6 offset:0
  v_rcp_f32 v200, v200
  v_mul_f32 v207, v207, v103
  v_mul_f32 v204, s40, v108
  v_mfma_f32_32x32x16_bf16 v[144:159], v[180:183], a[104:107], v[144:159]
  ds_read_b64_tr_b16 v[178:179], v6 offset:512
  v_exp_f32 v203, v203
  v_add_f32 v202, 1.0, v202
  v_rcp_f32 v201, v201
  v_mfma_f32_32x32x16_bf16 v[160:175], v[180:183], a[108:111], v[160:175]
  ds_read_b64_tr_b16 v[180:181], v6 offset:2048
  v_mul_f32 v200, v200, v104
  v_cvt_pk_bf16_f32 v99, v206, v207
  s_waitcnt lgkmcnt(7)
  v_mfma_f32_32x32x16_bf16 v[144:159], v[184:187], a[112:115], v[144:159]
  ds_read_b64_tr_b16 v[182:183], v6 offset:2560
  buffer_store_dwordx4 v[96:99], v12, s[8:11], s38 offen offset:2048 sc1
  v_mul_f32 v205, s40, v109
  v_mfma_f32_32x32x16_bf16 v[160:175], v[184:187], a[116:119], v[160:175]
  ds_read_b64_tr_b16 v[184:185], v6 offset:4096
  v_exp_f32 v204, v204
  v_add_f32 v203, 1.0, v203
  v_rcp_f32 v202, v202
  v_mfma_f32_32x32x16_bf16 v[144:159], v[188:191], a[120:123], v[144:159]
  ds_read_b64_tr_b16 v[186:187], v6 offset:4608
  v_mul_f32 v201, v201, v105
  v_mul_f32 v206, s40, v110
  v_exp_f32 v205, v205
  v_add_f32 v204, 1.0, v204
  v_mfma_f32_32x32x16_bf16 v[160:175], v[188:191], a[124:127], v[160:175]
  ds_read_b64_tr_b16 v[188:189], v6 offset:6144
  v_rcp_f32 v203, v203
  v_mul_f32 v202, v202, v106
  v_cvt_pk_bf16_f32 v104, v200, v201
  s_waitcnt lgkmcnt(7)
  v_mfma_f32_32x32x16_bf16 v[144:159], v[192:195], a[128:131], v[144:159]
  ds_read_b64_tr_b16 v[190:191], v6 offset:6656
  v_mul_f32 v207, s40, v111
  v_exp_f32 v206, v206
  v_add_f32 v205, 1.0, v205
  v_mfma_f32_32x32x16_bf16 v[160:175], v[192:195], a[132:135], v[160:175]
  ds_read_b64_tr_b16 v[192:193], v6 offset:8192
  v_rcp_f32 v204, v204
  v_mul_f32 v203, v203, v107
  v_exp_f32 v207, v207
  v_mfma_f32_32x32x16_bf16 v[144:159], v[196:199], a[136:139], v[144:159]
  ds_read_b64_tr_b16 v[194:195], v6 offset:8704
  v_add_f32 v206, 1.0, v206
  v_rcp_f32 v205, v205
  v_mul_f32 v204, v204, v108
  v_cvt_pk_bf16_f32 v105, v202, v203
  v_mfma_f32_32x32x16_bf16 v[160:175], v[196:199], a[140:143], v[160:175]
  ds_read_b64_tr_b16 v[196:197], v6 offset:10240
  v_add_f32 v207, 1.0, v207
  v_rcp_f32 v206, v206
  v_mul_f32 v205, v205, v109
  s_waitcnt lgkmcnt(7)
  v_mfma_f32_32x32x16_bf16 v[144:159], v[176:179], a[144:147], v[144:159]
  ds_read_b64_tr_b16 v[198:199], v6 offset:10752
  v_rcp_f32 v207, v207
  v_mul_f32 v206, v206, v110
  v_cvt_pk_bf16_f32 v106, v204, v205
  v_mul_f32 v207, v207, v111
  v_mfma_f32_32x32x16_bf16 v[160:175], v[176:179], a[148:151], v[160:175]
  ds_read_b64_tr_b16 v[176:177], v6 offset:12288
  v_cvt_pk_bf16_f32 v107, v206, v207
  buffer_store_dwordx4 v[104:107], v12, s[8:11], s38 offen offset:3072 sc1
  s_lshl_b32 s38, s35, 5
  v_mfma_f32_32x32x16_bf16 v[144:159], v[180:183], a[152:155], v[144:159]
  ds_read_b64_tr_b16 v[178:179], v6 offset:12800
  s_add_u32 s38, s38, s37
  v_mul_f32 v200, s40, v112
  v_mul_f32 v201, s40, v113
  v_exp_f32 v200, v200
  v_mfma_f32_32x32x16_bf16 v[160:175], v[180:183], a[156:159], v[160:175]
  ds_read_b64_tr_b16 v[180:181], v6 offset:14336
  v_mul_f32 v202, s40, v114
  v_exp_f32 v201, v201
  v_add_f32 v200, 1.0, v200
  s_waitcnt lgkmcnt(7)
  v_mfma_f32_32x32x16_bf16 v[144:159], v[184:187], a[160:163], v[144:159]
  ds_read_b64_tr_b16 v[182:183], v6 offset:14848
  v_mul_f32 v203, s40, v115
  v_exp_f32 v202, v202
  v_add_f32 v201, 1.0, v201
  v_mfma_f32_32x32x16_bf16 v[160:175], v[184:187], a[164:167], v[160:175]
  ds_read_b64_tr_b16 v[184:185], v6 offset:16384
  v_rcp_f32 v200, v200
  v_mul_f32 v204, s40, v116
  v_exp_f32 v203, v203
  v_mfma_f32_32x32x16_bf16 v[144:159], v[188:191], a[168:171], v[144:159]
  ds_read_b64_tr_b16 v[186:187], v6 offset:16896
  v_add_f32 v202, 1.0, v202
  v_rcp_f32 v201, v201
  v_mul_f32 v200, v200, v112
  v_mul_f32 v205, s40, v117
  v_mfma_f32_32x32x16_bf16 v[160:175], v[188:191], a[172:175], v[160:175]
  ds_read_b64_tr_b16 v[188:189], v6 offset:18432
  v_exp_f32 v204, v204
  v_add_f32 v203, 1.0, v203
  s_waitcnt lgkmcnt(7)
  v_mfma_f32_32x32x16_bf16 v[144:159], v[192:195], a[176:179], v[144:159]
  ds_read_b64_tr_b16 v[190:191], v6 offset:18944
  v_rcp_f32 v202, v202
  v_mul_f32 v201, v201, v113
  v_mul_f32 v206, s40, v118
  v_mfma_f32_32x32x16_bf16 v[160:175], v[192:195], a[180:183], v[160:175]
  ds_read_b64_tr_b16 v[192:193], v6 offset:20480
  v_exp_f32 v205, v205
  v_add_f32 v204, 1.0, v204
  v_rcp_f32 v203, v203
  v_mfma_f32_32x32x16_bf16 v[144:159], v[196:199], a[184:187], v[144:159]
  ds_read_b64_tr_b16 v[194:195], v6 offset:20992
  v_mul_f32 v202, v202, v114
  v_cvt_pk_bf16_f32 v112, v200, v201
  v_mul_f32 v207, s40, v119
  v_exp_f32 v206, v206
  v_mfma_f32_32x32x16_bf16 v[160:175], v[196:199], a[188:191], v[160:175]
  ds_read_b64_tr_b16 v[196:197], v6 offset:22528
  v_add_f32 v205, 1.0, v205
  v_rcp_f32 v204, v204
  v_mul_f32 v203, v203, v115
  s_waitcnt lgkmcnt(7)
  v_mfma_f32_32x32x16_bf16 v[144:159], v[176:179], a[192:195], v[144:159]
  ds_read_b64_tr_b16 v[198:199], v6 offset:23040
  v_mul_f32 v200, s40, v120
  v_exp_f32 v207, v207
  v_add_f32 v206, 1.0, v206
  v_mfma_f32_32x32x16_bf16 v[160:175], v[176:179], a[196:199], v[160:175]
  ds_read_b64_tr_b16 v[176:177], v6 offset:24576
  v_rcp_f32 v205, v205
  v_mul_f32 v204, v204, v116
  v_cvt_pk_bf16_f32 v113, v202, v203
  v_mul_f32 v201, s40, v121
  v_mfma_f32_32x32x16_bf16 v[144:159], v[180:183], a[200:203], v[144:159]
  ds_read_b64_tr_b16 v[178:179], v6 offset:25088
  v_exp_f32 v200, v200
  v_add_f32 v207, 1.0, v207
  v_rcp_f32 v206, v206
  v_mfma_f32_32x32x16_bf16 v[160:175], v[180:183], a[204:207], v[160:175]
  ds_read_b64_tr_b16 v[180:181], v6 offset:26624
  v_mul_f32 v205, v205, v117
  v_mul_f32 v202, s40, v122
  v_exp_f32 v201, v201
  s_waitcnt lgkmcnt(7)
  v_mfma_f32_32x32x16_bf16 v[144:159], v[184:187], a[208:211], v[144:159]
  ds_read_b64_tr_b16 v[182:183], v6 offset:27136
  v_add_f32 v200, 1.0, v200
  v_rcp_f32 v207, v207
  v_mul_f32 v206, v206, v118
  v_cvt_pk_bf16_f32 v114, v204, v205
  v_mfma_f32_32x32x16_bf16 v[160:175], v[184:187], a[212:215], v[160:175]
  ds_read_b64_tr_b16 v[184:185], v6 offset:28672
  v_mul_f32 v203, s40, v123
  v_exp_f32 v202, v202
  v_add_f32 v201, 1.0, v201
  v_mfma_f32_32x32x16_bf16 v[144:159], v[188:191], a[216:219], v[144:159]
  ds_read_b64_tr_b16 v[186:187], v6 offset:29184
  v_rcp_f32 v200, v200
  v_mul_f32 v207, v207, v119
  v_mul_f32 v204, s40, v124
  v_mfma_f32_32x32x16_bf16 v[160:175], v[188:191], a[220:223], v[160:175]
  ds_read_b64_tr_b16 v[188:189], v6 offset:30720
  v_exp_f32 v203, v203
  v_add_f32 v202, 1.0, v202
  s_waitcnt lgkmcnt(7)
  v_mfma_f32_32x32x16_bf16 v[144:159], v[192:195], a[224:227], v[144:159]
  ds_read_b64_tr_b16 v[190:191], v6 offset:31232
  v_rcp_f32 v201, v201
  v_mul_f32 v200, v200, v120
  v_cvt_pk_bf16_f32 v115, v206, v207
  v_mfma_f32_32x32x16_bf16 v[160:175], v[192:195], a[228:231], v[160:175]
  ds_read_b64_tr_b16 v[192:193], v6 offset:32768
  buffer_store_dwordx4 v[112:115], v11, s[8:11], s38 offen offset:0 sc1
  v_mul_f32 v205, s40, v125
  v_mfma_f32_32x32x16_bf16 v[144:159], v[196:199], a[232:235], v[144:159]
  ds_read_b64_tr_b16 v[194:195], v6 offset:33280
  v_exp_f32 v204, v204
  v_add_f32 v203, 1.0, v203
  v_rcp_f32 v202, v202
  v_mfma_f32_32x32x16_bf16 v[160:175], v[196:199], a[236:239], v[160:175]
  ds_read_b64_tr_b16 v[196:197], v6 offset:34816
  v_mul_f32 v201, v201, v121
  v_mul_f32 v206, s40, v126
  v_exp_f32 v205, v205
  s_waitcnt lgkmcnt(7)
  v_mfma_f32_32x32x16_bf16 v[144:159], v[176:179], a[240:243], v[144:159]
  ds_read_b64_tr_b16 v[198:199], v6 offset:35328
  v_add_f32 v204, 1.0, v204
  v_rcp_f32 v203, v203
  v_mul_f32 v202, v202, v122
  v_cvt_pk_bf16_f32 v120, v200, v201
  v_mfma_f32_32x32x16_bf16 v[160:175], v[176:179], a[244:247], v[160:175]
  s_waitcnt vmcnt(5)
  s_waitcnt lgkmcnt(0)
  s_barrier
  v_add_u32 v5, 0xfffe5000, v5
  ds_read_b64_tr_b16 v[176:177], v5 offset:0
  v_mul_f32 v207, s40, v127
  v_mfma_f32_32x32x16_bf16 v[144:159], v[180:183], a[248:251], v[144:159]
  ds_read_b64_tr_b16 v[178:179], v5 offset:512
  v_exp_f32 v206, v206
  v_add_f32 v205, 1.0, v205
  v_rcp_f32 v204, v204
  v_mfma_f32_32x32x16_bf16 v[160:175], v[180:183], a[252:255], v[160:175]
  ds_read_b64_tr_b16 v[180:181], v5 offset:2048
  v_mul_f32 v203, v203, v123
  v_mul_f32 v200, s40, v128
  v_exp_f32 v207, v207
  v_add_f32 v206, 1.0, v206
  v_mfma_f32_32x32x16_bf16 v[144:159], v[184:187], v[16:19], v[144:159]
  ds_read_b64_tr_b16 v[182:183], v5 offset:2560
  v_rcp_f32 v205, v205
  v_mul_f32 v204, v204, v124
  v_cvt_pk_bf16_f32 v121, v202, v203
  v_mul_f32 v201, s40, v129
  v_mfma_f32_32x32x16_bf16 v[160:175], v[184:187], v[20:23], v[160:175]
  ds_read_b64_tr_b16 v[184:185], v5 offset:4096
  v_exp_f32 v200, v200
  v_add_f32 v207, 1.0, v207
  v_rcp_f32 v206, v206
  v_mfma_f32_32x32x16_bf16 v[144:159], v[188:191], v[24:27], v[144:159]
  ds_read_b64_tr_b16 v[186:187], v5 offset:4608
  v_mul_f32 v205, v205, v125
  v_mul_f32 v202, s40, v130
  v_exp_f32 v201, v201
  v_add_f32 v200, 1.0, v200
  v_mfma_f32_32x32x16_bf16 v[160:175], v[188:191], v[28:31], v[160:175]
  ds_read_b64_tr_b16 v[188:189], v5 offset:6144
  v_rcp_f32 v207, v207
  v_mul_f32 v206, v206, v126
  v_cvt_pk_bf16_f32 v122, v204, v205
  v_mul_f32 v203, s40, v131
  v_mfma_f32_32x32x16_bf16 v[144:159], v[192:195], v[32:35], v[144:159]
  ds_read_b64_tr_b16 v[190:191], v5 offset:6656
  v_exp_f32 v202, v202
  v_add_f32 v201, 1.0, v201
  v_rcp_f32 v200, v200
  v_mfma_f32_32x32x16_bf16 v[160:175], v[192:195], v[36:39], v[160:175]
  ds_read_b64_tr_b16 v[192:193], v5 offset:8192
  v_mul_f32 v207, v207, v127
  v_mul_f32 v204, s40, v132
  v_exp_f32 v203, v203
  v_add_f32 v202, 1.0, v202
  v_mfma_f32_32x32x16_bf16 v[144:159], v[196:199], v[40:43], v[144:159]
  ds_read_b64_tr_b16 v[194:195], v5 offset:8704
  v_rcp_f32 v201, v201
  v_mul_f32 v200, v200, v128
  v_cvt_pk_bf16_f32 v123, v206, v207
  v_mfma_f32_32x32x16_bf16 v[160:175], v[196:199], v[44:47], v[160:175]
  ds_read_b64_tr_b16 v[196:197], v5 offset:10240
  s_cmp_eq_u32 s48, 4
  s_cbranch_scc1 AS0
  s_mov_b32 s54, 0x3fffffff
  s_mov_b32 s12, 327680
  s_waitcnt lgkmcnt(7)
  v_mfma_f32_32x32x16_bf16 v[48:63], v[176:179], a[0:3], 0
  ds_read_b64_tr_b16 v[198:199], v5 offset:10752
  s_lshl_b32 s3, s46, 12
  s_add_u32 s12, s12, s3
  buffer_store_dwordx4 v[120:123], v11, s[8:11], s38 offen offset:1024 sc1
  v_mfma_f32_32x32x16_bf16 v[64:79], v[176:179], a[4:7], 0
  ds_read_b64_tr_b16 v[176:177], v5 offset:12288
  v_mul_f32 v205, s40, v133
  v_exp_f32 v204, v204
  v_add_f32 v203, 1.0, v203
  v_mfma_f32_32x32x16_bf16 v[48:63], v[180:183], a[8:11], v[48:63]
  ds_read_b64_tr_b16 v[178:179], v5 offset:12800
  v_and_b32 v14, 31, v0
  v_lshrrev_b32 v15, v14, s54
  v_and_b32 v15, 1, v15
  v_xor_b32 v15, 1, v15
  v_lshlrev_b32 v9, 7, v14
  v_lshl_add_u32 v9, v15, 30, v9
  v_mfma_f32_32x32x16_bf16 v[64:79], v[180:183], a[12:15], v[64:79]
  ds_read_b64_tr_b16 v[180:181], v5 offset:14336
  s_add_u32 m0, s51, 73728
  v_rcp_f32 v202, v202
  v_mul_f32 v201, v201, v129
  s_waitcnt lgkmcnt(7)
  v_mfma_f32_32x32x16_bf16 v[48:63], v[184:187], a[16:19], v[48:63]
  ds_read_b64_tr_b16 v[182:183], v5 offset:14848
  v_mul_f32 v206, s40, v134
  v_exp_f32 v205, v205
  v_add_f32 v204, 1.0, v204
  v_mfma_f32_32x32x16_bf16 v[64:79], v[184:187], a[20:23], v[64:79]
  ds_read_b64_tr_b16 v[184:185], v5 offset:16384
  v_rcp_f32 v203, v203
  v_mul_f32 v202, v202, v130
  v_cvt_pk_bf16_f32 v128, v200, v201
  v_mul_f32 v207, s40, v135
  v_mfma_f32_32x32x16_bf16 v[48:63], v[188:191], a[24:27], v[48:63]
  ds_read_b64_tr_b16 v[186:187], v5 offset:16896
  buffer_load_dwordx4 v253, s[24:27], s49 offen offset:0 sc1 lds
  v_exp_f32 v206, v206
  v_add_f32 v205, 1.0, v205
  v_mfma_f32_32x32x16_bf16 v[64:79], v[188:191], a[28:31], v[64:79]
  ds_read_b64_tr_b16 v[188:189], v5 offset:18432
  v_rcp_f32 v204, v204
  v_mul_f32 v203, v203, v131
  v_mul_f32 v200, s40, v136
  s_waitcnt lgkmcnt(7)
  v_mfma_f32_32x32x16_bf16 v[48:63], v[192:195], a[32:35], v[48:63]
  ds_read_b64_tr_b16 v[190:191], v5 offset:18944
  v_exp_f32 v207, v207
  v_add_f32 v206, 1.0, v206
  v_rcp_f32 v205, v205
  v_mfma_f32_32x32x16_bf16 v[64:79], v[192:195], a[36:39], v[64:79]
  ds_read_b64_tr_b16 v[192:193], v5 offset:20480
  buffer_load_dwordx4 v254, s[24:27], s49 offen offset:1024 sc1 lds
  v_mul_f32 v204, v204, v132
  v_cvt_pk_bf16_f32 v129, v202, v203
  v_mul_f32 v201, s40, v137
  v_mfma_f32_32x32x16_bf16 v[48:63], v[196:199], a[40:43], v[48:63]
  ds_read_b64_tr_b16 v[194:195], v5 offset:20992
  v_exp_f32 v200, v200
  v_add_f32 v207, 1.0, v207
  v_rcp_f32 v206, v206
  v_mfma_f32_32x32x16_bf16 v[64:79], v[196:199], a[44:47], v[64:79]
  ds_read_b64_tr_b16 v[196:197], v5 offset:22528
  v_mul_f32 v205, v205, v133
  v_mul_f32 v202, s40, v138
  v_exp_f32 v201, v201
  s_waitcnt lgkmcnt(7)
  v_mfma_f32_32x32x16_bf16 v[48:63], v[176:179], a[48:51], v[48:63]
  ds_read_b64_tr_b16 v[198:199], v5 offset:23040
  buffer_load_dwordx4 v255, s[24:27], s49 offen offset:2048 sc1 lds
  s_add_u32 s49, s49, s50
  v_add_f32 v200, 1.0, v200
  v_mfma_f32_32x32x16_bf16 v[64:79], v[176:179], a[52:55], v[64:79]
  ds_read_b64_tr_b16 v[176:177], v5 offset:24576
  v_rcp_f32 v207, v207
  v_mul_f32 v206, v206, v134
  v_cvt_pk_bf16_f32 v130, v204, v205
  v_mul_f32 v203, s40, v139
  v_mfma_f32_32x32x16_bf16 v[48:63], v[180:183], a[56:59], v[48:63]
  ds_read_b64_tr_b16 v[178:179], v5 offset:25088
  s_add_u32 m0, s51, 76800
  v_exp_f32 v202, v202
  v_add_f32 v201, 1.0, v201
  v_mfma_f32_32x32x16_bf16 v[64:79], v[180:183], a[60:63], v[64:79]
  ds_read_b64_tr_b16 v[180:181], v5 offset:26624
  v_rcp_f32 v200, v200
  v_mul_f32 v207, v207, v135
  v_mul_f32 v204, s40, v140
  s_waitcnt lgkmcnt(7)
  v_mfma_f32_32x32x16_bf16 v[48:63], v[184:187], a[64:67], v[48:63]
  ds_read_b64_tr_b16 v[182:183], v5 offset:27136
  v_exp_f32 v203, v203
  v_add_f32 v202, 1.0, v202
  v_rcp_f32 v201, v201
  v_mfma_f32_32x32x16_bf16 v[64:79], v[184:187], a[68:71], v[64:79]
  ds_read_b64_tr_b16 v[184:185], v5 offset:28672
  buffer_load_dwordx4 v253, s[24:27], s49 offen offset:0 sc1 lds
  v_mul_f32 v200, v200, v136
  v_cvt_pk_bf16_f32 v131, v206, v207
  v_mfma_f32_32x32x16_bf16 v[48:63], v[188:191], a[72:75], v[48:63]
  ds_read_b64_tr_b16 v[186:187], v5 offset:29184
  buffer_store_dwordx4 v[128:131], v12, s[8:11], s38 offen offset:0 sc1
  v_mul_f32 v205, s40, v141
  v_mfma_f32_32x32x16_bf16 v[64:79], v[188:191], a[76:79], v[64:79]
  ds_read_b64_tr_b16 v[188:189], v5 offset:30720
  v_exp_f32 v204, v204
  v_add_f32 v203, 1.0, v203
  s_waitcnt lgkmcnt(7)
  v_mfma_f32_32x32x16_bf16 v[48:63], v[192:195], a[80:83], v[48:63]
  ds_read_b64_tr_b16 v[190:191], v5 offset:31232
  buffer_load_dwordx4 v254, s[24:27], s49 offen offset:1024 sc1 lds
  v_rcp_f32 v202, v202
  v_mul_f32 v201, v201, v137
  v_mfma_f32_32x32x16_bf16 v[64:79], v[192:195], a[84:87], v[64:79]
  ds_read_b64_tr_b16 v[192:193], v5 offset:32768
  v_mul_f32 v206, s40, v142
  v_exp_f32 v205, v205
  v_add_f32 v204, 1.0, v204
  v_mfma_f32_32x32x16_bf16 v[48:63], v[196:199], a[88:91], v[48:63]
  ds_read_b64_tr_b16 v[194:195], v5 offset:33280
  v_rcp_f32 v203, v203
  v_mul_f32 v202, v202, v138
  v_cvt_pk_bf16_f32 v136, v200, v201
  v_mul_f32 v207, s40, v143
  v_mfma_f32_32x32x16_bf16 v[64:79], v[196:199], a[92:95], v[64:79]
  ds_read_b64_tr_b16 v[196:197], v5 offset:34816
  buffer_load_dwordx4 v255, s[24:27], s49 offen offset:2048 sc1 lds
  s_add_u32 s49, s49, s50
  s_waitcnt lgkmcnt(7)
  v_mfma_f32_32x32x16_bf16 v[48:63], v[176:179], a[96:99], v[48:63]
  ds_read_b64_tr_b16 v[198:199], v5 offset:35328
  v_exp_f32 v206, v206
  v_add_f32 v205, 1.0, v205
  v_rcp_f32 v204, v204
  v_mfma_f32_32x32x16_bf16 v[64:79], v[176:179], a[100:103], v[64:79]
  v_add_u32 v5, 0x9000, v5
  ds_read_b64_tr_b16 v[176:177], v5 offset:0
  s_add_u32 m0, s51, 79872
  v_mul_f32 v203, v203, v139
  v_exp_f32 v207, v207
  v_mfma_f32_32x32x16_bf16 v[48:63], v[180:183], a[104:107], v[48:63]
  ds_read_b64_tr_b16 v[178:179], v5 offset:512
  v_add_f32 v206, 1.0, v206
  v_rcp_f32 v205, v205
  v_mul_f32 v204, v204, v140
  v_cvt_pk_bf16_f32 v137, v202, v203
  v_mfma_f32_32x32x16_bf16 v[64:79], v[180:183], a[108:111], v[64:79]
  ds_read_b64_tr_b16 v[180:181], v5 offset:2048
  v_add_f32 v207, 1.0, v207
  v_rcp_f32 v206, v206
  v_mul_f32 v205, v205, v141
  s_waitcnt lgkmcnt(7)
  v_mfma_f32_32x32x16_bf16 v[48:63], v[184:187], a[112:115], v[48:63]
  ds_read_b64_tr_b16 v[182:183], v5 offset:2560
  buffer_load_dwordx4 v253, s[24:27], s49 offen offset:0 sc1 lds
  v_rcp_f32 v207, v207
  v_mul_f32 v206, v206, v142
  v_mfma_f32_32x32x16_bf16 v[64:79], v[184:187], a[116:119], v[64:79]
  ds_read_b64_tr_b16 v[184:185], v5 offset:4096
  v_cvt_pk_bf16_f32 v138, v204, v205
  v_mul_f32 v207, v207, v143
  v_cvt_pk_bf16_f32 v139, v206, v207
  v_mfma_f32_32x32x16_bf16 v[48:63], v[188:191], a[120:123], v[48:63]
  ds_read_b64_tr_b16 v[186:187], v5 offset:4608
  buffer_store_dwordx4 v[136:139], v12, s[8:11], s38 offen offset:1024 sc1
  s_lshl_b32 s38, s35, 5
  s_add_u32 s38, s38, s37
  v_mfma_f32_32x32x16_bf16 v[64:79], v[188:191], a[124:127], v[64:79]
  ds_read_b64_tr_b16 v[188:189], v5 offset:6144
  buffer_load_dwordx4 v254, s[24:27], s49 offen offset:1024 sc1 lds
  v_mul_f32 v200, s40, v144
  v_mul_f32 v201, s40, v145
  s_waitcnt lgkmcnt(7)
  v_mfma_f32_32x32x16_bf16 v[48:63], v[192:195], a[128:131], v[48:63]
  ds_read_b64_tr_b16 v[190:191], v5 offset:6656
  v_exp_f32 v200, v200
  v_mul_f32 v202, s40, v146
  v_exp_f32 v201, v201
  v_mfma_f32_32x32x16_bf16 v[64:79], v[192:195], a[132:135], v[64:79]
  ds_read_b64_tr_b16 v[192:193], v5 offset:8192
  v_add_f32 v200, 1.0, v200
  v_mul_f32 v203, s40, v147
  v_exp_f32 v202, v202
  v_add_f32 v201, 1.0, v201
  v_mfma_f32_32x32x16_bf16 v[48:63], v[196:199], a[136:139], v[48:63]
  ds_read_b64_tr_b16 v[194:195], v5 offset:8704
  buffer_load_dwordx4 v255, s[24:27], s49 offen offset:2048 sc1 lds
  s_add_u32 s49, s49, s50
  v_rcp_f32 v200, v200
  v_mfma_f32_32x32x16_bf16 v[64:79], v[196:199], a[140:143], v[64:79]
  ds_read_b64_tr_b16 v[196:197], v5 offset:10240
  v_mul_f32 v204, s40, v148
  v_exp_f32 v203, v203
  v_add_f32 v202, 1.0, v202
  s_waitcnt lgkmcnt(7)
  v_mfma_f32_32x32x16_bf16 v[48:63], v[176:179], a[144:147], v[48:63]
  ds_read_b64_tr_b16 v[198:199], v5 offset:10752
  s_add_u32 m0, s51, 82944
  v_rcp_f32 v201, v201
  v_mul_f32 v200, v200, v144
  v_mul_f32 v205, s40, v149
  v_mfma_f32_32x32x16_bf16 v[64:79], v[176:179], a[148:151], v[64:79]
  ds_read_b64_tr_b16 v[176:177], v5 offset:12288
  v_exp_f32 v204, v204
  v_add_f32 v203, 1.0, v203
  v_rcp_f32 v202, v202
  v_mfma_f32_32x32x16_bf16 v[48:63], v[180:183], a[152:155], v[48:63]
  ds_read_b64_tr_b16 v[178:179], v5 offset:12800
  v_mul_f32 v201, v201, v145
  v_mul_f32 v206, s40, v150
  v_exp_f32 v205, v205
  v_add_f32 v204, 1.0, v204
  v_mfma_f32_32x32x16_bf16 v[64:79], v[180:183], a[156:159], v[64:79]
  ds_read_b64_tr_b16 v[180:181], v5 offset:14336
  buffer_load_dwordx4 v253, s[24:27], s49 offen offset:0 sc1 lds
  v_rcp_f32 v203, v203
  s_waitcnt lgkmcnt(7)
  v_mfma_f32_32x32x16_bf16 v[48:63], v[184:187], a[160:163], v[48:63]
  ds_read_b64_tr_b16 v[182:183], v5 offset:14848
  v_mul_f32 v202, v202, v146
  v_cvt_pk_bf16_f32 v144, v200, v201
  v_mul_f32 v207, s40, v151
  v_exp_f32 v206, v206
  v_mfma_f32_32x32x16_bf16 v[64:79], v[184:187], a[164:167], v[64:79]
  ds_read_b64_tr_b16 v[184:185], v5 offset:16384
  v_add_f32 v205, 1.0, v205
  v_rcp_f32 v204, v204
  v_mul_f32 v203, v203, v147
  v_mul_f32 v200, s40, v152
  v_mfma_f32_32x32x16_bf16 v[48:63], v[188:191], a[168:171], v[48:63]
  ds_read_b64_tr_b16 v[186:187], v5 offset:16896
  buffer_load_dwordx4 v254, s[24:27], s49 offen offset:1024 sc1 lds
  v_exp_f32 v207, v207
  v_add_f32 v206, 1.0, v206
  v_mfma_f32_32x32x16_bf16 v[64:79], v[188:191], a[172:175], v[64:79]
  ds_read_b64_tr_b16 v[188:189], v5 offset:18432
  v_rcp_f32 v205, v205
  v_mul_f32 v204, v204, v148
  v_cvt_pk_bf16_f32 v145, v202, v203
  s_waitcnt lgkmcnt(7)
  v_mfma_f32_32x32x16_bf16 v[48:63], v[192:195], a[176:179], v[48:63]
  ds_read_b64_tr_b16 v[190:191], v5 offset:18944
  v_mul_f32 v201, s40, v153
  v_exp_f32 v200, v200
  v_add_f32 v207, 1.0, v207
  v_mfma_f32_32x32x16_bf16 v[64:79], v[192:195], a[180:183], v[64:79]
  ds_read_b64_tr_b16 v[192:193], v5 offset:20480
  buffer_load_dwordx4 v255, s[24:27], s49 offen offset:2048 sc1 lds
  s_add_u32 s49, s49, s50
  v_rcp_f32 v206, v206
  v_mfma_f32_32x32x16_bf16 v[48:63], v[196:199], a[184:187], v[48:63]
  ds_read_b64_tr_b16 v[194:195], v5 offset:20992
  v_mul_f32 v205, v205, v149
  v_mul_f32 v202, s40, v154
  v_exp_f32 v201, v201
  v_add_f32 v200, 1.0, v200
  v_mfma_f32_32x32x16_bf16 v[64:79], v[196:199], a[188:191], v[64:79]
  ds_read_b64_tr_b16 v[196:197], v5 offset:22528
  s_add_u32 m0, s51, 86016
  v_rcp_f32 v207, v207
  v_mul_f32 v206, v206, v150
  s_waitcnt lgkmcnt(7)
  v_mfma_f32_32x32x16_bf16 v[48:63], v[176:179], a[192:195], v[48:63]
  ds_read_b64_tr_b16 v[198:199], v5 offset:23040
  v_cvt_pk_bf16_f32 v146, v204, v205
  v_mul_f32 v203, s40, v155
  v_exp_f32 v202, v202
  v_add_f32 v201, 1.0, v201
  v_mfma_f32_32x32x16_bf16 v[64:79], v[176:179], a[196:199], v[64:79]
  ds_read_b64_tr_b16 v[176:177], v5 offset:24576
  v_rcp_f32 v200, v200
  v_mul_f32 v207, v207, v151
  v_mul_f32 v204, s40, v156
  v_mfma_f32_32x32x16_bf16 v[48:63], v[180:183], a[200:203], v[48:63]
  ds_read_b64_tr_b16 v[178:179], v5 offset:25088
  buffer_load_dwordx4 v253, s[24:27], s49 offen offset:0 sc1 lds
  v_exp_f32 v203, v203
  v_add_f32 v202, 1.0, v202
  v_mfma_f32_32x32x16_bf16 v[64:79], v[180:183], a[204:207], v[64:79]
  ds_read_b64_tr_b16 v[180:181], v5 offset:26624
  v_rcp_f32 v201, v201
  v_mul_f32 v200, v200, v152
  v_cvt_pk_bf16_f32 v147, v206, v207
  s_waitcnt lgkmcnt(7)
  v_mfma_f32_32x32x16_bf16 v[48:63], v[184:187], a[208:211], v[48:63]
  ds_read_b64_tr_b16 v[182:183], v5 offset:27136
  buffer_store_dwordx4 v[144:147], v11, s[8:11], s38 offen offset:2048 sc1
  v_mul_f32 v205, s40, v157
  v_mfma_f32_32x32x16_bf16 v[64:79], v[184:187], a[212:215], v[64:79]
  ds_read_b64_tr_b16 v[184:185], v5 offset:28672
  buffer_load_dwordx4 v254, s[24:27], s49 offen offset:1024 sc1 lds
  v_exp_f32 v204, v204
  v_add_f32 v203, 1.0, v203
  v_mfma_f32_32x32x16_bf16 v[48:63], v[188:191], a[216:219], v[48:63]
  ds_read_b64_tr_b16 v[186:187], v5 offset:29184
  v_rcp_f32 v202, v202
  v_mul_f32 v201, v201, v153
  v_mul_f32 v206, s40, v158
  v_mfma_f32_32x32x16_bf16 v[64:79], v[188:191], a[220:223], v[64:79]
  ds_read_b64_tr_b16 v[188:189], v5 offset:30720
  v_exp_f32 v205, v205
  v_add_f32 v204, 1.0, v204
  s_waitcnt lgkmcnt(7)
  v_mfma_f32_32x32x16_bf16 v[48:63], v[192:195], a[224:227], v[48:63]
  ds_read_b64_tr_b16 v[190:191], v5 offset:31232
  buffer_load_dwordx4 v255, s[24:27], s49 offen offset:2048 sc1 lds
  s_add_u32 s49, s49, s50
  v_rcp_f32 v203, v203
  v_mfma_f32_32x32x16_bf16 v[64:79], v[192:195], a[228:231], v[64:79]
  ds_read_b64_tr_b16 v[192:193], v5 offset:32768
  v_mul_f32 v202, v202, v154
  v_cvt_pk_bf16_f32 v152, v200, v201
  v_mul_f32 v207, s40, v159
  v_exp_f32 v206, v206
  v_mfma_f32_32x32x16_bf16 v[48:63], v[196:199], a[232:235], v[48:63]
  ds_read_b64_tr_b16 v[194:195], v5 offset:33280
  s_add_u32 m0, s51, 89088
  v_add_f32 v205, 1.0, v205
  v_rcp_f32 v204, v204
  v_mul_f32 v203, v203, v155
  v_mfma_f32_32x32x16_bf16 v[64:79], v[196:199], a[236:239], v[64:79]
  ds_read_b64_tr_b16 v[196:197], v5 offset:34816
  v_mul_f32 v200, s40, v160
  v_exp_f32 v207, v207
  v_add_f32 v206, 1.0, v206
  s_waitcnt lgkmcnt(7)
  v_mfma_f32_32x32x16_bf16 v[48:63], v[176:179], a[240:243], v[48:63]
  ds_read_b64_tr_b16 v[198:199], v5 offset:35328
  v_rcp_f32 v205, v205
  v_mul_f32 v204, v204, v156
  v_cvt_pk_bf16_f32 v153, v202, v203
  v_mul_f32 v201, s40, v161
  v_mfma_f32_32x32x16_bf16 v[64:79], v[176:179], a[244:247], v[64:79]
  v_add_u32 v6, 0xfffe5000, v6
  ds_read_b64_tr_b16 v[176:177], v6 offset:0
  buffer_load_dwordx4 v253, s[24:27], s49 offen offset:0 sc1 lds
  v_exp_f32 v200, v200
  v_mfma_f32_32x32x16_bf16 v[48:63], v[180:183], a[248:251], v[48:63]
  ds_read_b64_tr_b16 v[178:179], v6 offset:512
  v_add_f32 v207, 1.0, v207
  v_rcp_f32 v206, v206
  v_mul_f32 v205, v205, v157
  v_mul_f32 v202, s40, v162
  v_mfma_f32_32x32x16_bf16 v[64:79], v[180:183], a[252:255], v[64:79]
  ds_read_b64_tr_b16 v[180:181], v6 offset:2048
  v_exp_f32 v201, v201
  v_add_f32 v200, 1.0, v200
  s_waitcnt lgkmcnt(7)
  v_mfma_f32_32x32x16_bf16 v[48:63], v[184:187], v[16:19], v[48:63]
  ds_read_b64_tr_b16 v[182:183], v6 offset:2560
  buffer_load_dwordx4 v254, s[24:27], s49 offen offset:1024 sc1 lds
  v_rcp_f32 v207, v207
  v_mul_f32 v206, v206, v158
  v_mfma_f32_32x32x16_bf16 v[64:79], v[184:187], v[20:23], v[64:79]
  ds_read_b64_tr_b16 v[184:185], v6 offset:4096
  v_cvt_pk_bf16_f32 v154, v204, v205
  v_mul_f32 v203, s40, v163
  v_exp_f32 v202, v202
  v_add_f32 v201, 1.0, v201
  v_mfma_f32_32x32x16_bf16 v[48:63], v[188:191], v[24:27], v[48:63]
  ds_read_b64_tr_b16 v[186:187], v6 offset:4608
  v_rcp_f32 v200, v200
  v_mul_f32 v207, v207, v159
  v_mul_f32 v204, s40, v164
  v_mfma_f32_32x32x16_bf16 v[64:79], v[188:191], v[28:31], v[64:79]
  ds_read_b64_tr_b16 v[188:189], v6 offset:6144
  buffer_load_dwordx4 v255, s[24:27], s49 offen offset:2048 sc1 lds
  s_add_u32 s49, s49, s50
  s_waitcnt lgkmcnt(7)
  v_mfma_f32_32x32x16_bf16 v[48:63], v[192:195], v[32:35], v[48:63]
  ds_read_b64_tr_b16 v[190:191], v6 offset:6656
  v_exp_f32 v203, v203
  v_add_f32 v202, 1.0, v202
  v_rcp_f32 v201, v201
  v_mfma_f32_32x32x16_bf16 v[64:79], v[192:195], v[36:39], v[64:79]
  ds_read_b64_tr_b16 v[192:193], v6 offset:8192
  v_mul_f32 v200, v200, v160
  v_cvt_pk_bf16_f32 v155, v206, v207
  buffer_store_dwordx4 v[152:155], v11, s[8:11], s38 offen offset:3072 sc1
  v_mfma_f32_32x32x16_bf16 v[48:63], v[196:199], v[40:43], v[48:63]
  ds_read_b64_tr_b16 v[194:195], v6 offset:8704
  v_mul_f32 v205, s40, v165
  v_exp_f32 v204, v204
  v_add_f32 v203, 1.0, v203
  v_mfma_f32_32x32x16_bf16 v[64:79], v[196:199], v[44:47], v[64:79]
  ds_read_b64_tr_b16 v[196:197], v6 offset:10240
  v_rcp_f32 v202, v202
  v_mul_f32 v201, v201, v161
  v_mul_f32 v206, s40, v166
  s_waitcnt lgkmcnt(7)
  v_mfma_f32_32x32x16_bf16 v[80:95], v[176:179], a[0:3], 0
  ds_read_b64_tr_b16 v[198:199], v6 offset:10752
  v_exp_f32 v205, v205
  v_add_f32 v204, 1.0, v204
  v_rcp_f32 v203, v203
  v_mfma_f32_32x32x16_bf16 v[96:111], v[176:179], a[4:7], 0
  ds_read_b64_tr_b16 v[176:177], v6 offset:12288
  v_mul_f32 v202, v202, v162
  v_cvt_pk_bf16_f32 v160, v200, v201
  v_mul_f32 v207, s40, v167
  v_exp_f32 v206, v206
  v_mfma_f32_32x32x16_bf16 v[80:95], v[180:183], a[8:11], v[80:95]
  ds_read_b64_tr_b16 v[178:179], v6 offset:12800
  v_add_f32 v205, 1.0, v205
  v_rcp_f32 v204, v204
  v_mul_f32 v203, v203, v163
  v_mul_f32 v200, s40, v168
  v_mfma_f32_32x32x16_bf16 v[96:111], v[180:183], a[12:15], v[96:111]
  ds_read_b64_tr_b16 v[180:181], v6 offset:14336
  v_exp_f32 v207, v207
  v_add_f32 v206, 1.0, v206
  s_waitcnt lgkmcnt(7)
  v_mfma_f32_32x32x16_bf16 v[80:95], v[184:187], a[16:19], v[80:95]
  ds_read_b64_tr_b16 v[182:183], v6 offset:14848
  s_waitcnt vmcnt(19)
  ds_read_b64_tr_b16 a[0:1], v251 offset:0
  ds_read_b64_tr_b16 a[2:3], v251 offset:1536
  v_rcp_f32 v205, v205
  v_mfma_f32_32x32x16_bf16 v[96:111], v[184:187], a[20:23], v[96:111]
  ds_read_b64_tr_b16 v[184:185], v6 offset:16384
  ds_read_b64_tr_b16 a[4:5], v251 offset:64
  ds_read_b64_tr_b16 a[6:7], v251 offset:1600
  v_mul_f32 v204, v204, v164
  v_cvt_pk_bf16_f32 v161, v202, v203
  v_mul_f32 v201, s40, v169
  v_mfma_f32_32x32x16_bf16 v[80:95], v[188:191], a[24:27], v[80:95]
  ds_read_b64_tr_b16 v[186:187], v6 offset:16896
  ds_read_b64_tr_b16 a[8:9], v251 offset:128
  ds_read_b64_tr_b16 a[10:11], v251 offset:1664
  v_exp_f32 v200, v200
  v_add_f32 v207, 1.0, v207
  v_mfma_f32_32x32x16_bf16 v[96:111], v[188:191], a[28:31], v[96:111]
  ds_read_b64_tr_b16 v[188:189], v6 offset:18432
  v_rcp_f32 v206, v206
  v_mul_f32 v205, v205, v165
  v_mul_f32 v202, s40, v170
  s_waitcnt lgkmcnt(13)
  v_mfma_f32_32x32x16_bf16 v[80:95], v[192:195], a[32:35], v[80:95]
  ds_read_b64_tr_b16 v[190:191], v6 offset:18944
  v_exp_f32 v201, v201
  v_add_f32 v200, 1.0, v200
  v_rcp_f32 v207, v207
  v_mfma_f32_32x32x16_bf16 v[96:111], v[192:195], a[36:39], v[96:111]
  ds_read_b64_tr_b16 v[192:193], v6 offset:20480
  s_waitcnt lgkmcnt(3)
  s_add_u32 m0, s51, 73728
  v_mul_f32 v206, v206, v166
  v_cvt_pk_bf16_f32 v162, v204, v205
  v_mul_f32 v203, s40, v171
  v_mfma_f32_32x32x16_bf16 v[80:95], v[196:199], a[40:43], v[80:95]
  ds_read_b64_tr_b16 v[194:195], v6 offset:20992
  v_exp_f32 v202, v202
  v_add_f32 v201, 1.0, v201
  v_rcp_f32 v200, v200
  v_mfma_f32_32x32x16_bf16 v[96:111], v[196:199], a[44:47], v[96:111]
  ds_read_b64_tr_b16 v[196:197], v6 offset:22528
  buffer_load_dwordx4 v253, s[24:27], s49 offen offset:0 sc1 lds
  v_mul_f32 v207, v207, v167
  v_mul_f32 v204, s40, v172
  v_mfma_f32_32x32x16_bf16 v[80:95], v[176:179], a[48:51], v[80:95]
  ds_read_b64_tr_b16 v[198:199], v6 offset:23040
  v_exp_f32 v203, v203
  v_add_f32 v202, 1.0, v202
  v_rcp_f32 v201, v201
  v_mfma_f32_32x32x16_bf16 v[96:111], v[176:179], a[52:55], v[96:111]
  ds_read_b64_tr_b16 v[176:177], v6 offset:24576
  buffer_load_dwordx4 v254, s[24:27], s49 offen offset:1024 sc1 lds
  v_mul_f32 v200, v200, v168
  v_cvt_pk_bf16_f32 v163, v206, v207
  v_mfma_f32_32x32x16_bf16 v[80:95], v[180:183], a[56:59], v[80:95]
  ds_read_b64_tr_b16 v[178:179], v6 offset:25088
  buffer_store_dwordx4 v[160:163], v12, s[8:11], s38 offen offset:2048 sc1
  v_mul_f32 v205, s40, v173
  v_mfma_f32_32x32x16_bf16 v[96:111], v[180:183], a[60:63], v[96:111]
  ds_read_b64_tr_b16 v[180:181], v6 offset:26624
  buffer_load_dwordx4 v255, s[24:27], s49 offen offset:2048 sc1 lds
  s_add_u32 s49, s49, s50
  s_waitcnt vmcnt(19)
  s_waitcnt lgkmcnt(7)
  v_mfma_f32_32x32x16_bf16 v[80:95], v[184:187], a[64:67], v[80:95]
  ds_read_b64_tr_b16 v[182:183], v6 offset:27136
  ds_read_b64_tr_b16 a[12:13], v251 offset:3072
  ds_read_b64_tr_b16 a[14:15], v251 offset:4608
  v_exp_f32 v204, v204
  v_add_f32 v203, 1.0, v203
  v_mfma_f32_32x32x16_bf16 v[96:111], v[184:187], a[68:71], v[96:111]
  ds_read_b64_tr_b16 v[184:185], v6 offset:28672
  ds_read_b64_tr_b16 a[16:17], v251 offset:3136
  ds_read_b64_tr_b16 a[18:19], v251 offset:4672
  v_rcp_f32 v202, v202
  v_mul_f32 v201, v201, v169
  v_mfma_f32_32x32x16_bf16 v[80:95], v[188:191], a[72:75], v[80:95]
  ds_read_b64_tr_b16 v[186:187], v6 offset:29184
  ds_read_b64_tr_b16 a[20:21], v251 offset:3200
  ds_read_b64_tr_b16 a[22:23], v251 offset:4736
  v_mul_f32 v206, s40, v174
  v_exp_f32 v205, v205
  v_mfma_f32_32x32x16_bf16 v[96:111], v[188:191], a[76:79], v[96:111]
  ds_read_b64_tr_b16 v[188:189], v6 offset:30720
  v_add_f32 v204, 1.0, v204
  v_rcp_f32 v203, v203
  v_mul_f32 v202, v202, v170
  s_waitcnt lgkmcnt(13)
  v_mfma_f32_32x32x16_bf16 v[80:95], v[192:195], a[80:83], v[80:95]
  ds_read_b64_tr_b16 v[190:191], v6 offset:31232
  v_cvt_pk_bf16_f32 v168, v200, v201
  v_mul_f32 v207, s40, v175
  v_exp_f32 v206, v206
  v_add_f32 v205, 1.0, v205
  v_mfma_f32_32x32x16_bf16 v[96:111], v[192:195], a[84:87], v[96:111]
  ds_read_b64_tr_b16 v[192:193], v6 offset:32768
  s_waitcnt lgkmcnt(3)
  s_add_u32 m0, s51, 76800
  v_rcp_f32 v204, v204
  v_mul_f32 v203, v203, v171
  v_mfma_f32_32x32x16_bf16 v[80:95], v[196:199], a[88:91], v[80:95]
  ds_read_b64_tr_b16 v[194:195], v6 offset:33280
  v_exp_f32 v207, v207
  v_add_f32 v206, 1.0, v206
  v_rcp_f32 v205, v205
  v_mfma_f32_32x32x16_bf16 v[96:111], v[196:199], a[92:95], v[96:111]
  ds_read_b64_tr_b16 v[196:197], v6 offset:34816
  buffer_load_dwordx4 v253, s[24:27], s49 offen offset:0 sc1 lds
  v_mul_f32 v204, v204, v172
  v_cvt_pk_bf16_f32 v169, v202, v203
  v_add_f32 v207, 1.0, v207
  v_mfma_f32_32x32x16_bf16 v[80:95], v[176:179], a[96:99], v[80:95]
  ds_read_b64_tr_b16 v[198:199], v6 offset:35328
  v_rcp_f32 v206, v206
  v_mul_f32 v205, v205, v173
  v_rcp_f32 v207, v207
  v_mfma_f32_32x32x16_bf16 v[96:111], v[176:179], a[100:103], v[96:111]
  v_add_u32 v6, 0x9000, v6
  ds_read_b64_tr_b16 v[176:177], v6 offset:0
  buffer_load_dwordx4 v254, s[24:27], s49 offen offset:1024 sc1 lds
  v_mul_f32 v206, v206, v174
  v_cvt_pk_bf16_f32 v170, v204, v205
  v_mfma_f32_32x32x16_bf16 v[80:95], v[180:183], a[104:107], v[80:95]
  ds_read_b64_tr_b16 v[178:179], v6 offset:512
  v_mul_f32 v207, v207, v175
  v_cvt_pk_bf16_f32 v171, v206, v207
  buffer_store_dwordx4 v[168:171], v12, s[8:11], s38 offen offset:3072 sc1
  v_mfma_f32_32x32x16_bf16 v[96:111], v[180:183], a[108:111], v[96:111]
  ds_read_b64_tr_b16 v[180:181], v6 offset:2048
  buffer_load_dwordx4 v255, s[24:27], s49 offen offset:2048 sc1 lds
  s_add_u32 s49, s49, s50
  s_waitcnt vmcnt(19)
  s_waitcnt lgkmcnt(7)
  v_mfma_f32_32x32x16_bf16 v[80:95], v[184:187], a[112:115], v[80:95]
  ds_read_b64_tr_b16 v[182:183], v6 offset:2560
  ds_read_b64_tr_b16 a[24:25], v251 offset:6144
  ds_read_b64_tr_b16 a[26:27], v251 offset:7680
  s_lshl_b32 s38, s36, 5
  s_add_u32 s38, s38, s37
  v_mul_f32 v200, s40, v48
  v_mfma_f32_32x32x16_bf16 v[96:111], v[184:187], a[116:119], v[96:111]
  ds_read_b64_tr_b16 v[184:185], v6 offset:4096
  ds_read_b64_tr_b16 a[28:29], v251 offset:6208
  ds_read_b64_tr_b16 a[30:31], v251 offset:7744
  v_mul_f32 v201, s40, v49
  v_exp_f32 v200, v200
  v_mfma_f32_32x32x16_bf16 v[80:95], v[188:191], a[120:123], v[80:95]
  ds_read_b64_tr_b16 v[186:187], v6 offset:4608
  ds_read_b64_tr_b16 a[32:33], v251 offset:6272
  ds_read_b64_tr_b16 a[34:35], v251 offset:7808
  v_mul_f32 v202, s40, v50
  v_exp_f32 v201, v201
  v_mfma_f32_32x32x16_bf16 v[96:111], v[188:191], a[124:127], v[96:111]
  ds_read_b64_tr_b16 v[188:189], v6 offset:6144
  v_add_f32 v200, 1.0, v200
  v_mul_f32 v203, s40, v51
  v_exp_f32 v202, v202
  s_waitcnt lgkmcnt(13)
  v_mfma_f32_32x32x16_bf16 v[80:95], v[192:195], a[128:131], v[80:95]
  ds_read_b64_tr_b16 v[190:191], v6 offset:6656
  v_add_f32 v201, 1.0, v201
  v_rcp_f32 v200, v200
  v_mul_f32 v204, s40, v52
  v_mfma_f32_32x32x16_bf16 v[96:111], v[192:195], a[132:135], v[96:111]
  ds_read_b64_tr_b16 v[192:193], v6 offset:8192
  s_waitcnt lgkmcnt(3)
  s_add_u32 m0, s51, 79872
  v_exp_f32 v203, v203
  v_add_f32 v202, 1.0, v202
  v_mfma_f32_32x32x16_bf16 v[80:95], v[196:199], a[136:139], v[80:95]
  ds_read_b64_tr_b16 v[194:195], v6 offset:8704
  v_rcp_f32 v201, v201
  v_mul_f32 v200, v200, v48
  v_mul_f32 v205, s40, v53
  v_mfma_f32_32x32x16_bf16 v[96:111], v[196:199], a[140:143], v[96:111]
  ds_read_b64_tr_b16 v[196:197], v6 offset:10240
  buffer_load_dwordx4 v253, s[24:27], s49 offen offset:0 sc1 lds
  v_exp_f32 v204, v204
  v_add_f32 v203, 1.0, v203
  v_mfma_f32_32x32x16_bf16 v[80:95], v[176:179], a[144:147], v[80:95]
  ds_read_b64_tr_b16 v[198:199], v6 offset:10752
  v_rcp_f32 v202, v202
  v_mul_f32 v201, v201, v49
  v_mul_f32 v206, s40, v54
  v_mfma_f32_32x32x16_bf16 v[96:111], v[176:179], a[148:151], v[96:111]
  ds_read_b64_tr_b16 v[176:177], v6 offset:12288
  buffer_load_dwordx4 v254, s[24:27], s49 offen offset:1024 sc1 lds
  v_exp_f32 v205, v205
  v_add_f32 v204, 1.0, v204
  v_mfma_f32_32x32x16_bf16 v[80:95], v[180:183], a[152:155], v[80:95]
  ds_read_b64_tr_b16 v[178:179], v6 offset:12800
  v_rcp_f32 v203, v203
  v_mul_f32 v202, v202, v50
  v_cvt_pk_bf16_f32 v48, v200, v201
  v_mul_f32 v207, s40, v55
  v_mfma_f32_32x32x16_bf16 v[96:111], v[180:183], a[156:159], v[96:111]
  ds_read_b64_tr_b16 v[180:181], v6 offset:14336
  buffer_load_dwordx4 v255, s[24:27], s49 offen offset:2048 sc1 lds
  s_add_u32 s49, s49, s50
  s_waitcnt vmcnt(19)
  s_waitcnt lgkmcnt(7)
  v_mfma_f32_32x32x16_bf16 v[80:95], v[184:187], a[160:163], v[80:95]
  ds_read_b64_tr_b16 v[182:183], v6 offset:14848
  ds_read_b64_tr_b16 a[36:37], v251 offset:9216
  ds_read_b64_tr_b16 a[38:39], v251 offset:10752
  v_exp_f32 v206, v206
  v_add_f32 v205, 1.0, v205
  v_mfma_f32_32x32x16_bf16 v[96:111], v[184:187], a[164:167], v[96:111]
  ds_read_b64_tr_b16 v[184:185], v6 offset:16384
  ds_read_b64_tr_b16 a[40:41], v251 offset:9280
  ds_read_b64_tr_b16 a[42:43], v251 offset:10816
  v_rcp_f32 v204, v204
  v_mul_f32 v203, v203, v51
  v_mfma_f32_32x32x16_bf16 v[80:95], v[188:191], a[168:171], v[80:95]
  ds_read_b64_tr_b16 v[186:187], v6 offset:16896
  ds_read_b64_tr_b16 a[44:45], v251 offset:9344
  ds_read_b64_tr_b16 a[46:47], v251 offset:10880
  v_mul_f32 v200, s40, v56
  v_exp_f32 v207, v207
  v_mfma_f32_32x32x16_bf16 v[96:111], v[188:191], a[172:175], v[96:111]
  ds_read_b64_tr_b16 v[188:189], v6 offset:18432
  v_add_f32 v206, 1.0, v206
  v_rcp_f32 v205, v205
  v_mul_f32 v204, v204, v52
  s_waitcnt lgkmcnt(13)
  v_mfma_f32_32x32x16_bf16 v[80:95], v[192:195], a[176:179], v[80:95]
  ds_read_b64_tr_b16 v[190:191], v6 offset:18944
  v_cvt_pk_bf16_f32 v49, v202, v203
  v_mul_f32 v201, s40, v57
  v_exp_f32 v200, v200
  v_add_f32 v207, 1.0, v207
  v_mfma_f32_32x32x16_bf16 v[96:111], v[192:195], a[180:183], v[96:111]
  ds_read_b64_tr_b16 v[192:193], v6 offset:20480
  s_waitcnt lgkmcnt(3)
  s_add_u32 m0, s51, 82944
  v_rcp_f32 v206, v206
  v_mul_f32 v205, v205, v53
  v_mfma_f32_32x32x16_bf16 v[80:95], v[196:199], a[184:187], v[80:95]
  ds_read_b64_tr_b16 v[194:195], v6 offset:20992
  v_mul_f32 v202, s40, v58
  v_exp_f32 v201, v201
  v_add_f32 v200, 1.0, v200
  v_mfma_f32_32x32x16_bf16 v[96:111], v[196:199], a[188:191], v[96:111]
  ds_read_b64_tr_b16 v[196:197], v6 offset:22528
  buffer_load_dwordx4 v253, s[24:27], s49 offen offset:0 sc1 lds
  v_rcp_f32 v207, v207
  v_mul_f32 v206, v206, v54
  v_mfma_f32_32x32x16_bf16 v[80:95], v[176:179], a[192:195], v[80:95]
  ds_read_b64_tr_b16 v[198:199], v6 offset:23040
  v_cvt_pk_bf16_f32 v50, v204, v205
  v_mul_f32 v203, s40, v59
  v_exp_f32 v202, v202
  v_add_f32 v201, 1.0, v201
  v_mfma_f32_32x32x16_bf16 v[96:111], v[176:179], a[196:199], v[96:111]
  ds_read_b64_tr_b16 v[176:177], v6 offset:24576
  buffer_load_dwordx4 v254, s[24:27], s49 offen offset:1024 sc1 lds
  v_rcp_f32 v200, v200
  v_mul_f32 v207, v207, v55
  v_mfma_f32_32x32x16_bf16 v[80:95], v[180:183], a[200:203], v[80:95]
  ds_read_b64_tr_b16 v[178:179], v6 offset:25088
  v_mul_f32 v204, s40, v60
  v_exp_f32 v203, v203
  v_add_f32 v202, 1.0, v202
  v_mfma_f32_32x32x16_bf16 v[96:111], v[180:183], a[204:207], v[96:111]
  ds_read_b64_tr_b16 v[180:181], v6 offset:26624
  buffer_load_dwordx4 v255, s[24:27], s49 offen offset:2048 sc1 lds
  s_add_u32 s49, s49, s50
  s_waitcnt vmcnt(18)
  s_waitcnt lgkmcnt(7)
  v_mfma_f32_32x32x16_bf16 v[80:95], v[184:187], a[208:211], v[80:95]
  ds_read_b64_tr_b16 v[182:183], v6 offset:27136
  ds_read_b64_tr_b16 a[48:49], v251 offset:12288
  ds_read_b64_tr_b16 a[50:51], v251 offset:13824
  v_rcp_f32 v201, v201
  v_mul_f32 v200, v200, v56
  v_mfma_f32_32x32x16_bf16 v[96:111], v[184:187], a[212:215], v[96:111]
  ds_read_b64_tr_b16 v[184:185], v6 offset:28672
  ds_read_b64_tr_b16 a[52:53], v251 offset:12352
  ds_read_b64_tr_b16 a[54:55], v251 offset:13888
  v_cvt_pk_bf16_f32 v51, v206, v207
  v_mfma_f32_32x32x16_bf16 v[80:95], v[188:191], a[216:219], v[80:95]
  ds_read_b64_tr_b16 v[186:187], v6 offset:29184
  ds_read_b64_tr_b16 a[56:57], v251 offset:12416
  ds_read_b64_tr_b16 a[58:59], v251 offset:13952
  buffer_store_dwordx4 v[48:51], v11, s[8:11], s38 offen offset:0 sc1
  v_mfma_f32_32x32x16_bf16 v[96:111], v[188:191], a[220:223], v[96:111]
  ds_read_b64_tr_b16 v[188:189], v6 offset:30720
  v_mul_f32 v205, s40, v61
  v_exp_f32 v204, v204
  v_add_f32 v203, 1.0, v203
  s_waitcnt lgkmcnt(13)
  v_mfma_f32_32x32x16_bf16 v[80:95], v[192:195], a[224:227], v[80:95]
  ds_read_b64_tr_b16 v[190:191], v6 offset:31232
  s_add_u32 s32, s53, 327680
  s_waitcnt vmcnt(8)
  s_barrier
  buffer_store_dword v250, v252, s[8:11], s32 offen sc1
  v_mfma_f32_32x32x16_bf16 v[96:111], v[192:195], a[228:231], v[96:111]
  ds_read_b64_tr_b16 v[192:193], v6 offset:32768
  s_waitcnt lgkmcnt(3)
  s_add_u32 m0, s51, 86016
  v_rcp_f32 v202, v202
  v_mul_f32 v201, v201, v57
  v_mfma_f32_32x32x16_bf16 v[80:95], v[196:199], a[232:235], v[80:95]
  ds_read_b64_tr_b16 v[194:195], v6 offset:33280
  v_mul_f32 v206, s40, v62
  v_exp_f32 v205, v205
  v_add_f32 v204, 1.0, v204
  v_mfma_f32_32x32x16_bf16 v[96:111], v[196:199], a[236:239], v[96:111]
  ds_read_b64_tr_b16 v[196:197], v6 offset:34816
  buffer_load_dwordx4 v253, s[24:27], s49 offen offset:0 sc1 lds
  v_rcp_f32 v203, v203
  v_mul_f32 v202, v202, v58
  v_mfma_f32_32x32x16_bf16 v[80:95], v[176:179], a[240:243], v[80:95]
  ds_read_b64_tr_b16 v[198:199], v6 offset:35328
  v_cvt_pk_bf16_f32 v56, v200, v201
  v_mul_f32 v207, s40, v63
  v_exp_f32 v206, v206
  v_add_f32 v205, 1.0, v205
  v_mfma_f32_32x32x16_bf16 v[96:111], v[176:179], a[244:247], v[96:111]
  buffer_load_dwordx4 v254, s[24:27], s49 offen offset:1024 sc1 lds
  v_rcp_f32 v204, v204
  v_mul_f32 v203, v203, v59
  v_mul_f32 v200, s40, v64
  v_mfma_f32_32x32x16_bf16 v[80:95], v[180:183], a[248:251], v[80:95]
  v_exp_f32 v207, v207
  v_add_f32 v206, 1.0, v206
  v_rcp_f32 v205, v205
  v_mul_f32 v204, v204, v60
  v_mfma_f32_32x32x16_bf16 v[96:111], v[180:183], a[252:255], v[96:111]
  buffer_load_dwordx4 v255, s[24:27], s49 offen offset:2048 sc1 lds
  s_add_u32 s49, s49, s50
  ds_read_b64_tr_b16 a[60:61], v251 offset:15360
  s_waitcnt lgkmcnt(5)
  v_mfma_f32_32x32x16_bf16 v[80:95], v[184:187], v[16:19], v[80:95]
  ds_read_b64_tr_b16 a[62:63], v251 offset:16896
  v_cvt_pk_bf16_f32 v57, v202, v203
  v_mul_f32 v201, s40, v65
  v_exp_f32 v200, v200
  v_add_f32 v207, 1.0, v207
  v_mfma_f32_32x32x16_bf16 v[96:111], v[184:187], v[20:23], v[96:111]
  ds_read_b64_tr_b16 a[64:65], v251 offset:15424
  ds_read_b64_tr_b16 a[66:67], v251 offset:16960
  v_rcp_f32 v206, v206
  v_mul_f32 v205, v205, v61
  v_mul_f32 v202, s40, v66
  v_mfma_f32_32x32x16_bf16 v[80:95], v[188:191], v[24:27], v[80:95]
  ds_read_b64_tr_b16 a[68:69], v251 offset:15488
  ds_read_b64_tr_b16 a[70:71], v251 offset:17024
  v_exp_f32 v201, v201
  v_add_f32 v200, 1.0, v200
  v_mfma_f32_32x32x16_bf16 v[96:111], v[188:191], v[28:31], v[96:111]
  v_rcp_f32 v207, v207
  v_mul_f32 v206, v206, v62
  v_cvt_pk_bf16_f32 v58, v204, v205
  v_mul_f32 v203, s40, v67
  s_waitcnt lgkmcnt(6)
  v_mfma_f32_32x32x16_bf16 v[80:95], v[192:195], v[32:35], v[80:95]
  v_exp_f32 v202, v202
  v_add_f32 v201, 1.0, v201
  v_rcp_f32 v200, v200
  v_mul_f32 v207, v207, v63
  v_mfma_f32_32x32x16_bf16 v[96:111], v[192:195], v[36:39], v[96:111]
  s_waitcnt lgkmcnt(0)
  s_add_u32 m0, s51, 89088
  v_mul_f32 v204, s40, v68
  v_exp_f32 v203, v203
  v_add_f32 v202, 1.0, v202
  v_mfma_f32_32x32x16_bf16 v[80:95], v[196:199], v[40:43], v[80:95]
  v_rcp_f32 v201, v201
  v_mul_f32 v200, v200, v64
  v_cvt_pk_bf16_f32 v59, v206, v207
  v_mfma_f32_32x32x16_bf16 v[96:111], v[196:199], v[44:47], v[96:111]
  buffer_load_dwordx4 v253, s[24:27], s49 offen offset:0 sc1 lds
  buffer_load_dwordx4 v254, s[24:27], s49 offen offset:1024 sc1 lds
  buffer_load_dwordx4 v255, s[24:27], s49 offen offset:2048 sc1 lds
  s_add_u32 s49, s49, s50
  s_barrier
  buffer_store_dwordx4 v[56:59], v11, s[8:11], s38 offen offset:1024 sc1
  v_mul_f32 v205, s40, v69
  v_exp_f32 v204, v204
  v_add_f32 v203, 1.0, v203
  v_rcp_f32 v202, v202
  v_mul_f32 v201, v201, v65
  v_mul_f32 v206, s40, v70
  v_exp_f32 v205, v205
  v_add_f32 v204, 1.0, v204
  v_rcp_f32 v203, v203
  v_mul_f32 v202, v202, v66
  v_cvt_pk_bf16_f32 v64, v200, v201
  v_mul_f32 v207, s40, v71
  v_exp_f32 v206, v206
  v_add_f32 v205, 1.0, v205
  v_rcp_f32 v204, v204
  v_mul_f32 v203, v203, v67
  v_mul_f32 v200, s40, v72
  v_exp_f32 v207, v207
  v_add_f32 v206, 1.0, v206
  v_rcp_f32 v205, v205
  v_mul_f32 v204, v204, v68
  v_cvt_pk_bf16_f32 v65, v202, v203
  v_mul_f32 v201, s40, v73
  v_exp_f32 v200, v200
  v_add_f32 v207, 1.0, v207
  v_rcp_f32 v206, v206
  v_mul_f32 v205, v205, v69
  v_mul_f32 v202, s40, v74
  v_exp_f32 v201, v201
  v_add_f32 v200, 1.0, v200
  v_rcp_f32 v207, v207
  v_mul_f32 v206, v206, v70
  v_cvt_pk_bf16_f32 v66, v204, v205
  v_mul_f32 v203, s40, v75
  v_exp_f32 v202, v202
  v_add_f32 v201, 1.0, v201
  v_rcp_f32 v200, v200
  v_mul_f32 v207, v207, v71
  v_mul_f32 v204, s40, v76
  v_exp_f32 v203, v203
  v_add_f32 v202, 1.0, v202
  v_rcp_f32 v201, v201
  v_mul_f32 v200, v200, v72
  v_cvt_pk_bf16_f32 v67, v206, v207
  buffer_store_dwordx4 v[64:67], v12, s[8:11], s38 offen offset:0 sc1
  v_mul_f32 v205, s40, v77
  v_exp_f32 v204, v204
  v_add_f32 v203, 1.0, v203
  v_rcp_f32 v202, v202
  v_mul_f32 v201, v201, v73
  v_mul_f32 v206, s40, v78
  v_exp_f32 v205, v205
  v_add_f32 v204, 1.0, v204
  v_rcp_f32 v203, v203
  v_mul_f32 v202, v202, v74
  v_cvt_pk_bf16_f32 v72, v200, v201
  v_mul_f32 v207, s40, v79
  v_exp_f32 v206, v206
  v_add_f32 v205, 1.0, v205
  v_rcp_f32 v204, v204
  v_mul_f32 v203, v203, v75
  v_exp_f32 v207, v207
  v_add_f32 v206, 1.0, v206
  v_rcp_f32 v205, v205
  v_mul_f32 v204, v204, v76
  v_cvt_pk_bf16_f32 v73, v202, v203
  v_add_f32 v207, 1.0, v207
  v_rcp_f32 v206, v206
  v_mul_f32 v205, v205, v77
  v_rcp_f32 v207, v207
  v_mul_f32 v206, v206, v78
  v_cvt_pk_bf16_f32 v74, v204, v205
  v_mul_f32 v207, v207, v79
  v_cvt_pk_bf16_f32 v75, v206, v207
  buffer_store_dwordx4 v[72:75], v12, s[8:11], s38 offen offset:1024 sc1
  s_lshl_b32 s38, s36, 5
  s_add_u32 s38, s38, s37
  v_mul_f32 v200, s40, v80
  v_mul_f32 v201, s40, v81
  v_exp_f32 v200, v200
  v_mul_f32 v202, s40, v82
  v_exp_f32 v201, v201
  v_add_f32 v200, 1.0, v200
  v_mul_f32 v203, s40, v83
  v_exp_f32 v202, v202
  v_add_f32 v201, 1.0, v201
  v_rcp_f32 v200, v200
  v_mul_f32 v204, s40, v84
  v_exp_f32 v203, v203
  v_add_f32 v202, 1.0, v202
  v_rcp_f32 v201, v201
  v_mul_f32 v200, v200, v80
  v_mul_f32 v205, s40, v85
  v_exp_f32 v204, v204
  v_add_f32 v203, 1.0, v203
  v_rcp_f32 v202, v202
  v_mul_f32 v201, v201, v81
  v_mul_f32 v206, s40, v86
  v_exp_f32 v205, v205
  v_add_f32 v204, 1.0, v204
  v_rcp_f32 v203, v203
  v_mul_f32 v202, v202, v82
  v_cvt_pk_bf16_f32 v80, v200, v201
  v_mul_f32 v207, s40, v87
  v_exp_f32 v206, v206
  v_add_f32 v205, 1.0, v205
  v_rcp_f32 v204, v204
  buffer_load_dword v8, v9, s[8:11], s12 offen sc1
  v_mul_f32 v203, v203, v83
  v_mul_f32 v200, s40, v88
  v_exp_f32 v207, v207
  v_add_f32 v206, 1.0, v206
  v_rcp_f32 v205, v205
  v_mul_f32 v204, v204, v84
  v_cvt_pk_bf16_f32 v81, v202, v203
  v_mul_f32 v201, s40, v89
  v_exp_f32 v200, v200
  v_add_f32 v207, 1.0, v207
  v_rcp_f32 v206, v206
  v_mul_f32 v205, v205, v85
  v_mul_f32 v202, s40, v90
  v_exp_f32 v201, v201
  v_add_f32 v200, 1.0, v200
  v_rcp_f32 v207, v207
  v_mul_f32 v206, v206, v86
  v_cvt_pk_bf16_f32 v82, v204, v205
  v_mul_f32 v203, s40, v91
  v_exp_f32 v202, v202
  v_add_f32 v201, 1.0, v201
  v_rcp_f32 v200, v200
  v_mul_f32 v207, v207, v87
  v_mul_f32 v204, s40, v92
  v_exp_f32 v203, v203
  v_add_f32 v202, 1.0, v202
  v_rcp_f32 v201, v201
  v_mul_f32 v200, v200, v88
  v_cvt_pk_bf16_f32 v83, v206, v207
  buffer_store_dwordx4 v[80:83], v11, s[8:11], s38 offen offset:2048 sc1
  v_mul_f32 v205, s40, v93
  v_exp_f32 v204, v204
  v_add_f32 v203, 1.0, v203
  v_rcp_f32 v202, v202
  v_mul_f32 v201, v201, v89
  v_mul_f32 v206, s40, v94
  v_exp_f32 v205, v205
  v_add_f32 v204, 1.0, v204
  v_rcp_f32 v203, v203
  v_mul_f32 v202, v202, v90
  v_cvt_pk_bf16_f32 v88, v200, v201
  v_mul_f32 v207, s40, v95
  v_exp_f32 v206, v206
  v_add_f32 v205, 1.0, v205
  v_rcp_f32 v204, v204
  v_mul_f32 v203, v203, v91
  v_mul_f32 v200, s40, v96
  v_exp_f32 v207, v207
  v_add_f32 v206, 1.0, v206
  v_rcp_f32 v205, v205
  v_mul_f32 v204, v204, v92
  v_cvt_pk_bf16_f32 v89, v202, v203
  v_mul_f32 v201, s40, v97
  v_exp_f32 v200, v200
  v_add_f32 v207, 1.0, v207
  v_rcp_f32 v206, v206
  v_mul_f32 v205, v205, v93
  v_mul_f32 v202, s40, v98
  v_exp_f32 v201, v201
  v_add_f32 v200, 1.0, v200
  v_rcp_f32 v207, v207
  v_mul_f32 v206, v206, v94
  v_cvt_pk_bf16_f32 v90, v204, v205
  v_mul_f32 v203, s40, v99
  v_exp_f32 v202, v202
  v_add_f32 v201, 1.0, v201
  v_rcp_f32 v200, v200
  v_mul_f32 v207, v207, v95
  v_mul_f32 v204, s40, v100
  v_exp_f32 v203, v203
  v_add_f32 v202, 1.0, v202
  v_rcp_f32 v201, v201
  v_mul_f32 v200, v200, v96
  v_cvt_pk_bf16_f32 v91, v206, v207
  buffer_store_dwordx4 v[88:91], v11, s[8:11], s38 offen offset:3072 sc1
  v_mul_f32 v205, s40, v101
  v_exp_f32 v204, v204
  v_add_f32 v203, 1.0, v203
  v_rcp_f32 v202, v202
  v_mul_f32 v201, v201, v97
  v_mul_f32 v206, s40, v102
  v_exp_f32 v205, v205
  v_add_f32 v204, 1.0, v204
  v_rcp_f32 v203, v203
  v_mul_f32 v202, v202, v98
  v_cvt_pk_bf16_f32 v96, v200, v201
  v_mul_f32 v207, s40, v103
  v_exp_f32 v206, v206
  v_add_f32 v205, 1.0, v205
  v_rcp_f32 v204, v204
  v_mul_f32 v203, v203, v99
  v_mul_f32 v200, s40, v104
  v_exp_f32 v207, v207
  v_add_f32 v206, 1.0, v206
  v_rcp_f32 v205, v205
  v_mul_f32 v204, v204, v100
  v_cvt_pk_bf16_f32 v97, v202, v203
  v_mul_f32 v201, s40, v105
  v_exp_f32 v200, v200
  v_add_f32 v207, 1.0, v207
  v_rcp_f32 v206, v206
  v_mul_f32 v205, v205, v101
  v_mul_f32 v202, s40, v106
  v_exp_f32 v201, v201
  v_add_f32 v200, 1.0, v200
  v_rcp_f32 v207, v207
  v_mul_f32 v206, v206, v102
  v_cvt_pk_bf16_f32 v98, v204, v205
  v_mul_f32 v203, s40, v107
  v_exp_f32 v202, v202
  v_add_f32 v201, 1.0, v201
  v_rcp_f32 v200, v200
  v_mul_f32 v207, v207, v103
  v_mul_f32 v204, s40, v108
  v_exp_f32 v203, v203
  v_add_f32 v202, 1.0, v202
  v_rcp_f32 v201, v201
  v_mul_f32 v200, v200, v104
  v_cvt_pk_bf16_f32 v99, v206, v207
  buffer_store_dwordx4 v[96:99], v12, s[8:11], s38 offen offset:2048 sc1
  v_mul_f32 v205, s40, v109
  v_exp_f32 v204, v204
  v_add_f32 v203, 1.0, v203
  v_rcp_f32 v202, v202
  v_mul_f32 v201, v201, v105
  v_mul_f32 v206, s40, v110
  v_exp_f32 v205, v205
  v_add_f32 v204, 1.0, v204
  v_rcp_f32 v203, v203
  v_mul_f32 v202, v202, v106
  v_cvt_pk_bf16_f32 v104, v200, v201
  v_mul_f32 v207, s40, v111
  v_exp_f32 v206, v206
  v_add_f32 v205, 1.0, v205
  v_rcp_f32 v204, v204
  v_mul_f32 v203, v203, v107
  v_exp_f32 v207, v207
  v_add_f32 v206, 1.0, v206
  v_rcp_f32 v205, v205
  v_mul_f32 v204, v204, v108
  v_cvt_pk_bf16_f32 v105, v202, v203
  v_add_f32 v207, 1.0, v207
  v_rcp_f32 v206, v206
  v_mul_f32 v205, v205, v109
  v_rcp_f32 v207, v207
  v_mul_f32 v206, v206, v110
  v_cvt_pk_bf16_f32 v106, v204, v205
  v_mul_f32 v207, v207, v111
  v_cvt_pk_bf16_f32 v107, v206, v207
  buffer_store_dwordx4 v[104:107], v12, s[8:11], s38 offen offset:3072 sc1
  s_waitcnt vmcnt(4)
  v_cmp_ne_u32 vcc, s45, v8
  s_nop 1
  s_or_b32 s4, vcc_lo, vcc_hi
  s_and_b32 s4, s4, s54
  s_cmp_eq_u32 s4, 0
  s_cbranch_scc0 POLL2
POLL2_OK:
  s_nop 3
  s_branch B_FFN
AS0:
  s_nop 9
  v_min_u32 v15, 47, v0
  v_lshlrev_b32 v15, 7, v15
  s_waitcnt lgkmcnt(7)
  v_mfma_f32_32x32x16_bf16 v[48:63], v[176:179], a[0:3], 0
  ds_read_b64_tr_b16 v[198:199], v5 offset:10752
  s_mov_b32 s52, 524288
  buffer_load_dword v10, v15, s[8:11], s52 offen sc1
  v_mfma_f32_32x32x16_bf16 v[64:79], v[176:179], a[4:7], 0
  ds_read_b64_tr_b16 v[176:177], v5 offset:12288
  buffer_store_dwordx4 v[120:123], v11, s[8:11], s38 offen offset:1024 sc1
  v_mul_f32 v205, s40, v133
  v_mfma_f32_32x32x16_bf16 v[48:63], v[180:183], a[8:11], v[48:63]
  ds_read_b64_tr_b16 v[178:179], v5 offset:12800
  v_exp_f32 v204, v204
  v_add_f32 v203, 1.0, v203
  v_rcp_f32 v202, v202
  v_mfma_f32_32x32x16_bf16 v[64:79], v[180:183], a[12:15], v[64:79]
  ds_read_b64_tr_b16 v[180:181], v5 offset:14336
  v_mul_f32 v201, v201, v129
  v_mul_f32 v206, s40, v134
  v_exp_f32 v205, v205
  s_waitcnt lgkmcnt(7)
  v_mfma_f32_32x32x16_bf16 v[48:63], v[184:187], a[16:19], v[48:63]
  ds_read_b64_tr_b16 v[182:183], v5 offset:14848
  v_add_f32 v204, 1.0, v204
  v_rcp_f32 v203, v203
  v_mul_f32 v202, v202, v130
  v_cvt_pk_bf16_f32 v128, v200, v201
  v_mfma_f32_32x32x16_bf16 v[64:79], v[184:187], a[20:23], v[64:79]
  ds_read_b64_tr_b16 v[184:185], v5 offset:16384
  v_mul_f32 v207, s40, v135
  v_exp_f32 v206, v206
  v_add_f32 v205, 1.0, v205
  v_mfma_f32_32x32x16_bf16 v[48:63], v[188:191], a[24:27], v[48:63]
  ds_read_b64_tr_b16 v[186:187], v5 offset:16896
  v_rcp_f32 v204, v204
  v_mul_f32 v203, v203, v131
  v_mul_f32 v200, s40, v136
  v_mfma_f32_32x32x16_bf16 v[64:79], v[188:191], a[28:31], v[64:79]
  ds_read_b64_tr_b16 v[188:189], v5 offset:18432
  v_exp_f32 v207, v207
  v_add_f32 v206, 1.0, v206
  s_waitcnt lgkmcnt(7)
  v_mfma_f32_32x32x16_bf16 v[48:63], v[192:195], a[32:35], v[48:63]
  ds_read_b64_tr_b16 v[190:191], v5 offset:18944
  v_rcp_f32 v205, v205
  v_mul_f32 v204, v204, v132
  v_cvt_pk_bf16_f32 v129, v202, v203
  v_mul_f32 v201, s40, v137
  v_mfma_f32_32x32x16_bf16 v[64:79], v[192:195], a[36:39], v[64:79]
  ds_read_b64_tr_b16 v[192:193], v5 offset:20480
  v_exp_f32 v200, v200
  v_add_f32 v207, 1.0, v207
  v_rcp_f32 v206, v206
  v_mfma_f32_32x32x16_bf16 v[48:63], v[196:199], a[40:43], v[48:63]
  ds_read_b64_tr_b16 v[194:195], v5 offset:20992
  v_mul_f32 v205, v205, v133
  v_mul_f32 v202, s40, v138
  v_exp_f32 v201, v201
  v_add_f32 v200, 1.0, v200
  v_mfma_f32_32x32x16_bf16 v[64:79], v[196:199], a[44:47], v[64:79]
  ds_read_b64_tr_b16 v[196:197], v5 offset:22528
  v_rcp_f32 v207, v207
  v_mul_f32 v206, v206, v134
  v_cvt_pk_bf16_f32 v130, v204, v205
  s_waitcnt lgkmcnt(7)
  v_mfma_f32_32x32x16_bf16 v[48:63], v[176:179], a[48:51], v[48:63]
  ds_read_b64_tr_b16 v[198:199], v5 offset:23040
  v_mul_f32 v203, s40, v139
  v_exp_f32 v202, v202
  v_add_f32 v201, 1.0, v201
  v_mfma_f32_32x32x16_bf16 v[64:79], v[176:179], a[52:55], v[64:79]
  ds_read_b64_tr_b16 v[176:177], v5 offset:24576
  v_rcp_f32 v200, v200
  v_mul_f32 v207, v207, v135
  v_mul_f32 v204, s40, v140
  v_mfma_f32_32x32x16_bf16 v[48:63], v[180:183], a[56:59], v[48:63]
  ds_read_b64_tr_b16 v[178:179], v5 offset:25088
  v_exp_f32 v203, v203
  v_add_f32 v202, 1.0, v202
  v_rcp_f32 v201, v201
  v_mfma_f32_32x32x16_bf16 v[64:79], v[180:183], a[60:63], v[64:79]
  ds_read_b64_tr_b16 v[180:181], v5 offset:26624
  v_mul_f32 v200, v200, v136
  v_cvt_pk_bf16_f32 v131, v206, v207
  s_waitcnt lgkmcnt(7)
  v_mfma_f32_32x32x16_bf16 v[48:63], v[184:187], a[64:67], v[48:63]
  ds_read_b64_tr_b16 v[182:183], v5 offset:27136
  buffer_store_dwordx4 v[128:131], v12, s[8:11], s38 offen offset:0 sc1
  v_mul_f32 v205, s40, v141
  v_mfma_f32_32x32x16_bf16 v[64:79], v[184:187], a[68:71], v[64:79]
  ds_read_b64_tr_b16 v[184:185], v5 offset:28672
  v_exp_f32 v204, v204
  v_add_f32 v203, 1.0, v203
  v_rcp_f32 v202, v202
  v_mfma_f32_32x32x16_bf16 v[48:63], v[188:191], a[72:75], v[48:63]
  ds_read_b64_tr_b16 v[186:187], v5 offset:29184
  v_mul_f32 v201, v201, v137
  v_mul_f32 v206, s40, v142
  v_exp_f32 v205, v205
  v_add_f32 v204, 1.0, v204
  v_mfma_f32_32x32x16_bf16 v[64:79], v[188:191], a[76:79], v[64:79]
  ds_read_b64_tr_b16 v[188:189], v5 offset:30720
  v_rcp_f32 v203, v203
  v_mul_f32 v202, v202, v138
  v_cvt_pk_bf16_f32 v136, v200, v201
  s_waitcnt lgkmcnt(7)
  v_mfma_f32_32x32x16_bf16 v[48:63], v[192:195], a[80:83], v[48:63]
  ds_read_b64_tr_b16 v[190:191], v5 offset:31232
  s_waitcnt vmcnt(2)
  v_cmp_ne_u32 vcc, s45, v10
  s_nop 1
  s_cmp_eq_u64 vcc, 0
  s_cbranch_scc0 POLL3
POLL3_OK:
  v_mfma_f32_32x32x16_bf16 v[64:79], v[192:195], a[84:87], v[64:79]
  ds_read_b64_tr_b16 v[192:193], v5 offset:32768
  s_mov_b32 s54, 0x3ffff
  s_mov_b32 s12, 458752
  s_lshl_b32 s3, s46, 12
  s_add_u32 s12, s12, s3
  v_mul_f32 v207, s40, v143
  v_mfma_f32_32x32x16_bf16 v[48:63], v[196:199], a[88:91], v[48:63]
  ds_read_b64_tr_b16 v[194:195], v5 offset:33280
  v_and_b32 v14, 31, v0
  v_lshrrev_b32 v15, v14, s54
  v_and_b32 v15, 1, v15
  v_xor_b32 v15, 1, v15
  v_lshlrev_b32 v9, 7, v14
  v_lshl_add_u32 v9, v15, 30, v9
  v_mfma_f32_32x32x16_bf16 v[64:79], v[196:199], a[92:95], v[64:79]
  ds_read_b64_tr_b16 v[196:197], v5 offset:34816
  s_add_u32 m0, s51, 73728
  v_exp_f32 v206, v206
  v_add_f32 v205, 1.0, v205
  s_waitcnt lgkmcnt(7)
  v_mfma_f32_32x32x16_bf16 v[48:63], v[176:179], a[96:99], v[48:63]
  ds_read_b64_tr_b16 v[198:199], v5 offset:35328
  v_rcp_f32 v204, v204
  v_mul_f32 v203, v203, v139
  v_exp_f32 v207, v207
  v_mfma_f32_32x32x16_bf16 v[64:79], v[176:179], a[100:103], v[64:79]
  v_add_u32 v5, 0x9000, v5
  ds_read_b64_tr_b16 v[176:177], v5 offset:0
  buffer_load_dwordx4 v253, s[24:27], s49 offen offset:0 sc1 lds
  v_add_f32 v206, 1.0, v206
  v_mfma_f32_32x32x16_bf16 v[48:63], v[180:183], a[104:107], v[48:63]
  ds_read_b64_tr_b16 v[178:179], v5 offset:512
  v_rcp_f32 v205, v205
  v_mul_f32 v204, v204, v140
  v_cvt_pk_bf16_f32 v137, v202, v203
  v_add_f32 v207, 1.0, v207
  v_mfma_f32_32x32x16_bf16 v[64:79], v[180:183], a[108:111], v[64:79]
  ds_read_b64_tr_b16 v[180:181], v5 offset:2048
  buffer_load_dwordx4 v254, s[24:27], s49 offen offset:1024 sc1 lds
  v_rcp_f32 v206, v206
  s_waitcnt lgkmcnt(7)
  v_mfma_f32_32x32x16_bf16 v[48:63], v[184:187], a[112:115], v[48:63]
  ds_read_b64_tr_b16 v[182:183], v5 offset:2560
  v_mul_f32 v205, v205, v141
  v_rcp_f32 v207, v207
  v_mul_f32 v206, v206, v142
  v_cvt_pk_bf16_f32 v138, v204, v205
  v_mfma_f32_32x32x16_bf16 v[64:79], v[184:187], a[116:119], v[64:79]
  ds_read_b64_tr_b16 v[184:185], v5 offset:4096
  buffer_load_dwordx4 v255, s[24:27], s49 offen offset:2048 sc1 lds
  s_add_u32 s49, s49, s50
  v_mul_f32 v207, v207, v143
  v_cvt_pk_bf16_f32 v139, v206, v207
  v_mfma_f32_32x32x16_bf16 v[48:63], v[188:191], a[120:123], v[48:63]
  ds_read_b64_tr_b16 v[186:187], v5 offset:4608
  buffer_store_dwordx4 v[136:139], v12, s[8:11], s38 offen offset:1024 sc1
  s_lshl_b32 s38, s35, 5
  s_add_u32 s38, s38, s37
  v_mfma_f32_32x32x16_bf16 v[64:79], v[188:191], a[124:127], v[64:79]
  ds_read_b64_tr_b16 v[188:189], v5 offset:6144
  s_add_u32 m0, s51, 76800
  v_mul_f32 v200, s40, v144
  v_mul_f32 v201, s40, v145
  s_waitcnt lgkmcnt(7)
  v_mfma_f32_32x32x16_bf16 v[48:63], v[192:195], a[128:131], v[48:63]
  ds_read_b64_tr_b16 v[190:191], v5 offset:6656
  v_exp_f32 v200, v200
  v_mul_f32 v202, s40, v146
  v_exp_f32 v201, v201
  v_mfma_f32_32x32x16_bf16 v[64:79], v[192:195], a[132:135], v[64:79]
  ds_read_b64_tr_b16 v[192:193], v5 offset:8192
  buffer_load_dwordx4 v253, s[24:27], s49 offen offset:0 sc1 lds
  v_add_f32 v200, 1.0, v200
  v_mul_f32 v203, s40, v147
  v_mfma_f32_32x32x16_bf16 v[48:63], v[196:199], a[136:139], v[48:63]
  ds_read_b64_tr_b16 v[194:195], v5 offset:8704
  v_exp_f32 v202, v202
  v_add_f32 v201, 1.0, v201
  v_rcp_f32 v200, v200
  v_mfma_f32_32x32x16_bf16 v[64:79], v[196:199], a[140:143], v[64:79]
  ds_read_b64_tr_b16 v[196:197], v5 offset:10240
  buffer_load_dwordx4 v254, s[24:27], s49 offen offset:1024 sc1 lds
  v_mul_f32 v204, s40, v148
  s_waitcnt lgkmcnt(7)
  v_mfma_f32_32x32x16_bf16 v[48:63], v[176:179], a[144:147], v[48:63]
  ds_read_b64_tr_b16 v[198:199], v5 offset:10752
  v_exp_f32 v203, v203
  v_add_f32 v202, 1.0, v202
  v_rcp_f32 v201, v201
  v_mfma_f32_32x32x16_bf16 v[64:79], v[176:179], a[148:151], v[64:79]
  ds_read_b64_tr_b16 v[176:177], v5 offset:12288
  buffer_load_dwordx4 v255, s[24:27], s49 offen offset:2048 sc1 lds
  s_add_u32 s49, s49, s50
  v_mul_f32 v200, v200, v144
  v_mul_f32 v205, s40, v149
  v_mfma_f32_32x32x16_bf16 v[48:63], v[180:183], a[152:155], v[48:63]
  ds_read_b64_tr_b16 v[178:179], v5 offset:12800
  v_exp_f32 v204, v204
  v_add_f32 v203, 1.0, v203
  v_rcp_f32 v202, v202
  v_mfma_f32_32x32x16_bf16 v[64:79], v[180:183], a[156:159], v[64:79]
  ds_read_b64_tr_b16 v[180:181], v5 offset:14336
  s_add_u32 m0, s51, 79872
  v_mul_f32 v201, v201, v145
  v_mul_f32 v206, s40, v150
  s_waitcnt lgkmcnt(7)
  v_mfma_f32_32x32x16_bf16 v[48:63], v[184:187], a[160:163], v[48:63]
  ds_read_b64_tr_b16 v[182:183], v5 offset:14848
  v_exp_f32 v205, v205
  v_add_f32 v204, 1.0, v204
  v_rcp_f32 v203, v203
  v_mfma_f32_32x32x16_bf16 v[64:79], v[184:187], a[164:167], v[64:79]
  ds_read_b64_tr_b16 v[184:185], v5 offset:16384
  buffer_load_dwordx4 v253, s[24:27], s49 offen offset:0 sc1 lds
  v_mul_f32 v202, v202, v146
  v_cvt_pk_bf16_f32 v144, v200, v201
  v_mul_f32 v207, s40, v151
  v_mfma_f32_32x32x16_bf16 v[48:63], v[188:191], a[168:171], v[48:63]
  ds_read_b64_tr_b16 v[186:187], v5 offset:16896
  v_exp_f32 v206, v206
  v_add_f32 v205, 1.0, v205
  v_rcp_f32 v204, v204
  v_mfma_f32_32x32x16_bf16 v[64:79], v[188:191], a[172:175], v[64:79]
  ds_read_b64_tr_b16 v[188:189], v5 offset:18432
  buffer_load_dwordx4 v254, s[24:27], s49 offen offset:1024 sc1 lds
  v_mul_f32 v203, v203, v147
  v_mul_f32 v200, s40, v152
  s_waitcnt lgkmcnt(7)
  v_mfma_f32_32x32x16_bf16 v[48:63], v[192:195], a[176:179], v[48:63]
  ds_read_b64_tr_b16 v[190:191], v5 offset:18944
  v_exp_f32 v207, v207
  v_add_f32 v206, 1.0, v206
  v_rcp_f32 v205, v205
  v_mfma_f32_32x32x16_bf16 v[64:79], v[192:195], a[180:183], v[64:79]
  ds_read_b64_tr_b16 v[192:193], v5 offset:20480
  buffer_load_dwordx4 v255, s[24:27], s49 offen offset:2048 sc1 lds
  s_add_u32 s49, s49, s50
  v_mul_f32 v204, v204, v148
  v_cvt_pk_bf16_f32 v145, v202, v203
  v_mfma_f32_32x32x16_bf16 v[48:63], v[196:199], a[184:187], v[48:63]
  ds_read_b64_tr_b16 v[194:195], v5 offset:20992
  v_mul_f32 v201, s40, v153
  v_exp_f32 v200, v200
  v_add_f32 v207, 1.0, v207
  v_mfma_f32_32x32x16_bf16 v[64:79], v[196:199], a[188:191], v[64:79]
  ds_read_b64_tr_b16 v[196:197], v5 offset:22528
  s_add_u32 m0, s51, 82944
  v_rcp_f32 v206, v206
  v_mul_f32 v205, v205, v149
  s_waitcnt lgkmcnt(7)
  v_mfma_f32_32x32x16_bf16 v[48:63], v[176:179], a[192:195], v[48:63]
  ds_read_b64_tr_b16 v[198:199], v5 offset:23040
  v_mul_f32 v202, s40, v154
  v_exp_f32 v201, v201
  v_add_f32 v200, 1.0, v200
  v_mfma_f32_32x32x16_bf16 v[64:79], v[176:179], a[196:199], v[64:79]
  ds_read_b64_tr_b16 v[176:177], v5 offset:24576
  buffer_load_dwordx4 v253, s[24:27], s49 offen offset:0 sc1 lds
  v_rcp_f32 v207, v207
  v_mul_f32 v206, v206, v150
  v_mfma_f32_32x32x16_bf16 v[48:63], v[180:183], a[200:203], v[48:63]
  ds_read_b64_tr_b16 v[178:179], v5 offset:25088
  v_cvt_pk_bf16_f32 v146, v204, v205
  v_mul_f32 v203, s40, v155
  v_exp_f32 v202, v202
  v_add_f32 v201, 1.0, v201
  v_mfma_f32_32x32x16_bf16 v[64:79], v[180:183], a[204:207], v[64:79]
  ds_read_b64_tr_b16 v[180:181], v5 offset:26624
  buffer_load_dwordx4 v254, s[24:27], s49 offen offset:1024 sc1 lds
  v_rcp_f32 v200, v200
  s_waitcnt lgkmcnt(7)
  v_mfma_f32_32x32x16_bf16 v[48:63], v[184:187], a[208:211], v[48:63]
  ds_read_b64_tr_b16 v[182:183], v5 offset:27136
  v_mul_f32 v207, v207, v151
  v_mul_f32 v204, s40, v156
  v_exp_f32 v203, v203
  v_add_f32 v202, 1.0, v202
  v_mfma_f32_32x32x16_bf16 v[64:79], v[184:187], a[212:215], v[64:79]
  ds_read_b64_tr_b16 v[184:185], v5 offset:28672
  buffer_load_dwordx4 v255, s[24:27], s49 offen offset:2048 sc1 lds
  s_add_u32 s49, s49, s50
  v_rcp_f32 v201, v201
  v_mfma_f32_32x32x16_bf16 v[48:63], v[188:191], a[216:219], v[48:63]
  ds_read_b64_tr_b16 v[186:187], v5 offset:29184
  v_mul_f32 v200, v200, v152
  v_cvt_pk_bf16_f32 v147, v206, v207
  buffer_store_dwordx4 v[144:147], v11, s[8:11], s38 offen offset:2048 sc1
  v_mfma_f32_32x32x16_bf16 v[64:79], v[188:191], a[220:223], v[64:79]
  ds_read_b64_tr_b16 v[188:189], v5 offset:30720
  s_add_u32 m0, s51, 86016
  v_mul_f32 v205, s40, v157
  v_exp_f32 v204, v204
  s_waitcnt lgkmcnt(7)
  v_mfma_f32_32x32x16_bf16 v[48:63], v[192:195], a[224:227], v[48:63]
  ds_read_b64_tr_b16 v[190:191], v5 offset:31232
  v_add_f32 v203, 1.0, v203
  v_rcp_f32 v202, v202
  v_mul_f32 v201, v201, v153
  v_mul_f32 v206, s40, v158
  v_mfma_f32_32x32x16_bf16 v[64:79], v[192:195], a[228:231], v[64:79]
  ds_read_b64_tr_b16 v[192:193], v5 offset:32768
  buffer_load_dwordx4 v253, s[24:27], s49 offen offset:0 sc1 lds
  v_exp_f32 v205, v205
  v_add_f32 v204, 1.0, v204
  v_mfma_f32_32x32x16_bf16 v[48:63], v[196:199], a[232:235], v[48:63]
  ds_read_b64_tr_b16 v[194:195], v5 offset:33280
  v_rcp_f32 v203, v203
  v_mul_f32 v202, v202, v154
  v_cvt_pk_bf16_f32 v152, v200, v201
  v_mul_f32 v207, s40, v159
  v_mfma_f32_32x32x16_bf16 v[64:79], v[196:199], a[236:239], v[64:79]
  ds_read_b64_tr_b16 v[196:197], v5 offset:34816
  buffer_load_dwordx4 v254, s[24:27], s49 offen offset:1024 sc1 lds
  v_exp_f32 v206, v206
  s_waitcnt lgkmcnt(7)
  v_mfma_f32_32x32x16_bf16 v[48:63], v[176:179], a[240:243], v[48:63]
  ds_read_b64_tr_b16 v[198:199], v5 offset:35328
  v_add_f32 v205, 1.0, v205
  v_rcp_f32 v204, v204
  v_mul_f32 v203, v203, v155
  v_mul_f32 v200, s40, v160
  v_mfma_f32_32x32x16_bf16 v[64:79], v[176:179], a[244:247], v[64:79]
  v_add_u32 v6, 0xfffe5000, v6
  ds_read_b64_tr_b16 v[176:177], v6 offset:0
  buffer_load_dwordx4 v255, s[24:27], s49 offen offset:2048 sc1 lds
  s_add_u32 s49, s49, s50
  v_mfma_f32_32x32x16_bf16 v[48:63], v[180:183], a[248:251], v[48:63]
  ds_read_b64_tr_b16 v[178:179], v6 offset:512
  v_exp_f32 v207, v207
  v_add_f32 v206, 1.0, v206
  v_rcp_f32 v205, v205
  v_mfma_f32_32x32x16_bf16 v[64:79], v[180:183], a[252:255], v[64:79]
  ds_read_b64_tr_b16 v[180:181], v6 offset:2048
  s_add_u32 m0, s51, 89088
  v_mul_f32 v204, v204, v156
  v_cvt_pk_bf16_f32 v153, v202, v203
  v_mul_f32 v201, s40, v161
  s_waitcnt lgkmcnt(7)
  v_mfma_f32_32x32x16_bf16 v[48:63], v[184:187], v[16:19], v[48:63]
  ds_read_b64_tr_b16 v[182:183], v6 offset:2560
  v_exp_f32 v200, v200
  v_add_f32 v207, 1.0, v207
  v_rcp_f32 v206, v206
  v_mfma_f32_32x32x16_bf16 v[64:79], v[184:187], v[20:23], v[64:79]
  ds_read_b64_tr_b16 v[184:185], v6 offset:4096
  buffer_load_dwordx4 v253, s[24:27], s49 offen offset:0 sc1 lds
  v_mul_f32 v205, v205, v157
  v_mul_f32 v202, s40, v162
  v_mfma_f32_32x32x16_bf16 v[48:63], v[188:191], v[24:27], v[48:63]
  ds_read_b64_tr_b16 v[186:187], v6 offset:4608
  v_exp_f32 v201, v201
  v_add_f32 v200, 1.0, v200
  v_rcp_f32 v207, v207
  v_mfma_f32_32x32x16_bf16 v[64:79], v[188:191], v[28:31], v[64:79]
  ds_read_b64_tr_b16 v[188:189], v6 offset:6144
  buffer_load_dwordx4 v254, s[24:27], s49 offen offset:1024 sc1 lds
  v_mul_f32 v206, v206, v158
  v_cvt_pk_bf16_f32 v154, v204, v205
  s_waitcnt lgkmcnt(7)
  v_mfma_f32_32x32x16_bf16 v[48:63], v[192:195], v[32:35], v[48:63]
  ds_read_b64_tr_b16 v[190:191], v6 offset:6656
  v_mul_f32 v203, s40, v163
  v_exp_f32 v202, v202
  v_add_f32 v201, 1.0, v201
  v_mfma_f32_32x32x16_bf16 v[64:79], v[192:195], v[36:39], v[64:79]
  ds_read_b64_tr_b16 v[192:193], v6 offset:8192
  buffer_load_dwordx4 v255, s[24:27], s49 offen offset:2048 sc1 lds
  s_add_u32 s49, s49, s50
  v_rcp_f32 v200, v200
  v_mfma_f32_32x32x16_bf16 v[48:63], v[196:199], v[40:43], v[48:63]
  ds_read_b64_tr_b16 v[194:195], v6 offset:8704
  v_mul_f32 v207, v207, v159
  v_mul_f32 v204, s40, v164
  v_exp_f32 v203, v203
  v_add_f32 v202, 1.0, v202
  v_mfma_f32_32x32x16_bf16 v[64:79], v[196:199], v[44:47], v[64:79]
  ds_read_b64_tr_b16 v[196:197], v6 offset:10240
  v_rcp_f32 v201, v201
  v_mul_f32 v200, v200, v160
  v_cvt_pk_bf16_f32 v155, v206, v207
  s_waitcnt lgkmcnt(7)
  v_mfma_f32_32x32x16_bf16 v[80:95], v[176:179], a[0:3], 0
  ds_read_b64_tr_b16 v[198:199], v6 offset:10752
  buffer_store_dwordx4 v[152:155], v11, s[8:11], s38 offen offset:3072 sc1
  v_mul_f32 v205, s40, v165
  v_mfma_f32_32x32x16_bf16 v[96:111], v[176:179], a[4:7], 0
  ds_read_b64_tr_b16 v[176:177], v6 offset:12288
  v_exp_f32 v204, v204
  v_add_f32 v203, 1.0, v203
  v_rcp_f32 v202, v202
  v_mfma_f32_32x32x16_bf16 v[80:95], v[180:183], a[8:11], v[80:95]
  ds_read_b64_tr_b16 v[178:179], v6 offset:12800
  v_mul_f32 v201, v201, v161
  v_mul_f32 v206, s40, v166
  v_exp_f32 v205, v205
  v_add_f32 v204, 1.0, v204
  v_mfma_f32_32x32x16_bf16 v[96:111], v[180:183], a[12:15], v[96:111]
  ds_read_b64_tr_b16 v[180:181], v6 offset:14336
  v_rcp_f32 v203, v203
  v_mul_f32 v202, v202, v162
  v_cvt_pk_bf16_f32 v160, v200, v201
  s_waitcnt lgkmcnt(7)
  v_mfma_f32_32x32x16_bf16 v[80:95], v[184:187], a[16:19], v[80:95]
  ds_read_b64_tr_b16 v[182:183], v6 offset:14848
  s_waitcnt vmcnt(18)
  ds_read_b128 a[0:3], v251 offset:0
  ds_read_b128 a[4:7], v251 offset:1024
  v_mul_f32 v207, s40, v167
  v_mfma_f32_32x32x16_bf16 v[96:111], v[184:187], a[20:23], v[96:111]
  ds_read_b64_tr_b16 v[184:185], v6 offset:16384
  ds_read_b128 a[8:11], v251 offset:2048
  v_exp_f32 v206, v206
  v_add_f32 v205, 1.0, v205
  v_mfma_f32_32x32x16_bf16 v[80:95], v[188:191], a[24:27], v[80:95]
  ds_read_b64_tr_b16 v[186:187], v6 offset:16896
  v_rcp_f32 v204, v204
  v_mul_f32 v203, v203, v163
  v_mul_f32 v200, s40, v168
  v_mfma_f32_32x32x16_bf16 v[96:111], v[188:191], a[28:31], v[96:111]
  ds_read_b64_tr_b16 v[188:189], v6 offset:18432
  v_exp_f32 v207, v207
  v_add_f32 v206, 1.0, v206
  s_waitcnt lgkmcnt(10)
  v_mfma_f32_32x32x16_bf16 v[80:95], v[192:195], a[32:35], v[80:95]
  ds_read_b64_tr_b16 v[190:191], v6 offset:18944
  s_waitcnt lgkmcnt(3)
  s_add_u32 m0, s51, 73728
  v_rcp_f32 v205, v205
  v_mul_f32 v204, v204, v164
  v_mfma_f32_32x32x16_bf16 v[96:111], v[192:195], a[36:39], v[96:111]
  ds_read_b64_tr_b16 v[192:193], v6 offset:20480
  v_cvt_pk_bf16_f32 v161, v202, v203
  v_mul_f32 v201, s40, v169
  v_exp_f32 v200, v200
  v_add_f32 v207, 1.0, v207
  v_mfma_f32_32x32x16_bf16 v[80:95], v[196:199], a[40:43], v[80:95]
  ds_read_b64_tr_b16 v[194:195], v6 offset:20992
  buffer_load_dwordx4 v253, s[24:27], s49 offen offset:0 sc1 lds
  v_rcp_f32 v206, v206
  v_mul_f32 v205, v205, v165
  v_mfma_f32_32x32x16_bf16 v[96:111], v[196:199], a[44:47], v[96:111]
  ds_read_b64_tr_b16 v[196:197], v6 offset:22528
  v_mul_f32 v202, s40, v170
  v_exp_f32 v201, v201
  v_add_f32 v200, 1.0, v200
  v_mfma_f32_32x32x16_bf16 v[80:95], v[176:179], a[48:51], v[80:95]
  ds_read_b64_tr_b16 v[198:199], v6 offset:23040
  buffer_load_dwordx4 v254, s[24:27], s49 offen offset:1024 sc1 lds
  v_rcp_f32 v207, v207
  v_mul_f32 v206, v206, v166
  v_mfma_f32_32x32x16_bf16 v[96:111], v[176:179], a[52:55], v[96:111]
  ds_read_b64_tr_b16 v[176:177], v6 offset:24576
  v_cvt_pk_bf16_f32 v162, v204, v205
  v_mul_f32 v203, s40, v171
  v_exp_f32 v202, v202
  v_add_f32 v201, 1.0, v201
  v_mfma_f32_32x32x16_bf16 v[80:95], v[180:183], a[56:59], v[80:95]
  ds_read_b64_tr_b16 v[178:179], v6 offset:25088
  buffer_load_dwordx4 v255, s[24:27], s49 offen offset:2048 sc1 lds
  s_add_u32 s49, s49, s50
  v_rcp_f32 v200, v200
  v_mfma_f32_32x32x16_bf16 v[96:111], v[180:183], a[60:63], v[96:111]
  ds_read_b64_tr_b16 v[180:181], v6 offset:26624
  s_waitcnt vmcnt(17)
  ds_read_b128 a[12:15], v251 offset:3072
  ds_read_b128 a[16:19], v251 offset:4096
  v_mul_f32 v207, v207, v167
  s_waitcnt lgkmcnt(9)
  v_mfma_f32_32x32x16_bf16 v[80:95], v[184:187], a[64:67], v[80:95]
  ds_read_b64_tr_b16 v[182:183], v6 offset:27136
  ds_read_b128 a[20:23], v251 offset:5120
  v_mul_f32 v204, s40, v172
  v_exp_f32 v203, v203
  v_add_f32 v202, 1.0, v202
  v_mfma_f32_32x32x16_bf16 v[96:111], v[184:187], a[68:71], v[96:111]
  ds_read_b64_tr_b16 v[184:185], v6 offset:28672
  v_rcp_f32 v201, v201
  v_mul_f32 v200, v200, v168
  v_cvt_pk_bf16_f32 v163, v206, v207
  v_mfma_f32_32x32x16_bf16 v[80:95], v[188:191], a[72:75], v[80:95]
  ds_read_b64_tr_b16 v[186:187], v6 offset:29184
  buffer_store_dwordx4 v[160:163], v12, s[8:11], s38 offen offset:2048 sc1
  v_mul_f32 v205, s40, v173
  v_mfma_f32_32x32x16_bf16 v[96:111], v[188:191], a[76:79], v[96:111]
  ds_read_b64_tr_b16 v[188:189], v6 offset:30720
  s_waitcnt lgkmcnt(3)
  s_add_u32 m0, s51, 76800
  v_exp_f32 v204, v204
  v_add_f32 v203, 1.0, v203
  v_mfma_f32_32x32x16_bf16 v[80:95], v[192:195], a[80:83], v[80:95]
  ds_read_b64_tr_b16 v[190:191], v6 offset:31232
  v_rcp_f32 v202, v202
  v_mul_f32 v201, v201, v169
  v_mul_f32 v206, s40, v174
  v_mfma_f32_32x32x16_bf16 v[96:111], v[192:195], a[84:87], v[96:111]
  ds_read_b64_tr_b16 v[192:193], v6 offset:32768
  buffer_load_dwordx4 v253, s[24:27], s49 offen offset:0 sc1 lds
  v_exp_f32 v205, v205
  v_add_f32 v204, 1.0, v204
  v_mfma_f32_32x32x16_bf16 v[80:95], v[196:199], a[88:91], v[80:95]
  ds_read_b64_tr_b16 v[194:195], v6 offset:33280
  v_rcp_f32 v203, v203
  v_mul_f32 v202, v202, v170
  v_cvt_pk_bf16_f32 v168, v200, v201
  v_mul_f32 v207, s40, v175
  v_mfma_f32_32x32x16_bf16 v[96:111], v[196:199], a[92:95], v[96:111]
  ds_read_b64_tr_b16 v[196:197], v6 offset:34816
  buffer_load_dwordx4 v254, s[24:27], s49 offen offset:1024 sc1 lds
  v_exp_f32 v206, v206
  v_add_f32 v205, 1.0, v205
  v_mfma_f32_32x32x16_bf16 v[80:95], v[176:179], a[96:99], v[80:95]
  ds_read_b64_tr_b16 v[198:199], v6 offset:35328
  v_rcp_f32 v204, v204
  v_mul_f32 v203, v203, v171
  v_exp_f32 v207, v207
  v_mfma_f32_32x32x16_bf16 v[96:111], v[176:179], a[100:103], v[96:111]
  v_add_u32 v6, 0x9000, v6
  ds_read_b64_tr_b16 v[176:177], v6 offset:0
  buffer_load_dwordx4 v255, s[24:27], s49 offen offset:2048 sc1 lds
  s_add_u32 s49, s49, s50
  v_add_f32 v206, 1.0, v206
  v_mfma_f32_32x32x16_bf16 v[80:95], v[180:183], a[104:107], v[80:95]
  ds_read_b64_tr_b16 v[178:179], v6 offset:512
  s_waitcnt vmcnt(18)
  ds_read_b128 a[24:27], v251 offset:6144
  ds_read_b128 a[28:31], v251 offset:7168
  v_rcp_f32 v205, v205
  v_mfma_f32_32x32x16_bf16 v[96:111], v[180:183], a[108:111], v[96:111]
  ds_read_b64_tr_b16 v[180:181], v6 offset:2048
  ds_read_b128 a[32:35], v251 offset:8192
  v_mul_f32 v204, v204, v172
  v_cvt_pk_bf16_f32 v169, v202, v203
  v_add_f32 v207, 1.0, v207
  s_waitcnt lgkmcnt(10)
  v_mfma_f32_32x32x16_bf16 v[80:95], v[184:187], a[112:115], v[80:95]
  ds_read_b64_tr_b16 v[182:183], v6 offset:2560
  v_rcp_f32 v206, v206
  v_mul_f32 v205, v205, v173
  v_rcp_f32 v207, v207
  v_mfma_f32_32x32x16_bf16 v[96:111], v[184:187], a[116:119], v[96:111]
  ds_read_b64_tr_b16 v[184:185], v6 offset:4096
  v_mul_f32 v206, v206, v174
  v_cvt_pk_bf16_f32 v170, v204, v205
  v_mul_f32 v207, v207, v175
  v_cvt_pk_bf16_f32 v171, v206, v207
  v_mfma_f32_32x32x16_bf16 v[80:95], v[188:191], a[120:123], v[80:95]
  ds_read_b64_tr_b16 v[186:187], v6 offset:4608
  s_waitcnt lgkmcnt(3)
  s_add_u32 m0, s51, 79872
  buffer_store_dwordx4 v[168:171], v12, s[8:11], s38 offen offset:3072 sc1
  v_mfma_f32_32x32x16_bf16 v[96:111], v[188:191], a[124:127], v[96:111]
  ds_read_b64_tr_b16 v[188:189], v6 offset:6144
  s_lshl_b32 s38, s36, 5
  s_add_u32 s38, s38, s37
  v_mul_f32 v200, s40, v48
  v_mul_f32 v201, s40, v49
  v_mfma_f32_32x32x16_bf16 v[80:95], v[192:195], a[128:131], v[80:95]
  ds_read_b64_tr_b16 v[190:191], v6 offset:6656
  buffer_load_dwordx4 v253, s[24:27], s49 offen offset:0 sc1 lds
  v_exp_f32 v200, v200
  v_mul_f32 v202, s40, v50
  v_mfma_f32_32x32x16_bf16 v[96:111], v[192:195], a[132:135], v[96:111]
  ds_read_b64_tr_b16 v[192:193], v6 offset:8192
  v_exp_f32 v201, v201
  v_add_f32 v200, 1.0, v200
  v_mul_f32 v203, s40, v51
  v_mfma_f32_32x32x16_bf16 v[80:95], v[196:199], a[136:139], v[80:95]
  ds_read_b64_tr_b16 v[194:195], v6 offset:8704
  buffer_load_dwordx4 v254, s[24:27], s49 offen offset:1024 sc1 lds
  v_exp_f32 v202, v202
  v_add_f32 v201, 1.0, v201
  v_mfma_f32_32x32x16_bf16 v[96:111], v[196:199], a[140:143], v[96:111]
  ds_read_b64_tr_b16 v[196:197], v6 offset:10240
  v_rcp_f32 v200, v200
  v_mul_f32 v204, s40, v52
  s_waitcnt lgkmcnt(7)
  v_mfma_f32_32x32x16_bf16 v[80:95], v[176:179], a[144:147], v[80:95]
  ds_read_b64_tr_b16 v[198:199], v6 offset:10752
  buffer_load_dwordx4 v255, s[24:27], s49 offen offset:2048 sc1 lds
  s_add_u32 s49, s49, s50
  v_exp_f32 v203, v203
  v_mfma_f32_32x32x16_bf16 v[96:111], v[176:179], a[148:151], v[96:111]
  ds_read_b64_tr_b16 v[176:177], v6 offset:12288
  s_waitcnt vmcnt(19)
  ds_read_b128 a[36:39], v251 offset:9216
  ds_read_b128 a[40:43], v251 offset:10240
  v_add_f32 v202, 1.0, v202
  v_mfma_f32_32x32x16_bf16 v[80:95], v[180:183], a[152:155], v[80:95]
  ds_read_b64_tr_b16 v[178:179], v6 offset:12800
  ds_read_b128 a[44:47], v251 offset:11264
  v_rcp_f32 v201, v201
  v_mul_f32 v200, v200, v48
  v_mul_f32 v205, s40, v53
  v_mfma_f32_32x32x16_bf16 v[96:111], v[180:183], a[156:159], v[96:111]
  ds_read_b64_tr_b16 v[180:181], v6 offset:14336
  v_exp_f32 v204, v204
  v_add_f32 v203, 1.0, v203
  s_waitcnt lgkmcnt(10)
  v_mfma_f32_32x32x16_bf16 v[80:95], v[184:187], a[160:163], v[80:95]
  ds_read_b64_tr_b16 v[182:183], v6 offset:14848
  v_rcp_f32 v202, v202
  v_mul_f32 v201, v201, v49
  v_mul_f32 v206, s40, v54
  v_mfma_f32_32x32x16_bf16 v[96:111], v[184:187], a[164:167], v[96:111]
  ds_read_b64_tr_b16 v[184:185], v6 offset:16384
  s_waitcnt lgkmcnt(3)
  s_add_u32 m0, s51, 82944
  v_exp_f32 v205, v205
  v_add_f32 v204, 1.0, v204
  v_mfma_f32_32x32x16_bf16 v[80:95], v[188:191], a[168:171], v[80:95]
  ds_read_b64_tr_b16 v[186:187], v6 offset:16896
  v_rcp_f32 v203, v203
  v_mul_f32 v202, v202, v50
  v_cvt_pk_bf16_f32 v48, v200, v201
  v_mul_f32 v207, s40, v55
  v_mfma_f32_32x32x16_bf16 v[96:111], v[188:191], a[172:175], v[96:111]
  ds_read_b64_tr_b16 v[188:189], v6 offset:18432
  buffer_load_dwordx4 v253, s[24:27], s49 offen offset:0 sc1 lds
  v_exp_f32 v206, v206
  v_add_f32 v205, 1.0, v205
  v_mfma_f32_32x32x16_bf16 v[80:95], v[192:195], a[176:179], v[80:95]
  ds_read_b64_tr_b16 v[190:191], v6 offset:18944
  v_rcp_f32 v204, v204
  v_mul_f32 v203, v203, v51
  v_mul_f32 v200, s40, v56
  v_mfma_f32_32x32x16_bf16 v[96:111], v[192:195], a[180:183], v[96:111]
  ds_read_b64_tr_b16 v[192:193], v6 offset:20480
  buffer_load_dwordx4 v254, s[24:27], s49 offen offset:1024 sc1 lds
  v_exp_f32 v207, v207
  v_add_f32 v206, 1.0, v206
  v_mfma_f32_32x32x16_bf16 v[80:95], v[196:199], a[184:187], v[80:95]
  ds_read_b64_tr_b16 v[194:195], v6 offset:20992
  v_rcp_f32 v205, v205
  v_mul_f32 v204, v204, v52
  v_cvt_pk_bf16_f32 v49, v202, v203
  v_mul_f32 v201, s40, v57
  v_mfma_f32_32x32x16_bf16 v[96:111], v[196:199], a[188:191], v[96:111]
  ds_read_b64_tr_b16 v[196:197], v6 offset:22528
  buffer_load_dwordx4 v255, s[24:27], s49 offen offset:2048 sc1 lds
  s_add_u32 s49, s49, s50
  s_waitcnt lgkmcnt(7)
  v_mfma_f32_32x32x16_bf16 v[80:95], v[176:179], a[192:195], v[80:95]
  ds_read_b64_tr_b16 v[198:199], v6 offset:23040
  s_waitcnt vmcnt(18)
  ds_read_b128 a[48:51], v251 offset:12288
  ds_read_b128 a[52:55], v251 offset:13312
  v_exp_f32 v200, v200
  v_mfma_f32_32x32x16_bf16 v[96:111], v[176:179], a[196:199], v[96:111]
  ds_read_b64_tr_b16 v[176:177], v6 offset:24576
  ds_read_b128 a[56:59], v251 offset:14336
  v_add_f32 v207, 1.0, v207
  v_rcp_f32 v206, v206
  v_mul_f32 v205, v205, v53
  v_mfma_f32_32x32x16_bf16 v[80:95], v[180:183], a[200:203], v[80:95]
  ds_read_b64_tr_b16 v[178:179], v6 offset:25088
  v_mul_f32 v202, s40, v58
  v_exp_f32 v201, v201
  v_add_f32 v200, 1.0, v200
  v_mfma_f32_32x32x16_bf16 v[96:111], v[180:183], a[204:207], v[96:111]
  ds_read_b64_tr_b16 v[180:181], v6 offset:26624
  v_rcp_f32 v207, v207
  v_mul_f32 v206, v206, v54
  v_cvt_pk_bf16_f32 v50, v204, v205
  s_waitcnt lgkmcnt(10)
  v_mfma_f32_32x32x16_bf16 v[80:95], v[184:187], a[208:211], v[80:95]
  ds_read_b64_tr_b16 v[182:183], v6 offset:27136
  s_waitcnt lgkmcnt(3)
  s_add_u32 m0, s51, 86016
  v_mul_f32 v203, s40, v59
  v_exp_f32 v202, v202
  v_mfma_f32_32x32x16_bf16 v[96:111], v[184:187], a[212:215], v[96:111]
  ds_read_b64_tr_b16 v[184:185], v6 offset:28672
  v_add_f32 v201, 1.0, v201
  v_rcp_f32 v200, v200
  v_mul_f32 v207, v207, v55
  v_mul_f32 v204, s40, v60
  v_mfma_f32_32x32x16_bf16 v[80:95], v[188:191], a[216:219], v[80:95]
  ds_read_b64_tr_b16 v[186:187], v6 offset:29184
  buffer_load_dwordx4 v253, s[24:27], s49 offen offset:0 sc1 lds
  v_exp_f32 v203, v203
  v_add_f32 v202, 1.0, v202
  v_mfma_f32_32x32x16_bf16 v[96:111], v[188:191], a[220:223], v[96:111]
  ds_read_b64_tr_b16 v[188:189], v6 offset:30720
  v_rcp_f32 v201, v201
  v_mul_f32 v200, v200, v56
  v_cvt_pk_bf16_f32 v51, v206, v207
  v_mfma_f32_32x32x16_bf16 v[80:95], v[192:195], a[224:227], v[80:95]
  ds_read_b64_tr_b16 v[190:191], v6 offset:31232
  buffer_load_dwordx4 v254, s[24:27], s49 offen offset:1024 sc1 lds
  buffer_store_dwordx4 v[48:51], v11, s[8:11], s38 offen offset:0 sc1
  v_mfma_f32_32x32x16_bf16 v[96:111], v[192:195], a[228:231], v[96:111]
  ds_read_b64_tr_b16 v[192:193], v6 offset:32768
  v_mul_f32 v205, s40, v61
  v_exp_f32 v204, v204
  v_add_f32 v203, 1.0, v203
  v_mfma_f32_32x32x16_bf16 v[80:95], v[196:199], a[232:235], v[80:95]
  ds_read_b64_tr_b16 v[194:195], v6 offset:33280
  buffer_load_dwordx4 v255, s[24:27], s49 offen offset:2048 sc1 lds
  s_add_u32 s49, s49, s50
  v_rcp_f32 v202, v202
  v_mfma_f32_32x32x16_bf16 v[96:111], v[196:199], a[236:239], v[96:111]
  ds_read_b64_tr_b16 v[196:197], v6 offset:34816
  s_waitcnt vmcnt(19)
  ds_read_b128 a[60:63], v251 offset:15360
  ds_read_b128 a[64:67], v251 offset:16384
  v_mul_f32 v201, v201, v57
  s_waitcnt lgkmcnt(9)
  v_mfma_f32_32x32x16_bf16 v[80:95], v[176:179], a[240:243], v[80:95]
  ds_read_b64_tr_b16 v[198:199], v6 offset:35328
  s_add_u32 s32, s53, 327680
  s_waitcnt vmcnt(10)
  s_barrier
  buffer_store_dword v250, v252, s[8:11], s32 offen sc1
  v_mfma_f32_32x32x16_bf16 v[96:111], v[176:179], a[244:247], v[96:111]
  ds_read_b128 a[68:71], v251 offset:17408
  v_mul_f32 v206, s40, v62
  v_exp_f32 v205, v205
  v_add_f32 v204, 1.0, v204
  v_mfma_f32_32x32x16_bf16 v[80:95], v[180:183], a[248:251], v[80:95]
  v_rcp_f32 v203, v203
  v_mul_f32 v202, v202, v58
  v_cvt_pk_bf16_f32 v56, v200, v201
  v_mul_f32 v207, s40, v63
  v_mfma_f32_32x32x16_bf16 v[96:111], v[180:183], a[252:255], v[96:111]
  v_exp_f32 v206, v206
  v_add_f32 v205, 1.0, v205
  v_rcp_f32 v204, v204
  s_waitcnt lgkmcnt(7)
  v_mfma_f32_32x32x16_bf16 v[80:95], v[184:187], v[16:19], v[80:95]
  s_waitcnt lgkmcnt(0)
  s_add_u32 m0, s51, 89088
  v_mul_f32 v203, v203, v59
  v_mul_f32 v200, s40, v64
  v_exp_f32 v207, v207
  v_mfma_f32_32x32x16_bf16 v[96:111], v[184:187], v[20:23], v[96:111]
  v_add_f32 v206, 1.0, v206
  v_rcp_f32 v205, v205
  v_mul_f32 v204, v204, v60
  v_cvt_pk_bf16_f32 v57, v202, v203
  v_mul_f32 v201, s40, v65
  v_mfma_f32_32x32x16_bf16 v[80:95], v[188:191], v[24:27], v[80:95]
  buffer_load_dwordx4 v253, s[24:27], s49 offen offset:0 sc1 lds
  v_exp_f32 v200, v200
  v_add_f32 v207, 1.0, v207
  v_mfma_f32_32x32x16_bf16 v[96:111], v[188:191], v[28:31], v[96:111]
  v_rcp_f32 v206, v206
  v_mul_f32 v205, v205, v61
  v_mul_f32 v202, s40, v66
  v_exp_f32 v201, v201
  v_mfma_f32_32x32x16_bf16 v[80:95], v[192:195], v[32:35], v[80:95]
  buffer_load_dwordx4 v254, s[24:27], s49 offen offset:1024 sc1 lds
  v_add_f32 v200, 1.0, v200
  v_rcp_f32 v207, v207
  v_mul_f32 v206, v206, v62
  v_mfma_f32_32x32x16_bf16 v[96:111], v[192:195], v[36:39], v[96:111]
  v_cvt_pk_bf16_f32 v58, v204, v205
  v_mul_f32 v203, s40, v67
  v_exp_f32 v202, v202
  v_add_f32 v201, 1.0, v201
  v_mfma_f32_32x32x16_bf16 v[80:95], v[196:199], v[40:43], v[80:95]
  buffer_load_dwordx4 v255, s[24:27], s49 offen offset:2048 sc1 lds
  s_add_u32 s49, s49, s50
  v_rcp_f32 v200, v200
  v_mul_f32 v207, v207, v63
  v_mfma_f32_32x32x16_bf16 v[96:111], v[196:199], v[44:47], v[96:111]
  s_barrier
  v_mul_f32 v204, s40, v68
  v_exp_f32 v203, v203
  v_add_f32 v202, 1.0, v202
  v_rcp_f32 v201, v201
  v_mul_f32 v200, v200, v64
  v_cvt_pk_bf16_f32 v59, v206, v207
  buffer_store_dwordx4 v[56:59], v11, s[8:11], s38 offen offset:1024 sc1
  v_mul_f32 v205, s40, v69
  v_exp_f32 v204, v204
  v_add_f32 v203, 1.0, v203
  v_rcp_f32 v202, v202
  v_mul_f32 v201, v201, v65
  v_mul_f32 v206, s40, v70
  v_exp_f32 v205, v205
  v_add_f32 v204, 1.0, v204
  v_rcp_f32 v203, v203
  v_mul_f32 v202, v202, v66
  v_cvt_pk_bf16_f32 v64, v200, v201
  v_mul_f32 v207, s40, v71
  v_exp_f32 v206, v206
  v_add_f32 v205, 1.0, v205
  v_rcp_f32 v204, v204
  v_mul_f32 v203, v203, v67
  v_mul_f32 v200, s40, v72
  v_exp_f32 v207, v207
  v_add_f32 v206, 1.0, v206
  v_rcp_f32 v205, v205
  v_mul_f32 v204, v204, v68
  v_cvt_pk_bf16_f32 v65, v202, v203
  v_mul_f32 v201, s40, v73
  v_exp_f32 v200, v200
  v_add_f32 v207, 1.0, v207
  v_rcp_f32 v206, v206
  v_mul_f32 v205, v205, v69
  v_mul_f32 v202, s40, v74
  v_exp_f32 v201, v201
  v_add_f32 v200, 1.0, v200
  v_rcp_f32 v207, v207
  v_mul_f32 v206, v206, v70
  v_cvt_pk_bf16_f32 v66, v204, v205
  v_mul_f32 v203, s40, v75
  v_exp_f32 v202, v202
  v_add_f32 v201, 1.0, v201
  v_rcp_f32 v200, v200
  v_mul_f32 v207, v207, v71
  v_mul_f32 v204, s40, v76
  v_exp_f32 v203, v203
  v_add_f32 v202, 1.0, v202
  v_rcp_f32 v201, v201
  v_mul_f32 v200, v200, v72
  v_cvt_pk_bf16_f32 v67, v206, v207
  buffer_store_dwordx4 v[64:67], v12, s[8:11], s38 offen offset:0 sc1
  v_mul_f32 v205, s40, v77
  v_exp_f32 v204, v204
  v_add_f32 v203, 1.0, v203
  v_rcp_f32 v202, v202
  v_mul_f32 v201, v201, v73
  v_mul_f32 v206, s40, v78
  v_exp_f32 v205, v205
  v_add_f32 v204, 1.0, v204
  v_rcp_f32 v203, v203
  v_mul_f32 v202, v202, v74
  v_cvt_pk_bf16_f32 v72, v200, v201
  v_mul_f32 v207, s40, v79
  v_exp_f32 v206, v206
  v_add_f32 v205, 1.0, v205
  v_rcp_f32 v204, v204
  v_mul_f32 v203, v203, v75
  v_exp_f32 v207, v207
  v_add_f32 v206, 1.0, v206
  v_rcp_f32 v205, v205
  v_mul_f32 v204, v204, v76
  v_cvt_pk_bf16_f32 v73, v202, v203
  v_add_f32 v207, 1.0, v207
  v_rcp_f32 v206, v206
  v_mul_f32 v205, v205, v77
  v_rcp_f32 v207, v207
  v_mul_f32 v206, v206, v78
  v_cvt_pk_bf16_f32 v74, v204, v205
  v_mul_f32 v207, v207, v79
  v_cvt_pk_bf16_f32 v75, v206, v207
  buffer_store_dwordx4 v[72:75], v12, s[8:11], s38 offen offset:1024 sc1
  s_lshl_b32 s38, s36, 5
  s_add_u32 s38, s38, s37
  v_mul_f32 v200, s40, v80
  v_mul_f32 v201, s40, v81
  v_exp_f32 v200, v200
  v_mul_f32 v202, s40, v82
  v_exp_f32 v201, v201
  v_add_f32 v200, 1.0, v200
  v_mul_f32 v203, s40, v83
  v_exp_f32 v202, v202
  v_add_f32 v201, 1.0, v201
  v_rcp_f32 v200, v200
  v_mul_f32 v204, s40, v84
  v_exp_f32 v203, v203
  v_add_f32 v202, 1.0, v202
  v_rcp_f32 v201, v201
  v_mul_f32 v200, v200, v80
  v_mul_f32 v205, s40, v85
  v_exp_f32 v204, v204
  v_add_f32 v203, 1.0, v203
  v_rcp_f32 v202, v202
  v_mul_f32 v201, v201, v81
  v_mul_f32 v206, s40, v86
  v_exp_f32 v205, v205
  v_add_f32 v204, 1.0, v204
  v_rcp_f32 v203, v203
  v_mul_f32 v202, v202, v82
  v_cvt_pk_bf16_f32 v80, v200, v201
  v_mul_f32 v207, s40, v87
  v_exp_f32 v206, v206
  v_add_f32 v205, 1.0, v205
  v_rcp_f32 v204, v204
  buffer_load_dword v8, v9, s[8:11], s12 offen sc1
  v_mul_f32 v203, v203, v83
  v_mul_f32 v200, s40, v88
  v_exp_f32 v207, v207
  v_add_f32 v206, 1.0, v206
  v_rcp_f32 v205, v205
  v_mul_f32 v204, v204, v84
  v_cvt_pk_bf16_f32 v81, v202, v203
  v_mul_f32 v201, s40, v89
  v_exp_f32 v200, v200
  v_add_f32 v207, 1.0, v207
  v_rcp_f32 v206, v206
  v_mul_f32 v205, v205, v85
  v_mul_f32 v202, s40, v90
  v_exp_f32 v201, v201
  v_add_f32 v200, 1.0, v200
  v_rcp_f32 v207, v207
  v_mul_f32 v206, v206, v86
  v_cvt_pk_bf16_f32 v82, v204, v205
  v_mul_f32 v203, s40, v91
  v_exp_f32 v202, v202
  v_add_f32 v201, 1.0, v201
  v_rcp_f32 v200, v200
  v_mul_f32 v207, v207, v87
  v_mul_f32 v204, s40, v92
  v_exp_f32 v203, v203
  v_add_f32 v202, 1.0, v202
  v_rcp_f32 v201, v201
  v_mul_f32 v200, v200, v88
  v_cvt_pk_bf16_f32 v83, v206, v207
  buffer_store_dwordx4 v[80:83], v11, s[8:11], s38 offen offset:2048 sc1
  v_mul_f32 v205, s40, v93
  v_exp_f32 v204, v204
  v_add_f32 v203, 1.0, v203
  v_rcp_f32 v202, v202
  v_mul_f32 v201, v201, v89
  v_mul_f32 v206, s40, v94
  v_exp_f32 v205, v205
  v_add_f32 v204, 1.0, v204
  v_rcp_f32 v203, v203
  v_mul_f32 v202, v202, v90
  v_cvt_pk_bf16_f32 v88, v200, v201
  v_mul_f32 v207, s40, v95
  v_exp_f32 v206, v206
  v_add_f32 v205, 1.0, v205
  v_rcp_f32 v204, v204
  v_mul_f32 v203, v203, v91
  v_mul_f32 v200, s40, v96
  v_exp_f32 v207, v207
  v_add_f32 v206, 1.0, v206
  v_rcp_f32 v205, v205
  v_mul_f32 v204, v204, v92
  v_cvt_pk_bf16_f32 v89, v202, v203
  v_mul_f32 v201, s40, v97
  v_exp_f32 v200, v200
  v_add_f32 v207, 1.0, v207
  v_rcp_f32 v206, v206
  v_mul_f32 v205, v205, v93
  v_mul_f32 v202, s40, v98
  v_exp_f32 v201, v201
  v_add_f32 v200, 1.0, v200
  v_rcp_f32 v207, v207
  v_mul_f32 v206, v206, v94
  v_cvt_pk_bf16_f32 v90, v204, v205
  v_mul_f32 v203, s40, v99
  v_exp_f32 v202, v202
  v_add_f32 v201, 1.0, v201
  v_rcp_f32 v200, v200
  v_mul_f32 v207, v207, v95
  v_mul_f32 v204, s40, v100
  v_exp_f32 v203, v203
  v_add_f32 v202, 1.0, v202
  v_rcp_f32 v201, v201
  v_mul_f32 v200, v200, v96
  v_cvt_pk_bf16_f32 v91, v206, v207
  buffer_store_dwordx4 v[88:91], v11, s[8:11], s38 offen offset:3072 sc1
  v_mul_f32 v205, s40, v101
  v_exp_f32 v204, v204
  v_add_f32 v203, 1.0, v203
  v_rcp_f32 v202, v202
  v_mul_f32 v201, v201, v97
  v_mul_f32 v206, s40, v102
  v_exp_f32 v205, v205
  v_add_f32 v204, 1.0, v204
  v_rcp_f32 v203, v203
  v_mul_f32 v202, v202, v98
  v_cvt_pk_bf16_f32 v96, v200, v201
  v_mul_f32 v207, s40, v103
  v_exp_f32 v206, v206
  v_add_f32 v205, 1.0, v205
  v_rcp_f32 v204, v204
  v_mul_f32 v203, v203, v99
  v_mul_f32 v200, s40, v104
  v_exp_f32 v207, v207
  v_add_f32 v206, 1.0, v206
  v_rcp_f32 v205, v205
  v_mul_f32 v204, v204, v100
  v_cvt_pk_bf16_f32 v97, v202, v203
  v_mul_f32 v201, s40, v105
  v_exp_f32 v200, v200
  v_add_f32 v207, 1.0, v207
  v_rcp_f32 v206, v206
  v_mul_f32 v205, v205, v101
  v_mul_f32 v202, s40, v106
  v_exp_f32 v201, v201
  v_add_f32 v200, 1.0, v200
  v_rcp_f32 v207, v207
  v_mul_f32 v206, v206, v102
  v_cvt_pk_bf16_f32 v98, v204, v205
  v_mul_f32 v203, s40, v107
  v_exp_f32 v202, v202
  v_add_f32 v201, 1.0, v201
  v_rcp_f32 v200, v200
  v_mul_f32 v207, v207, v103
  v_mul_f32 v204, s40, v108
  v_exp_f32 v203, v203
  v_add_f32 v202, 1.0, v202
  v_rcp_f32 v201, v201
  v_mul_f32 v200, v200, v104
  v_cvt_pk_bf16_f32 v99, v206, v207
  buffer_store_dwordx4 v[96:99], v12, s[8:11], s38 offen offset:2048 sc1
  v_mul_f32 v205, s40, v109
  v_exp_f32 v204, v204
  v_add_f32 v203, 1.0, v203
  v_rcp_f32 v202, v202
  v_mul_f32 v201, v201, v105
  v_mul_f32 v206, s40, v110
  v_exp_f32 v205, v205
  v_add_f32 v204, 1.0, v204
  v_rcp_f32 v203, v203
  v_mul_f32 v202, v202, v106
  v_cvt_pk_bf16_f32 v104, v200, v201
  v_mul_f32 v207, s40, v111
  v_exp_f32 v206, v206
  v_add_f32 v205, 1.0, v205
  v_rcp_f32 v204, v204
  v_mul_f32 v203, v203, v107
  v_exp_f32 v207, v207
  v_add_f32 v206, 1.0, v206
  v_rcp_f32 v205, v205
  v_mul_f32 v204, v204, v108
  v_cvt_pk_bf16_f32 v105, v202, v203
  v_add_f32 v207, 1.0, v207
  v_rcp_f32 v206, v206
  v_mul_f32 v205, v205, v109
  v_rcp_f32 v207, v207
  v_mul_f32 v206, v206, v110
  v_cvt_pk_bf16_f32 v106, v204, v205
  v_mul_f32 v207, v207, v111
  v_cvt_pk_bf16_f32 v107, v206, v207
  buffer_store_dwordx4 v[104:107], v12, s[8:11], s38 offen offset:3072 sc1
  s_waitcnt vmcnt(8)
  s_nop 3
  s_branch B_SSM
A_MIXED:
  s_lshl_b32 s7, s29, 5
  v_and_b32 v13, 31, v0
  v_lshrrev_b32 v14, 5, v0
  v_bfe_u32 v15, v0, 1, 3
  v_xor_b32 v14, v14, v15
  v_lshlrev_b32 v14, 4, v14
  v_lshl_add_u32 v7, v13, 7, v14
  v_xor_b32 v8, 32, v7
  v_xor_b32 v9, 64, v7
  v_xor_b32 v10, 96, v7
  v_lshrrev_b32 v14, 5, v0
  s_lshl_b32 s4, s30, 1
  v_add_u32 v225, s4, v14
  v_add_u32 v248, s28, v14
  v_mul_u32_u24 v227, 80, v13
  v_add_u32 v227, 0x20000, v227
  v_lshl_add_u32 v224, v225, 3, v227
  v_add_u32 v224, 0x4000, v224
  v_add_u32 v15, s7, v13
  v_lshlrev_b32 v249, 4, v15
  v_mul_u32_u24 v14, 9216, v14
  v_add_u32 v226, v14, v249
  v_min_u32 v14, 1, v225
  v_lshl_add_u32 v249, v14, 30, v249
  v_lshlrev_b32 v15, 1, v15
  global_load_ushort v218, v15, s[60:61]
  global_load_ushort v219, v15, s[62:63]
  global_load_ushort v220, v15, s[54:55]
  s_mul_i32 s39, s28, 9216
  s_add_u32 s39, s39, 65536
  s_lshl_b32 s4, s30, 11
  s_add_u32 s4, s4, 150528
  v_lshrrev_b32 v14, 5, v0
  v_lshlrev_b32 v14, 9, v14
  v_bfe_u32 v15, v0, 2, 2
  v_lshl_add_u32 v14, v15, 6, v14
  v_and_b32 v15, 1, v0
  v_lshl_add_u32 v14, v15, 5, v14
  v_bfe_u32 v15, v0, 4, 1
  v_lshl_add_u32 v14, v15, 4, v14
  v_bfe_u32 v15, v0, 1, 1
  v_lshl_add_u32 v14, v15, 3, v14
  v_bfe_u32 v15, v0, 3, 1
  v_lshlrev_b32 v15, 4, v15
  v_xor_b32 v14, v14, v15
  v_add_u32 v245, s4, v14
  v_lshrrev_b32 v14, 5, v0
  v_lshlrev_b32 v14, 1, v14
  v_bfe_u32 v15, v0, 1, 2
  v_xor_b32 v14, v14, v15
  v_lshlrev_b32 v14, 4, v14
  v_lshl_add_u32 v14, v13, 6, v14
  v_add_u32 v244, s4, v14
  s_lshr_b32 s4, s34, 5
  v_xor_b32 v5, s4, v5
  v_xor_b32 v6, s4, v6
  s_lshl_b32 s4, s29, 11
  s_add_u32 s4, s4, 294912
  s_add_u32 s44, s4, s37
  s_waitcnt vmcnt(7)
  v_cmp_ne_u32 vcc, s45, v250
  s_nop 1
  s_cmp_eq_u64 vcc, 0
  s_cbranch_scc0 POLL4
POLL4_OK:
  s_add_u32 s41, s31, 0
  buffer_load_dwordx4 a[0:3], v1, s[8:11], s41 offen offset:0 sc1
  buffer_load_dwordx4 a[8:11], v1, s[8:11], s41 offen offset:1024 sc1
  buffer_load_dwordx4 a[16:19], v1, s[8:11], s41 offen offset:2048 sc1
  buffer_load_dwordx4 a[24:27], v1, s[8:11], s41 offen offset:3072 sc1
  s_add_u32 s41, s31, 4096
  buffer_load_dwordx4 a[32:35], v1, s[8:11], s41 offen offset:0 sc1
  buffer_load_dwordx4 a[40:43], v1, s[8:11], s41 offen offset:1024 sc1
  buffer_load_dwordx4 a[48:51], v1, s[8:11], s41 offen offset:2048 sc1
  buffer_load_dwordx4 a[56:59], v1, s[8:11], s41 offen offset:3072 sc1
  s_add_u32 s41, s31, 8192
  buffer_load_dwordx4 a[64:67], v1, s[8:11], s41 offen offset:0 sc1
  buffer_load_dwordx4 a[72:75], v1, s[8:11], s41 offen offset:1024 sc1
  buffer_load_dwordx4 a[80:83], v1, s[8:11], s41 offen offset:2048 sc1
  buffer_load_dwordx4 a[88:91], v1, s[8:11], s41 offen offset:3072 sc1
  s_add_u32 s41, s31, 12288
  buffer_load_dwordx4 a[96:99], v1, s[8:11], s41 offen offset:0 sc1
  buffer_load_dwordx4 a[104:107], v1, s[8:11], s41 offen offset:1024 sc1
  buffer_load_dwordx4 a[112:115], v1, s[8:11], s41 offen offset:2048 sc1
  buffer_load_dwordx4 a[120:123], v1, s[8:11], s41 offen offset:3072 sc1
  s_waitcnt vmcnt(16)
  s_barrier
  ds_read_b128 v[176:179], v7 offset:0
  ds_read_b128 v[180:183], v7 offset:4096
  ds_read_b128 v[184:187], v8 offset:0
  ds_read_b128 v[188:191], v8 offset:4096
  ds_read_b128 v[192:195], v9 offset:0
  ds_read_b128 v[196:199], v9 offset:4096
  s_waitcnt vmcnt(15)
  s_waitcnt lgkmcnt(4)
  v_mfma_f32_32x32x16_bf16 v[48:63], a[0:3], v[176:179], 0
  ds_read_b128 v[176:179], v10 offset:0
  s_add_u32 s41, s31, 16384
  buffer_load_dwordx4 a[128:131], v1, s[8:11], s41 offen offset:0 sc1
  v_lshlrev_b32 v218, 16, v218
  v_lshlrev_b32 v219, 16, v219
  v_mfma_f32_32x32x16_bf16 v[80:95], a[0:3], v[180:183], 0
  ds_read_b128 v[180:183], v10 offset:4096
  v_lshlrev_b32 v220, 16, v220
  v_mul_f32 v220, 0x3fb8aa3b, v220
  s_load_dwordx2 s[96:97], s[0:1], 88
  s_waitcnt vmcnt(15)
  s_waitcnt lgkmcnt(4)
  v_mfma_f32_32x32x16_bf16 v[48:63], a[8:11], v[184:187], v[48:63]
  ds_read_b128 v[184:187], v7 offset:8192
  buffer_load_dwordx4 a[136:139], v1, s[8:11], s41 offen offset:1024 sc1
  v_exp_f32 v220, v220
  s_nop 0
  v_cvt_pk_bf16_f32 v220, v220, v220
  v_mfma_f32_32x32x16_bf16 v[80:95], a[8:11], v[188:191], v[80:95]
  ds_read_b128 v[188:191], v7 offset:12288
  v_lshlrev_b32 v220, 16, v220
  v_mul_f32 v216, v220, v218
  v_mul_f32 v217, v220, v219
  s_waitcnt vmcnt(15)
  s_waitcnt lgkmcnt(4)
  v_mfma_f32_32x32x16_bf16 v[48:63], a[16:19], v[192:195], v[48:63]
  ds_read_b128 v[192:195], v8 offset:8192
  buffer_load_dwordx4 a[144:147], v1, s[8:11], s41 offen offset:2048 sc1
  v_mul_f32 v216, 0x3fb8aa3b, v216
  s_and_b32 s3, s2, 7
  s_lshr_b32 s4, s2, 3
  v_mfma_f32_32x32x16_bf16 v[80:95], a[16:19], v[196:199], v[80:95]
  ds_read_b128 v[196:199], v8 offset:12288
  v_exp_f32 v216, v216
  v_mul_f32 v217, 0.15915494, v217
  s_waitcnt vmcnt(15)
  s_waitcnt lgkmcnt(4)
  v_mfma_f32_32x32x16_bf16 v[48:63], a[24:27], v[176:179], v[48:63]
  ds_read_b128 v[176:179], v9 offset:8192
  buffer_load_dwordx4 a[152:155], v1, s[8:11], s41 offen offset:3072 sc1
  v_rndne_f32 v221, v217
  v_sub_f32 v217, v217, v221
  s_mul_i32 s5, s4, 43
  v_mfma_f32_32x32x16_bf16 v[80:95], a[24:27], v[180:183], v[80:95]
  ds_read_b128 v[180:183], v9 offset:12288
  v_cos_f32 v208, v217
  s_lshr_b32 s5, s5, 8
  s_waitcnt vmcnt(15)
  s_waitcnt lgkmcnt(4)
  v_mfma_f32_32x32x16_bf16 v[48:63], a[32:35], v[184:187], v[48:63]
  ds_read_b128 v[184:187], v10 offset:8192
  s_add_u32 s41, s31, 20480
  buffer_load_dwordx4 a[160:163], v1, s[8:11], s41 offen offset:0 sc1
  s_mul_i32 s6, s5, 6
  s_sub_u32 s47, s4, s6
  v_mfma_f32_32x32x16_bf16 v[80:95], a[32:35], v[188:191], v[80:95]
  ds_read_b128 v[188:191], v10 offset:12288
  v_sin_f32 v209, v217
  v_mul_f32 v208, v208, v216
  s_waitcnt vmcnt(15)
  s_waitcnt lgkmcnt(4)
  v_mfma_f32_32x32x16_bf16 v[48:63], a[40:43], v[192:195], v[48:63]
  ds_read_b128 v[192:195], v7 offset:16384
  buffer_load_dwordx4 a[168:171], v1, s[8:11], s41 offen offset:1024 sc1
  v_mul_f32 v209, v209, v216
  v_add_f32 v220, -1.0, v208
  v_mul_f32 v216, v218, v218
  v_mfma_f32_32x32x16_bf16 v[80:95], a[40:43], v[196:199], v[80:95]
  ds_read_b128 v[196:199], v7 offset:20480
  v_fmac_f32 v216, v219, v219
  v_rcp_f32 v216, v216
  s_waitcnt vmcnt(15)
  s_waitcnt lgkmcnt(4)
  v_mfma_f32_32x32x16_bf16 v[48:63], a[48:51], v[176:179], v[48:63]
  ds_read_b128 v[176:179], v8 offset:16384
  buffer_load_dwordx4 a[176:179], v1, s[8:11], s41 offen offset:2048 sc1
  v_mul_f32 v210, v220, v218
  v_fmac_f32 v210, v209, v219
  v_mul_f32 v211, v209, v218
  v_mfma_f32_32x32x16_bf16 v[80:95], a[48:51], v[180:183], v[80:95]
  ds_read_b128 v[180:183], v8 offset:20480
  v_fma_f32 v211, -v220, v219, v211
  v_mul_f32 v210, v210, v216
  v_mul_f32 v211, v211, v216
  s_waitcnt vmcnt(15)
  s_waitcnt lgkmcnt(4)
  v_mfma_f32_32x32x16_bf16 v[48:63], a[56:59], v[184:187], v[48:63]
  ds_read_b128 v[184:187], v9 offset:16384
  buffer_load_dwordx4 a[184:187], v1, s[8:11], s41 offen offset:3072 sc1
  v_mul_f32 v216, v209, v209
  v_mul_f32 v217, v208, v209
  v_fma_f32 v212, v208, v208, -v216
  v_mfma_f32_32x32x16_bf16 v[80:95], a[56:59], v[188:191], v[80:95]
  ds_read_b128 v[188:191], v9 offset:20480
  v_add_f32 v213, v217, v217
  v_mul_f32 v216, v213, v213
  v_mul_f32 v217, v212, v213
  s_waitcnt vmcnt(15)
  s_waitcnt lgkmcnt(4)
  v_mfma_f32_32x32x16_bf16 v[48:63], a[64:67], v[192:195], v[48:63]
  ds_read_b128 v[192:195], v10 offset:16384
  s_add_u32 s41, s31, 24576
  buffer_load_dwordx4 a[192:195], v1, s[8:11], s41 offen offset:0 sc1
  v_fma_f32 v212, v212, v212, -v216
  v_add_f32 v213, v217, v217
  v_mfma_f32_32x32x16_bf16 v[80:95], a[64:67], v[196:199], v[80:95]
  ds_read_b128 v[196:199], v10 offset:20480
  v_mul_f32 v216, v213, v213
  v_mul_f32 v217, v212, v213
  v_fma_f32 v212, v212, v212, -v216
  s_waitcnt vmcnt(15)
  s_waitcnt lgkmcnt(4)
  v_mfma_f32_32x32x16_bf16 v[48:63], a[72:75], v[176:179], v[48:63]
  ds_read_b128 v[176:179], v7 offset:24576
  buffer_load_dwordx4 a[200:203], v1, s[8:11], s41 offen offset:1024 sc1
  v_add_f32 v213, v217, v217
  v_mul_f32 v216, v213, v213
  v_mul_f32 v217, v212, v213
  v_mfma_f32_32x32x16_bf16 v[80:95], a[72:75], v[180:183], v[80:95]
  ds_read_b128 v[180:183], v7 offset:28672
  v_fma_f32 v212, v212, v212, -v216
  v_add_f32 v213, v217, v217
  v_mul_f32 v216, v213, v213
  s_waitcnt vmcnt(15)
  s_waitcnt lgkmcnt(4)
  v_mfma_f32_32x32x16_bf16 v[48:63], a[80:83], v[184:187], v[48:63]
  ds_read_b128 v[184:187], v8 offset:24576
  buffer_load_dwordx4 a[208:211], v1, s[8:11], s41 offen offset:2048 sc1
  v_mul_f32 v217, v212, v213
  v_fma_f32 v212, v212, v212, -v216
  v_add_f32 v213, v217, v217
  v_mfma_f32_32x32x16_bf16 v[80:95], a[80:83], v[188:191], v[80:95]
  ds_read_b128 v[188:191], v8 offset:28672
  v_mov_b32 v230, 0
  v_and_b32 v218, 1, v225
  v_cmp_ne_u32 s[60:61], 0, v218
  s_waitcnt vmcnt(15)
  s_waitcnt lgkmcnt(4)
  v_mfma_f32_32x32x16_bf16 v[48:63], a[88:91], v[192:195], v[48:63]
  ds_read_b128 v[192:195], v9 offset:24576
  buffer_load_dwordx4 a[216:219], v1, s[8:11], s41 offen offset:3072 sc1
  v_cndmask_b32 v228, 1.0, v212, s[60:61]
  v_cndmask_b32 v229, 0, v213, s[60:61]
  v_mul_f32 v216, v213, v213
  v_mfma_f32_32x32x16_bf16 v[80:95], a[88:91], v[196:199], v[80:95]
  ds_read_b128 v[196:199], v9 offset:28672
  v_mul_f32 v217, v212, v213
  v_fma_f32 v214, v212, v212, -v216
  v_add_f32 v215, v217, v217
  s_waitcnt vmcnt(15)
  s_waitcnt lgkmcnt(4)
  v_mfma_f32_32x32x16_bf16 v[48:63], a[96:99], v[176:179], v[48:63]
  ds_read_b128 v[176:179], v10 offset:24576
  s_add_u32 s41, s31, 28672
  buffer_load_dwordx4 a[224:227], v1, s[8:11], s41 offen offset:0 sc1
  v_and_b32 v218, 2, v225
  v_cmp_ne_u32 s[60:61], 0, v218
  v_mfma_f32_32x32x16_bf16 v[80:95], a[96:99], v[180:183], v[80:95]
  ds_read_b128 v[180:183], v10 offset:28672
  v_fma_f32 v216, -v215, v229, v230
  v_fma_f32 v217, v215, v228, v230
  v_fma_f32 v232, v214, v228, v216
  s_waitcnt vmcnt(15)
  s_waitcnt lgkmcnt(4)
  v_mfma_f32_32x32x16_bf16 v[48:63], a[104:107], v[184:187], v[48:63]
  ds_read_b128 v[184:187], v7 offset:32768
  buffer_load_dwordx4 a[232:235], v1, s[8:11], s41 offen offset:1024 sc1
  v_fma_f32 v233, v214, v229, v217
  v_cndmask_b32 v228, v228, v232, s[60:61]
  v_cndmask_b32 v229, v229, v233, s[60:61]
  v_mfma_f32_32x32x16_bf16 v[80:95], a[104:107], v[188:191], v[80:95]
  ds_read_b128 v[188:191], v7 offset:36864
  v_mul_f32 v216, v215, v215
  v_mul_f32 v217, v214, v215
  v_fma_f32 v214, v214, v214, -v216
  s_waitcnt vmcnt(15)
  s_waitcnt lgkmcnt(4)
  v_mfma_f32_32x32x16_bf16 v[48:63], a[112:115], v[192:195], v[48:63]
  ds_read_b128 v[192:195], v8 offset:32768
  buffer_load_dwordx4 a[240:243], v1, s[8:11], s41 offen offset:2048 sc1
  v_add_f32 v215, v217, v217
  v_and_b32 v218, 4, v225
  v_cmp_ne_u32 s[60:61], 0, v218
  v_mfma_f32_32x32x16_bf16 v[80:95], a[112:115], v[196:199], v[80:95]
  ds_read_b128 v[196:199], v8 offset:36864
  v_fma_f32 v216, -v215, v229, v230
  v_fma_f32 v217, v215, v228, v230
  v_fma_f32 v232, v214, v228, v216
  s_waitcnt vmcnt(15)
  s_waitcnt lgkmcnt(4)
  v_mfma_f32_32x32x16_bf16 v[48:63], a[120:123], v[176:179], v[48:63]
  ds_read_b128 v[176:179], v9 offset:32768
  buffer_load_dwordx4 a[248:251], v1, s[8:11], s41 offen offset:3072 sc1
  v_fma_f32 v233, v214, v229, v217
  v_cndmask_b32 v228, v228, v232, s[60:61]
  v_cndmask_b32 v229, v229, v233, s[60:61]
  v_mfma_f32_32x32x16_bf16 v[80:95], a[120:123], v[180:183], v[80:95]
  ds_read_b128 v[180:183], v9 offset:36864
  v_mul_f32 v216, v215, v215
  v_mul_f32 v217, v214, v215
  v_fma_f32 v214, v214, v214, -v216
  s_waitcnt vmcnt(15)
  s_waitcnt lgkmcnt(4)
  v_mfma_f32_32x32x16_bf16 v[48:63], a[128:131], v[184:187], v[48:63]
  ds_read_b128 v[184:187], v10 offset:32768
  s_add_u32 s41, s31, 32768
  buffer_load_dwordx4 v[16:19], v1, s[8:11], s41 offen offset:0 sc1
  v_add_f32 v215, v217, v217
  v_mul_f32 v216, v215, v215
  v_mfma_f32_32x32x16_bf16 v[80:95], a[128:131], v[188:191], v[80:95]
  ds_read_b128 v[188:191], v10 offset:36864
  v_mul_f32 v217, v214, v215
  v_fma_f32 v246, v214, v214, -v216
  v_add_f32 v247, v217, v217
  s_waitcnt vmcnt(15)
  s_waitcnt lgkmcnt(4)
  v_mfma_f32_32x32x16_bf16 v[48:63], a[136:139], v[192:195], v[48:63]
  ds_read_b128 v[192:195], v7 offset:40960
  buffer_load_dwordx4 v[24:27], v1, s[8:11], s41 offen offset:1024 sc1
  v_mov_b32 v222, s45
  v_sub_f32 v4, 0, v209
  v_sub_f32 v223, 0, v211
  v_mfma_f32_32x32x16_bf16 v[80:95], a[136:139], v[196:199], v[80:95]
  ds_read_b128 v[196:199], v7 offset:45056
  s_lshr_b32 s48, s3, 1
  s_and_b32 s6, s3, 1
  s_lshl_b32 s6, s6, 2
  s_waitcnt vmcnt(15)
  s_waitcnt lgkmcnt(4)
  v_mfma_f32_32x32x16_bf16 v[48:63], a[144:147], v[176:179], v[48:63]
  ds_read_b128 v[176:179], v8 offset:40960
  buffer_load_dwordx4 v[32:35], v1, s[8:11], s41 offen offset:2048 sc1
  s_add_u32 s46, s6, s5
  v_mfma_f32_32x32x16_bf16 v[80:95], a[144:147], v[180:183], v[80:95]
  ds_read_b128 v[180:183], v8 offset:45056
  s_cmp_eq_u32 s5, 4
  s_cselect_b32 s48, 4, s48
  s_cselect_b32 s46, s3, s46
  s_waitcnt vmcnt(15)
  s_waitcnt lgkmcnt(4)
  v_mfma_f32_32x32x16_bf16 v[48:63], a[152:155], v[184:187], v[48:63]
  ds_read_b128 v[184:187], v9 offset:40960
  buffer_load_dwordx4 v[40:43], v1, s[8:11], s41 offen offset:3072 sc1
  s_mul_i32 s51, s30, 18432
  s_mul_i32 s3, s48, 1152
  s_mul_i32 s4, s30, 288
  v_mfma_f32_32x32x16_bf16 v[80:95], a[152:155], v[188:191], v[80:95]
  ds_read_b128 v[188:191], v9 offset:45056
  s_add_u32 s3, s3, s4
  s_mul_i32 s3, s3, 1152
  s_mul_i32 s4, s47, 192
  s_waitcnt vmcnt(15)
  s_waitcnt lgkmcnt(4)
  v_mfma_f32_32x32x16_bf16 v[48:63], a[160:163], v[192:195], v[48:63]
  ds_read_b128 v[192:195], v10 offset:40960
  s_add_u32 s41, s31, 0
  buffer_load_dwordx4 a[4:7], v2, s[8:11], s41 offen offset:0 sc1
  s_add_u32 s3, s3, s4
  s_lshl_b32 s4, s47, 2
  v_mfma_f32_32x32x16_bf16 v[80:95], a[160:163], v[196:199], v[80:95]
  ds_read_b128 v[196:199], v10 offset:45056
  s_add_u32 s4, s4, s30
  s_mul_i32 s4, s4, 55296
  s_add_u32 s4, s4, 4194304
  s_waitcnt vmcnt(15)
  s_waitcnt lgkmcnt(4)
  v_mfma_f32_32x32x16_bf16 v[48:63], a[168:171], v[176:179], v[48:63]
  ds_read_b128 v[176:179], v7 offset:49152
  buffer_load_dwordx4 a[12:15], v2, s[8:11], s41 offen offset:1024 sc1
  v_add_u32 v13, 0, v0
  v_mul_u32_u24 v14, 0x1556, v13
  v_lshrrev_b32 v14, 16, v14
  v_mfma_f32_32x32x16_bf16 v[80:95], a[168:171], v[180:183], v[80:95]
  ds_read_b128 v[180:183], v7 offset:53248
  v_mul_u32_u24 v15, 960, v14
  v_lshl_add_u32 v253, v0, 4, v15
  v_add_u32 v13, 64, v0
  s_waitcnt vmcnt(15)
  s_waitcnt lgkmcnt(4)
  v_mfma_f32_32x32x16_bf16 v[48:63], a[176:179], v[184:187], v[48:63]
  ds_read_b128 v[184:187], v8 offset:49152
  buffer_load_dwordx4 a[20:23], v2, s[8:11], s41 offen offset:2048 sc1
  v_mul_u32_u24 v14, 0x1556, v13
  v_lshrrev_b32 v14, 16, v14
  v_mul_u32_u24 v15, 960, v14
  v_mfma_f32_32x32x16_bf16 v[80:95], a[176:179], v[188:191], v[80:95]
  ds_read_b128 v[188:191], v8 offset:53248
  v_lshl_add_u32 v254, v0, 4, v15
  v_add_u32 v13, 128, v0
  v_mul_u32_u24 v14, 0x1556, v13
  s_waitcnt vmcnt(15)
  s_waitcnt lgkmcnt(4)
  v_mfma_f32_32x32x16_bf16 v[48:63], a[184:187], v[192:195], v[48:63]
  ds_read_b128 v[192:195], v9 offset:49152
  buffer_load_dwordx4 a[28:31], v2, s[8:11], s41 offen offset:3072 sc1
  v_lshrrev_b32 v14, 16, v14
  v_mul_u32_u24 v15, 960, v14
  v_lshl_add_u32 v255, v0, 4, v15
  v_mfma_f32_32x32x16_bf16 v[80:95], a[184:187], v[196:199], v[80:95]
  ds_read_b128 v[196:199], v9 offset:53248
  v_lshrrev_b32 v14, 5, v0
  v_lshlrev_b32 v14, 2, v14
  v_bfe_u32 v15, v0, 2, 2
  s_waitcnt vmcnt(15)
  s_waitcnt lgkmcnt(4)
  v_mfma_f32_32x32x16_bf16 v[48:63], a[192:195], v[176:179], v[48:63]
  ds_read_b128 v[176:179], v10 offset:49152
  s_add_u32 s41, s31, 4096
  buffer_load_dwordx4 a[36:39], v2, s[8:11], s41 offen offset:0 sc1
  v_add_u32 v14, v14, v15
  v_mul_u32_u24 v14, 192, v14
  v_mfma_f32_32x32x16_bf16 v[80:95], a[192:195], v[180:183], v[80:95]
  ds_read_b128 v[180:183], v10 offset:53248
  v_bfe_u32 v15, v0, 4, 1
  v_lshl_add_u32 v14, v15, 5, v14
  v_and_b32 v15, 3, v0
  s_waitcnt vmcnt(15)
  s_waitcnt lgkmcnt(4)
  v_mfma_f32_32x32x16_bf16 v[48:63], a[200:203], v[184:187], v[48:63]
  ds_read_b128 v[184:187], v7 offset:57344
  buffer_load_dwordx4 a[44:47], v2, s[8:11], s41 offen offset:1024 sc1
  v_lshl_add_u32 v251, v15, 3, v14
  s_mov_b32 s50, 18432
  s_mov_b32 s26, 5308416
  v_mfma_f32_32x32x16_bf16 v[80:95], a[200:203], v[188:191], v[80:95]
  ds_read_b128 v[188:191], v7 offset:61440
  s_mov_b32 s27, 0x00020000
  s_waitcnt vmcnt(15)
  s_waitcnt lgkmcnt(4)
  v_mfma_f32_32x32x16_bf16 v[48:63], a[208:211], v[192:195], v[48:63]
  ds_read_b128 v[192:195], v8 offset:57344
  buffer_load_dwordx4 a[52:55], v2, s[8:11], s41 offen offset:2048 sc1
  v_mfma_f32_32x32x16_bf16 v[80:95], a[208:211], v[196:199], v[80:95]
  ds_read_b128 v[196:199], v8 offset:61440
  s_waitcnt vmcnt(15)
  s_waitcnt lgkmcnt(4)
  v_mfma_f32_32x32x16_bf16 v[48:63], a[216:219], v[176:179], v[48:63]
  ds_read_b128 v[176:179], v9 offset:57344
  buffer_load_dwordx4 a[60:63], v2, s[8:11], s41 offen offset:3072 sc1
  v_mfma_f32_32x32x16_bf16 v[80:95], a[216:219], v[180:183], v[80:95]
  ds_read_b128 v[180:183], v9 offset:61440
  s_waitcnt vmcnt(15)
  s_waitcnt lgkmcnt(4)
  v_mfma_f32_32x32x16_bf16 v[48:63], a[224:227], v[184:187], v[48:63]
  ds_read_b128 v[184:187], v10 offset:57344
  s_add_u32 s41, s31, 8192
  buffer_load_dwordx4 a[68:71], v2, s[8:11], s41 offen offset:0 sc1
  v_mfma_f32_32x32x16_bf16 v[80:95], a[224:227], v[188:191], v[80:95]
  ds_read_b128 v[188:191], v10 offset:61440
  s_waitcnt vmcnt(15)
  s_waitcnt lgkmcnt(4)
  v_mfma_f32_32x32x16_bf16 v[48:63], a[232:235], v[192:195], v[48:63]
  v_add_u32 v7, 0x10000, v7
  v_add_u32 v8, 0x10000, v8
  v_add_u32 v9, 0x10000, v9
  v_add_u32 v10, 0x10000, v10
  ds_read_b128 v[192:195], v7 offset:0
  buffer_load_dwordx4 a[76:79], v2, s[8:11], s41 offen offset:1024 sc1
  v_mfma_f32_32x32x16_bf16 v[80:95], a[232:235], v[196:199], v[80:95]
  ds_read_b128 v[196:199], v7 offset:4096
  s_waitcnt vmcnt(15)
  s_waitcnt lgkmcnt(4)
  v_mfma_f32_32x32x16_bf16 v[48:63], a[240:243], v[176:179], v[48:63]
  ds_read_b128 v[176:179], v8 offset:0
  buffer_load_dwordx4 a[84:87], v2, s[8:11], s41 offen offset:2048 sc1
  v_mfma_f32_32x32x16_bf16 v[80:95], a[240:243], v[180:183], v[80:95]
  ds_read_b128 v[180:183], v8 offset:4096
  s_waitcnt vmcnt(15)
  s_waitcnt lgkmcnt(4)
  v_mfma_f32_32x32x16_bf16 v[48:63], a[248:251], v[184:187], v[48:63]
  ds_read_b128 v[184:187], v9 offset:0
  buffer_load_dwordx4 a[92:95], v2, s[8:11], s41 offen offset:3072 sc1
  v_mfma_f32_32x32x16_bf16 v[80:95], a[248:251], v[188:191], v[80:95]
  ds_read_b128 v[188:191], v9 offset:4096
  s_waitcnt vmcnt(15)
  s_waitcnt lgkmcnt(4)
  v_mfma_f32_32x32x16_bf16 v[48:63], v[16:19], v[192:195], v[48:63]
  ds_read_b128 v[192:195], v10 offset:0
  s_add_u32 s41, s31, 12288
  buffer_load_dwordx4 a[100:103], v2, s[8:11], s41 offen offset:0 sc1
  v_mfma_f32_32x32x16_bf16 v[80:95], v[16:19], v[196:199], v[80:95]
  ds_read_b128 v[196:199], v10 offset:4096
  s_waitcnt vmcnt(15)
  s_waitcnt lgkmcnt(4)
  v_mfma_f32_32x32x16_bf16 v[48:63], v[24:27], v[176:179], v[48:63]
  v_subrev_u32 v7, 0x10000, v7
  v_subrev_u32 v8, 0x10000, v8
  v_subrev_u32 v9, 0x10000, v9
  v_subrev_u32 v10, 0x10000, v10
  ds_read_b128 v[176:179], v7 offset:0
  buffer_load_dwordx4 a[108:111], v2, s[8:11], s41 offen offset:1024 sc1
  v_mfma_f32_32x32x16_bf16 v[80:95], v[24:27], v[180:183], v[80:95]
  ds_read_b128 v[180:183], v7 offset:4096
  s_waitcnt vmcnt(15)
  s_waitcnt lgkmcnt(4)
  v_mfma_f32_32x32x16_bf16 v[48:63], v[32:35], v[184:187], v[48:63]
  ds_read_b128 v[184:187], v8 offset:0
  buffer_load_dwordx4 a[116:119], v2, s[8:11], s41 offen offset:2048 sc1
  v_mfma_f32_32x32x16_bf16 v[80:95], v[32:35], v[188:191], v[80:95]
  ds_read_b128 v[188:191], v8 offset:4096
  s_waitcnt vmcnt(15)
  s_waitcnt lgkmcnt(4)
  v_mfma_f32_32x32x16_bf16 v[48:63], v[40:43], v[192:195], v[48:63]
  ds_read_b128 v[192:195], v9 offset:0
  buffer_load_dwordx4 a[124:127], v2, s[8:11], s41 offen offset:3072 sc1
  v_mfma_f32_32x32x16_bf16 v[80:95], v[40:43], v[196:199], v[80:95]
  ds_read_b128 v[196:199], v9 offset:4096
  s_waitcnt lgkmcnt(0)
  s_cmp_eq_u32 s48, 4
  s_cselect_b32 s49, s4, s3
  s_cselect_b32 s50, 3072, s50
  s_cselect_b32 s24, s8, s96
  s_cselect_b32 s25, s9, s97
  s_cselect_b32 s26, s10, s26
  s_cselect_b64 vcc, -1, 0
  s_and_b32 s25, s25, 0xffff
  v_lshlrev_b32 v13, 4, v0
  v_cndmask_b32 v253, v253, v13, vcc
  v_cndmask_b32 v254, v254, v13, vcc
  v_cndmask_b32 v255, v255, v13, vcc
  v_cndmask_b32 v251, v251, v13, vcc
  s_add_u32 s3, s51, 73728
  v_add_u32 v251, s3, v251
  s_mov_b32 s16, s96
  s_and_b32 s17, s97, 0xffff
  s_mov_b32 s18, 0x510000
  s_mov_b32 s19, 0x00020000
  s_lshl_b32 s3, s28, 12
  s_lshl_b32 s4, s29, 7
  s_add_u32 s53, s3, s4
  v_or_b32 v252, s30, v0
  v_min_u32 v252, 1, v252
  v_lshlrev_b32 v252, 30, v252
  v_mov_b32 v250, s45
  s_waitcnt vmcnt(15)
  v_mfma_f32_32x32x16_bf16 v[64:79], a[4:7], v[176:179], 0
  ds_read_b128 v[176:179], v10 offset:0
  s_add_u32 s41, s31, 16384
  buffer_load_dwordx4 a[132:135], v2, s[8:11], s41 offen offset:0 sc1
  v_mfma_f32_32x32x16_bf16 v[96:111], a[4:7], v[180:183], 0
  ds_read_b128 v[180:183], v10 offset:4096
  s_waitcnt vmcnt(15)
  v_mfma_f32_32x32x16_bf16 v[64:79], a[12:15], v[184:187], v[64:79]
  ds_read_b128 v[184:187], v7 offset:8192
  buffer_load_dwordx4 a[140:143], v2, s[8:11], s41 offen offset:1024 sc1
  v_mul_f32 v219, v211, v48
  v_mul_f32 v48, v210, v48
  v_fmac_f32 v219, v210, v80
  v_mfma_f32_32x32x16_bf16 v[96:111], a[12:15], v[188:191], v[96:111]
  ds_read_b128 v[188:191], v7 offset:12288
  v_fmac_f32 v48, v223, v80
  v_mul_f32 v80, v211, v49
  v_mul_f32 v49, v210, v49
  s_waitcnt vmcnt(15)
  v_fmac_f32 v80, v210, v81
  v_mfma_f32_32x32x16_bf16 v[64:79], a[20:23], v[192:195], v[64:79]
  ds_read_b128 v[192:195], v8 offset:8192
  buffer_load_dwordx4 a[148:151], v2, s[8:11], s41 offen offset:2048 sc1
  v_fmac_f32 v49, v223, v81
  v_fma_f32 v221, v209, v48, v80
  v_fma_f32 v220, v4, v219, v49
  v_mfma_f32_32x32x16_bf16 v[96:111], a[20:23], v[196:199], v[96:111]
  ds_read_b128 v[196:199], v8 offset:12288
  v_fmac_f32 v221, v208, v219
  v_fmac_f32 v220, v208, v48
  v_mul_f32 v81, v211, v50
  s_waitcnt vmcnt(15)
  s_waitcnt lgkmcnt(4)
  v_mfma_f32_32x32x16_bf16 v[64:79], a[28:31], v[176:179], v[64:79]
  ds_read_b128 v[176:179], v9 offset:8192
  buffer_load_dwordx4 a[156:159], v2, s[8:11], s41 offen offset:3072 sc1
  v_mul_f32 v50, v210, v50
  v_fmac_f32 v81, v210, v82
  v_fmac_f32 v50, v223, v82
  v_mfma_f32_32x32x16_bf16 v[96:111], a[28:31], v[180:183], v[96:111]
  ds_read_b128 v[180:183], v9 offset:12288
  v_fma_f32 v217, v209, v220, v81
  v_fma_f32 v216, v4, v221, v50
  v_fmac_f32 v217, v208, v221
  s_waitcnt vmcnt(15)
  s_waitcnt lgkmcnt(4)
  v_mfma_f32_32x32x16_bf16 v[64:79], a[36:39], v[184:187], v[64:79]
  ds_read_b128 v[184:187], v10 offset:8192
  s_add_u32 s41, s31, 20480
  buffer_load_dwordx4 a[164:167], v2, s[8:11], s41 offen offset:0 sc1
  v_fmac_f32 v216, v208, v220
  v_mul_f32 v82, v211, v51
  v_mfma_f32_32x32x16_bf16 v[96:111], a[36:39], v[188:191], v[96:111]
  ds_read_b128 v[188:191], v10 offset:12288
  v_mul_f32 v51, v210, v51
  v_fmac_f32 v82, v210, v83
  v_fmac_f32 v51, v223, v83
  s_waitcnt vmcnt(15)
  s_waitcnt lgkmcnt(4)
  v_mfma_f32_32x32x16_bf16 v[64:79], a[44:47], v[192:195], v[64:79]
  ds_read_b128 v[192:195], v7 offset:16384
  buffer_load_dwordx4 a[172:175], v2, s[8:11], s41 offen offset:1024 sc1
  v_fma_f32 v221, v209, v216, v82
  v_fma_f32 v220, v4, v217, v51
  v_fmac_f32 v221, v208, v217
  v_mfma_f32_32x32x16_bf16 v[96:111], a[44:47], v[196:199], v[96:111]
  ds_read_b128 v[196:199], v7 offset:20480
  v_fmac_f32 v220, v208, v216
  v_mul_f32 v83, v211, v52
  v_mul_f32 v52, v210, v52
  s_waitcnt vmcnt(15)
  s_waitcnt lgkmcnt(4)
  v_mfma_f32_32x32x16_bf16 v[64:79], a[52:55], v[176:179], v[64:79]
  ds_read_b128 v[176:179], v8 offset:16384
  buffer_load_dwordx4 a[180:183], v2, s[8:11], s41 offen offset:2048 sc1
  v_fmac_f32 v83, v210, v84
  v_fmac_f32 v52, v223, v84
  v_fma_f32 v217, v209, v220, v83
  v_mfma_f32_32x32x16_bf16 v[96:111], a[52:55], v[180:183], v[96:111]
  ds_read_b128 v[180:183], v8 offset:20480
  v_fma_f32 v216, v4, v221, v52
  v_fmac_f32 v217, v208, v221
  v_fmac_f32 v216, v208, v220
  s_waitcnt vmcnt(15)
  s_waitcnt lgkmcnt(4)
  v_mfma_f32_32x32x16_bf16 v[64:79], a[60:63], v[184:187], v[64:79]
  ds_read_b128 v[184:187], v9 offset:16384
  buffer_load_dwordx4 a[188:191], v2, s[8:11], s41 offen offset:3072 sc1
  v_mul_f32 v84, v211, v53
  v_mul_f32 v53, v210, v53
  v_fmac_f32 v84, v210, v85
  v_mfma_f32_32x32x16_bf16 v[96:111], a[60:63], v[188:191], v[96:111]
  ds_read_b128 v[188:191], v9 offset:20480
  v_fmac_f32 v53, v223, v85
  v_fma_f32 v221, v209, v216, v84
  v_fma_f32 v220, v4, v217, v53
  s_waitcnt vmcnt(15)
  s_waitcnt lgkmcnt(4)
  v_mfma_f32_32x32x16_bf16 v[64:79], a[68:71], v[192:195], v[64:79]
  ds_read_b128 v[192:195], v10 offset:16384
  s_add_u32 s41, s31, 24576
  buffer_load_dwordx4 a[196:199], v2, s[8:11], s41 offen offset:0 sc1
  v_fmac_f32 v221, v208, v217
  v_fmac_f32 v220, v208, v216
  v_mfma_f32_32x32x16_bf16 v[96:111], a[68:71], v[196:199], v[96:111]
  ds_read_b128 v[196:199], v10 offset:20480
  v_mul_f32 v85, v211, v54
  v_mul_f32 v54, v210, v54
  v_fmac_f32 v85, v210, v86
  s_waitcnt vmcnt(15)
  s_waitcnt lgkmcnt(4)
  v_mfma_f32_32x32x16_bf16 v[64:79], a[76:79], v[176:179], v[64:79]
  ds_read_b128 v[176:179], v7 offset:24576
  buffer_load_dwordx4 a[204:207], v2, s[8:11], s41 offen offset:1024 sc1
  v_fmac_f32 v54, v223, v86
  v_fma_f32 v217, v209, v220, v85
  v_fma_f32 v216, v4, v221, v54
  v_mfma_f32_32x32x16_bf16 v[96:111], a[76:79], v[180:183], v[96:111]
  ds_read_b128 v[180:183], v7 offset:28672
  v_fmac_f32 v217, v208, v221
  v_fmac_f32 v216, v208, v220
  v_mul_f32 v86, v211, v55
  s_waitcnt vmcnt(15)
  s_waitcnt lgkmcnt(4)
  v_mfma_f32_32x32x16_bf16 v[64:79], a[84:87], v[184:187], v[64:79]
  ds_read_b128 v[184:187], v8 offset:24576
  buffer_load_dwordx4 a[212:215], v2, s[8:11], s41 offen offset:2048 sc1
  v_mul_f32 v55, v210, v55
  v_fmac_f32 v86, v210, v87
  v_fmac_f32 v55, v223, v87
  v_mfma_f32_32x32x16_bf16 v[96:111], a[84:87], v[188:191], v[96:111]
  ds_read_b128 v[188:191], v8 offset:28672
  v_fma_f32 v221, v209, v216, v86
  v_fma_f32 v220, v4, v217, v55
  v_fmac_f32 v221, v208, v217
  s_waitcnt vmcnt(15)
  s_waitcnt lgkmcnt(4)
  v_mfma_f32_32x32x16_bf16 v[64:79], a[92:95], v[192:195], v[64:79]
  ds_read_b128 v[192:195], v9 offset:24576
  buffer_load_dwordx4 a[220:223], v2, s[8:11], s41 offen offset:3072 sc1
  v_fmac_f32 v220, v208, v216
  v_mul_f32 v87, v211, v56
  v_mul_f32 v56, v210, v56
  v_mfma_f32_32x32x16_bf16 v[96:111], a[92:95], v[196:199], v[96:111]
  ds_read_b128 v[196:199], v9 offset:28672
  v_fmac_f32 v87, v210, v88
  v_fmac_f32 v56, v223, v88
  v_fma_f32 v217, v209, v220, v87
  s_waitcnt vmcnt(15)
  s_waitcnt lgkmcnt(4)
  v_mfma_f32_32x32x16_bf16 v[64:79], a[100:103], v[176:179], v[64:79]
  ds_read_b128 v[176:179], v10 offset:24576
  s_add_u32 s41, s31, 28672
  buffer_load_dwordx4 a[228:231], v2, s[8:11], s41 offen offset:0 sc1
  v_fma_f32 v216, v4, v221, v56
  v_fmac_f32 v217, v208, v221
  v_mfma_f32_32x32x16_bf16 v[96:111], a[100:103], v[180:183], v[96:111]
  ds_read_b128 v[180:183], v10 offset:28672
  v_fmac_f32 v216, v208, v220
  v_mul_f32 v88, v211, v57
  v_mul_f32 v57, v210, v57
  s_waitcnt vmcnt(15)
  s_waitcnt lgkmcnt(4)
  v_mfma_f32_32x32x16_bf16 v[64:79], a[108:111], v[184:187], v[64:79]
  ds_read_b128 v[184:187], v7 offset:32768
  buffer_load_dwordx4 a[236:239], v2, s[8:11], s41 offen offset:1024 sc1
  v_fmac_f32 v88, v210, v89
  v_fmac_f32 v57, v223, v89
  v_fma_f32 v221, v209, v216, v88
  v_mfma_f32_32x32x16_bf16 v[96:111], a[108:111], v[188:191], v[96:111]
  ds_read_b128 v[188:191], v7 offset:36864
  v_fma_f32 v220, v4, v217, v57
  v_fmac_f32 v221, v208, v217
  v_fmac_f32 v220, v208, v216
  s_waitcnt vmcnt(15)
  s_waitcnt lgkmcnt(4)
  v_mfma_f32_32x32x16_bf16 v[64:79], a[116:119], v[192:195], v[64:79]
  ds_read_b128 v[192:195], v8 offset:32768
  buffer_load_dwordx4 a[244:247], v2, s[8:11], s41 offen offset:2048 sc1
  v_mul_f32 v89, v211, v58
  v_mul_f32 v58, v210, v58
  v_fmac_f32 v89, v210, v90
  v_mfma_f32_32x32x16_bf16 v[96:111], a[116:119], v[196:199], v[96:111]
  ds_read_b128 v[196:199], v8 offset:36864
  v_fmac_f32 v58, v223, v90
  v_fma_f32 v217, v209, v220, v89
  v_fma_f32 v216, v4, v221, v58
  s_waitcnt vmcnt(15)
  s_waitcnt lgkmcnt(4)
  v_mfma_f32_32x32x16_bf16 v[64:79], a[124:127], v[176:179], v[64:79]
  ds_read_b128 v[176:179], v9 offset:32768
  buffer_load_dwordx4 a[252:255], v2, s[8:11], s41 offen offset:3072 sc1
  v_fmac_f32 v217, v208, v221
  v_fmac_f32 v216, v208, v220
  v_mul_f32 v90, v211, v59
  v_mfma_f32_32x32x16_bf16 v[96:111], a[124:127], v[180:183], v[96:111]
  ds_read_b128 v[180:183], v9 offset:36864
  v_mul_f32 v59, v210, v59
  v_fmac_f32 v90, v210, v91
  v_fmac_f32 v59, v223, v91
  s_waitcnt vmcnt(15)
  s_waitcnt lgkmcnt(4)
  v_mfma_f32_32x32x16_bf16 v[64:79], a[132:135], v[184:187], v[64:79]
  ds_read_b128 v[184:187], v10 offset:32768
  s_add_u32 s41, s31, 32768
  buffer_load_dwordx4 v[20:23], v2, s[8:11], s41 offen offset:0 sc1
  v_fma_f32 v221, v209, v216, v90
  v_fma_f32 v220, v4, v217, v59
  v_mfma_f32_32x32x16_bf16 v[96:111], a[132:135], v[188:191], v[96:111]
  ds_read_b128 v[188:191], v10 offset:36864
  v_fmac_f32 v221, v208, v217
  v_fmac_f32 v220, v208, v216
  v_mul_f32 v91, v211, v60
  s_waitcnt vmcnt(15)
  s_waitcnt lgkmcnt(4)
  v_mfma_f32_32x32x16_bf16 v[64:79], a[140:143], v[192:195], v[64:79]
  ds_read_b128 v[192:195], v7 offset:40960
  buffer_load_dwordx4 v[28:31], v2, s[8:11], s41 offen offset:1024 sc1
  v_mul_f32 v60, v210, v60
  v_fmac_f32 v91, v210, v92
  v_fmac_f32 v60, v223, v92
  v_mfma_f32_32x32x16_bf16 v[96:111], a[140:143], v[196:199], v[96:111]
  ds_read_b128 v[196:199], v7 offset:45056
  v_fma_f32 v217, v209, v220, v91
  v_fma_f32 v216, v4, v221, v60
  v_fmac_f32 v217, v208, v221
  s_waitcnt vmcnt(15)
  s_waitcnt lgkmcnt(4)
  v_mfma_f32_32x32x16_bf16 v[64:79], a[148:151], v[176:179], v[64:79]
  ds_read_b128 v[176:179], v8 offset:40960
  buffer_load_dwordx4 v[36:39], v2, s[8:11], s41 offen offset:2048 sc1
  v_fmac_f32 v216, v208, v220
  v_mul_f32 v92, v211, v61
  v_mul_f32 v61, v210, v61
  v_mfma_f32_32x32x16_bf16 v[96:111], a[148:151], v[180:183], v[96:111]
  ds_read_b128 v[180:183], v8 offset:45056
  v_fmac_f32 v92, v210, v93
  v_fmac_f32 v61, v223, v93
  v_fma_f32 v221, v209, v216, v92
  s_waitcnt vmcnt(15)
  s_waitcnt lgkmcnt(4)
  v_mfma_f32_32x32x16_bf16 v[64:79], a[156:159], v[184:187], v[64:79]
  ds_read_b128 v[184:187], v9 offset:40960
  buffer_load_dwordx4 v[44:47], v2, s[8:11], s41 offen offset:3072 sc1
  v_fma_f32 v220, v4, v217, v61
  v_fmac_f32 v221, v208, v217
  v_fmac_f32 v220, v208, v216
  v_mfma_f32_32x32x16_bf16 v[96:111], a[156:159], v[188:191], v[96:111]
  ds_read_b128 v[188:191], v9 offset:45056
  v_mul_f32 v93, v211, v62
  v_mul_f32 v62, v210, v62
  v_fmac_f32 v93, v210, v94
  s_waitcnt vmcnt(15)
  s_waitcnt lgkmcnt(4)
  v_mfma_f32_32x32x16_bf16 v[64:79], a[164:167], v[192:195], v[64:79]
  ds_read_b128 v[192:195], v10 offset:40960
  v_fmac_f32 v62, v223, v94
  v_fma_f32 v217, v209, v220, v93
  v_fma_f32 v216, v4, v221, v62
  v_fmac_f32 v217, v208, v221
  v_fmac_f32 v216, v208, v220
  v_mfma_f32_32x32x16_bf16 v[96:111], a[164:167], v[196:199], v[96:111]
  ds_read_b128 v[196:199], v10 offset:45056
  v_mul_f32 v94, v211, v63
  v_mul_f32 v63, v210, v63
  v_fmac_f32 v94, v210, v95
  s_waitcnt vmcnt(14)
  s_waitcnt lgkmcnt(4)
  v_mfma_f32_32x32x16_bf16 v[64:79], a[172:175], v[176:179], v[64:79]
  ds_read_b128 v[176:179], v7 offset:49152
  v_fmac_f32 v63, v223, v95
  v_fma_f32 v221, v209, v216, v94
  v_fma_f32 v220, v4, v217, v63
  v_fmac_f32 v221, v208, v217
  v_fmac_f32 v220, v208, v216
  v_mfma_f32_32x32x16_bf16 v[96:111], a[172:175], v[180:183], v[96:111]
  ds_read_b128 v[180:183], v7 offset:53248
  s_lshl_b32 s3, s2, 2
  s_add_u32 s3, s3, s30
  s_mul_i32 s3, s3, 5760
  s_waitcnt vmcnt(13)
  s_waitcnt lgkmcnt(4)
  v_mfma_f32_32x32x16_bf16 v[64:79], a[180:183], v[184:187], v[64:79]
  ds_read_b128 v[184:187], v8 offset:49152
  s_add_u32 s3, s3, 256
  v_min_u32 v13, 19, v0
  v_lshrrev_b32 v15, 2, v13
  v_mul_u32_u24 v15, 5, v15
  v_add_u32 v15, v15, v13
  v_mfma_f32_32x32x16_bf16 v[96:111], a[180:183], v[188:191], v[96:111]
  ds_read_b128 v[188:191], v8 offset:53248
  v_bfe_u32 v13, v13, 1, 1
  v_mul_u32_u24 v13, 3, v13
  v_add_u32 v15, v15, v13
  s_waitcnt vmcnt(12)
  s_waitcnt lgkmcnt(4)
  v_mfma_f32_32x32x16_bf16 v[64:79], a[188:191], v[192:195], v[64:79]
  ds_read_b128 v[192:195], v9 offset:49152
  v_lshl_add_u32 v15, v15, 7, s3
  buffer_load_dword v13, v15, s[12:15], 0 offen
  s_lshl_b32 s3, s2, 2
  s_add_u32 s3, s3, s30
  v_mfma_f32_32x32x16_bf16 v[96:111], a[188:191], v[196:199], v[96:111]
  ds_read_b128 v[196:199], v9 offset:53248
  s_mul_i32 s3, s3, 5632
  v_min_u32 v14, 10, v0
  v_lshl_add_u32 v14, v14, 7, s3
  s_waitcnt vmcnt(12)
  s_waitcnt lgkmcnt(4)
  v_mfma_f32_32x32x16_bf16 v[64:79], a[196:199], v[176:179], v[64:79]
  ds_read_b128 v[176:179], v10 offset:49152
  buffer_load_dword v13, v14, s[16:19], 0 offen
  v_add_u32 v14, 1408, v14
  v_mfma_f32_32x32x16_bf16 v[96:111], a[196:199], v[180:183], v[96:111]
  ds_read_b128 v[180:183], v10 offset:53248
  s_waitcnt vmcnt(12)
  s_waitcnt lgkmcnt(4)
  v_mfma_f32_32x32x16_bf16 v[64:79], a[204:207], v[184:187], v[64:79]
  ds_read_b128 v[184:187], v7 offset:57344
  v_mfma_f32_32x32x16_bf16 v[96:111], a[204:207], v[188:191], v[96:111]
  ds_read_b128 v[188:191], v7 offset:61440
  s_waitcnt vmcnt(11)
  s_waitcnt lgkmcnt(4)
  v_mfma_f32_32x32x16_bf16 v[64:79], a[212:215], v[192:195], v[64:79]
  ds_read_b128 v[192:195], v8 offset:57344
  v_mfma_f32_32x32x16_bf16 v[96:111], a[212:215], v[196:199], v[96:111]
  ds_read_b128 v[196:199], v8 offset:61440
  s_waitcnt vmcnt(10)
  s_waitcnt lgkmcnt(4)
  v_mfma_f32_32x32x16_bf16 v[64:79], a[220:223], v[176:179], v[64:79]
  ds_read_b128 v[176:179], v9 offset:57344
  v_mfma_f32_32x32x16_bf16 v[96:111], a[220:223], v[180:183], v[96:111]
  ds_read_b128 v[180:183], v9 offset:61440
  s_waitcnt vmcnt(9)
  s_waitcnt lgkmcnt(4)
  v_mfma_f32_32x32x16_bf16 v[64:79], a[228:231], v[184:187], v[64:79]
  ds_read_b128 v[184:187], v10 offset:57344
  v_mfma_f32_32x32x16_bf16 v[96:111], a[228:231], v[188:191], v[96:111]
  ds_read_b128 v[188:191], v10 offset:61440
  s_waitcnt vmcnt(8)
  s_waitcnt lgkmcnt(4)
  v_mfma_f32_32x32x16_bf16 v[64:79], a[236:239], v[192:195], v[64:79]
  v_add_u32 v7, 0x10000, v7
  v_add_u32 v8, 0x10000, v8
  v_add_u32 v9, 0x10000, v9
  v_add_u32 v10, 0x10000, v10
  ds_read_b128 v[192:195], v7 offset:0
  v_mfma_f32_32x32x16_bf16 v[96:111], a[236:239], v[196:199], v[96:111]
  ds_read_b128 v[196:199], v7 offset:4096
  buffer_load_dword v13, v14, s[16:19], 0 offen
  v_add_u32 v14, 1408, v14
  s_waitcnt vmcnt(8)
  s_waitcnt lgkmcnt(4)
  v_mfma_f32_32x32x16_bf16 v[64:79], a[244:247], v[176:179], v[64:79]
  ds_read_b128 v[176:179], v8 offset:0
  v_mfma_f32_32x32x16_bf16 v[96:111], a[244:247], v[180:183], v[96:111]
  ds_read_b128 v[180:183], v8 offset:4096
  s_waitcnt vmcnt(7)
  s_waitcnt lgkmcnt(4)
  v_mfma_f32_32x32x16_bf16 v[64:79], a[252:255], v[184:187], v[64:79]
  ds_read_b128 v[184:187], v9 offset:0
  v_mfma_f32_32x32x16_bf16 v[96:111], a[252:255], v[188:191], v[96:111]
  ds_read_b128 v[188:191], v9 offset:4096
  s_waitcnt vmcnt(6)
  s_waitcnt lgkmcnt(4)
  v_mfma_f32_32x32x16_bf16 v[64:79], v[20:23], v[192:195], v[64:79]
  ds_read_b128 v[192:195], v10 offset:0
  v_mfma_f32_32x32x16_bf16 v[96:111], v[20:23], v[196:199], v[96:111]
  ds_read_b128 v[196:199], v10 offset:4096
  s_waitcnt vmcnt(5)
  s_waitcnt lgkmcnt(4)
  v_mfma_f32_32x32x16_bf16 v[64:79], v[28:31], v[176:179], v[64:79]
  s_waitcnt lgkmcnt(0)
  s_barrier
  v_add_u32 v5, 0x12000, v5
  ds_read_b64_tr_b16 v[176:177], v5 offset:0
  ds_read_b64_tr_b16 v[178:179], v5 offset:512
  v_mfma_f32_32x32x16_bf16 v[96:111], v[28:31], v[180:183], v[96:111]
  ds_read_b64_tr_b16 v[180:181], v5 offset:2048
  ds_read_b64_tr_b16 v[182:183], v5 offset:2560
  s_waitcnt vmcnt(4)
  v_mfma_f32_32x32x16_bf16 v[64:79], v[36:39], v[184:187], v[64:79]
  ds_read_b64_tr_b16 v[184:185], v5 offset:4096
  ds_read_b64_tr_b16 v[186:187], v5 offset:4608
  s_add_u32 m0, s33, 0
  s_add_u32 s32, s36, 0
  buffer_load_dwordx4 v3, s[12:15], s32 offen lds
  v_mfma_f32_32x32x16_bf16 v[96:111], v[36:39], v[188:191], v[96:111]
  ds_read_b64_tr_b16 v[188:189], v5 offset:6144
  ds_read_b64_tr_b16 v[190:191], v5 offset:6656
  buffer_load_dword v13, v14, s[16:19], 0 offen
  s_waitcnt vmcnt(5)
  v_add_u32 v14, 1408, v14
  v_mfma_f32_32x32x16_bf16 v[64:79], v[44:47], v[192:195], v[64:79]
  ds_read_b64_tr_b16 v[192:193], v5 offset:8192
  ds_read_b64_tr_b16 v[194:195], v5 offset:8704
  v_mfma_f32_32x32x16_bf16 v[96:111], v[44:47], v[196:199], v[96:111]
  ds_read_b64_tr_b16 v[196:197], v5 offset:10240
  ds_read_b64_tr_b16 v[198:199], v5 offset:10752
  s_waitcnt lgkmcnt(8)
  v_mfma_f32_32x32x16_bf16 v[112:127], v[176:179], a[0:3], 0
  s_add_u32 m0, s33, 4096
  s_add_u32 s32, s36, 294912
  buffer_load_dwordx4 v3, s[12:15], s32 offen lds
  v_mfma_f32_32x32x16_bf16 v[128:143], v[176:179], a[4:7], 0
  ds_read_b64_tr_b16 v[176:177], v5 offset:12288
  v_mul_f32 v95, v211, v64
  v_mul_f32 v64, v210, v64
  s_nop 0
  v_fmac_f32 v95, v210, v96
  v_fmac_f32 v64, v223, v96
  v_fma_f32 v217, v209, v220, v95
  v_mfma_f32_32x32x16_bf16 v[112:127], v[180:183], a[8:11], v[112:127]
  ds_read_b64_tr_b16 v[178:179], v5 offset:12800
  v_fma_f32 v216, v4, v221, v64
  v_fmac_f32 v217, v208, v221
  v_fmac_f32 v216, v208, v220
  v_mul_f32 v96, v211, v65
  v_mul_f32 v65, v210, v65
  v_mfma_f32_32x32x16_bf16 v[128:143], v[180:183], a[12:15], v[128:143]
  ds_read_b64_tr_b16 v[180:181], v5 offset:14336
  v_fmac_f32 v96, v210, v97
  v_fmac_f32 v65, v223, v97
  v_fma_f32 v221, v209, v216, v96
  v_fma_f32 v220, v4, v217, v65
  s_waitcnt lgkmcnt(7)
  v_mfma_f32_32x32x16_bf16 v[112:127], v[184:187], a[16:19], v[112:127]
  ds_read_b64_tr_b16 v[182:183], v5 offset:14848
  v_fmac_f32 v221, v208, v217
  v_fmac_f32 v220, v208, v216
  v_mul_f32 v97, v211, v66
  v_mul_f32 v66, v210, v66
  v_fmac_f32 v97, v210, v98
  v_mfma_f32_32x32x16_bf16 v[128:143], v[184:187], a[20:23], v[128:143]
  ds_read_b64_tr_b16 v[184:185], v5 offset:16384
  v_fmac_f32 v66, v223, v98
  v_fma_f32 v217, v209, v220, v97
  v_fma_f32 v216, v4, v221, v66
  v_fmac_f32 v217, v208, v221
  v_fmac_f32 v216, v208, v220
  v_mfma_f32_32x32x16_bf16 v[112:127], v[188:191], a[24:27], v[112:127]
  ds_read_b64_tr_b16 v[186:187], v5 offset:16896
  v_mul_f32 v98, v211, v67
  v_mul_f32 v67, v210, v67
  v_fmac_f32 v98, v210, v99
  v_fmac_f32 v67, v223, v99
  v_fma_f32 v221, v209, v216, v98
  v_mfma_f32_32x32x16_bf16 v[128:143], v[188:191], a[28:31], v[128:143]
  ds_read_b64_tr_b16 v[188:189], v5 offset:18432
  buffer_load_dword v13, v14, s[16:19], 0 offen
  v_add_u32 v14, 1408, v14
  v_fma_f32 v220, v4, v217, v67
  s_waitcnt lgkmcnt(7)
  v_mfma_f32_32x32x16_bf16 v[112:127], v[192:195], a[32:35], v[112:127]
  ds_read_b64_tr_b16 v[190:191], v5 offset:18944
  v_fmac_f32 v221, v208, v217
  v_fmac_f32 v220, v208, v216
  v_mul_f32 v99, v211, v68
  v_mul_f32 v68, v210, v68
  v_fmac_f32 v99, v210, v100
  v_mfma_f32_32x32x16_bf16 v[128:143], v[192:195], a[36:39], v[128:143]
  ds_read_b64_tr_b16 v[192:193], v5 offset:20480
  v_fmac_f32 v68, v223, v100
  v_fma_f32 v217, v209, v220, v99
  v_fma_f32 v216, v4, v221, v68
  v_fmac_f32 v217, v208, v221
  v_fmac_f32 v216, v208, v220
  v_mfma_f32_32x32x16_bf16 v[112:127], v[196:199], a[40:43], v[112:127]
  ds_read_b64_tr_b16 v[194:195], v5 offset:20992
  v_mul_f32 v100, v211, v69
  v_mul_f32 v69, v210, v69
  v_fmac_f32 v100, v210, v101
  v_fmac_f32 v69, v223, v101
  v_fma_f32 v221, v209, v216, v100
  v_mfma_f32_32x32x16_bf16 v[128:143], v[196:199], a[44:47], v[128:143]
  ds_read_b64_tr_b16 v[196:197], v5 offset:22528
  v_fma_f32 v220, v4, v217, v69
  v_fmac_f32 v221, v208, v217
  v_fmac_f32 v220, v208, v216
  v_mul_f32 v101, v211, v70
  s_waitcnt lgkmcnt(7)
  v_mfma_f32_32x32x16_bf16 v[112:127], v[176:179], a[48:51], v[112:127]
  ds_read_b64_tr_b16 v[198:199], v5 offset:23040
  v_mul_f32 v70, v210, v70
  v_fmac_f32 v101, v210, v102
  v_fmac_f32 v70, v223, v102
  v_fma_f32 v217, v209, v220, v101
  v_fma_f32 v216, v4, v221, v70
  v_mfma_f32_32x32x16_bf16 v[128:143], v[176:179], a[52:55], v[128:143]
  ds_read_b64_tr_b16 v[176:177], v5 offset:24576
  v_fmac_f32 v217, v208, v221
  v_fmac_f32 v216, v208, v220
  v_mul_f32 v102, v211, v71
  v_mul_f32 v71, v210, v71
  v_fmac_f32 v102, v210, v103
  v_mfma_f32_32x32x16_bf16 v[112:127], v[180:183], a[56:59], v[112:127]
  ds_read_b64_tr_b16 v[178:179], v5 offset:25088
  v_fmac_f32 v71, v223, v103
  v_fma_f32 v221, v209, v216, v102
  v_fma_f32 v220, v4, v217, v71
  v_fmac_f32 v221, v208, v217
  v_fmac_f32 v220, v208, v216
  v_mfma_f32_32x32x16_bf16 v[128:143], v[180:183], a[60:63], v[128:143]
  ds_read_b64_tr_b16 v[180:181], v5 offset:26624
  v_mul_f32 v103, v211, v72
  v_mul_f32 v72, v210, v72
  v_fmac_f32 v103, v210, v104
  v_fmac_f32 v72, v223, v104
  s_waitcnt lgkmcnt(7)
  v_mfma_f32_32x32x16_bf16 v[112:127], v[184:187], a[64:67], v[112:127]
  ds_read_b64_tr_b16 v[182:183], v5 offset:27136
  v_fma_f32 v217, v209, v220, v103
  v_fma_f32 v216, v4, v221, v72
  v_fmac_f32 v217, v208, v221
  v_fmac_f32 v216, v208, v220
  v_mul_f32 v104, v211, v73
  v_mfma_f32_32x32x16_bf16 v[128:143], v[184:187], a[68:71], v[128:143]
  ds_read_b64_tr_b16 v[184:185], v5 offset:28672
  v_mul_f32 v73, v210, v73
  v_fmac_f32 v104, v210, v105
  v_fmac_f32 v73, v223, v105
  v_fma_f32 v221, v209, v216, v104
  v_fma_f32 v220, v4, v217, v73
  v_mfma_f32_32x32x16_bf16 v[112:127], v[188:191], a[72:75], v[112:127]
  ds_read_b64_tr_b16 v[186:187], v5 offset:29184
  v_fmac_f32 v221, v208, v217
  v_fmac_f32 v220, v208, v216
  v_mul_f32 v105, v211, v74
  v_mul_f32 v74, v210, v74
  v_fmac_f32 v105, v210, v106
  v_mfma_f32_32x32x16_bf16 v[128:143], v[188:191], a[76:79], v[128:143]
  ds_read_b64_tr_b16 v[188:189], v5 offset:30720
  v_fmac_f32 v74, v223, v106
  v_fma_f32 v217, v209, v220, v105
  v_fma_f32 v216, v4, v221, v74
  v_fmac_f32 v217, v208, v221
  s_waitcnt lgkmcnt(7)
  v_mfma_f32_32x32x16_bf16 v[112:127], v[192:195], a[80:83], v[112:127]
  ds_read_b64_tr_b16 v[190:191], v5 offset:31232
  v_fmac_f32 v216, v208, v220
  v_mul_f32 v106, v211, v75
  v_mul_f32 v75, v210, v75
  v_fmac_f32 v106, v210, v107
  v_fmac_f32 v75, v223, v107
  v_mfma_f32_32x32x16_bf16 v[128:143], v[192:195], a[84:87], v[128:143]
  ds_read_b64_tr_b16 v[192:193], v5 offset:32768
  v_fma_f32 v221, v209, v216, v106
  v_fma_f32 v220, v4, v217, v75
  v_fmac_f32 v221, v208, v217
  v_fmac_f32 v220, v208, v216
  v_mul_f32 v107, v211, v76
  v_mfma_f32_32x32x16_bf16 v[112:127], v[196:199], a[88:91], v[112:127]
  ds_read_b64_tr_b16 v[194:195], v5 offset:33280
  v_mul_f32 v76, v210, v76
  v_fmac_f32 v107, v210, v108
  v_fmac_f32 v76, v223, v108
  v_fma_f32 v217, v209, v220, v107
  v_fma_f32 v216, v4, v221, v76
  v_mfma_f32_32x32x16_bf16 v[128:143], v[196:199], a[92:95], v[128:143]
  ds_read_b64_tr_b16 v[196:197], v5 offset:34816
  v_fmac_f32 v217, v208, v221
  v_fmac_f32 v216, v208, v220
  v_mul_f32 v108, v211, v77
  v_mul_f32 v77, v210, v77
  s_waitcnt lgkmcnt(7)
  v_mfma_f32_32x32x16_bf16 v[112:127], v[176:179], a[96:99], v[112:127]
  ds_read_b64_tr_b16 v[198:199], v5 offset:35328
  v_fmac_f32 v108, v210, v109
  v_fmac_f32 v77, v223, v109
  v_fma_f32 v221, v209, v216, v108
  v_fma_f32 v220, v4, v217, v77
  v_fmac_f32 v221, v208, v217
  v_mfma_f32_32x32x16_bf16 v[128:143], v[176:179], a[100:103], v[128:143]
  v_add_u32 v5, 0x9000, v5
  ds_read_b64_tr_b16 v[176:177], v5 offset:0
  v_fmac_f32 v220, v208, v216
  v_mul_f32 v109, v211, v78
  v_mul_f32 v78, v210, v78
  v_fmac_f32 v109, v210, v110
  v_mfma_f32_32x32x16_bf16 v[112:127], v[180:183], a[104:107], v[112:127]
  ds_read_b64_tr_b16 v[178:179], v5 offset:512
  v_fmac_f32 v78, v223, v110
  v_fma_f32 v217, v209, v220, v109
  v_fma_f32 v216, v4, v221, v78
  v_fmac_f32 v217, v208, v221
  v_fmac_f32 v216, v208, v220
  v_mfma_f32_32x32x16_bf16 v[128:143], v[180:183], a[108:111], v[128:143]
  ds_read_b64_tr_b16 v[180:181], v5 offset:2048
  v_mul_f32 v110, v211, v79
  v_mul_f32 v79, v210, v79
  v_fmac_f32 v110, v210, v111
  v_fmac_f32 v79, v223, v111
  s_waitcnt lgkmcnt(7)
  v_mfma_f32_32x32x16_bf16 v[112:127], v[184:187], a[112:115], v[112:127]
  ds_read_b64_tr_b16 v[182:183], v5 offset:2560
  v_fma_f32 v221, v209, v216, v110
  v_fma_f32 v220, v4, v217, v79
  v_fmac_f32 v221, v208, v217
  v_fmac_f32 v220, v208, v216
  v_mov_b32 v1, v228
  v_mfma_f32_32x32x16_bf16 v[128:143], v[184:187], a[116:119], v[128:143]
  ds_read_b64_tr_b16 v[184:185], v5 offset:4096
  v_mov_b32 v2, v229
  ds_write_b64 v224, v[220:221]
  v_mfma_f32_32x32x16_bf16 v[112:127], v[188:191], a[120:123], v[112:127]
  ds_read_b64_tr_b16 v[186:187], v5 offset:4608
  s_add_u32 m0, s33, 8192
  s_add_u32 s32, s36, 589824
  buffer_load_dwordx4 v3, s[12:15], s32 offen lds
  v_mfma_f32_32x32x16_bf16 v[128:143], v[188:191], a[124:127], v[128:143]
  ds_read_b64_tr_b16 v[188:189], v5 offset:6144
  s_waitcnt lgkmcnt(2)
  s_barrier
  ds_read_b128 v[228:231], v227 offset:16384
  ds_read_b128 v[232:235], v227 offset:16400
  ds_read_b128 v[236:239], v227 offset:16416
  v_mfma_f32_32x32x16_bf16 v[112:127], v[192:195], a[128:131], v[112:127]
  ds_read_b64_tr_b16 v[190:191], v5 offset:6656
  ds_read_b128 v[240:243], v227 offset:16432
  v_mov_b32 v223, s45
  s_add_u32 s42, s39, 73728
  v_mfma_f32_32x32x16_bf16 v[128:143], v[192:195], a[132:135], v[128:143]
  ds_read_b64_tr_b16 v[192:193], v5 offset:8192
  s_add_u32 m0, s33, 12288
  s_add_u32 s32, s36, 884736
  buffer_load_dwordx4 v3, s[12:15], s32 offen lds
  v_mfma_f32_32x32x16_bf16 v[112:127], v[196:199], a[136:139], v[112:127]
  ds_read_b64_tr_b16 v[194:195], v5 offset:8704
  v_mfma_f32_32x32x16_bf16 v[128:143], v[196:199], a[140:143], v[128:143]
  ds_read_b64_tr_b16 v[196:197], v5 offset:10240
  v_mfma_f32_32x32x16_bf16 v[112:127], v[176:179], a[144:147], v[112:127]
  ds_read_b64_tr_b16 v[198:199], v5 offset:10752
  s_waitcnt lgkmcnt(4)
  v_fma_f32 v216, -v213, v229, v230
  v_fma_f32 v217, v213, v228, v231
  v_fma_f32 v220, v212, v228, v216
  v_fma_f32 v221, v212, v229, v217
  v_mfma_f32_32x32x16_bf16 v[128:143], v[176:179], a[148:151], v[128:143]
  ds_read_b64_tr_b16 v[176:177], v5 offset:12288
  v_fma_f32 v216, -v213, v221, v232
  v_fma_f32 v217, v213, v220, v233
  v_fma_f32 v220, v212, v220, v216
  v_fma_f32 v221, v212, v221, v217
  v_fma_f32 v216, -v213, v221, v234
  v_mfma_f32_32x32x16_bf16 v[112:127], v[180:183], a[152:155], v[112:127]
  ds_read_b64_tr_b16 v[178:179], v5 offset:12800
  v_fma_f32 v217, v213, v220, v235
  v_fma_f32 v220, v212, v220, v216
  v_fma_f32 v221, v212, v221, v217
  v_fma_f32 v216, -v213, v221, v236
  v_fma_f32 v217, v213, v220, v237
  v_mfma_f32_32x32x16_bf16 v[128:143], v[180:183], a[156:159], v[128:143]
  ds_read_b64_tr_b16 v[180:181], v5 offset:14336
  v_fma_f32 v220, v212, v220, v216
  v_fma_f32 v221, v212, v221, v217
  v_fma_f32 v216, -v213, v221, v238
  v_fma_f32 v217, v213, v220, v239
  v_fma_f32 v220, v212, v220, v216
  v_mfma_f32_32x32x16_bf16 v[112:127], v[184:187], a[160:163], v[112:127]
  ds_read_b64_tr_b16 v[182:183], v5 offset:14848
  v_fma_f32 v221, v212, v221, v217
  v_fma_f32 v216, -v213, v221, v240
  v_fma_f32 v217, v213, v220, v241
  v_fma_f32 v220, v212, v220, v216
  v_fma_f32 v221, v212, v221, v217
  v_mfma_f32_32x32x16_bf16 v[128:143], v[184:187], a[164:167], v[128:143]
  ds_read_b64_tr_b16 v[184:185], v5 offset:16384
  v_fma_f32 v216, -v213, v221, v242
  v_fma_f32 v217, v213, v220, v243
  v_fma_f32 v220, v212, v220, v216
  v_fma_f32 v221, v212, v221, v217
  v_mfma_f32_32x32x16_bf16 v[112:127], v[188:191], a[168:171], v[112:127]
  ds_read_b64_tr_b16 v[186:187], v5 offset:16896
  buffer_store_dwordx4 v[220:223], v249, s[8:11], s42 offen sc1
  v_xor_b32 v224, 16, v244
  v_xor_b32 v227, 32, v245
  v_mfma_f32_32x32x16_bf16 v[128:143], v[188:191], a[172:175], v[128:143]
  ds_read_b64_tr_b16 v[188:189], v5 offset:18432
  s_add_u32 m0, s33, 16384
  s_add_u32 s32, s36, 1179648
  buffer_load_dwordx4 v3, s[12:15], s32 offen lds
  s_waitcnt lgkmcnt(7)
  v_mfma_f32_32x32x16_bf16 v[112:127], v[192:195], a[176:179], v[112:127]
  ds_read_b64_tr_b16 v[190:191], v5 offset:18944
  v_mov_b32 v7, 0
  v_mov_b32 v8, 0
  v_cmp_lt_u32 s[60:61], 0, v225
  v_fma_f32 v216, -v213, v8, v228
  v_fma_f32 v217, v213, v7, v229
  v_mfma_f32_32x32x16_bf16 v[128:143], v[192:195], a[180:183], v[128:143]
  ds_read_b64_tr_b16 v[192:193], v5 offset:20480
  v_fma_f32 v218, v212, v7, v216
  v_fma_f32 v211, v212, v8, v217
  v_cndmask_b32 v7, v7, v218, s[60:61]
  v_cndmask_b32 v8, v8, v211, s[60:61]
  v_cmp_lt_u32 s[60:61], 1, v225
  v_mfma_f32_32x32x16_bf16 v[112:127], v[196:199], a[184:187], v[112:127]
  ds_read_b64_tr_b16 v[194:195], v5 offset:20992
  s_add_u32 m0, s33, 20480
  s_add_u32 s32, s36, 1474560
  buffer_load_dwordx4 v3, s[12:15], s32 offen lds
  v_fma_f32 v216, -v213, v8, v230
  v_mfma_f32_32x32x16_bf16 v[128:143], v[196:199], a[188:191], v[128:143]
  ds_read_b64_tr_b16 v[196:197], v5 offset:22528
  v_fma_f32 v217, v213, v7, v231
  v_fma_f32 v218, v212, v7, v216
  v_fma_f32 v211, v212, v8, v217
  v_cndmask_b32 v7, v7, v218, s[60:61]
  s_waitcnt lgkmcnt(7)
  v_mfma_f32_32x32x16_bf16 v[112:127], v[176:179], a[192:195], v[112:127]
  ds_read_b64_tr_b16 v[198:199], v5 offset:23040
  v_cndmask_b32 v8, v8, v211, s[60:61]
  v_cmp_lt_u32 s[60:61], 2, v225
  v_fma_f32 v216, -v213, v8, v232
  v_fma_f32 v217, v213, v7, v233
  v_fma_f32 v218, v212, v7, v216
  v_mfma_f32_32x32x16_bf16 v[128:143], v[176:179], a[196:199], v[128:143]
  ds_read_b64_tr_b16 v[176:177], v5 offset:24576
  s_add_u32 m0, s33, 24576
  s_add_u32 s32, s36, 1769472
  buffer_load_dwordx4 v3, s[12:15], s32 offen lds
  v_fma_f32 v211, v212, v8, v217
  v_mfma_f32_32x32x16_bf16 v[112:127], v[180:183], a[200:203], v[112:127]
  ds_read_b64_tr_b16 v[178:179], v5 offset:25088
  v_cndmask_b32 v7, v7, v218, s[60:61]
  v_cndmask_b32 v8, v8, v211, s[60:61]
  v_cmp_lt_u32 s[60:61], 3, v225
  v_fma_f32 v216, -v213, v8, v234
  v_fma_f32 v217, v213, v7, v235
  v_mfma_f32_32x32x16_bf16 v[128:143], v[180:183], a[204:207], v[128:143]
  ds_read_b64_tr_b16 v[180:181], v5 offset:26624
  v_fma_f32 v218, v212, v7, v216
  v_fma_f32 v211, v212, v8, v217
  v_cndmask_b32 v7, v7, v218, s[60:61]
  v_cndmask_b32 v8, v8, v211, s[60:61]
  s_waitcnt lgkmcnt(7)
  v_mfma_f32_32x32x16_bf16 v[112:127], v[184:187], a[208:211], v[112:127]
  ds_read_b64_tr_b16 v[182:183], v5 offset:27136
  s_add_u32 m0, s33, 28672
  s_add_u32 s32, s36, 2064384
  buffer_load_dwordx4 v3, s[12:15], s32 offen lds
  v_cmp_lt_u32 s[60:61], 4, v225
  v_mfma_f32_32x32x16_bf16 v[128:143], v[184:187], a[212:215], v[128:143]
  ds_read_b64_tr_b16 v[184:185], v5 offset:28672
  v_fma_f32 v216, -v213, v8, v236
  v_fma_f32 v217, v213, v7, v237
  v_fma_f32 v218, v212, v7, v216
  v_fma_f32 v211, v212, v8, v217
  v_cndmask_b32 v7, v7, v218, s[60:61]
  v_mfma_f32_32x32x16_bf16 v[112:127], v[188:191], a[216:219], v[112:127]
  ds_read_b64_tr_b16 v[186:187], v5 offset:29184
  v_cndmask_b32 v8, v8, v211, s[60:61]
  v_cmp_lt_u32 s[60:61], 5, v225
  v_fma_f32 v216, -v213, v8, v238
  v_fma_f32 v217, v213, v7, v239
  v_fma_f32 v218, v212, v7, v216
  v_mfma_f32_32x32x16_bf16 v[128:143], v[188:191], a[220:223], v[128:143]
  ds_read_b64_tr_b16 v[188:189], v5 offset:30720
  s_add_u32 m0, s33, 32768
  s_add_u32 s32, s36, 2359296
  buffer_load_dwordx4 v3, s[12:15], s32 offen lds
  s_waitcnt lgkmcnt(7)
  v_mfma_f32_32x32x16_bf16 v[112:127], v[192:195], a[224:227], v[112:127]
  ds_read_b64_tr_b16 v[190:191], v5 offset:31232
  v_fma_f32 v211, v212, v8, v217
  v_cndmask_b32 v7, v7, v218, s[60:61]
  v_cndmask_b32 v8, v8, v211, s[60:61]
  v_cmp_lt_u32 s[60:61], 6, v225
  v_fma_f32 v216, -v213, v8, v240
  v_mfma_f32_32x32x16_bf16 v[128:143], v[192:195], a[228:231], v[128:143]
  ds_read_b64_tr_b16 v[192:193], v5 offset:32768
  v_fma_f32 v217, v213, v7, v241
  v_fma_f32 v218, v212, v7, v216
  v_fma_f32 v211, v212, v8, v217
  v_cndmask_b32 v7, v7, v218, s[60:61]
  v_cndmask_b32 v8, v8, v211, s[60:61]
  v_mfma_f32_32x32x16_bf16 v[112:127], v[196:199], a[232:235], v[112:127]
  ds_read_b64_tr_b16 v[194:195], v5 offset:33280
  s_add_u32 m0, s33, 36864
  s_add_u32 s32, s36, 2654208
  buffer_load_dwordx4 v3, s[12:15], s32 offen lds
  v_mfma_f32_32x32x16_bf16 v[128:143], v[196:199], a[236:239], v[128:143]
  ds_read_b64_tr_b16 v[196:197], v5 offset:34816
  s_waitcnt lgkmcnt(7)
  v_mfma_f32_32x32x16_bf16 v[112:127], v[176:179], a[240:243], v[112:127]
  ds_read_b64_tr_b16 v[198:199], v5 offset:35328
  v_mfma_f32_32x32x16_bf16 v[128:143], v[176:179], a[244:247], v[128:143]
  v_add_u32 v6, 0x12000, v6
  ds_read_b64_tr_b16 v[176:177], v6 offset:0
  s_add_u32 m0, s33, 40960
  s_add_u32 s32, s36, 2949120
  buffer_load_dwordx4 v3, s[12:15], s32 offen lds
  v_mfma_f32_32x32x16_bf16 v[112:127], v[180:183], a[248:251], v[112:127]
  ds_read_b64_tr_b16 v[178:179], v6 offset:512
  v_mfma_f32_32x32x16_bf16 v[128:143], v[180:183], a[252:255], v[128:143]
  ds_read_b64_tr_b16 v[180:181], v6 offset:2048
  s_waitcnt lgkmcnt(7)
  v_mfma_f32_32x32x16_bf16 v[112:127], v[184:187], v[16:19], v[112:127]
  ds_read_b64_tr_b16 v[182:183], v6 offset:2560
  s_add_u32 m0, s33, 45056
  s_add_u32 s32, s36, 3244032
  buffer_load_dwordx4 v3, s[12:15], s32 offen lds
  v_mfma_f32_32x32x16_bf16 v[128:143], v[184:187], v[20:23], v[128:143]
  ds_read_b64_tr_b16 v[184:185], v6 offset:4096
  v_mfma_f32_32x32x16_bf16 v[112:127], v[188:191], v[24:27], v[112:127]
  ds_read_b64_tr_b16 v[186:187], v6 offset:4608
  v_mfma_f32_32x32x16_bf16 v[128:143], v[188:191], v[28:31], v[128:143]
  ds_read_b64_tr_b16 v[188:189], v6 offset:6144
  s_add_u32 m0, s33, 49152
  s_add_u32 s32, s36, 3538944
  buffer_load_dwordx4 v3, s[12:15], s32 offen lds
  s_waitcnt lgkmcnt(7)
  v_mfma_f32_32x32x16_bf16 v[112:127], v[192:195], v[32:35], v[112:127]
  ds_read_b64_tr_b16 v[190:191], v6 offset:6656
  v_mfma_f32_32x32x16_bf16 v[128:143], v[192:195], v[36:39], v[128:143]
  ds_read_b64_tr_b16 v[192:193], v6 offset:8192
  v_mfma_f32_32x32x16_bf16 v[112:127], v[196:199], v[40:43], v[112:127]
  ds_read_b64_tr_b16 v[194:195], v6 offset:8704
  s_add_u32 m0, s33, 53248
  s_add_u32 s32, s36, 3833856
  buffer_load_dwordx4 v3, s[12:15], s32 offen lds
  v_mfma_f32_32x32x16_bf16 v[128:143], v[196:199], v[44:47], v[128:143]
  ds_read_b64_tr_b16 v[196:197], v6 offset:10240
  s_waitcnt lgkmcnt(7)
  v_mfma_f32_32x32x16_bf16 v[144:159], v[176:179], a[0:3], 0
  ds_read_b64_tr_b16 v[198:199], v6 offset:10752
  v_mfma_f32_32x32x16_bf16 v[160:175], v[176:179], a[4:7], 0
  ds_read_b64_tr_b16 v[176:177], v6 offset:12288
  s_add_u32 m0, s33, 57344
  s_add_u32 s32, s36, 4128768
  buffer_load_dwordx4 v3, s[12:15], s32 offen lds
  s_lshl_b32 s38, s35, 5
  v_mfma_f32_32x32x16_bf16 v[144:159], v[180:183], a[8:11], v[144:159]
  ds_read_b64_tr_b16 v[178:179], v6 offset:12800
  s_add_u32 s38, s38, s37
  s_add_u32 s38, s38, s34
  v_mul_f32 v200, s40, v112
  v_mul_f32 v201, s40, v113
  v_mfma_f32_32x32x16_bf16 v[160:175], v[180:183], a[12:15], v[160:175]
  ds_read_b64_tr_b16 v[180:181], v6 offset:14336
  v_exp_f32 v200, v200
  v_mul_f32 v202, s40, v114
  s_waitcnt lgkmcnt(7)
  v_mfma_f32_32x32x16_bf16 v[144:159], v[184:187], a[16:19], v[144:159]
  ds_read_b64_tr_b16 v[182:183], v6 offset:14848
  s_add_u32 m0, s33, 61440
  s_add_u32 s32, s36, 4423680
  buffer_load_dwordx4 v3, s[12:15], s32 offen lds
  v_mfma_f32_32x32x16_bf16 v[160:175], v[184:187], a[20:23], v[160:175]
  ds_read_b64_tr_b16 v[184:185], v6 offset:16384
  v_exp_f32 v201, v201
  v_add_f32 v200, 1.0, v200
  v_mul_f32 v203, s40, v115
  v_mfma_f32_32x32x16_bf16 v[144:159], v[188:191], a[24:27], v[144:159]
  ds_read_b64_tr_b16 v[186:187], v6 offset:16896
  v_exp_f32 v202, v202
  v_add_f32 v201, 1.0, v201
  v_rcp_f32 v200, v200
  v_mfma_f32_32x32x16_bf16 v[160:175], v[188:191], a[28:31], v[160:175]
  ds_read_b64_tr_b16 v[188:189], v6 offset:18432
  s_add_u32 m0, s33, 65536
  s_add_u32 s32, s36, 4718592
  buffer_load_dwordx4 v3, s[12:15], s32 offen lds
  s_waitcnt lgkmcnt(7)
  v_mfma_f32_32x32x16_bf16 v[144:159], v[192:195], a[32:35], v[144:159]
  ds_read_b64_tr_b16 v[190:191], v6 offset:18944
  v_mul_f32 v204, s40, v116
  v_exp_f32 v203, v203
  v_add_f32 v202, 1.0, v202
  v_mfma_f32_32x32x16_bf16 v[160:175], v[192:195], a[36:39], v[160:175]
  ds_read_b64_tr_b16 v[192:193], v6 offset:20480
  v_rcp_f32 v201, v201
  v_mul_f32 v200, v200, v112
  v_mul_f32 v205, s40, v117
  v_mfma_f32_32x32x16_bf16 v[144:159], v[196:199], a[40:43], v[144:159]
  ds_read_b64_tr_b16 v[194:195], v6 offset:20992
  s_add_u32 m0, s33, 69632
  s_add_u32 s32, s36, 5013504
  buffer_load_dwordx4 v3, s[12:15], s32 offen lds
  v_mfma_f32_32x32x16_bf16 v[160:175], v[196:199], a[44:47], v[160:175]
  ds_read_b64_tr_b16 v[196:197], v6 offset:22528
  v_exp_f32 v204, v204
  v_add_f32 v203, 1.0, v203
  s_waitcnt lgkmcnt(7)
  v_mfma_f32_32x32x16_bf16 v[144:159], v[176:179], a[48:51], v[144:159]
  ds_read_b64_tr_b16 v[198:199], v6 offset:23040
  v_rcp_f32 v202, v202
  v_mul_f32 v201, v201, v113
  v_mul_f32 v206, s40, v118
  v_mfma_f32_32x32x16_bf16 v[160:175], v[176:179], a[52:55], v[160:175]
  ds_read_b64_tr_b16 v[176:177], v6 offset:24576
  v_exp_f32 v205, v205
  v_add_f32 v204, 1.0, v204
  v_rcp_f32 v203, v203
  v_mfma_f32_32x32x16_bf16 v[144:159], v[180:183], a[56:59], v[144:159]
  ds_read_b64_tr_b16 v[178:179], v6 offset:25088
  v_mul_f32 v202, v202, v114
  v_cvt_pk_bf16_f32 v112, v200, v201
  v_mul_f32 v207, s40, v119
  v_exp_f32 v206, v206
  v_mfma_f32_32x32x16_bf16 v[160:175], v[180:183], a[60:63], v[160:175]
  ds_read_b64_tr_b16 v[180:181], v6 offset:26624
  v_add_f32 v205, 1.0, v205
  v_rcp_f32 v204, v204
  v_mul_f32 v203, v203, v115
  s_waitcnt lgkmcnt(7)
  v_mfma_f32_32x32x16_bf16 v[144:159], v[184:187], a[64:67], v[144:159]
  ds_read_b64_tr_b16 v[182:183], v6 offset:27136
  v_mul_f32 v200, s40, v120
  v_exp_f32 v207, v207
  v_add_f32 v206, 1.0, v206
  v_mfma_f32_32x32x16_bf16 v[160:175], v[184:187], a[68:71], v[160:175]
  ds_read_b64_tr_b16 v[184:185], v6 offset:28672
  v_rcp_f32 v205, v205
  v_mul_f32 v204, v204, v116
  v_cvt_pk_bf16_f32 v113, v202, v203
  v_mul_f32 v201, s40, v121
  v_mfma_f32_32x32x16_bf16 v[144:159], v[188:191], a[72:75], v[144:159]
  ds_read_b64_tr_b16 v[186:187], v6 offset:29184
  v_exp_f32 v200, v200
  v_add_f32 v207, 1.0, v207
  v_rcp_f32 v206, v206
  v_mfma_f32_32x32x16_bf16 v[160:175], v[188:191], a[76:79], v[160:175]
  ds_read_b64_tr_b16 v[188:189], v6 offset:30720
  v_mul_f32 v205, v205, v117
  v_mul_f32 v202, s40, v122
  v_exp_f32 v201, v201
  s_waitcnt lgkmcnt(7)
  v_mfma_f32_32x32x16_bf16 v[144:159], v[192:195], a[80:83], v[144:159]
  ds_read_b64_tr_b16 v[190:191], v6 offset:31232
  v_add_f32 v200, 1.0, v200
  v_rcp_f32 v207, v207
  v_mul_f32 v206, v206, v118
  v_cvt_pk_bf16_f32 v114, v204, v205
  v_mfma_f32_32x32x16_bf16 v[160:175], v[192:195], a[84:87], v[160:175]
  ds_read_b64_tr_b16 v[192:193], v6 offset:32768
  v_mul_f32 v203, s40, v123
  v_exp_f32 v202, v202
  v_add_f32 v201, 1.0, v201
  v_mfma_f32_32x32x16_bf16 v[144:159], v[196:199], a[88:91], v[144:159]
  ds_read_b64_tr_b16 v[194:195], v6 offset:33280
  v_rcp_f32 v200, v200
  v_mul_f32 v207, v207, v119
  v_mul_f32 v204, s40, v124
  v_mfma_f32_32x32x16_bf16 v[160:175], v[196:199], a[92:95], v[160:175]
  ds_read_b64_tr_b16 v[196:197], v6 offset:34816
  v_exp_f32 v203, v203
  v_add_f32 v202, 1.0, v202
  s_waitcnt lgkmcnt(7)
  v_mfma_f32_32x32x16_bf16 v[144:159], v[176:179], a[96:99], v[144:159]
  ds_read_b64_tr_b16 v[198:199], v6 offset:35328
  v_rcp_f32 v201, v201
  v_mul_f32 v200, v200, v120
  v_cvt_pk_bf16_f32 v115, v206, v207
  v_mfma_f32_32x32x16_bf16 v[160:175], v[176:179], a[100:103], v[160:175]
  v_add_u32 v6, 0x9000, v6
  ds_read_b64_tr_b16 v[176:177], v6 offset:0
  buffer_store_dwordx4 v[112:115], v11, s[8:11], s38 offen offset:0 sc1
  v_mul_f32 v205, s40, v125
  v_mfma_f32_32x32x16_bf16 v[144:159], v[180:183], a[104:107], v[144:159]
  ds_read_b64_tr_b16 v[178:179], v6 offset:512
  v_exp_f32 v204, v204
  v_add_f32 v203, 1.0, v203
  v_rcp_f32 v202, v202
  v_mfma_f32_32x32x16_bf16 v[160:175], v[180:183], a[108:111], v[160:175]
  ds_read_b64_tr_b16 v[180:181], v6 offset:2048
  s_add_u32 s42, s39, 0
  buffer_load_dwordx4 v[228:231], v226, s[8:11], s42 offen sc1
  s_add_u32 s42, s39, 18432
  s_waitcnt lgkmcnt(7)
  v_mfma_f32_32x32x16_bf16 v[144:159], v[184:187], a[112:115], v[144:159]
  ds_read_b64_tr_b16 v[182:183], v6 offset:2560
  buffer_load_dwordx4 v[232:235], v226, s[8:11], s42 offen sc1
  s_add_u32 s42, s39, 36864
  buffer_load_dwordx4 v[236:239], v226, s[8:11], s42 offen sc1
  v_mfma_f32_32x32x16_bf16 v[160:175], v[184:187], a[116:119], v[160:175]
  ds_read_b64_tr_b16 v[184:185], v6 offset:4096
  s_add_u32 s42, s39, 55296
  buffer_load_dwordx4 v[240:243], v226, s[8:11], s42 offen sc1
  v_mul_f32 v201, v201, v121
  v_mul_f32 v206, s40, v126
  v_mfma_f32_32x32x16_bf16 v[144:159], v[188:191], a[120:123], v[144:159]
  ds_read_b64_tr_b16 v[186:187], v6 offset:4608
  v_exp_f32 v205, v205
  v_add_f32 v204, 1.0, v204
  v_rcp_f32 v203, v203
  v_mfma_f32_32x32x16_bf16 v[160:175], v[188:191], a[124:127], v[160:175]
  ds_read_b64_tr_b16 v[188:189], v6 offset:6144
  v_mul_f32 v202, v202, v122
  v_cvt_pk_bf16_f32 v120, v200, v201
  v_mul_f32 v207, s40, v127
  s_waitcnt lgkmcnt(7)
  v_mfma_f32_32x32x16_bf16 v[144:159], v[192:195], a[128:131], v[144:159]
  ds_read_b64_tr_b16 v[190:191], v6 offset:6656
  v_exp_f32 v206, v206
  v_add_f32 v205, 1.0, v205
  v_rcp_f32 v204, v204
  v_mfma_f32_32x32x16_bf16 v[160:175], v[192:195], a[132:135], v[160:175]
  ds_read_b64_tr_b16 v[192:193], v6 offset:8192
  v_mul_f32 v203, v203, v123
  v_mul_f32 v200, s40, v128
  v_exp_f32 v207, v207
  v_add_f32 v206, 1.0, v206
  v_mfma_f32_32x32x16_bf16 v[144:159], v[196:199], a[136:139], v[144:159]
  ds_read_b64_tr_b16 v[194:195], v6 offset:8704
  v_rcp_f32 v205, v205
  v_mul_f32 v204, v204, v124
  v_cvt_pk_bf16_f32 v121, v202, v203
  v_mul_f32 v201, s40, v129
  v_mfma_f32_32x32x16_bf16 v[160:175], v[196:199], a[140:143], v[160:175]
  ds_read_b64_tr_b16 v[196:197], v6 offset:10240
  v_exp_f32 v200, v200
  v_add_f32 v207, 1.0, v207
  s_waitcnt lgkmcnt(7)
  v_mfma_f32_32x32x16_bf16 v[144:159], v[176:179], a[144:147], v[144:159]
  ds_read_b64_tr_b16 v[198:199], v6 offset:10752
  v_rcp_f32 v206, v206
  v_mul_f32 v205, v205, v125
  v_mul_f32 v202, s40, v130
  v_mfma_f32_32x32x16_bf16 v[160:175], v[176:179], a[148:151], v[160:175]
  ds_read_b64_tr_b16 v[176:177], v6 offset:12288
  v_exp_f32 v201, v201
  v_add_f32 v200, 1.0, v200
  v_rcp_f32 v207, v207
  v_mfma_f32_32x32x16_bf16 v[144:159], v[180:183], a[152:155], v[144:159]
  ds_read_b64_tr_b16 v[178:179], v6 offset:12800
  v_mul_f32 v206, v206, v126
  v_cvt_pk_bf16_f32 v122, v204, v205
  v_mul_f32 v203, s40, v131
  v_exp_f32 v202, v202
  v_mfma_f32_32x32x16_bf16 v[160:175], v[180:183], a[156:159], v[160:175]
  ds_read_b64_tr_b16 v[180:181], v6 offset:14336
  v_add_f32 v201, 1.0, v201
  v_rcp_f32 v200, v200
  v_mul_f32 v207, v207, v127
  s_waitcnt lgkmcnt(7)
  v_mfma_f32_32x32x16_bf16 v[144:159], v[184:187], a[160:163], v[144:159]
  ds_read_b64_tr_b16 v[182:183], v6 offset:14848
  v_mul_f32 v204, s40, v132
  v_exp_f32 v203, v203
  v_add_f32 v202, 1.0, v202
  v_mfma_f32_32x32x16_bf16 v[160:175], v[184:187], a[164:167], v[160:175]
  ds_read_b64_tr_b16 v[184:185], v6 offset:16384
  v_rcp_f32 v201, v201
  v_mul_f32 v200, v200, v128
  v_cvt_pk_bf16_f32 v123, v206, v207
  v_mfma_f32_32x32x16_bf16 v[144:159], v[188:191], a[168:171], v[144:159]
  ds_read_b64_tr_b16 v[186:187], v6 offset:16896
  buffer_store_dwordx4 v[120:123], v11, s[8:11], s38 offen offset:1024 sc1
  v_mul_f32 v205, s40, v133
  v_mfma_f32_32x32x16_bf16 v[160:175], v[188:191], a[172:175], v[160:175]
  ds_read_b64_tr_b16 v[188:189], v6 offset:18432
  v_exp_f32 v204, v204
  v_add_f32 v203, 1.0, v203
  s_waitcnt lgkmcnt(7)
  v_mfma_f32_32x32x16_bf16 v[144:159], v[192:195], a[176:179], v[144:159]
  ds_read_b64_tr_b16 v[190:191], v6 offset:18944
  v_rcp_f32 v202, v202
  v_mul_f32 v201, v201, v129
  v_mul_f32 v206, s40, v134
  v_mfma_f32_32x32x16_bf16 v[160:175], v[192:195], a[180:183], v[160:175]
  ds_read_b64_tr_b16 v[192:193], v6 offset:20480
  v_exp_f32 v205, v205
  v_add_f32 v204, 1.0, v204
  v_rcp_f32 v203, v203
  v_mfma_f32_32x32x16_bf16 v[144:159], v[196:199], a[184:187], v[144:159]
  ds_read_b64_tr_b16 v[194:195], v6 offset:20992
  v_mul_f32 v202, v202, v130
  v_cvt_pk_bf16_f32 v128, v200, v201
  v_mul_f32 v207, s40, v135
  v_exp_f32 v206, v206
  v_mfma_f32_32x32x16_bf16 v[160:175], v[196:199], a[188:191], v[160:175]
  ds_read_b64_tr_b16 v[196:197], v6 offset:22528
  v_add_f32 v205, 1.0, v205
  v_rcp_f32 v204, v204
  v_mul_f32 v203, v203, v131
  s_waitcnt lgkmcnt(7)
  v_mfma_f32_32x32x16_bf16 v[144:159], v[176:179], a[192:195], v[144:159]
  ds_read_b64_tr_b16 v[198:199], v6 offset:23040
  v_mul_f32 v200, s40, v136
  v_exp_f32 v207, v207
  v_add_f32 v206, 1.0, v206
  v_mfma_f32_32x32x16_bf16 v[160:175], v[176:179], a[196:199], v[160:175]
  ds_read_b64_tr_b16 v[176:177], v6 offset:24576
  v_rcp_f32 v205, v205
  v_mul_f32 v204, v204, v132
  v_cvt_pk_bf16_f32 v129, v202, v203
  v_mul_f32 v201, s40, v137
  v_mfma_f32_32x32x16_bf16 v[144:159], v[180:183], a[200:203], v[144:159]
  ds_read_b64_tr_b16 v[178:179], v6 offset:25088
  v_exp_f32 v200, v200
  v_add_f32 v207, 1.0, v207
  v_rcp_f32 v206, v206
  v_mfma_f32_32x32x16_bf16 v[160:175], v[180:183], a[204:207], v[160:175]
  ds_read_b64_tr_b16 v[180:181], v6 offset:26624
  v_mul_f32 v205, v205, v133
  v_mul_f32 v202, s40, v138
  v_exp_f32 v201, v201
  s_waitcnt lgkmcnt(7)
  v_mfma_f32_32x32x16_bf16 v[144:159], v[184:187], a[208:211], v[144:159]
  ds_read_b64_tr_b16 v[182:183], v6 offset:27136
  v_add_f32 v200, 1.0, v200
  v_rcp_f32 v207, v207
  v_mul_f32 v206, v206, v134
  v_cvt_pk_bf16_f32 v130, v204, v205
  v_mfma_f32_32x32x16_bf16 v[160:175], v[184:187], a[212:215], v[160:175]
  ds_read_b64_tr_b16 v[184:185], v6 offset:28672
  v_mul_f32 v203, s40, v139
  v_exp_f32 v202, v202
  v_add_f32 v201, 1.0, v201
  v_mfma_f32_32x32x16_bf16 v[144:159], v[188:191], a[216:219], v[144:159]
  ds_read_b64_tr_b16 v[186:187], v6 offset:29184
  v_rcp_f32 v200, v200
  v_mul_f32 v207, v207, v135
  v_mul_f32 v204, s40, v140
  v_mfma_f32_32x32x16_bf16 v[160:175], v[188:191], a[220:223], v[160:175]
  ds_read_b64_tr_b16 v[188:189], v6 offset:30720
  v_exp_f32 v203, v203
  v_add_f32 v202, 1.0, v202
  s_waitcnt lgkmcnt(7)
  v_mfma_f32_32x32x16_bf16 v[144:159], v[192:195], a[224:227], v[144:159]
  ds_read_b64_tr_b16 v[190:191], v6 offset:31232
  v_rcp_f32 v201, v201
  v_mul_f32 v200, v200, v136
  v_cvt_pk_bf16_f32 v131, v206, v207
  v_mfma_f32_32x32x16_bf16 v[160:175], v[192:195], a[228:231], v[160:175]
  ds_read_b64_tr_b16 v[192:193], v6 offset:32768
  buffer_store_dwordx4 v[128:131], v12, s[8:11], s38 offen offset:0 sc1
  v_mul_f32 v205, s40, v141
  v_mfma_f32_32x32x16_bf16 v[144:159], v[196:199], a[232:235], v[144:159]
  ds_read_b64_tr_b16 v[194:195], v6 offset:33280
  v_exp_f32 v204, v204
  v_add_f32 v203, 1.0, v203
  v_rcp_f32 v202, v202
  v_mfma_f32_32x32x16_bf16 v[160:175], v[196:199], a[236:239], v[160:175]
  ds_read_b64_tr_b16 v[196:197], v6 offset:34816
  v_mul_f32 v201, v201, v137
  v_mul_f32 v206, s40, v142
  v_exp_f32 v205, v205
  s_waitcnt lgkmcnt(7)
  v_mfma_f32_32x32x16_bf16 v[144:159], v[176:179], a[240:243], v[144:159]
  ds_read_b64_tr_b16 v[198:199], v6 offset:35328
  v_add_f32 v204, 1.0, v204
  v_rcp_f32 v203, v203
  v_mul_f32 v202, v202, v138
  v_cvt_pk_bf16_f32 v136, v200, v201
  v_mfma_f32_32x32x16_bf16 v[160:175], v[176:179], a[244:247], v[160:175]
  s_waitcnt vmcnt(7)
  s_waitcnt lgkmcnt(0)
  s_barrier
  v_add_u32 v5, 0xfffe5000, v5
  ds_read_b64_tr_b16 v[176:177], v5 offset:0
  v_mul_f32 v207, s40, v143
  v_mfma_f32_32x32x16_bf16 v[144:159], v[180:183], a[248:251], v[144:159]
  ds_read_b64_tr_b16 v[178:179], v5 offset:512
  v_exp_f32 v206, v206
  v_add_f32 v205, 1.0, v205
  v_rcp_f32 v204, v204
  v_mfma_f32_32x32x16_bf16 v[160:175], v[180:183], a[252:255], v[160:175]
  ds_read_b64_tr_b16 v[180:181], v5 offset:2048
  s_waitcnt vmcnt(2)
  v_cmp_le_u32 s[60:61], 8, v248
  s_nop 1
  v_cndmask_b32 v231, v222, v230, s[60:61]
  v_cndmask_b32 v228, 0, v228, s[60:61]
  v_cndmask_b32 v229, 0, v229, s[60:61]
  v_mfma_f32_32x32x16_bf16 v[144:159], v[184:187], v[16:19], v[144:159]
  ds_read_b64_tr_b16 v[182:183], v5 offset:2560
  v_cmp_le_u32 s[60:61], 6, v248
  s_nop 1
  v_cndmask_b32 v235, v222, v234, s[60:61]
  v_cndmask_b32 v232, 0, v232, s[60:61]
  v_cndmask_b32 v233, 0, v233, s[60:61]
  v_cmp_le_u32 s[60:61], 4, v248
  v_mfma_f32_32x32x16_bf16 v[160:175], v[184:187], v[20:23], v[160:175]
  ds_read_b64_tr_b16 v[184:185], v5 offset:4096
  v_cndmask_b32 v239, v222, v238, s[60:61]
  v_cndmask_b32 v236, 0, v236, s[60:61]
  v_cndmask_b32 v237, 0, v237, s[60:61]
  v_cmp_le_u32 s[60:61], 2, v248
  s_nop 1
  v_cndmask_b32 v243, v222, v242, s[60:61]
  v_mfma_f32_32x32x16_bf16 v[144:159], v[188:191], v[24:27], v[144:159]
  ds_read_b64_tr_b16 v[186:187], v5 offset:4608
  v_cndmask_b32 v240, 0, v240, s[60:61]
  v_cndmask_b32 v241, 0, v241, s[60:61]
  v_xor_b32 v216, v231, v235
  v_xor_b32 v217, v239, v243
  v_xor_b32 v218, v231, v222
  v_mfma_f32_32x32x16_bf16 v[160:175], v[188:191], v[28:31], v[160:175]
  ds_read_b64_tr_b16 v[188:189], v5 offset:6144
  v_xor_b32 v211, v239, v222
  v_or3_b32 v216, v216, v217, v218
  v_or_b32 v216, v216, v211
  v_mul_f32 v203, v203, v139
  v_mfma_f32_32x32x16_bf16 v[144:159], v[192:195], v[32:35], v[144:159]
  ds_read_b64_tr_b16 v[190:191], v5 offset:6656
  v_cmp_ne_u32 vcc, 0, v216
  s_nop 1
  s_cmp_eq_u64 vcc, 0
  s_cbranch_scc0 POLL5
POLL5_OK:
  v_fma_f32 v216, -v247, v229, v232
  v_mfma_f32_32x32x16_bf16 v[160:175], v[192:195], v[36:39], v[160:175]
  ds_read_b64_tr_b16 v[192:193], v5 offset:8192
  v_fma_f32 v217, v247, v228, v233
  v_fma_f32 v220, v246, v228, v216
  v_fma_f32 v221, v246, v229, v217
  v_fma_f32 v216, -v247, v221, v236
  v_fma_f32 v217, v247, v220, v237
  v_mfma_f32_32x32x16_bf16 v[144:159], v[196:199], v[40:43], v[144:159]
  ds_read_b64_tr_b16 v[194:195], v5 offset:8704
  v_fma_f32 v220, v246, v220, v216
  v_fma_f32 v221, v246, v221, v217
  v_fma_f32 v216, -v247, v221, v240
  v_fma_f32 v217, v247, v220, v241
  v_fma_f32 v220, v246, v220, v216
  v_mfma_f32_32x32x16_bf16 v[160:175], v[196:199], v[44:47], v[160:175]
  ds_read_b64_tr_b16 v[196:197], v5 offset:10240
  v_exp_f32 v207, v207
  v_add_f32 v206, 1.0, v206
  v_rcp_f32 v205, v205
  v_mul_f32 v204, v204, v140
  v_cvt_pk_bf16_f32 v137, v202, v203
  v_add_f32 v207, 1.0, v207
  v_rcp_f32 v206, v206
  v_mul_f32 v205, v205, v141
  v_rcp_f32 v207, v207
  v_mul_f32 v206, v206, v142
  v_cvt_pk_bf16_f32 v138, v204, v205
  v_mul_f32 v207, v207, v143
  v_cvt_pk_bf16_f32 v139, v206, v207
  buffer_store_dwordx4 v[136:139], v12, s[8:11], s38 offen offset:1024 sc1
  s_cmp_eq_u32 s48, 4
  s_cbranch_scc1 AS1
  s_waitcnt lgkmcnt(7)
  v_mfma_f32_32x32x16_bf16 v[112:127], v[176:179], a[0:3], 0
  ds_read_b64_tr_b16 v[198:199], v5 offset:10752
  s_mov_b32 s54, 0x3fffffff
  s_mov_b32 s12, 327680
  s_lshl_b32 s3, s46, 12
  s_add_u32 s12, s12, s3
  v_fma_f32 v221, v246, v221, v217
  v_mfma_f32_32x32x16_bf16 v[128:143], v[176:179], a[4:7], 0
  ds_read_b64_tr_b16 v[176:177], v5 offset:12288
  v_mov_b32 v218, v220
  v_mov_b32 v211, v221
  s_nop 0
  v_permlane32_swap_b32 v220, v218
  v_permlane32_swap_b32 v221, v211
  v_fma_f32 v216, -v215, v221, v218
  v_mfma_f32_32x32x16_bf16 v[112:127], v[180:183], a[8:11], v[112:127]
  ds_read_b64_tr_b16 v[178:179], v5 offset:12800
  v_and_b32 v14, 31, v0
  v_lshrrev_b32 v15, v14, s54
  v_and_b32 v15, 1, v15
  v_xor_b32 v15, 1, v15
  v_lshlrev_b32 v9, 7, v14
  v_lshl_add_u32 v9, v15, 30, v9
  v_mfma_f32_32x32x16_bf16 v[128:143], v[180:183], a[12:15], v[128:143]
  ds_read_b64_tr_b16 v[180:181], v5 offset:14336
  s_add_u32 m0, s51, 73728
  v_fma_f32 v217, v215, v220, v211
  v_fma_f32 v220, v214, v220, v216
  v_fma_f32 v221, v214, v221, v217
  s_waitcnt lgkmcnt(7)
  v_mfma_f32_32x32x16_bf16 v[112:127], v[184:187], a[16:19], v[112:127]
  ds_read_b64_tr_b16 v[182:183], v5 offset:14848
  v_fma_f32 v216, -v2, v221, v7
  v_fma_f32 v217, v2, v220, v8
  v_fma_f32 v220, v1, v220, v216
  v_fma_f32 v221, v1, v221, v217
  v_fmac_f32 v48, v208, v220
  v_mfma_f32_32x32x16_bf16 v[128:143], v[184:187], a[20:23], v[128:143]
  ds_read_b64_tr_b16 v[184:185], v5 offset:16384
  v_fmac_f32 v219, v209, v220
  v_fmac_f32 v48, v4, v221
  v_fmac_f32 v219, v208, v221
  v_fmac_f32 v49, v208, v48
  v_fmac_f32 v80, v209, v48
  v_mfma_f32_32x32x16_bf16 v[112:127], v[188:191], a[24:27], v[112:127]
  ds_read_b64_tr_b16 v[186:187], v5 offset:16896
  buffer_load_dwordx4 v253, s[24:27], s49 offen offset:0 sc1 lds
  v_fmac_f32 v49, v4, v219
  v_fmac_f32 v80, v208, v219
  v_fmac_f32 v50, v208, v49
  v_mfma_f32_32x32x16_bf16 v[128:143], v[188:191], a[28:31], v[128:143]
  ds_read_b64_tr_b16 v[188:189], v5 offset:18432
  v_fmac_f32 v81, v209, v49
  v_fmac_f32 v50, v4, v80
  v_fmac_f32 v81, v208, v80
  v_fmac_f32 v51, v208, v50
  s_waitcnt lgkmcnt(7)
  v_mfma_f32_32x32x16_bf16 v[112:127], v[192:195], a[32:35], v[112:127]
  ds_read_b64_tr_b16 v[190:191], v5 offset:18944
  v_fmac_f32 v82, v209, v50
  v_fmac_f32 v51, v4, v81
  v_fmac_f32 v82, v208, v81
  v_fmac_f32 v52, v208, v51
  v_fmac_f32 v83, v209, v51
  v_mfma_f32_32x32x16_bf16 v[128:143], v[192:195], a[36:39], v[128:143]
  ds_read_b64_tr_b16 v[192:193], v5 offset:20480
  buffer_load_dwordx4 v254, s[24:27], s49 offen offset:1024 sc1 lds
  v_fmac_f32 v52, v4, v82
  v_fmac_f32 v83, v208, v82
  v_fmac_f32 v53, v208, v52
  v_mfma_f32_32x32x16_bf16 v[112:127], v[196:199], a[40:43], v[112:127]
  ds_read_b64_tr_b16 v[194:195], v5 offset:20992
  v_fmac_f32 v84, v209, v52
  v_fmac_f32 v53, v4, v83
  v_fmac_f32 v84, v208, v83
  v_fmac_f32 v54, v208, v53
  v_fmac_f32 v85, v209, v53
  v_mfma_f32_32x32x16_bf16 v[128:143], v[196:199], a[44:47], v[128:143]
  ds_read_b64_tr_b16 v[196:197], v5 offset:22528
  v_fmac_f32 v54, v4, v84
  v_fmac_f32 v85, v208, v84
  v_fmac_f32 v55, v208, v54
  v_fmac_f32 v86, v209, v54
  s_waitcnt lgkmcnt(7)
  v_mfma_f32_32x32x16_bf16 v[112:127], v[176:179], a[48:51], v[112:127]
  ds_read_b64_tr_b16 v[198:199], v5 offset:23040
  buffer_load_dwordx4 v255, s[24:27], s49 offen offset:2048 sc1 lds
  s_add_u32 s49, s49, s50
  v_fmac_f32 v55, v4, v85
  v_fmac_f32 v86, v208, v85
  v_mfma_f32_32x32x16_bf16 v[128:143], v[176:179], a[52:55], v[128:143]
  ds_read_b64_tr_b16 v[176:177], v5 offset:24576
  v_fmac_f32 v56, v208, v55
  v_fmac_f32 v87, v209, v55
  v_fmac_f32 v56, v4, v86
  v_fmac_f32 v87, v208, v86
  v_fmac_f32 v57, v208, v56
  v_mfma_f32_32x32x16_bf16 v[112:127], v[180:183], a[56:59], v[112:127]
  ds_read_b64_tr_b16 v[178:179], v5 offset:25088
  s_add_u32 m0, s51, 76800
  v_fmac_f32 v88, v209, v56
  v_fmac_f32 v57, v4, v87
  v_fmac_f32 v88, v208, v87
  v_fmac_f32 v58, v208, v57
  v_mfma_f32_32x32x16_bf16 v[128:143], v[180:183], a[60:63], v[128:143]
  ds_read_b64_tr_b16 v[180:181], v5 offset:26624
  v_fmac_f32 v89, v209, v57
  v_fmac_f32 v58, v4, v88
  v_fmac_f32 v89, v208, v88
  v_fmac_f32 v59, v208, v58
  s_waitcnt lgkmcnt(7)
  v_mfma_f32_32x32x16_bf16 v[112:127], v[184:187], a[64:67], v[112:127]
  ds_read_b64_tr_b16 v[182:183], v5 offset:27136
  v_fmac_f32 v90, v209, v58
  v_fmac_f32 v59, v4, v89
  v_fmac_f32 v90, v208, v89
  v_fmac_f32 v60, v208, v59
  v_fmac_f32 v91, v209, v59
  v_mfma_f32_32x32x16_bf16 v[128:143], v[184:187], a[68:71], v[128:143]
  ds_read_b64_tr_b16 v[184:185], v5 offset:28672
  buffer_load_dwordx4 v253, s[24:27], s49 offen offset:0 sc1 lds
  v_fmac_f32 v60, v4, v90
  v_fmac_f32 v91, v208, v90
  v_fmac_f32 v61, v208, v60
  v_mfma_f32_32x32x16_bf16 v[112:127], v[188:191], a[72:75], v[112:127]
  ds_read_b64_tr_b16 v[186:187], v5 offset:29184
  v_fmac_f32 v92, v209, v60
  v_fmac_f32 v61, v4, v91
  v_fmac_f32 v92, v208, v91
  v_fmac_f32 v62, v208, v61
  v_fmac_f32 v93, v209, v61
  v_mfma_f32_32x32x16_bf16 v[128:143], v[188:191], a[76:79], v[128:143]
  ds_read_b64_tr_b16 v[188:189], v5 offset:30720
  v_fmac_f32 v62, v4, v92
  v_fmac_f32 v93, v208, v92
  v_fmac_f32 v63, v208, v62
  v_fmac_f32 v94, v209, v62
  s_waitcnt lgkmcnt(7)
  v_mfma_f32_32x32x16_bf16 v[112:127], v[192:195], a[80:83], v[112:127]
  ds_read_b64_tr_b16 v[190:191], v5 offset:31232
  buffer_load_dwordx4 v254, s[24:27], s49 offen offset:1024 sc1 lds
  v_fmac_f32 v63, v4, v93
  v_fmac_f32 v94, v208, v93
  v_fmac_f32 v64, v208, v63
  v_mfma_f32_32x32x16_bf16 v[128:143], v[192:195], a[84:87], v[128:143]
  ds_read_b64_tr_b16 v[192:193], v5 offset:32768
  v_fmac_f32 v95, v209, v63
  v_fmac_f32 v64, v4, v94
  v_fmac_f32 v95, v208, v94
  v_cvt_pk_bf16_f32 v48, v48, v49
  v_cvt_pk_bf16_f32 v49, v50, v51
  v_mfma_f32_32x32x16_bf16 v[112:127], v[196:199], a[88:91], v[112:127]
  ds_read_b64_tr_b16 v[194:195], v5 offset:33280
  v_cvt_pk_bf16_f32 v50, v52, v53
  v_cvt_pk_bf16_f32 v51, v54, v55
  v_cvt_pk_bf16_f32 v52, v56, v57
  v_cvt_pk_bf16_f32 v53, v58, v59
  v_cvt_pk_bf16_f32 v54, v60, v61
  v_mfma_f32_32x32x16_bf16 v[128:143], v[196:199], a[92:95], v[128:143]
  ds_read_b64_tr_b16 v[196:197], v5 offset:34816
  buffer_load_dwordx4 v255, s[24:27], s49 offen offset:2048 sc1 lds
  s_add_u32 s49, s49, s50
  v_cvt_pk_bf16_f32 v55, v62, v63
  s_waitcnt lgkmcnt(7)
  v_mfma_f32_32x32x16_bf16 v[112:127], v[176:179], a[96:99], v[112:127]
  ds_read_b64_tr_b16 v[198:199], v5 offset:35328
  ds_write_b128 v244, v[48:51]
  v_mfma_f32_32x32x16_bf16 v[128:143], v[176:179], a[100:103], v[128:143]
  v_add_u32 v5, 0x9000, v5
  ds_read_b64_tr_b16 v[176:177], v5 offset:0
  s_add_u32 m0, s51, 79872
  s_lshl_b32 s38, s35, 5
  s_add_u32 s38, s38, s37
  s_sub_u32 s38, s38, s34
  v_mfma_f32_32x32x16_bf16 v[112:127], v[180:183], a[104:107], v[112:127]
  ds_read_b64_tr_b16 v[178:179], v5 offset:512
  ds_write_b128 v224, v[52:55]
  v_mfma_f32_32x32x16_bf16 v[128:143], v[180:183], a[108:111], v[128:143]
  ds_read_b64_tr_b16 v[180:181], v5 offset:2048
  ds_read_b64_tr_b16 v[56:57], v245 offset:0
  ds_read_b64_tr_b16 v[58:59], v227 offset:256
  ds_read_b64_tr_b16 v[60:61], v245 offset:1024
  ds_read_b64_tr_b16 v[62:63], v227 offset:1280
  s_waitcnt lgkmcnt(13)
  v_mfma_f32_32x32x16_bf16 v[112:127], v[184:187], a[112:115], v[112:127]
  ds_read_b64_tr_b16 v[182:183], v5 offset:2560
  buffer_load_dwordx4 v253, s[24:27], s49 offen offset:0 sc1 lds
  v_cvt_pk_bf16_f32 v80, -v219, -v80
  v_cvt_pk_bf16_f32 v81, -v81, -v82
  v_cvt_pk_bf16_f32 v82, -v83, -v84
  v_mfma_f32_32x32x16_bf16 v[128:143], v[184:187], a[116:119], v[128:143]
  ds_read_b64_tr_b16 v[184:185], v5 offset:4096
  v_cvt_pk_bf16_f32 v83, -v85, -v86
  v_cvt_pk_bf16_f32 v84, -v87, -v88
  v_cvt_pk_bf16_f32 v85, -v89, -v90
  v_cvt_pk_bf16_f32 v86, -v91, -v92
  v_cvt_pk_bf16_f32 v87, -v93, -v94
  v_mfma_f32_32x32x16_bf16 v[112:127], v[188:191], a[120:123], v[112:127]
  ds_read_b64_tr_b16 v[186:187], v5 offset:4608
  s_add_u32 s32, s53, 327680
  s_waitcnt vmcnt(7)
  s_barrier
  buffer_store_dword v250, v252, s[8:11], s32 offen sc1
  v_mfma_f32_32x32x16_bf16 v[128:143], v[188:191], a[124:127], v[128:143]
  ds_read_b64_tr_b16 v[188:189], v5 offset:6144
  buffer_load_dwordx4 v254, s[24:27], s49 offen offset:1024 sc1 lds
  v_mul_f32 v200, s40, v144
  v_mul_f32 v201, s40, v145
  s_waitcnt lgkmcnt(13)
  v_mfma_f32_32x32x16_bf16 v[112:127], v[192:195], a[128:131], v[112:127]
  ds_read_b64_tr_b16 v[190:191], v5 offset:6656
  ds_write_b128 v244, v[80:83]
  v_mfma_f32_32x32x16_bf16 v[128:143], v[192:195], a[132:135], v[128:143]
  ds_read_b64_tr_b16 v[192:193], v5 offset:8192
  v_exp_f32 v200, v200
  v_mul_f32 v202, s40, v146
  v_exp_f32 v201, v201
  v_mfma_f32_32x32x16_bf16 v[112:127], v[196:199], a[136:139], v[112:127]
  ds_read_b64_tr_b16 v[194:195], v5 offset:8704
  buffer_load_dwordx4 v255, s[24:27], s49 offen offset:2048 sc1 lds
  s_add_u32 s49, s49, s50
  v_add_f32 v200, 1.0, v200
  v_mul_f32 v203, s40, v147
  v_mfma_f32_32x32x16_bf16 v[128:143], v[196:199], a[140:143], v[128:143]
  ds_read_b64_tr_b16 v[196:197], v5 offset:10240
  v_exp_f32 v202, v202
  v_add_f32 v201, 1.0, v201
  s_waitcnt lgkmcnt(8)
  v_mfma_f32_32x32x16_bf16 v[112:127], v[176:179], a[144:147], v[112:127]
  ds_read_b64_tr_b16 v[198:199], v5 offset:10752
  s_add_u32 m0, s51, 82944
  v_rcp_f32 v200, v200
  v_mul_f32 v204, s40, v148
  v_mfma_f32_32x32x16_bf16 v[128:143], v[176:179], a[148:151], v[128:143]
  ds_read_b64_tr_b16 v[176:177], v5 offset:12288
  v_exp_f32 v203, v203
  v_add_f32 v202, 1.0, v202
  v_rcp_f32 v201, v201
  v_mfma_f32_32x32x16_bf16 v[112:127], v[180:183], a[152:155], v[112:127]
  ds_read_b64_tr_b16 v[178:179], v5 offset:12800
  ds_write_b128 v224, v[84:87]
  v_mfma_f32_32x32x16_bf16 v[128:143], v[180:183], a[156:159], v[128:143]
  ds_read_b64_tr_b16 v[180:181], v5 offset:14336
  buffer_load_dwordx4 v253, s[24:27], s49 offen offset:0 sc1 lds
  ds_read_b64_tr_b16 v[228:229], v245 offset:0
  ds_read_b64_tr_b16 v[230:231], v227 offset:256
  s_waitcnt lgkmcnt(11)
  v_mfma_f32_32x32x16_bf16 v[112:127], v[184:187], a[160:163], v[112:127]
  ds_read_b64_tr_b16 v[182:183], v5 offset:14848
  ds_read_b64_tr_b16 v[232:233], v245 offset:1024
  ds_read_b64_tr_b16 v[234:235], v227 offset:1280
  v_fmac_f32 v65, v208, v64
  v_fmac_f32 v96, v209, v64
  v_fmac_f32 v65, v4, v95
  v_mfma_f32_32x32x16_bf16 v[128:143], v[184:187], a[164:167], v[128:143]
  ds_read_b64_tr_b16 v[184:185], v5 offset:16384
  v_fmac_f32 v96, v208, v95
  v_fmac_f32 v66, v208, v65
  v_fmac_f32 v97, v209, v65
  v_fmac_f32 v66, v4, v96
  v_fmac_f32 v97, v208, v96
  v_mfma_f32_32x32x16_bf16 v[112:127], v[188:191], a[168:171], v[112:127]
  ds_read_b64_tr_b16 v[186:187], v5 offset:16896
  buffer_load_dwordx4 v254, s[24:27], s49 offen offset:1024 sc1 lds
  v_fmac_f32 v67, v208, v66
  v_fmac_f32 v98, v209, v66
  v_fmac_f32 v67, v4, v97
  v_mfma_f32_32x32x16_bf16 v[128:143], v[188:191], a[172:175], v[128:143]
  ds_read_b64_tr_b16 v[188:189], v5 offset:18432
  v_fmac_f32 v98, v208, v97
  v_fmac_f32 v68, v208, v67
  v_fmac_f32 v99, v209, v67
  v_fmac_f32 v68, v4, v98
  s_waitcnt lgkmcnt(12)
  v_mfma_f32_32x32x16_bf16 v[112:127], v[192:195], a[176:179], v[112:127]
  ds_read_b64_tr_b16 v[190:191], v5 offset:18944
  v_fmac_f32 v99, v208, v98
  v_fmac_f32 v69, v208, v68
  v_fmac_f32 v100, v209, v68
  v_fmac_f32 v69, v4, v99
  v_fmac_f32 v100, v208, v99
  v_mfma_f32_32x32x16_bf16 v[128:143], v[192:195], a[180:183], v[128:143]
  ds_read_b64_tr_b16 v[192:193], v5 offset:20480
  buffer_load_dwordx4 v255, s[24:27], s49 offen offset:2048 sc1 lds
  s_add_u32 s49, s49, s50
  v_fmac_f32 v70, v208, v69
  v_fmac_f32 v101, v209, v69
  v_mfma_f32_32x32x16_bf16 v[112:127], v[196:199], a[184:187], v[112:127]
  ds_read_b64_tr_b16 v[194:195], v5 offset:20992
  v_fmac_f32 v70, v4, v100
  v_fmac_f32 v101, v208, v100
  v_fmac_f32 v71, v208, v70
  v_fmac_f32 v102, v209, v70
  v_fmac_f32 v71, v4, v101
  v_mfma_f32_32x32x16_bf16 v[128:143], v[196:199], a[188:191], v[128:143]
  ds_read_b64_tr_b16 v[196:197], v5 offset:22528
  s_add_u32 m0, s51, 86016
  v_fmac_f32 v102, v208, v101
  v_fmac_f32 v72, v208, v71
  v_fmac_f32 v103, v209, v71
  s_waitcnt lgkmcnt(9)
  v_mfma_f32_32x32x16_bf16 v[112:127], v[176:179], a[192:195], v[112:127]
  ds_read_b64_tr_b16 v[198:199], v5 offset:23040
  v_fmac_f32 v72, v4, v102
  v_fmac_f32 v103, v208, v102
  s_add_u32 s42, s44, 0
  v_mul_f32 v200, v200, v144
  v_mfma_f32_32x32x16_bf16 v[128:143], v[176:179], a[196:199], v[128:143]
  ds_read_b64_tr_b16 v[176:177], v5 offset:24576
  buffer_store_dwordx4 v[56:59], v11, s[8:11], s42 offen offset:0 sc1
  v_mul_f32 v205, s40, v149
  v_mfma_f32_32x32x16_bf16 v[112:127], v[180:183], a[200:203], v[112:127]
  ds_read_b64_tr_b16 v[178:179], v5 offset:25088
  buffer_load_dwordx4 v253, s[24:27], s49 offen offset:0 sc1 lds
  buffer_store_dwordx4 v[60:63], v11, s[8:11], s42 offen offset:1024 sc1
  v_mfma_f32_32x32x16_bf16 v[128:143], v[180:183], a[204:207], v[128:143]
  ds_read_b64_tr_b16 v[180:181], v5 offset:26624
  s_add_u32 s42, s44, 36864
  s_waitcnt lgkmcnt(11)
  v_exp_f32 v204, v204
  s_waitcnt lgkmcnt(7)
  v_mfma_f32_32x32x16_bf16 v[112:127], v[184:187], a[208:211], v[112:127]
  ds_read_b64_tr_b16 v[182:183], v5 offset:27136
  buffer_store_dwordx4 v[228:231], v11, s[8:11], s42 offen offset:0 sc1
  v_add_f32 v203, 1.0, v203
  v_mfma_f32_32x32x16_bf16 v[128:143], v[184:187], a[212:215], v[128:143]
  ds_read_b64_tr_b16 v[184:185], v5 offset:28672
  buffer_load_dwordx4 v254, s[24:27], s49 offen offset:1024 sc1 lds
  v_rcp_f32 v202, v202
  v_mul_f32 v201, v201, v145
  v_mfma_f32_32x32x16_bf16 v[112:127], v[188:191], a[216:219], v[112:127]
  ds_read_b64_tr_b16 v[186:187], v5 offset:29184
  buffer_store_dwordx4 v[232:235], v11, s[8:11], s42 offen offset:1024 sc1
  v_fmac_f32 v73, v208, v72
  v_fmac_f32 v104, v209, v72
  v_mfma_f32_32x32x16_bf16 v[128:143], v[188:191], a[220:223], v[128:143]
  ds_read_b64_tr_b16 v[188:189], v5 offset:30720
  v_fmac_f32 v73, v4, v103
  v_fmac_f32 v104, v208, v103
  v_fmac_f32 v74, v208, v73
  v_fmac_f32 v105, v209, v73
  s_waitcnt lgkmcnt(7)
  v_mfma_f32_32x32x16_bf16 v[112:127], v[192:195], a[224:227], v[112:127]
  ds_read_b64_tr_b16 v[190:191], v5 offset:31232
  buffer_load_dwordx4 v255, s[24:27], s49 offen offset:2048 sc1 lds
  s_add_u32 s49, s49, s50
  v_fmac_f32 v74, v4, v104
  v_fmac_f32 v105, v208, v104
  v_mfma_f32_32x32x16_bf16 v[128:143], v[192:195], a[228:231], v[128:143]
  ds_read_b64_tr_b16 v[192:193], v5 offset:32768
  v_fmac_f32 v75, v208, v74
  v_fmac_f32 v106, v209, v74
  v_fmac_f32 v75, v4, v105
  v_fmac_f32 v106, v208, v105
  v_fmac_f32 v76, v208, v75
  v_mfma_f32_32x32x16_bf16 v[112:127], v[196:199], a[232:235], v[112:127]
  ds_read_b64_tr_b16 v[194:195], v5 offset:33280
  s_add_u32 m0, s51, 89088
  v_fmac_f32 v107, v209, v75
  v_fmac_f32 v76, v4, v106
  v_fmac_f32 v107, v208, v106
  v_fmac_f32 v77, v208, v76
  v_mfma_f32_32x32x16_bf16 v[128:143], v[196:199], a[236:239], v[128:143]
  ds_read_b64_tr_b16 v[196:197], v5 offset:34816
  v_fmac_f32 v108, v209, v76
  v_fmac_f32 v77, v4, v107
  v_fmac_f32 v108, v208, v107
  v_fmac_f32 v78, v208, v77
  s_waitcnt lgkmcnt(7)
  v_mfma_f32_32x32x16_bf16 v[112:127], v[176:179], a[240:243], v[112:127]
  ds_read_b64_tr_b16 v[198:199], v5 offset:35328
  v_fmac_f32 v109, v209, v77
  v_fmac_f32 v78, v4, v108
  v_fmac_f32 v109, v208, v108
  v_fmac_f32 v79, v208, v78
  v_fmac_f32 v110, v209, v78
  v_mfma_f32_32x32x16_bf16 v[128:143], v[176:179], a[244:247], v[128:143]
  v_add_u32 v6, 0xfffe5000, v6
  ds_read_b64_tr_b16 v[176:177], v6 offset:0
  buffer_load_dwordx4 v253, s[24:27], s49 offen offset:0 sc1 lds
  v_fmac_f32 v79, v4, v109
  v_fmac_f32 v110, v208, v109
  v_mfma_f32_32x32x16_bf16 v[112:127], v[180:183], a[248:251], v[112:127]
  ds_read_b64_tr_b16 v[178:179], v6 offset:512
  v_cvt_pk_bf16_f32 v64, v64, v65
  v_cvt_pk_bf16_f32 v65, v66, v67
  v_cvt_pk_bf16_f32 v66, v68, v69
  v_cvt_pk_bf16_f32 v67, v70, v71
  v_cvt_pk_bf16_f32 v68, v72, v73
  v_mfma_f32_32x32x16_bf16 v[128:143], v[180:183], a[252:255], v[128:143]
  ds_read_b64_tr_b16 v[180:181], v6 offset:2048
  v_cvt_pk_bf16_f32 v69, v74, v75
  v_cvt_pk_bf16_f32 v70, v76, v77
  v_cvt_pk_bf16_f32 v71, v78, v79
  v_mul_f32 v206, s40, v150
  s_waitcnt lgkmcnt(7)
  v_mfma_f32_32x32x16_bf16 v[112:127], v[184:187], v[16:19], v[112:127]
  ds_read_b64_tr_b16 v[182:183], v6 offset:2560
  buffer_load_dwordx4 v254, s[24:27], s49 offen offset:1024 sc1 lds
  v_exp_f32 v205, v205
  v_add_f32 v204, 1.0, v204
  v_mfma_f32_32x32x16_bf16 v[128:143], v[184:187], v[20:23], v[128:143]
  ds_read_b64_tr_b16 v[184:185], v6 offset:4096
  v_rcp_f32 v203, v203
  v_mul_f32 v202, v202, v146
  v_cvt_pk_bf16_f32 v144, v200, v201
  v_mul_f32 v207, s40, v151
  v_mfma_f32_32x32x16_bf16 v[112:127], v[188:191], v[24:27], v[112:127]
  ds_read_b64_tr_b16 v[186:187], v6 offset:4608
  ds_write_b128 v244, v[64:67]
  v_mfma_f32_32x32x16_bf16 v[128:143], v[188:191], v[28:31], v[128:143]
  ds_read_b64_tr_b16 v[188:189], v6 offset:6144
  buffer_load_dwordx4 v255, s[24:27], s49 offen offset:2048 sc1 lds
  s_add_u32 s49, s49, s50
  s_waitcnt lgkmcnt(8)
  v_mfma_f32_32x32x16_bf16 v[112:127], v[192:195], v[32:35], v[112:127]
  ds_read_b64_tr_b16 v[190:191], v6 offset:6656
  ds_write_b128 v224, v[68:71]
  v_mfma_f32_32x32x16_bf16 v[128:143], v[192:195], v[36:39], v[128:143]
  ds_read_b64_tr_b16 v[192:193], v6 offset:8192
  ds_read_b64_tr_b16 v[72:73], v245 offset:0
  ds_read_b64_tr_b16 v[74:75], v227 offset:256
  ds_read_b64_tr_b16 v[76:77], v245 offset:1024
  ds_read_b64_tr_b16 v[78:79], v227 offset:1280
  v_cvt_pk_bf16_f32 v96, -v95, -v96
  v_mfma_f32_32x32x16_bf16 v[112:127], v[196:199], v[40:43], v[112:127]
  ds_read_b64_tr_b16 v[194:195], v6 offset:8704
  v_cvt_pk_bf16_f32 v97, -v97, -v98
  v_cvt_pk_bf16_f32 v98, -v99, -v100
  v_cvt_pk_bf16_f32 v99, -v101, -v102
  v_cvt_pk_bf16_f32 v100, -v103, -v104
  v_cvt_pk_bf16_f32 v101, -v105, -v106
  v_mfma_f32_32x32x16_bf16 v[128:143], v[196:199], v[44:47], v[128:143]
  ds_read_b64_tr_b16 v[196:197], v6 offset:10240
  v_cvt_pk_bf16_f32 v102, -v107, -v108
  v_cvt_pk_bf16_f32 v103, -v109, -v110
  ds_write_b128 v244, v[96:99]
  ds_write_b128 v224, v[100:103]
  ds_read_b64_tr_b16 v[104:105], v245 offset:0
  ds_read_b64_tr_b16 v[106:107], v227 offset:256
  ds_read_b64_tr_b16 v[108:109], v245 offset:1024
  ds_read_b64_tr_b16 v[110:111], v227 offset:1280
  s_add_u32 s42, s44, 0
  s_waitcnt lgkmcnt(8)
  buffer_store_dwordx4 v[72:75], v12, s[8:11], s42 offen offset:0 sc1
  buffer_store_dwordx4 v[76:79], v12, s[8:11], s42 offen offset:1024 sc1
  s_add_u32 s42, s44, 36864
  s_waitcnt lgkmcnt(0)
  buffer_store_dwordx4 v[104:107], v12, s[8:11], s42 offen offset:0 sc1
  buffer_store_dwordx4 v[108:111], v12, s[8:11], s42 offen offset:1024 sc1
  v_mfma_f32_32x32x16_bf16 v[48:63], v[176:179], a[0:3], 0
  ds_read_b64_tr_b16 v[198:199], v6 offset:10752
  v_exp_f32 v206, v206
  v_add_f32 v205, 1.0, v205
  v_rcp_f32 v204, v204
  v_mfma_f32_32x32x16_bf16 v[64:79], v[176:179], a[4:7], 0
  ds_read_b64_tr_b16 v[176:177], v6 offset:12288
  v_mul_f32 v203, v203, v147
  v_mul_f32 v200, s40, v152
  v_exp_f32 v207, v207
  v_add_f32 v206, 1.0, v206
  v_mfma_f32_32x32x16_bf16 v[48:63], v[180:183], a[8:11], v[48:63]
  ds_read_b64_tr_b16 v[178:179], v6 offset:12800
  v_rcp_f32 v205, v205
  v_mul_f32 v204, v204, v148
  v_cvt_pk_bf16_f32 v145, v202, v203
  v_mul_f32 v201, s40, v153
  v_mfma_f32_32x32x16_bf16 v[64:79], v[180:183], a[12:15], v[64:79]
  ds_read_b64_tr_b16 v[180:181], v6 offset:14336
  v_exp_f32 v200, v200
  v_add_f32 v207, 1.0, v207
  v_rcp_f32 v206, v206
  v_mfma_f32_32x32x16_bf16 v[48:63], v[184:187], a[16:19], v[48:63]
  ds_read_b64_tr_b16 v[182:183], v6 offset:14848
  s_waitcnt vmcnt(24)
  ds_read_b64_tr_b16 a[0:1], v251 offset:0
  ds_read_b64_tr_b16 a[2:3], v251 offset:1536
  v_mul_f32 v205, v205, v149
  v_mul_f32 v202, s40, v154
  v_mfma_f32_32x32x16_bf16 v[64:79], v[184:187], a[20:23], v[64:79]
  ds_read_b64_tr_b16 v[184:185], v6 offset:16384
  ds_read_b64_tr_b16 a[4:5], v251 offset:64
  ds_read_b64_tr_b16 a[6:7], v251 offset:1600
  v_exp_f32 v201, v201
  v_add_f32 v200, 1.0, v200
  v_mfma_f32_32x32x16_bf16 v[48:63], v[188:191], a[24:27], v[48:63]
  ds_read_b64_tr_b16 v[186:187], v6 offset:16896
  ds_read_b64_tr_b16 a[8:9], v251 offset:128
  ds_read_b64_tr_b16 a[10:11], v251 offset:1664
  v_rcp_f32 v207, v207
  v_mul_f32 v206, v206, v150
  v_mfma_f32_32x32x16_bf16 v[64:79], v[188:191], a[28:31], v[64:79]
  ds_read_b64_tr_b16 v[188:189], v6 offset:18432
  v_cvt_pk_bf16_f32 v146, v204, v205
  v_mul_f32 v203, s40, v155
  v_exp_f32 v202, v202
  s_waitcnt lgkmcnt(13)
  v_mfma_f32_32x32x16_bf16 v[48:63], v[192:195], a[32:35], v[48:63]
  ds_read_b64_tr_b16 v[190:191], v6 offset:18944
  v_add_f32 v201, 1.0, v201
  v_rcp_f32 v200, v200
  v_mul_f32 v207, v207, v151
  v_mul_f32 v204, s40, v156
  v_mfma_f32_32x32x16_bf16 v[64:79], v[192:195], a[36:39], v[64:79]
  ds_read_b64_tr_b16 v[192:193], v6 offset:20480
  s_waitcnt lgkmcnt(3)
  s_add_u32 m0, s51, 73728
  v_exp_f32 v203, v203
  v_add_f32 v202, 1.0, v202
  v_mfma_f32_32x32x16_bf16 v[48:63], v[196:199], a[40:43], v[48:63]
  ds_read_b64_tr_b16 v[194:195], v6 offset:20992
  v_rcp_f32 v201, v201
  v_mul_f32 v200, v200, v152
  v_cvt_pk_bf16_f32 v147, v206, v207
  v_mfma_f32_32x32x16_bf16 v[64:79], v[196:199], a[44:47], v[64:79]
  ds_read_b64_tr_b16 v[196:197], v6 offset:22528
  buffer_load_dwordx4 v253, s[24:27], s49 offen offset:0 sc1 lds
  buffer_store_dwordx4 v[144:147], v11, s[8:11], s38 offen offset:2048 sc1
  v_mfma_f32_32x32x16_bf16 v[48:63], v[176:179], a[48:51], v[48:63]
  ds_read_b64_tr_b16 v[198:199], v6 offset:23040
  v_mul_f32 v205, s40, v157
  v_exp_f32 v204, v204
  v_add_f32 v203, 1.0, v203
  v_mfma_f32_32x32x16_bf16 v[64:79], v[176:179], a[52:55], v[64:79]
  ds_read_b64_tr_b16 v[176:177], v6 offset:24576
  buffer_load_dwordx4 v254, s[24:27], s49 offen offset:1024 sc1 lds
  v_rcp_f32 v202, v202
  v_mul_f32 v201, v201, v153
  v_mfma_f32_32x32x16_bf16 v[48:63], v[180:183], a[56:59], v[48:63]
  ds_read_b64_tr_b16 v[178:179], v6 offset:25088
  v_mul_f32 v206, s40, v158
  v_exp_f32 v205, v205
  v_add_f32 v204, 1.0, v204
  v_mfma_f32_32x32x16_bf16 v[64:79], v[180:183], a[60:63], v[64:79]
  ds_read_b64_tr_b16 v[180:181], v6 offset:26624
  buffer_load_dwordx4 v255, s[24:27], s49 offen offset:2048 sc1 lds
  s_add_u32 s49, s49, s50
  s_waitcnt vmcnt(25)
  s_waitcnt lgkmcnt(7)
  v_mfma_f32_32x32x16_bf16 v[48:63], v[184:187], a[64:67], v[48:63]
  ds_read_b64_tr_b16 v[182:183], v6 offset:27136
  ds_read_b64_tr_b16 a[12:13], v251 offset:3072
  ds_read_b64_tr_b16 a[14:15], v251 offset:4608
  v_rcp_f32 v203, v203
  v_mul_f32 v202, v202, v154
  v_mfma_f32_32x32x16_bf16 v[64:79], v[184:187], a[68:71], v[64:79]
  ds_read_b64_tr_b16 v[184:185], v6 offset:28672
  ds_read_b64_tr_b16 a[16:17], v251 offset:3136
  ds_read_b64_tr_b16 a[18:19], v251 offset:4672
  v_cvt_pk_bf16_f32 v152, v200, v201
  v_mul_f32 v207, s40, v159
  v_mfma_f32_32x32x16_bf16 v[48:63], v[188:191], a[72:75], v[48:63]
  ds_read_b64_tr_b16 v[186:187], v6 offset:29184
  ds_read_b64_tr_b16 a[20:21], v251 offset:3200
  ds_read_b64_tr_b16 a[22:23], v251 offset:4736
  v_exp_f32 v206, v206
  v_add_f32 v205, 1.0, v205
  v_mfma_f32_32x32x16_bf16 v[64:79], v[188:191], a[76:79], v[64:79]
  ds_read_b64_tr_b16 v[188:189], v6 offset:30720
  v_rcp_f32 v204, v204
  v_mul_f32 v203, v203, v155
  v_mul_f32 v200, s40, v160
  s_waitcnt lgkmcnt(13)
  v_mfma_f32_32x32x16_bf16 v[48:63], v[192:195], a[80:83], v[48:63]
  ds_read_b64_tr_b16 v[190:191], v6 offset:31232
  v_exp_f32 v207, v207
  v_add_f32 v206, 1.0, v206
  v_rcp_f32 v205, v205
  v_mfma_f32_32x32x16_bf16 v[64:79], v[192:195], a[84:87], v[64:79]
  ds_read_b64_tr_b16 v[192:193], v6 offset:32768
  s_waitcnt lgkmcnt(3)
  s_add_u32 m0, s51, 76800
  v_mul_f32 v204, v204, v156
  v_cvt_pk_bf16_f32 v153, v202, v203
  v_mul_f32 v201, s40, v161
  v_mfma_f32_32x32x16_bf16 v[48:63], v[196:199], a[88:91], v[48:63]
  ds_read_b64_tr_b16 v[194:195], v6 offset:33280
  v_exp_f32 v200, v200
  v_add_f32 v207, 1.0, v207
  v_rcp_f32 v206, v206
  v_mfma_f32_32x32x16_bf16 v[64:79], v[196:199], a[92:95], v[64:79]
  ds_read_b64_tr_b16 v[196:197], v6 offset:34816
  buffer_load_dwordx4 v253, s[24:27], s49 offen offset:0 sc1 lds
  v_mul_f32 v205, v205, v157
  v_mul_f32 v202, s40, v162
  v_mfma_f32_32x32x16_bf16 v[48:63], v[176:179], a[96:99], v[48:63]
  ds_read_b64_tr_b16 v[198:199], v6 offset:35328
  v_exp_f32 v201, v201
  v_add_f32 v200, 1.0, v200
  v_rcp_f32 v207, v207
  v_mfma_f32_32x32x16_bf16 v[64:79], v[176:179], a[100:103], v[64:79]
  v_add_u32 v6, 0x9000, v6
  ds_read_b64_tr_b16 v[176:177], v6 offset:0
  buffer_load_dwordx4 v254, s[24:27], s49 offen offset:1024 sc1 lds
  v_mul_f32 v206, v206, v158
  v_cvt_pk_bf16_f32 v154, v204, v205
  v_mfma_f32_32x32x16_bf16 v[48:63], v[180:183], a[104:107], v[48:63]
  ds_read_b64_tr_b16 v[178:179], v6 offset:512
  s_add_u32 s42, s53, 458752
  s_waitcnt vmcnt(6)
  s_barrier
  buffer_store_dword v222, v252, s[8:11], s42 offen sc1
  v_mfma_f32_32x32x16_bf16 v[64:79], v[180:183], a[108:111], v[64:79]
  ds_read_b64_tr_b16 v[180:181], v6 offset:2048
  buffer_load_dwordx4 v255, s[24:27], s49 offen offset:2048 sc1 lds
  s_add_u32 s49, s49, s50
  s_waitcnt lgkmcnt(7)
  v_mfma_f32_32x32x16_bf16 v[48:63], v[184:187], a[112:115], v[48:63]
  ds_read_b64_tr_b16 v[182:183], v6 offset:2560
  ds_read_b64_tr_b16 a[24:25], v251 offset:6144
  ds_read_b64_tr_b16 a[26:27], v251 offset:7680
  v_mul_f32 v203, s40, v163
  v_exp_f32 v202, v202
  v_mfma_f32_32x32x16_bf16 v[64:79], v[184:187], a[116:119], v[64:79]
  ds_read_b64_tr_b16 v[184:185], v6 offset:4096
  ds_read_b64_tr_b16 a[28:29], v251 offset:6208
  ds_read_b64_tr_b16 a[30:31], v251 offset:7744
  v_add_f32 v201, 1.0, v201
  v_rcp_f32 v200, v200
  v_mfma_f32_32x32x16_bf16 v[48:63], v[188:191], a[120:123], v[48:63]
  ds_read_b64_tr_b16 v[186:187], v6 offset:4608
  ds_read_b64_tr_b16 a[32:33], v251 offset:6272
  ds_read_b64_tr_b16 a[34:35], v251 offset:7808
  v_mul_f32 v207, v207, v159
  v_mul_f32 v204, s40, v164
  v_mfma_f32_32x32x16_bf16 v[64:79], v[188:191], a[124:127], v[64:79]
  ds_read_b64_tr_b16 v[188:189], v6 offset:6144
  v_exp_f32 v203, v203
  v_add_f32 v202, 1.0, v202
  s_waitcnt lgkmcnt(13)
  v_mfma_f32_32x32x16_bf16 v[48:63], v[192:195], a[128:131], v[48:63]
  ds_read_b64_tr_b16 v[190:191], v6 offset:6656
  v_rcp_f32 v201, v201
  v_mul_f32 v200, v200, v160
  v_cvt_pk_bf16_f32 v155, v206, v207
  v_mfma_f32_32x32x16_bf16 v[64:79], v[192:195], a[132:135], v[64:79]
  ds_read_b64_tr_b16 v[192:193], v6 offset:8192
  s_waitcnt lgkmcnt(3)
  s_add_u32 m0, s51, 79872
  buffer_store_dwordx4 v[152:155], v11, s[8:11], s38 offen offset:3072 sc1
  v_mfma_f32_32x32x16_bf16 v[48:63], v[196:199], a[136:139], v[48:63]
  ds_read_b64_tr_b16 v[194:195], v6 offset:8704
  v_mul_f32 v205, s40, v165
  v_exp_f32 v204, v204
  v_add_f32 v203, 1.0, v203
  v_mfma_f32_32x32x16_bf16 v[64:79], v[196:199], a[140:143], v[64:79]
  ds_read_b64_tr_b16 v[196:197], v6 offset:10240
  buffer_load_dwordx4 v253, s[24:27], s49 offen offset:0 sc1 lds
  v_rcp_f32 v202, v202
  v_mul_f32 v201, v201, v161
  v_mfma_f32_32x32x16_bf16 v[48:63], v[176:179], a[144:147], v[48:63]
  ds_read_b64_tr_b16 v[198:199], v6 offset:10752
  v_mul_f32 v206, s40, v166
  v_exp_f32 v205, v205
  v_add_f32 v204, 1.0, v204
  v_mfma_f32_32x32x16_bf16 v[64:79], v[176:179], a[148:151], v[64:79]
  ds_read_b64_tr_b16 v[176:177], v6 offset:12288
  buffer_load_dwordx4 v254, s[24:27], s49 offen offset:1024 sc1 lds
  v_rcp_f32 v203, v203
  v_mul_f32 v202, v202, v162
  v_mfma_f32_32x32x16_bf16 v[48:63], v[180:183], a[152:155], v[48:63]
  ds_read_b64_tr_b16 v[178:179], v6 offset:12800
  v_cvt_pk_bf16_f32 v160, v200, v201
  v_mul_f32 v207, s40, v167
  v_exp_f32 v206, v206
  v_add_f32 v205, 1.0, v205
  v_mfma_f32_32x32x16_bf16 v[64:79], v[180:183], a[156:159], v[64:79]
  ds_read_b64_tr_b16 v[180:181], v6 offset:14336
  buffer_load_dwordx4 v255, s[24:27], s49 offen offset:2048 sc1 lds
  s_add_u32 s49, s49, s50
  s_waitcnt lgkmcnt(7)
  v_mfma_f32_32x32x16_bf16 v[48:63], v[184:187], a[160:163], v[48:63]
  ds_read_b64_tr_b16 v[182:183], v6 offset:14848
  ds_read_b64_tr_b16 a[36:37], v251 offset:9216
  ds_read_b64_tr_b16 a[38:39], v251 offset:10752
  v_rcp_f32 v204, v204
  v_mul_f32 v203, v203, v163
  v_mfma_f32_32x32x16_bf16 v[64:79], v[184:187], a[164:167], v[64:79]
  ds_read_b64_tr_b16 v[184:185], v6 offset:16384
  ds_read_b64_tr_b16 a[40:41], v251 offset:9280
  ds_read_b64_tr_b16 a[42:43], v251 offset:10816
  v_mul_f32 v200, s40, v168
  v_exp_f32 v207, v207
  v_mfma_f32_32x32x16_bf16 v[48:63], v[188:191], a[168:171], v[48:63]
  ds_read_b64_tr_b16 v[186:187], v6 offset:16896
  ds_read_b64_tr_b16 a[44:45], v251 offset:9344
  ds_read_b64_tr_b16 a[46:47], v251 offset:10880
  v_add_f32 v206, 1.0, v206
  v_rcp_f32 v205, v205
  v_mfma_f32_32x32x16_bf16 v[64:79], v[188:191], a[172:175], v[64:79]
  ds_read_b64_tr_b16 v[188:189], v6 offset:18432
  v_mul_f32 v204, v204, v164
  v_cvt_pk_bf16_f32 v161, v202, v203
  v_mul_f32 v201, s40, v169
  s_waitcnt lgkmcnt(13)
  v_mfma_f32_32x32x16_bf16 v[48:63], v[192:195], a[176:179], v[48:63]
  ds_read_b64_tr_b16 v[190:191], v6 offset:18944
  v_exp_f32 v200, v200
  v_add_f32 v207, 1.0, v207
  v_rcp_f32 v206, v206
  v_mfma_f32_32x32x16_bf16 v[64:79], v[192:195], a[180:183], v[64:79]
  ds_read_b64_tr_b16 v[192:193], v6 offset:20480
  s_waitcnt lgkmcnt(3)
  s_add_u32 m0, s51, 82944
  v_mul_f32 v205, v205, v165
  v_mul_f32 v202, s40, v170
  v_mfma_f32_32x32x16_bf16 v[48:63], v[196:199], a[184:187], v[48:63]
  ds_read_b64_tr_b16 v[194:195], v6 offset:20992
  v_exp_f32 v201, v201
  v_add_f32 v200, 1.0, v200
  v_rcp_f32 v207, v207
  v_mfma_f32_32x32x16_bf16 v[64:79], v[196:199], a[188:191], v[64:79]
  ds_read_b64_tr_b16 v[196:197], v6 offset:22528
  buffer_load_dwordx4 v253, s[24:27], s49 offen offset:0 sc1 lds
  v_mul_f32 v206, v206, v166
  v_cvt_pk_bf16_f32 v162, v204, v205
  v_mul_f32 v203, s40, v171
  v_mfma_f32_32x32x16_bf16 v[48:63], v[176:179], a[192:195], v[48:63]
  ds_read_b64_tr_b16 v[198:199], v6 offset:23040
  v_exp_f32 v202, v202
  v_add_f32 v201, 1.0, v201
  v_rcp_f32 v200, v200
  v_mfma_f32_32x32x16_bf16 v[64:79], v[176:179], a[196:199], v[64:79]
  ds_read_b64_tr_b16 v[176:177], v6 offset:24576
  buffer_load_dwordx4 v254, s[24:27], s49 offen offset:1024 sc1 lds
  v_mul_f32 v207, v207, v167
  v_mul_f32 v204, s40, v172
  v_mfma_f32_32x32x16_bf16 v[48:63], v[180:183], a[200:203], v[48:63]
  ds_read_b64_tr_b16 v[178:179], v6 offset:25088
  v_exp_f32 v203, v203
  v_add_f32 v202, 1.0, v202
  v_rcp_f32 v201, v201
  v_mfma_f32_32x32x16_bf16 v[64:79], v[180:183], a[204:207], v[64:79]
  ds_read_b64_tr_b16 v[180:181], v6 offset:26624
  buffer_load_dwordx4 v255, s[24:27], s49 offen offset:2048 sc1 lds
  s_add_u32 s49, s49, s50
  s_waitcnt lgkmcnt(7)
  v_mfma_f32_32x32x16_bf16 v[48:63], v[184:187], a[208:211], v[48:63]
  ds_read_b64_tr_b16 v[182:183], v6 offset:27136
  ds_read_b64_tr_b16 a[48:49], v251 offset:12288
  ds_read_b64_tr_b16 a[50:51], v251 offset:13824
  v_mul_f32 v200, v200, v168
  v_cvt_pk_bf16_f32 v163, v206, v207
  v_mfma_f32_32x32x16_bf16 v[64:79], v[184:187], a[212:215], v[64:79]
  ds_read_b64_tr_b16 v[184:185], v6 offset:28672
  ds_read_b64_tr_b16 a[52:53], v251 offset:12352
  ds_read_b64_tr_b16 a[54:55], v251 offset:13888
  buffer_store_dwordx4 v[160:163], v12, s[8:11], s38 offen offset:2048 sc1
  v_mfma_f32_32x32x16_bf16 v[48:63], v[188:191], a[216:219], v[48:63]
  ds_read_b64_tr_b16 v[186:187], v6 offset:29184
  ds_read_b64_tr_b16 a[56:57], v251 offset:12416
  ds_read_b64_tr_b16 a[58:59], v251 offset:13952
  v_mul_f32 v205, s40, v173
  v_exp_f32 v204, v204
  v_mfma_f32_32x32x16_bf16 v[64:79], v[188:191], a[220:223], v[64:79]
  ds_read_b64_tr_b16 v[188:189], v6 offset:30720
  v_add_f32 v203, 1.0, v203
  v_rcp_f32 v202, v202
  v_mul_f32 v201, v201, v169
  s_waitcnt lgkmcnt(13)
  v_mfma_f32_32x32x16_bf16 v[48:63], v[192:195], a[224:227], v[48:63]
  ds_read_b64_tr_b16 v[190:191], v6 offset:31232
  v_mul_f32 v206, s40, v174
  v_exp_f32 v205, v205
  v_add_f32 v204, 1.0, v204
  v_mfma_f32_32x32x16_bf16 v[64:79], v[192:195], a[228:231], v[64:79]
  ds_read_b64_tr_b16 v[192:193], v6 offset:32768
  s_waitcnt lgkmcnt(3)
  s_add_u32 m0, s51, 86016
  v_rcp_f32 v203, v203
  v_mul_f32 v202, v202, v170
  v_mfma_f32_32x32x16_bf16 v[48:63], v[196:199], a[232:235], v[48:63]
  ds_read_b64_tr_b16 v[194:195], v6 offset:33280
  v_cvt_pk_bf16_f32 v168, v200, v201
  v_mul_f32 v207, s40, v175
  v_exp_f32 v206, v206
  v_add_f32 v205, 1.0, v205
  v_mfma_f32_32x32x16_bf16 v[64:79], v[196:199], a[236:239], v[64:79]
  ds_read_b64_tr_b16 v[196:197], v6 offset:34816
  buffer_load_dwordx4 v253, s[24:27], s49 offen offset:0 sc1 lds
  v_rcp_f32 v204, v204
  v_mul_f32 v203, v203, v171
  v_mfma_f32_32x32x16_bf16 v[48:63], v[176:179], a[240:243], v[48:63]
  ds_read_b64_tr_b16 v[198:199], v6 offset:35328
  v_exp_f32 v207, v207
  v_add_f32 v206, 1.0, v206
  v_rcp_f32 v205, v205
  v_mfma_f32_32x32x16_bf16 v[64:79], v[176:179], a[244:247], v[64:79]
  buffer_load_dwordx4 v254, s[24:27], s49 offen offset:1024 sc1 lds
  v_mul_f32 v204, v204, v172
  v_cvt_pk_bf16_f32 v169, v202, v203
  v_add_f32 v207, 1.0, v207
  v_mfma_f32_32x32x16_bf16 v[48:63], v[180:183], a[248:251], v[48:63]
  v_rcp_f32 v206, v206
  v_mul_f32 v205, v205, v173
  v_rcp_f32 v207, v207
  v_mul_f32 v206, v206, v174
  v_mfma_f32_32x32x16_bf16 v[64:79], v[180:183], a[252:255], v[64:79]
  buffer_load_dwordx4 v255, s[24:27], s49 offen offset:2048 sc1 lds
  s_add_u32 s49, s49, s50
  ds_read_b64_tr_b16 a[60:61], v251 offset:15360
  s_waitcnt lgkmcnt(5)
  v_mfma_f32_32x32x16_bf16 v[48:63], v[184:187], v[16:19], v[48:63]
  ds_read_b64_tr_b16 a[62:63], v251 offset:16896
  v_cvt_pk_bf16_f32 v170, v204, v205
  v_mul_f32 v207, v207, v175
  v_cvt_pk_bf16_f32 v171, v206, v207
  v_mfma_f32_32x32x16_bf16 v[64:79], v[184:187], v[20:23], v[64:79]
  ds_read_b64_tr_b16 a[64:65], v251 offset:15424
  ds_read_b64_tr_b16 a[66:67], v251 offset:16960
  buffer_store_dwordx4 v[168:171], v12, s[8:11], s38 offen offset:3072 sc1
  s_lshl_b32 s38, s36, 5
  v_mfma_f32_32x32x16_bf16 v[48:63], v[188:191], v[24:27], v[48:63]
  ds_read_b64_tr_b16 a[68:69], v251 offset:15488
  ds_read_b64_tr_b16 a[70:71], v251 offset:17024
  s_add_u32 s38, s38, s37
  s_add_u32 s38, s38, s34
  v_mul_f32 v200, s40, v112
  v_mul_f32 v201, s40, v113
  v_mfma_f32_32x32x16_bf16 v[64:79], v[188:191], v[28:31], v[64:79]
  v_exp_f32 v200, v200
  v_mul_f32 v202, s40, v114
  v_exp_f32 v201, v201
  s_waitcnt lgkmcnt(6)
  v_mfma_f32_32x32x16_bf16 v[48:63], v[192:195], v[32:35], v[48:63]
  v_add_f32 v200, 1.0, v200
  v_mul_f32 v203, s40, v115
  v_exp_f32 v202, v202
  v_add_f32 v201, 1.0, v201
  v_mfma_f32_32x32x16_bf16 v[64:79], v[192:195], v[36:39], v[64:79]
  s_waitcnt lgkmcnt(0)
  s_add_u32 m0, s51, 89088
  v_rcp_f32 v200, v200
  v_mul_f32 v204, s40, v116
  v_mfma_f32_32x32x16_bf16 v[48:63], v[196:199], v[40:43], v[48:63]
  v_exp_f32 v203, v203
  v_add_f32 v202, 1.0, v202
  v_rcp_f32 v201, v201
  v_mul_f32 v200, v200, v112
  v_mfma_f32_32x32x16_bf16 v[64:79], v[196:199], v[44:47], v[64:79]
  buffer_load_dwordx4 v253, s[24:27], s49 offen offset:0 sc1 lds
  buffer_load_dwordx4 v254, s[24:27], s49 offen offset:1024 sc1 lds
  buffer_load_dwordx4 v255, s[24:27], s49 offen offset:2048 sc1 lds
  s_add_u32 s49, s49, s50
  s_barrier
  v_mul_f32 v205, s40, v117
  v_exp_f32 v204, v204
  v_add_f32 v203, 1.0, v203
  v_rcp_f32 v202, v202
  v_mul_f32 v201, v201, v113
  v_mul_f32 v206, s40, v118
  v_exp_f32 v205, v205
  v_add_f32 v204, 1.0, v204
  v_rcp_f32 v203, v203
  v_mul_f32 v202, v202, v114
  v_cvt_pk_bf16_f32 v112, v200, v201
  v_mul_f32 v207, s40, v119
  v_exp_f32 v206, v206
  v_add_f32 v205, 1.0, v205
  v_rcp_f32 v204, v204
  v_mul_f32 v203, v203, v115
  v_mul_f32 v200, s40, v120
  v_exp_f32 v207, v207
  v_add_f32 v206, 1.0, v206
  v_rcp_f32 v205, v205
  v_mul_f32 v204, v204, v116
  v_cvt_pk_bf16_f32 v113, v202, v203
  v_mul_f32 v201, s40, v121
  v_exp_f32 v200, v200
  v_add_f32 v207, 1.0, v207
  v_rcp_f32 v206, v206
  v_mul_f32 v205, v205, v117
  v_mul_f32 v202, s40, v122
  v_exp_f32 v201, v201
  v_add_f32 v200, 1.0, v200
  v_rcp_f32 v207, v207
  v_mul_f32 v206, v206, v118
  v_cvt_pk_bf16_f32 v114, v204, v205
  v_mul_f32 v203, s40, v123
  v_exp_f32 v202, v202
  v_add_f32 v201, 1.0, v201
  v_rcp_f32 v200, v200
  v_mul_f32 v207, v207, v119
  v_mul_f32 v204, s40, v124
  v_exp_f32 v203, v203
  v_add_f32 v202, 1.0, v202
  v_rcp_f32 v201, v201
  v_mul_f32 v200, v200, v120
  v_cvt_pk_bf16_f32 v115, v206, v207
  buffer_store_dwordx4 v[112:115], v11, s[8:11], s38 offen offset:0 sc1
  v_mul_f32 v205, s40, v125
  v_exp_f32 v204, v204
  v_add_f32 v203, 1.0, v203
  v_rcp_f32 v202, v202
  v_mul_f32 v201, v201, v121
  v_mul_f32 v206, s40, v126
  v_exp_f32 v205, v205
  v_add_f32 v204, 1.0, v204
  v_rcp_f32 v203, v203
  v_mul_f32 v202, v202, v122
  v_cvt_pk_bf16_f32 v120, v200, v201
  v_mul_f32 v207, s40, v127
  v_exp_f32 v206, v206
  v_add_f32 v205, 1.0, v205
  v_rcp_f32 v204, v204
  v_mul_f32 v203, v203, v123
  v_mul_f32 v200, s40, v128
  v_exp_f32 v207, v207
  v_add_f32 v206, 1.0, v206
  v_rcp_f32 v205, v205
  v_mul_f32 v204, v204, v124
  v_cvt_pk_bf16_f32 v121, v202, v203
  v_mul_f32 v201, s40, v129
  v_exp_f32 v200, v200
  v_add_f32 v207, 1.0, v207
  v_rcp_f32 v206, v206
  v_mul_f32 v205, v205, v125
  v_mul_f32 v202, s40, v130
  v_exp_f32 v201, v201
  v_add_f32 v200, 1.0, v200
  v_rcp_f32 v207, v207
  v_mul_f32 v206, v206, v126
  v_cvt_pk_bf16_f32 v122, v204, v205
  v_mul_f32 v203, s40, v131
  v_exp_f32 v202, v202
  v_add_f32 v201, 1.0, v201
  v_rcp_f32 v200, v200
  v_mul_f32 v207, v207, v127
  v_mul_f32 v204, s40, v132
  v_exp_f32 v203, v203
  v_add_f32 v202, 1.0, v202
  v_rcp_f32 v201, v201
  v_mul_f32 v200, v200, v128
  v_cvt_pk_bf16_f32 v123, v206, v207
  buffer_store_dwordx4 v[120:123], v11, s[8:11], s38 offen offset:1024 sc1
  v_mul_f32 v205, s40, v133
  v_exp_f32 v204, v204
  v_add_f32 v203, 1.0, v203
  v_rcp_f32 v202, v202
  v_mul_f32 v201, v201, v129
  v_mul_f32 v206, s40, v134
  v_exp_f32 v205, v205
  v_add_f32 v204, 1.0, v204
  v_rcp_f32 v203, v203
  v_mul_f32 v202, v202, v130
  v_cvt_pk_bf16_f32 v128, v200, v201
  v_mul_f32 v207, s40, v135
  v_exp_f32 v206, v206
  v_add_f32 v205, 1.0, v205
  v_rcp_f32 v204, v204
  v_mul_f32 v203, v203, v131
  v_mul_f32 v200, s40, v136
  v_exp_f32 v207, v207
  v_add_f32 v206, 1.0, v206
  v_rcp_f32 v205, v205
  v_mul_f32 v204, v204, v132
  v_cvt_pk_bf16_f32 v129, v202, v203
  v_mul_f32 v201, s40, v137
  v_exp_f32 v200, v200
  v_add_f32 v207, 1.0, v207
  v_rcp_f32 v206, v206
  v_mul_f32 v205, v205, v133
  v_mul_f32 v202, s40, v138
  v_exp_f32 v201, v201
  v_add_f32 v200, 1.0, v200
  v_rcp_f32 v207, v207
  v_mul_f32 v206, v206, v134
  v_cvt_pk_bf16_f32 v130, v204, v205
  v_mul_f32 v203, s40, v139
  v_exp_f32 v202, v202
  v_add_f32 v201, 1.0, v201
  v_rcp_f32 v200, v200
  v_mul_f32 v207, v207, v135
  v_mul_f32 v204, s40, v140
  v_exp_f32 v203, v203
  v_add_f32 v202, 1.0, v202
  v_rcp_f32 v201, v201
  v_mul_f32 v200, v200, v136
  v_cvt_pk_bf16_f32 v131, v206, v207
  buffer_store_dwordx4 v[128:131], v12, s[8:11], s38 offen offset:0 sc1
  v_mul_f32 v205, s40, v141
  v_exp_f32 v204, v204
  v_add_f32 v203, 1.0, v203
  v_rcp_f32 v202, v202
  v_mul_f32 v201, v201, v137
  v_mul_f32 v206, s40, v142
  v_exp_f32 v205, v205
  v_add_f32 v204, 1.0, v204
  v_rcp_f32 v203, v203
  v_mul_f32 v202, v202, v138
  v_cvt_pk_bf16_f32 v136, v200, v201
  v_mul_f32 v207, s40, v143
  v_exp_f32 v206, v206
  v_add_f32 v205, 1.0, v205
  v_rcp_f32 v204, v204
  v_mul_f32 v203, v203, v139
  v_exp_f32 v207, v207
  v_add_f32 v206, 1.0, v206
  v_rcp_f32 v205, v205
  v_mul_f32 v204, v204, v140
  v_cvt_pk_bf16_f32 v137, v202, v203
  v_add_f32 v207, 1.0, v207
  v_rcp_f32 v206, v206
  v_mul_f32 v205, v205, v141
  v_rcp_f32 v207, v207
  v_mul_f32 v206, v206, v142
  v_cvt_pk_bf16_f32 v138, v204, v205
  v_mul_f32 v207, v207, v143
  v_cvt_pk_bf16_f32 v139, v206, v207
  buffer_store_dwordx4 v[136:139], v12, s[8:11], s38 offen offset:1024 sc1
  s_lshl_b32 s38, s36, 5
  s_add_u32 s38, s38, s37
  s_sub_u32 s38, s38, s34
  v_mul_f32 v200, s40, v48
  v_mul_f32 v201, s40, v49
  v_exp_f32 v200, v200
  v_mul_f32 v202, s40, v50
  v_exp_f32 v201, v201
  v_add_f32 v200, 1.0, v200
  v_mul_f32 v203, s40, v51
  v_exp_f32 v202, v202
  v_add_f32 v201, 1.0, v201
  v_rcp_f32 v200, v200
  v_mul_f32 v204, s40, v52
  v_exp_f32 v203, v203
  v_add_f32 v202, 1.0, v202
  v_rcp_f32 v201, v201
  v_mul_f32 v200, v200, v48
  v_mul_f32 v205, s40, v53
  v_exp_f32 v204, v204
  v_add_f32 v203, 1.0, v203
  v_rcp_f32 v202, v202
  v_mul_f32 v201, v201, v49
  v_mul_f32 v206, s40, v54
  v_exp_f32 v205, v205
  v_add_f32 v204, 1.0, v204
  v_rcp_f32 v203, v203
  v_mul_f32 v202, v202, v50
  v_cvt_pk_bf16_f32 v48, v200, v201
  v_mul_f32 v207, s40, v55
  v_exp_f32 v206, v206
  v_add_f32 v205, 1.0, v205
  v_rcp_f32 v204, v204
  buffer_load_dword v8, v9, s[8:11], s12 offen sc1
  v_mul_f32 v203, v203, v51
  v_mul_f32 v200, s40, v56
  v_exp_f32 v207, v207
  v_add_f32 v206, 1.0, v206
  v_rcp_f32 v205, v205
  v_mul_f32 v204, v204, v52
  v_cvt_pk_bf16_f32 v49, v202, v203
  v_mul_f32 v201, s40, v57
  v_exp_f32 v200, v200
  v_add_f32 v207, 1.0, v207
  v_rcp_f32 v206, v206
  v_mul_f32 v205, v205, v53
  v_mul_f32 v202, s40, v58
  v_exp_f32 v201, v201
  v_add_f32 v200, 1.0, v200
  v_rcp_f32 v207, v207
  v_mul_f32 v206, v206, v54
  v_cvt_pk_bf16_f32 v50, v204, v205
  v_mul_f32 v203, s40, v59
  v_exp_f32 v202, v202
  v_add_f32 v201, 1.0, v201
  v_rcp_f32 v200, v200
  v_mul_f32 v207, v207, v55
  v_mul_f32 v204, s40, v60
  v_exp_f32 v203, v203
  v_add_f32 v202, 1.0, v202
  v_rcp_f32 v201, v201
  v_mul_f32 v200, v200, v56
  v_cvt_pk_bf16_f32 v51, v206, v207
  buffer_store_dwordx4 v[48:51], v11, s[8:11], s38 offen offset:2048 sc1
  v_mul_f32 v205, s40, v61
  v_exp_f32 v204, v204
  v_add_f32 v203, 1.0, v203
  v_rcp_f32 v202, v202
  v_mul_f32 v201, v201, v57
  v_mul_f32 v206, s40, v62
  v_exp_f32 v205, v205
  v_add_f32 v204, 1.0, v204
  v_rcp_f32 v203, v203
  v_mul_f32 v202, v202, v58
  v_cvt_pk_bf16_f32 v56, v200, v201
  v_mul_f32 v207, s40, v63
  v_exp_f32 v206, v206
  v_add_f32 v205, 1.0, v205
  v_rcp_f32 v204, v204
  v_mul_f32 v203, v203, v59
  v_mul_f32 v200, s40, v64
  v_exp_f32 v207, v207
  v_add_f32 v206, 1.0, v206
  v_rcp_f32 v205, v205
  v_mul_f32 v204, v204, v60
  v_cvt_pk_bf16_f32 v57, v202, v203
  v_mul_f32 v201, s40, v65
  v_exp_f32 v200, v200
  v_add_f32 v207, 1.0, v207
  v_rcp_f32 v206, v206
  v_mul_f32 v205, v205, v61
  v_mul_f32 v202, s40, v66
  v_exp_f32 v201, v201
  v_add_f32 v200, 1.0, v200
  v_rcp_f32 v207, v207
  v_mul_f32 v206, v206, v62
  v_cvt_pk_bf16_f32 v58, v204, v205
  v_mul_f32 v203, s40, v67
  v_exp_f32 v202, v202
  v_add_f32 v201, 1.0, v201
  v_rcp_f32 v200, v200
  v_mul_f32 v207, v207, v63
  v_mul_f32 v204, s40, v68
  v_exp_f32 v203, v203
  v_add_f32 v202, 1.0, v202
  v_rcp_f32 v201, v201
  v_mul_f32 v200, v200, v64
  v_cvt_pk_bf16_f32 v59, v206, v207
  buffer_store_dwordx4 v[56:59], v11, s[8:11], s38 offen offset:3072 sc1
  v_mul_f32 v205, s40, v69
  v_exp_f32 v204, v204
  v_add_f32 v203, 1.0, v203
  v_rcp_f32 v202, v202
  v_mul_f32 v201, v201, v65
  v_mul_f32 v206, s40, v70
  v_exp_f32 v205, v205
  v_add_f32 v204, 1.0, v204
  v_rcp_f32 v203, v203
  v_mul_f32 v202, v202, v66
  v_cvt_pk_bf16_f32 v64, v200, v201
  v_mul_f32 v207, s40, v71
  v_exp_f32 v206, v206
  v_add_f32 v205, 1.0, v205
  v_rcp_f32 v204, v204
  v_mul_f32 v203, v203, v67
  v_mul_f32 v200, s40, v72
  v_exp_f32 v207, v207
  v_add_f32 v206, 1.0, v206
  v_rcp_f32 v205, v205
  v_mul_f32 v204, v204, v68
  v_cvt_pk_bf16_f32 v65, v202, v203
  v_mul_f32 v201, s40, v73
  v_exp_f32 v200, v200
  v_add_f32 v207, 1.0, v207
  v_rcp_f32 v206, v206
  v_mul_f32 v205, v205, v69
  v_mul_f32 v202, s40, v74
  v_exp_f32 v201, v201
  v_add_f32 v200, 1.0, v200
  v_rcp_f32 v207, v207
  v_mul_f32 v206, v206, v70
  v_cvt_pk_bf16_f32 v66, v204, v205
  v_mul_f32 v203, s40, v75
  v_exp_f32 v202, v202
  v_add_f32 v201, 1.0, v201
  v_rcp_f32 v200, v200
  v_mul_f32 v207, v207, v71
  v_mul_f32 v204, s40, v76
  v_exp_f32 v203, v203
  v_add_f32 v202, 1.0, v202
  v_rcp_f32 v201, v201
  v_mul_f32 v200, v200, v72
  v_cvt_pk_bf16_f32 v67, v206, v207
  buffer_store_dwordx4 v[64:67], v12, s[8:11], s38 offen offset:2048 sc1
  v_mul_f32 v205, s40, v77
  v_exp_f32 v204, v204
  v_add_f32 v203, 1.0, v203
  v_rcp_f32 v202, v202
  v_mul_f32 v201, v201, v73
  v_mul_f32 v206, s40, v78
  v_exp_f32 v205, v205
  v_add_f32 v204, 1.0, v204
  v_rcp_f32 v203, v203
  v_mul_f32 v202, v202, v74
  v_cvt_pk_bf16_f32 v72, v200, v201
  v_mul_f32 v207, s40, v79
  v_exp_f32 v206, v206
  v_add_f32 v205, 1.0, v205
  v_rcp_f32 v204, v204
  v_mul_f32 v203, v203, v75
  v_exp_f32 v207, v207
  v_add_f32 v206, 1.0, v206
  v_rcp_f32 v205, v205
  v_mul_f32 v204, v204, v76
  v_cvt_pk_bf16_f32 v73, v202, v203
  v_add_f32 v207, 1.0, v207
  v_rcp_f32 v206, v206
  v_mul_f32 v205, v205, v77
  v_rcp_f32 v207, v207
  v_mul_f32 v206, v206, v78
  v_cvt_pk_bf16_f32 v74, v204, v205
  v_mul_f32 v207, v207, v79
  v_cvt_pk_bf16_f32 v75, v206, v207
  buffer_store_dwordx4 v[72:75], v12, s[8:11], s38 offen offset:3072 sc1
  s_waitcnt vmcnt(4)
  v_cmp_ne_u32 vcc, s45, v8
  s_nop 1
  s_or_b32 s4, vcc_lo, vcc_hi
  s_and_b32 s4, s4, s54
  s_cmp_eq_u32 s4, 0
  s_cbranch_scc0 POLL6
POLL6_OK:
  s_nop 3
  s_branch B_FFN
AS1:
  s_nop 9
  s_waitcnt lgkmcnt(7)
  v_mfma_f32_32x32x16_bf16 v[112:127], v[176:179], a[0:3], 0
  ds_read_b64_tr_b16 v[198:199], v5 offset:10752
  v_min_u32 v15, 47, v0
  v_lshlrev_b32 v15, 7, v15
  s_mov_b32 s52, 524288
  buffer_load_dword v10, v15, s[8:11], s52 offen sc1
  v_mfma_f32_32x32x16_bf16 v[128:143], v[176:179], a[4:7], 0
  ds_read_b64_tr_b16 v[176:177], v5 offset:12288
  v_fma_f32 v221, v246, v221, v217
  v_mov_b32 v218, v220
  v_mov_b32 v211, v221
  s_nop 0
  v_permlane32_swap_b32 v220, v218
  v_permlane32_swap_b32 v221, v211
  v_mfma_f32_32x32x16_bf16 v[112:127], v[180:183], a[8:11], v[112:127]
  ds_read_b64_tr_b16 v[178:179], v5 offset:12800
  v_fma_f32 v216, -v215, v221, v218
  v_fma_f32 v217, v215, v220, v211
  v_fma_f32 v220, v214, v220, v216
  v_fma_f32 v221, v214, v221, v217
  v_fma_f32 v216, -v2, v221, v7
  v_mfma_f32_32x32x16_bf16 v[128:143], v[180:183], a[12:15], v[128:143]
  ds_read_b64_tr_b16 v[180:181], v5 offset:14336
  v_fma_f32 v217, v2, v220, v8
  v_fma_f32 v220, v1, v220, v216
  v_fma_f32 v221, v1, v221, v217
  v_fmac_f32 v48, v208, v220
  s_waitcnt lgkmcnt(7)
  v_mfma_f32_32x32x16_bf16 v[112:127], v[184:187], a[16:19], v[112:127]
  ds_read_b64_tr_b16 v[182:183], v5 offset:14848
  v_fmac_f32 v219, v209, v220
  v_fmac_f32 v48, v4, v221
  v_fmac_f32 v219, v208, v221
  v_fmac_f32 v49, v208, v48
  v_fmac_f32 v80, v209, v48
  v_mfma_f32_32x32x16_bf16 v[128:143], v[184:187], a[20:23], v[128:143]
  ds_read_b64_tr_b16 v[184:185], v5 offset:16384
  v_fmac_f32 v49, v4, v219
  v_fmac_f32 v80, v208, v219
  v_fmac_f32 v50, v208, v49
  v_fmac_f32 v81, v209, v49
  v_fmac_f32 v50, v4, v80
  v_mfma_f32_32x32x16_bf16 v[112:127], v[188:191], a[24:27], v[112:127]
  ds_read_b64_tr_b16 v[186:187], v5 offset:16896
  v_fmac_f32 v81, v208, v80
  v_fmac_f32 v51, v208, v50
  v_fmac_f32 v82, v209, v50
  v_fmac_f32 v51, v4, v81
  v_fmac_f32 v82, v208, v81
  v_mfma_f32_32x32x16_bf16 v[128:143], v[188:191], a[28:31], v[128:143]
  ds_read_b64_tr_b16 v[188:189], v5 offset:18432
  v_fmac_f32 v52, v208, v51
  v_fmac_f32 v83, v209, v51
  v_fmac_f32 v52, v4, v82
  v_fmac_f32 v83, v208, v82
  s_waitcnt lgkmcnt(7)
  v_mfma_f32_32x32x16_bf16 v[112:127], v[192:195], a[32:35], v[112:127]
  ds_read_b64_tr_b16 v[190:191], v5 offset:18944
  v_fmac_f32 v53, v208, v52
  v_fmac_f32 v84, v209, v52
  v_fmac_f32 v53, v4, v83
  v_fmac_f32 v84, v208, v83
  v_fmac_f32 v54, v208, v53
  v_mfma_f32_32x32x16_bf16 v[128:143], v[192:195], a[36:39], v[128:143]
  ds_read_b64_tr_b16 v[192:193], v5 offset:20480
  v_fmac_f32 v85, v209, v53
  v_fmac_f32 v54, v4, v84
  v_fmac_f32 v85, v208, v84
  v_fmac_f32 v55, v208, v54
  v_fmac_f32 v86, v209, v54
  v_mfma_f32_32x32x16_bf16 v[112:127], v[196:199], a[40:43], v[112:127]
  ds_read_b64_tr_b16 v[194:195], v5 offset:20992
  v_fmac_f32 v55, v4, v85
  v_fmac_f32 v86, v208, v85
  v_fmac_f32 v56, v208, v55
  v_fmac_f32 v87, v209, v55
  v_fmac_f32 v56, v4, v86
  v_mfma_f32_32x32x16_bf16 v[128:143], v[196:199], a[44:47], v[128:143]
  ds_read_b64_tr_b16 v[196:197], v5 offset:22528
  v_fmac_f32 v87, v208, v86
  v_fmac_f32 v57, v208, v56
  v_fmac_f32 v88, v209, v56
  v_fmac_f32 v57, v4, v87
  s_waitcnt lgkmcnt(7)
  v_mfma_f32_32x32x16_bf16 v[112:127], v[176:179], a[48:51], v[112:127]
  ds_read_b64_tr_b16 v[198:199], v5 offset:23040
  v_fmac_f32 v88, v208, v87
  v_fmac_f32 v58, v208, v57
  v_fmac_f32 v89, v209, v57
  v_fmac_f32 v58, v4, v88
  v_fmac_f32 v89, v208, v88
  v_mfma_f32_32x32x16_bf16 v[128:143], v[176:179], a[52:55], v[128:143]
  ds_read_b64_tr_b16 v[176:177], v5 offset:24576
  v_fmac_f32 v59, v208, v58
  v_fmac_f32 v90, v209, v58
  v_fmac_f32 v59, v4, v89
  v_fmac_f32 v90, v208, v89
  v_fmac_f32 v60, v208, v59
  v_mfma_f32_32x32x16_bf16 v[112:127], v[180:183], a[56:59], v[112:127]
  ds_read_b64_tr_b16 v[178:179], v5 offset:25088
  v_fmac_f32 v91, v209, v59
  v_fmac_f32 v60, v4, v90
  v_fmac_f32 v91, v208, v90
  v_fmac_f32 v61, v208, v60
  v_fmac_f32 v92, v209, v60
  v_mfma_f32_32x32x16_bf16 v[128:143], v[180:183], a[60:63], v[128:143]
  ds_read_b64_tr_b16 v[180:181], v5 offset:26624
  v_fmac_f32 v61, v4, v91
  v_fmac_f32 v92, v208, v91
  v_fmac_f32 v62, v208, v61
  v_fmac_f32 v93, v209, v61
  s_waitcnt lgkmcnt(7)
  v_mfma_f32_32x32x16_bf16 v[112:127], v[184:187], a[64:67], v[112:127]
  ds_read_b64_tr_b16 v[182:183], v5 offset:27136
  v_fmac_f32 v62, v4, v92
  v_fmac_f32 v93, v208, v92
  v_fmac_f32 v63, v208, v62
  v_fmac_f32 v94, v209, v62
  v_fmac_f32 v63, v4, v93
  v_mfma_f32_32x32x16_bf16 v[128:143], v[184:187], a[68:71], v[128:143]
  ds_read_b64_tr_b16 v[184:185], v5 offset:28672
  v_fmac_f32 v94, v208, v93
  v_fmac_f32 v64, v208, v63
  v_fmac_f32 v95, v209, v63
  v_fmac_f32 v64, v4, v94
  v_fmac_f32 v95, v208, v94
  v_mfma_f32_32x32x16_bf16 v[112:127], v[188:191], a[72:75], v[112:127]
  ds_read_b64_tr_b16 v[186:187], v5 offset:29184
  v_cvt_pk_bf16_f32 v48, v48, v49
  v_cvt_pk_bf16_f32 v49, v50, v51
  v_cvt_pk_bf16_f32 v50, v52, v53
  v_cvt_pk_bf16_f32 v51, v54, v55
  v_cvt_pk_bf16_f32 v52, v56, v57
  v_mfma_f32_32x32x16_bf16 v[128:143], v[188:191], a[76:79], v[128:143]
  ds_read_b64_tr_b16 v[188:189], v5 offset:30720
  v_cvt_pk_bf16_f32 v53, v58, v59
  v_cvt_pk_bf16_f32 v54, v60, v61
  v_cvt_pk_bf16_f32 v55, v62, v63
  s_lshl_b32 s38, s35, 5
  s_waitcnt lgkmcnt(7)
  v_mfma_f32_32x32x16_bf16 v[112:127], v[192:195], a[80:83], v[112:127]
  ds_read_b64_tr_b16 v[190:191], v5 offset:31232
  s_waitcnt vmcnt(0)
  v_cmp_ne_u32 vcc, s45, v10
  s_nop 1
  s_cmp_eq_u64 vcc, 0
  s_cbranch_scc0 POLL7
POLL7_OK:
  v_mfma_f32_32x32x16_bf16 v[128:143], v[192:195], a[84:87], v[128:143]
  ds_read_b64_tr_b16 v[192:193], v5 offset:32768
  s_mov_b32 s54, 0x3ffff
  s_mov_b32 s12, 458752
  s_lshl_b32 s3, s46, 12
  s_add_u32 s12, s12, s3
  s_add_u32 s38, s38, s37
  v_mfma_f32_32x32x16_bf16 v[112:127], v[196:199], a[88:91], v[112:127]
  ds_read_b64_tr_b16 v[194:195], v5 offset:33280
  v_and_b32 v14, 31, v0
  v_lshrrev_b32 v15, v14, s54
  v_and_b32 v15, 1, v15
  v_xor_b32 v15, 1, v15
  v_lshlrev_b32 v9, 7, v14
  v_lshl_add_u32 v9, v15, 30, v9
  v_mfma_f32_32x32x16_bf16 v[128:143], v[196:199], a[92:95], v[128:143]
  ds_read_b64_tr_b16 v[196:197], v5 offset:34816
  s_add_u32 m0, s51, 73728
  s_sub_u32 s38, s38, s34
  v_mul_f32 v200, s40, v144
  v_mul_f32 v201, s40, v145
  s_waitcnt lgkmcnt(7)
  v_mfma_f32_32x32x16_bf16 v[112:127], v[176:179], a[96:99], v[112:127]
  ds_read_b64_tr_b16 v[198:199], v5 offset:35328
  ds_write_b128 v244, v[48:51]
  v_mfma_f32_32x32x16_bf16 v[128:143], v[176:179], a[100:103], v[128:143]
  v_add_u32 v5, 0x9000, v5
  ds_read_b64_tr_b16 v[176:177], v5 offset:0
  buffer_load_dwordx4 v253, s[24:27], s49 offen offset:0 sc1 lds
  v_exp_f32 v200, v200
  v_mfma_f32_32x32x16_bf16 v[112:127], v[180:183], a[104:107], v[112:127]
  ds_read_b64_tr_b16 v[178:179], v5 offset:512
  ds_write_b128 v224, v[52:55]
  v_mfma_f32_32x32x16_bf16 v[128:143], v[180:183], a[108:111], v[128:143]
  ds_read_b64_tr_b16 v[180:181], v5 offset:2048
  buffer_load_dwordx4 v254, s[24:27], s49 offen offset:1024 sc1 lds
  ds_read_b64_tr_b16 v[56:57], v245 offset:0
  ds_read_b64_tr_b16 v[58:59], v227 offset:256
  s_waitcnt lgkmcnt(11)
  v_mfma_f32_32x32x16_bf16 v[112:127], v[184:187], a[112:115], v[112:127]
  ds_read_b64_tr_b16 v[182:183], v5 offset:2560
  ds_read_b64_tr_b16 v[60:61], v245 offset:1024
  ds_read_b64_tr_b16 v[62:63], v227 offset:1280
  v_cvt_pk_bf16_f32 v80, -v219, -v80
  v_cvt_pk_bf16_f32 v81, -v81, -v82
  v_cvt_pk_bf16_f32 v82, -v83, -v84
  v_mfma_f32_32x32x16_bf16 v[128:143], v[184:187], a[116:119], v[128:143]
  ds_read_b64_tr_b16 v[184:185], v5 offset:4096
  buffer_load_dwordx4 v255, s[24:27], s49 offen offset:2048 sc1 lds
  s_add_u32 s49, s49, s50
  v_cvt_pk_bf16_f32 v83, -v85, -v86
  v_cvt_pk_bf16_f32 v84, -v87, -v88
  v_mfma_f32_32x32x16_bf16 v[112:127], v[188:191], a[120:123], v[112:127]
  ds_read_b64_tr_b16 v[186:187], v5 offset:4608
  s_add_u32 s32, s53, 327680
  s_barrier
  buffer_store_dword v250, v252, s[8:11], s32 offen sc1
  v_mfma_f32_32x32x16_bf16 v[128:143], v[188:191], a[124:127], v[128:143]
  ds_read_b64_tr_b16 v[188:189], v5 offset:6144
  s_add_u32 m0, s51, 76800
  v_cvt_pk_bf16_f32 v85, -v89, -v90
  v_cvt_pk_bf16_f32 v86, -v91, -v92
  v_cvt_pk_bf16_f32 v87, -v93, -v94
  s_waitcnt lgkmcnt(13)
  v_mfma_f32_32x32x16_bf16 v[112:127], v[192:195], a[128:131], v[112:127]
  ds_read_b64_tr_b16 v[190:191], v5 offset:6656
  ds_write_b128 v244, v[80:83]
  v_mfma_f32_32x32x16_bf16 v[128:143], v[192:195], a[132:135], v[128:143]
  ds_read_b64_tr_b16 v[192:193], v5 offset:8192
  buffer_load_dwordx4 v253, s[24:27], s49 offen offset:0 sc1 lds
  v_mul_f32 v202, s40, v146
  v_exp_f32 v201, v201
  v_mfma_f32_32x32x16_bf16 v[112:127], v[196:199], a[136:139], v[112:127]
  ds_read_b64_tr_b16 v[194:195], v5 offset:8704
  ds_write_b128 v224, v[84:87]
  v_mfma_f32_32x32x16_bf16 v[128:143], v[196:199], a[140:143], v[128:143]
  ds_read_b64_tr_b16 v[196:197], v5 offset:10240
  buffer_load_dwordx4 v254, s[24:27], s49 offen offset:1024 sc1 lds
  ds_read_b64_tr_b16 v[228:229], v245 offset:0
  ds_read_b64_tr_b16 v[230:231], v227 offset:256
  s_waitcnt lgkmcnt(13)
  v_mfma_f32_32x32x16_bf16 v[112:127], v[176:179], a[144:147], v[112:127]
  ds_read_b64_tr_b16 v[198:199], v5 offset:10752
  ds_read_b64_tr_b16 v[232:233], v245 offset:1024
  ds_read_b64_tr_b16 v[234:235], v227 offset:1280
  v_fmac_f32 v65, v208, v64
  v_fmac_f32 v96, v209, v64
  v_fmac_f32 v65, v4, v95
  v_mfma_f32_32x32x16_bf16 v[128:143], v[176:179], a[148:151], v[128:143]
  ds_read_b64_tr_b16 v[176:177], v5 offset:12288
  buffer_load_dwordx4 v255, s[24:27], s49 offen offset:2048 sc1 lds
  s_add_u32 s49, s49, s50
  v_fmac_f32 v96, v208, v95
  v_fmac_f32 v66, v208, v65
  v_mfma_f32_32x32x16_bf16 v[112:127], v[180:183], a[152:155], v[112:127]
  ds_read_b64_tr_b16 v[178:179], v5 offset:12800
  v_fmac_f32 v97, v209, v65
  v_fmac_f32 v66, v4, v96
  v_fmac_f32 v97, v208, v96
  v_fmac_f32 v67, v208, v66
  v_fmac_f32 v98, v209, v66
  v_mfma_f32_32x32x16_bf16 v[128:143], v[180:183], a[156:159], v[128:143]
  ds_read_b64_tr_b16 v[180:181], v5 offset:14336
  s_add_u32 m0, s51, 79872
  v_fmac_f32 v67, v4, v97
  v_fmac_f32 v98, v208, v97
  v_fmac_f32 v68, v208, v67
  s_waitcnt lgkmcnt(13)
  v_mfma_f32_32x32x16_bf16 v[112:127], v[184:187], a[160:163], v[112:127]
  ds_read_b64_tr_b16 v[182:183], v5 offset:14848
  v_fmac_f32 v99, v209, v67
  v_fmac_f32 v68, v4, v98
  v_fmac_f32 v99, v208, v98
  v_fmac_f32 v69, v208, v68
  v_fmac_f32 v100, v209, v68
  v_mfma_f32_32x32x16_bf16 v[128:143], v[184:187], a[164:167], v[128:143]
  ds_read_b64_tr_b16 v[184:185], v5 offset:16384
  buffer_load_dwordx4 v253, s[24:27], s49 offen offset:0 sc1 lds
  v_fmac_f32 v69, v4, v99
  v_fmac_f32 v100, v208, v99
  v_fmac_f32 v70, v208, v69
  v_mfma_f32_32x32x16_bf16 v[112:127], v[188:191], a[168:171], v[112:127]
  ds_read_b64_tr_b16 v[186:187], v5 offset:16896
  v_fmac_f32 v101, v209, v69
  v_fmac_f32 v70, v4, v100
  v_fmac_f32 v101, v208, v100
  v_fmac_f32 v71, v208, v70
  v_fmac_f32 v102, v209, v70
  v_mfma_f32_32x32x16_bf16 v[128:143], v[188:191], a[172:175], v[128:143]
  ds_read_b64_tr_b16 v[188:189], v5 offset:18432
  buffer_load_dwordx4 v254, s[24:27], s49 offen offset:1024 sc1 lds
  v_fmac_f32 v71, v4, v101
  v_fmac_f32 v102, v208, v101
  s_waitcnt lgkmcnt(9)
  v_mfma_f32_32x32x16_bf16 v[112:127], v[192:195], a[176:179], v[112:127]
  ds_read_b64_tr_b16 v[190:191], v5 offset:18944
  v_fmac_f32 v72, v208, v71
  v_fmac_f32 v103, v209, v71
  v_fmac_f32 v72, v4, v102
  v_fmac_f32 v103, v208, v102
  s_add_u32 s42, s44, 0
  v_mfma_f32_32x32x16_bf16 v[128:143], v[192:195], a[180:183], v[128:143]
  ds_read_b64_tr_b16 v[192:193], v5 offset:20480
  buffer_load_dwordx4 v255, s[24:27], s49 offen offset:2048 sc1 lds
  s_add_u32 s49, s49, s50
  v_add_f32 v200, 1.0, v200
  v_mfma_f32_32x32x16_bf16 v[112:127], v[196:199], a[184:187], v[112:127]
  ds_read_b64_tr_b16 v[194:195], v5 offset:20992
  buffer_store_dwordx4 v[56:59], v11, s[8:11], s42 offen offset:0 sc1
  v_mul_f32 v203, s40, v147
  v_mfma_f32_32x32x16_bf16 v[128:143], v[196:199], a[188:191], v[128:143]
  ds_read_b64_tr_b16 v[196:197], v5 offset:22528
  s_add_u32 m0, s51, 82944
  buffer_store_dwordx4 v[60:63], v11, s[8:11], s42 offen offset:1024 sc1
  s_waitcnt lgkmcnt(7)
  v_mfma_f32_32x32x16_bf16 v[112:127], v[176:179], a[192:195], v[112:127]
  ds_read_b64_tr_b16 v[198:199], v5 offset:23040
  s_add_u32 s42, s44, 36864
  buffer_store_dwordx4 v[228:231], v11, s[8:11], s42 offen offset:0 sc1
  v_mfma_f32_32x32x16_bf16 v[128:143], v[176:179], a[196:199], v[128:143]
  ds_read_b64_tr_b16 v[176:177], v5 offset:24576
  buffer_load_dwordx4 v253, s[24:27], s49 offen offset:0 sc1 lds
  v_exp_f32 v202, v202
  v_add_f32 v201, 1.0, v201
  v_mfma_f32_32x32x16_bf16 v[112:127], v[180:183], a[200:203], v[112:127]
  ds_read_b64_tr_b16 v[178:179], v5 offset:25088
  buffer_store_dwordx4 v[232:235], v11, s[8:11], s42 offen offset:1024 sc1
  v_fmac_f32 v73, v208, v72
  v_fmac_f32 v104, v209, v72
  v_mfma_f32_32x32x16_bf16 v[128:143], v[180:183], a[204:207], v[128:143]
  ds_read_b64_tr_b16 v[180:181], v5 offset:26624
  buffer_load_dwordx4 v254, s[24:27], s49 offen offset:1024 sc1 lds
  v_fmac_f32 v73, v4, v103
  v_fmac_f32 v104, v208, v103
  s_waitcnt lgkmcnt(7)
  v_mfma_f32_32x32x16_bf16 v[112:127], v[184:187], a[208:211], v[112:127]
  ds_read_b64_tr_b16 v[182:183], v5 offset:27136
  v_fmac_f32 v74, v208, v73
  v_fmac_f32 v105, v209, v73
  v_fmac_f32 v74, v4, v104
  v_fmac_f32 v105, v208, v104
  v_fmac_f32 v75, v208, v74
  v_mfma_f32_32x32x16_bf16 v[128:143], v[184:187], a[212:215], v[128:143]
  ds_read_b64_tr_b16 v[184:185], v5 offset:28672
  buffer_load_dwordx4 v255, s[24:27], s49 offen offset:2048 sc1 lds
  s_add_u32 s49, s49, s50
  v_fmac_f32 v106, v209, v74
  v_fmac_f32 v75, v4, v105
  v_mfma_f32_32x32x16_bf16 v[112:127], v[188:191], a[216:219], v[112:127]
  ds_read_b64_tr_b16 v[186:187], v5 offset:29184
  v_fmac_f32 v106, v208, v105
  v_fmac_f32 v76, v208, v75
  v_fmac_f32 v107, v209, v75
  v_fmac_f32 v76, v4, v106
  v_fmac_f32 v107, v208, v106
  v_mfma_f32_32x32x16_bf16 v[128:143], v[188:191], a[220:223], v[128:143]
  ds_read_b64_tr_b16 v[188:189], v5 offset:30720
  s_add_u32 m0, s51, 86016
  v_fmac_f32 v77, v208, v76
  v_fmac_f32 v108, v209, v76
  v_fmac_f32 v77, v4, v107
  s_waitcnt lgkmcnt(7)
  v_mfma_f32_32x32x16_bf16 v[112:127], v[192:195], a[224:227], v[112:127]
  ds_read_b64_tr_b16 v[190:191], v5 offset:31232
  v_fmac_f32 v108, v208, v107
  v_fmac_f32 v78, v208, v77
  v_fmac_f32 v109, v209, v77
  v_fmac_f32 v78, v4, v108
  v_fmac_f32 v109, v208, v108
  v_mfma_f32_32x32x16_bf16 v[128:143], v[192:195], a[228:231], v[128:143]
  ds_read_b64_tr_b16 v[192:193], v5 offset:32768
  buffer_load_dwordx4 v253, s[24:27], s49 offen offset:0 sc1 lds
  v_fmac_f32 v79, v208, v78
  v_fmac_f32 v110, v209, v78
  v_fmac_f32 v79, v4, v109
  v_mfma_f32_32x32x16_bf16 v[112:127], v[196:199], a[232:235], v[112:127]
  ds_read_b64_tr_b16 v[194:195], v5 offset:33280
  v_fmac_f32 v110, v208, v109
  v_cvt_pk_bf16_f32 v64, v64, v65
  v_cvt_pk_bf16_f32 v65, v66, v67
  v_cvt_pk_bf16_f32 v66, v68, v69
  v_cvt_pk_bf16_f32 v67, v70, v71
  v_mfma_f32_32x32x16_bf16 v[128:143], v[196:199], a[236:239], v[128:143]
  ds_read_b64_tr_b16 v[196:197], v5 offset:34816
  buffer_load_dwordx4 v254, s[24:27], s49 offen offset:1024 sc1 lds
  v_cvt_pk_bf16_f32 v68, v72, v73
  v_cvt_pk_bf16_f32 v69, v74, v75
  s_waitcnt lgkmcnt(7)
  v_mfma_f32_32x32x16_bf16 v[112:127], v[176:179], a[240:243], v[112:127]
  ds_read_b64_tr_b16 v[198:199], v5 offset:35328
  v_cvt_pk_bf16_f32 v70, v76, v77
  v_cvt_pk_bf16_f32 v71, v78, v79
  v_rcp_f32 v200, v200
  v_mul_f32 v204, s40, v148
  v_mfma_f32_32x32x16_bf16 v[128:143], v[176:179], a[244:247], v[128:143]
  v_add_u32 v6, 0xfffe5000, v6
  ds_read_b64_tr_b16 v[176:177], v6 offset:0
  buffer_load_dwordx4 v255, s[24:27], s49 offen offset:2048 sc1 lds
  s_add_u32 s49, s49, s50
  v_mfma_f32_32x32x16_bf16 v[112:127], v[180:183], a[248:251], v[112:127]
  ds_read_b64_tr_b16 v[178:179], v6 offset:512
  ds_write_b128 v244, v[64:67]
  v_mfma_f32_32x32x16_bf16 v[128:143], v[180:183], a[252:255], v[128:143]
  ds_read_b64_tr_b16 v[180:181], v6 offset:2048
  s_add_u32 m0, s51, 89088
  v_exp_f32 v203, v203
  v_add_f32 v202, 1.0, v202
  s_waitcnt lgkmcnt(8)
  v_mfma_f32_32x32x16_bf16 v[112:127], v[184:187], v[16:19], v[112:127]
  ds_read_b64_tr_b16 v[182:183], v6 offset:2560
  ds_write_b128 v224, v[68:71]
  v_mfma_f32_32x32x16_bf16 v[128:143], v[184:187], v[20:23], v[128:143]
  ds_read_b64_tr_b16 v[184:185], v6 offset:4096
  buffer_load_dwordx4 v253, s[24:27], s49 offen offset:0 sc1 lds
  ds_read_b64_tr_b16 v[72:73], v245 offset:0
  ds_read_b64_tr_b16 v[74:75], v227 offset:256
  ds_read_b64_tr_b16 v[76:77], v245 offset:1024
  v_mfma_f32_32x32x16_bf16 v[112:127], v[188:191], v[24:27], v[112:127]
  ds_read_b64_tr_b16 v[186:187], v6 offset:4608
  ds_read_b64_tr_b16 v[78:79], v227 offset:1280
  v_cvt_pk_bf16_f32 v96, -v95, -v96
  v_cvt_pk_bf16_f32 v97, -v97, -v98
  v_cvt_pk_bf16_f32 v98, -v99, -v100
  v_cvt_pk_bf16_f32 v99, -v101, -v102
  v_mfma_f32_32x32x16_bf16 v[128:143], v[188:191], v[28:31], v[128:143]
  ds_read_b64_tr_b16 v[188:189], v6 offset:6144
  buffer_load_dwordx4 v254, s[24:27], s49 offen offset:1024 sc1 lds
  v_cvt_pk_bf16_f32 v100, -v103, -v104
  v_cvt_pk_bf16_f32 v101, -v105, -v106
  s_waitcnt lgkmcnt(13)
  v_mfma_f32_32x32x16_bf16 v[112:127], v[192:195], v[32:35], v[112:127]
  ds_read_b64_tr_b16 v[190:191], v6 offset:6656
  v_cvt_pk_bf16_f32 v102, -v107, -v108
  v_cvt_pk_bf16_f32 v103, -v109, -v110
  v_rcp_f32 v201, v201
  v_mul_f32 v200, v200, v144
  v_mfma_f32_32x32x16_bf16 v[128:143], v[192:195], v[36:39], v[128:143]
  ds_read_b64_tr_b16 v[192:193], v6 offset:8192
  buffer_load_dwordx4 v255, s[24:27], s49 offen offset:2048 sc1 lds
  s_add_u32 s49, s49, s50
  v_mul_f32 v205, s40, v149
  v_mfma_f32_32x32x16_bf16 v[112:127], v[196:199], v[40:43], v[112:127]
  ds_read_b64_tr_b16 v[194:195], v6 offset:8704
  ds_write_b128 v244, v[96:99]
  v_mfma_f32_32x32x16_bf16 v[128:143], v[196:199], v[44:47], v[128:143]
  ds_read_b64_tr_b16 v[196:197], v6 offset:10240
  ds_write_b128 v224, v[100:103]
  ds_read_b64_tr_b16 v[104:105], v245 offset:0
  ds_read_b64_tr_b16 v[106:107], v227 offset:256
  ds_read_b64_tr_b16 v[108:109], v245 offset:1024
  ds_read_b64_tr_b16 v[110:111], v227 offset:1280
  s_add_u32 s42, s44, 0
  s_waitcnt lgkmcnt(11)
  buffer_store_dwordx4 v[72:75], v12, s[8:11], s42 offen offset:0 sc1
  buffer_store_dwordx4 v[76:79], v12, s[8:11], s42 offen offset:1024 sc1
  s_add_u32 s42, s44, 36864
  s_waitcnt lgkmcnt(0)
  buffer_store_dwordx4 v[104:107], v12, s[8:11], s42 offen offset:0 sc1
  buffer_store_dwordx4 v[108:111], v12, s[8:11], s42 offen offset:1024 sc1
  v_mfma_f32_32x32x16_bf16 v[48:63], v[176:179], a[0:3], 0
  ds_read_b64_tr_b16 v[198:199], v6 offset:10752
  v_exp_f32 v204, v204
  v_add_f32 v203, 1.0, v203
  v_rcp_f32 v202, v202
  v_mfma_f32_32x32x16_bf16 v[64:79], v[176:179], a[4:7], 0
  ds_read_b64_tr_b16 v[176:177], v6 offset:12288
  v_mul_f32 v201, v201, v145
  v_mul_f32 v206, s40, v150
  v_exp_f32 v205, v205
  v_add_f32 v204, 1.0, v204
  v_mfma_f32_32x32x16_bf16 v[48:63], v[180:183], a[8:11], v[48:63]
  ds_read_b64_tr_b16 v[178:179], v6 offset:12800
  v_rcp_f32 v203, v203
  v_mul_f32 v202, v202, v146
  v_cvt_pk_bf16_f32 v144, v200, v201
  v_mul_f32 v207, s40, v151
  v_mfma_f32_32x32x16_bf16 v[64:79], v[180:183], a[12:15], v[64:79]
  ds_read_b64_tr_b16 v[180:181], v6 offset:14336
  v_exp_f32 v206, v206
  v_add_f32 v205, 1.0, v205
  v_rcp_f32 v204, v204
  v_mfma_f32_32x32x16_bf16 v[48:63], v[184:187], a[16:19], v[48:63]
  ds_read_b64_tr_b16 v[182:183], v6 offset:14848
  s_waitcnt vmcnt(24)
  ds_read_b128 a[0:3], v251 offset:0
  ds_read_b128 a[4:7], v251 offset:1024
  v_mul_f32 v203, v203, v147
  v_mul_f32 v200, s40, v152
  v_mfma_f32_32x32x16_bf16 v[64:79], v[184:187], a[20:23], v[64:79]
  ds_read_b64_tr_b16 v[184:185], v6 offset:16384
  ds_read_b128 a[8:11], v251 offset:2048
  v_exp_f32 v207, v207
  v_add_f32 v206, 1.0, v206
  v_mfma_f32_32x32x16_bf16 v[48:63], v[188:191], a[24:27], v[48:63]
  ds_read_b64_tr_b16 v[186:187], v6 offset:16896
  v_rcp_f32 v205, v205
  v_mul_f32 v204, v204, v148
  v_cvt_pk_bf16_f32 v145, v202, v203
  v_mul_f32 v201, s40, v153
  v_mfma_f32_32x32x16_bf16 v[64:79], v[188:191], a[28:31], v[64:79]
  ds_read_b64_tr_b16 v[188:189], v6 offset:18432
  v_exp_f32 v200, v200
  v_add_f32 v207, 1.0, v207
  s_waitcnt lgkmcnt(10)
  v_mfma_f32_32x32x16_bf16 v[48:63], v[192:195], a[32:35], v[48:63]
  ds_read_b64_tr_b16 v[190:191], v6 offset:18944
  s_waitcnt lgkmcnt(3)
  s_add_u32 m0, s51, 73728
  v_rcp_f32 v206, v206
  v_mul_f32 v205, v205, v149
  v_mfma_f32_32x32x16_bf16 v[64:79], v[192:195], a[36:39], v[64:79]
  ds_read_b64_tr_b16 v[192:193], v6 offset:20480
  v_mul_f32 v202, s40, v154
  v_exp_f32 v201, v201
  v_add_f32 v200, 1.0, v200
  v_mfma_f32_32x32x16_bf16 v[48:63], v[196:199], a[40:43], v[48:63]
  ds_read_b64_tr_b16 v[194:195], v6 offset:20992
  buffer_load_dwordx4 v253, s[24:27], s49 offen offset:0 sc1 lds
  v_rcp_f32 v207, v207
  v_mul_f32 v206, v206, v150
  v_mfma_f32_32x32x16_bf16 v[64:79], v[196:199], a[44:47], v[64:79]
  ds_read_b64_tr_b16 v[196:197], v6 offset:22528
  v_cvt_pk_bf16_f32 v146, v204, v205
  v_mul_f32 v203, s40, v155
  v_exp_f32 v202, v202
  v_add_f32 v201, 1.0, v201
  v_mfma_f32_32x32x16_bf16 v[48:63], v[176:179], a[48:51], v[48:63]
  ds_read_b64_tr_b16 v[198:199], v6 offset:23040
  buffer_load_dwordx4 v254, s[24:27], s49 offen offset:1024 sc1 lds
  v_rcp_f32 v200, v200
  v_mul_f32 v207, v207, v151
  v_mfma_f32_32x32x16_bf16 v[64:79], v[176:179], a[52:55], v[64:79]
  ds_read_b64_tr_b16 v[176:177], v6 offset:24576
  v_mul_f32 v204, s40, v156
  v_exp_f32 v203, v203
  v_add_f32 v202, 1.0, v202
  v_mfma_f32_32x32x16_bf16 v[48:63], v[180:183], a[56:59], v[48:63]
  ds_read_b64_tr_b16 v[178:179], v6 offset:25088
  buffer_load_dwordx4 v255, s[24:27], s49 offen offset:2048 sc1 lds
  s_add_u32 s49, s49, s50
  v_rcp_f32 v201, v201
  v_mfma_f32_32x32x16_bf16 v[64:79], v[180:183], a[60:63], v[64:79]
  ds_read_b64_tr_b16 v[180:181], v6 offset:26624
  s_waitcnt vmcnt(23)
  ds_read_b128 a[12:15], v251 offset:3072
  ds_read_b128 a[16:19], v251 offset:4096
  v_mul_f32 v200, v200, v152
  s_waitcnt lgkmcnt(9)
  v_mfma_f32_32x32x16_bf16 v[48:63], v[184:187], a[64:67], v[48:63]
  ds_read_b64_tr_b16 v[182:183], v6 offset:27136
  ds_read_b128 a[20:23], v251 offset:5120
  v_cvt_pk_bf16_f32 v147, v206, v207
  buffer_store_dwordx4 v[144:147], v11, s[8:11], s38 offen offset:2048 sc1
  v_mfma_f32_32x32x16_bf16 v[64:79], v[184:187], a[68:71], v[64:79]
  ds_read_b64_tr_b16 v[184:185], v6 offset:28672
  v_mul_f32 v205, s40, v157
  v_exp_f32 v204, v204
  v_add_f32 v203, 1.0, v203
  v_mfma_f32_32x32x16_bf16 v[48:63], v[188:191], a[72:75], v[48:63]
  ds_read_b64_tr_b16 v[186:187], v6 offset:29184
  v_rcp_f32 v202, v202
  v_mul_f32 v201, v201, v153
  v_mul_f32 v206, s40, v158
  v_mfma_f32_32x32x16_bf16 v[64:79], v[188:191], a[76:79], v[64:79]
  ds_read_b64_tr_b16 v[188:189], v6 offset:30720
  s_waitcnt lgkmcnt(3)
  s_add_u32 m0, s51, 76800
  v_exp_f32 v205, v205
  v_add_f32 v204, 1.0, v204
  v_mfma_f32_32x32x16_bf16 v[48:63], v[192:195], a[80:83], v[48:63]
  ds_read_b64_tr_b16 v[190:191], v6 offset:31232
  v_rcp_f32 v203, v203
  v_mul_f32 v202, v202, v154
  v_cvt_pk_bf16_f32 v152, v200, v201
  v_mul_f32 v207, s40, v159
  v_mfma_f32_32x32x16_bf16 v[64:79], v[192:195], a[84:87], v[64:79]
  ds_read_b64_tr_b16 v[192:193], v6 offset:32768
  buffer_load_dwordx4 v253, s[24:27], s49 offen offset:0 sc1 lds
  v_exp_f32 v206, v206
  v_add_f32 v205, 1.0, v205
  v_mfma_f32_32x32x16_bf16 v[48:63], v[196:199], a[88:91], v[48:63]
  ds_read_b64_tr_b16 v[194:195], v6 offset:33280
  v_rcp_f32 v204, v204
  v_mul_f32 v203, v203, v155
  v_mul_f32 v200, s40, v160
  v_mfma_f32_32x32x16_bf16 v[64:79], v[196:199], a[92:95], v[64:79]
  ds_read_b64_tr_b16 v[196:197], v6 offset:34816
  buffer_load_dwordx4 v254, s[24:27], s49 offen offset:1024 sc1 lds
  v_exp_f32 v207, v207
  v_add_f32 v206, 1.0, v206
  v_mfma_f32_32x32x16_bf16 v[48:63], v[176:179], a[96:99], v[48:63]
  ds_read_b64_tr_b16 v[198:199], v6 offset:35328
  v_rcp_f32 v205, v205
  v_mul_f32 v204, v204, v156
  v_cvt_pk_bf16_f32 v153, v202, v203
  v_mul_f32 v201, s40, v161
  v_mfma_f32_32x32x16_bf16 v[64:79], v[176:179], a[100:103], v[64:79]
  v_add_u32 v6, 0x9000, v6
  ds_read_b64_tr_b16 v[176:177], v6 offset:0
  buffer_load_dwordx4 v255, s[24:27], s49 offen offset:2048 sc1 lds
  s_add_u32 s49, s49, s50
  v_mfma_f32_32x32x16_bf16 v[48:63], v[180:183], a[104:107], v[48:63]
  ds_read_b64_tr_b16 v[178:179], v6 offset:512
  s_waitcnt vmcnt(24)
  ds_read_b128 a[24:27], v251 offset:6144
  ds_read_b128 a[28:31], v251 offset:7168
  v_exp_f32 v200, v200
  v_mfma_f32_32x32x16_bf16 v[64:79], v[180:183], a[108:111], v[64:79]
  ds_read_b64_tr_b16 v[180:181], v6 offset:2048
  ds_read_b128 a[32:35], v251 offset:8192
  v_add_f32 v207, 1.0, v207
  v_rcp_f32 v206, v206
  s_waitcnt lgkmcnt(10)
  v_mfma_f32_32x32x16_bf16 v[48:63], v[184:187], a[112:115], v[48:63]
  ds_read_b64_tr_b16 v[182:183], v6 offset:2560
  s_add_u32 s42, s53, 458752
  s_waitcnt vmcnt(7)
  s_barrier
  buffer_store_dword v222, v252, s[8:11], s42 offen sc1
  v_mfma_f32_32x32x16_bf16 v[64:79], v[184:187], a[116:119], v[64:79]
  ds_read_b64_tr_b16 v[184:185], v6 offset:4096
  v_mul_f32 v205, v205, v157
  v_mul_f32 v202, s40, v162
  v_exp_f32 v201, v201
  v_add_f32 v200, 1.0, v200
  v_mfma_f32_32x32x16_bf16 v[48:63], v[188:191], a[120:123], v[48:63]
  ds_read_b64_tr_b16 v[186:187], v6 offset:4608
  s_waitcnt lgkmcnt(3)
  s_add_u32 m0, s51, 79872
  v_rcp_f32 v207, v207
  v_mul_f32 v206, v206, v158
  v_mfma_f32_32x32x16_bf16 v[64:79], v[188:191], a[124:127], v[64:79]
  ds_read_b64_tr_b16 v[188:189], v6 offset:6144
  v_cvt_pk_bf16_f32 v154, v204, v205
  v_mul_f32 v203, s40, v163
  v_exp_f32 v202, v202
  v_add_f32 v201, 1.0, v201
  v_mfma_f32_32x32x16_bf16 v[48:63], v[192:195], a[128:131], v[48:63]
  ds_read_b64_tr_b16 v[190:191], v6 offset:6656
  buffer_load_dwordx4 v253, s[24:27], s49 offen offset:0 sc1 lds
  v_rcp_f32 v200, v200
  v_mul_f32 v207, v207, v159
  v_mfma_f32_32x32x16_bf16 v[64:79], v[192:195], a[132:135], v[64:79]
  ds_read_b64_tr_b16 v[192:193], v6 offset:8192
  v_mul_f32 v204, s40, v164
  v_exp_f32 v203, v203
  v_add_f32 v202, 1.0, v202
  v_mfma_f32_32x32x16_bf16 v[48:63], v[196:199], a[136:139], v[48:63]
  ds_read_b64_tr_b16 v[194:195], v6 offset:8704
  buffer_load_dwordx4 v254, s[24:27], s49 offen offset:1024 sc1 lds
  v_rcp_f32 v201, v201
  v_mul_f32 v200, v200, v160
  v_mfma_f32_32x32x16_bf16 v[64:79], v[196:199], a[140:143], v[64:79]
  ds_read_b64_tr_b16 v[196:197], v6 offset:10240
  v_cvt_pk_bf16_f32 v155, v206, v207
  buffer_store_dwordx4 v[152:155], v11, s[8:11], s38 offen offset:3072 sc1
  s_waitcnt lgkmcnt(7)
  v_mfma_f32_32x32x16_bf16 v[48:63], v[176:179], a[144:147], v[48:63]
  ds_read_b64_tr_b16 v[198:199], v6 offset:10752
  buffer_load_dwordx4 v255, s[24:27], s49 offen offset:2048 sc1 lds
  s_add_u32 s49, s49, s50
  v_mul_f32 v205, s40, v165
  v_mfma_f32_32x32x16_bf16 v[64:79], v[176:179], a[148:151], v[64:79]
  ds_read_b64_tr_b16 v[176:177], v6 offset:12288
  ds_read_b128 a[36:39], v251 offset:9216
  ds_read_b128 a[40:43], v251 offset:10240
  v_exp_f32 v204, v204
  v_mfma_f32_32x32x16_bf16 v[48:63], v[180:183], a[152:155], v[48:63]
  ds_read_b64_tr_b16 v[178:179], v6 offset:12800
  ds_read_b128 a[44:47], v251 offset:11264
  v_add_f32 v203, 1.0, v203
  v_rcp_f32 v202, v202
  v_mul_f32 v201, v201, v161
  v_mfma_f32_32x32x16_bf16 v[64:79], v[180:183], a[156:159], v[64:79]
  ds_read_b64_tr_b16 v[180:181], v6 offset:14336
  v_mul_f32 v206, s40, v166
  v_exp_f32 v205, v205
  v_add_f32 v204, 1.0, v204
  s_waitcnt lgkmcnt(10)
  v_mfma_f32_32x32x16_bf16 v[48:63], v[184:187], a[160:163], v[48:63]
  ds_read_b64_tr_b16 v[182:183], v6 offset:14848
  v_rcp_f32 v203, v203
  v_mul_f32 v202, v202, v162
  v_cvt_pk_bf16_f32 v160, v200, v201
  v_mul_f32 v207, s40, v167
  v_mfma_f32_32x32x16_bf16 v[64:79], v[184:187], a[164:167], v[64:79]
  ds_read_b64_tr_b16 v[184:185], v6 offset:16384
  s_waitcnt lgkmcnt(3)
  s_add_u32 m0, s51, 82944
  v_exp_f32 v206, v206
  v_add_f32 v205, 1.0, v205
  v_mfma_f32_32x32x16_bf16 v[48:63], v[188:191], a[168:171], v[48:63]
  ds_read_b64_tr_b16 v[186:187], v6 offset:16896
  v_rcp_f32 v204, v204
  v_mul_f32 v203, v203, v163
  v_mul_f32 v200, s40, v168
  v_mfma_f32_32x32x16_bf16 v[64:79], v[188:191], a[172:175], v[64:79]
  ds_read_b64_tr_b16 v[188:189], v6 offset:18432
  buffer_load_dwordx4 v253, s[24:27], s49 offen offset:0 sc1 lds
  v_exp_f32 v207, v207
  v_add_f32 v206, 1.0, v206
  v_mfma_f32_32x32x16_bf16 v[48:63], v[192:195], a[176:179], v[48:63]
  ds_read_b64_tr_b16 v[190:191], v6 offset:18944
  v_rcp_f32 v205, v205
  v_mul_f32 v204, v204, v164
  v_cvt_pk_bf16_f32 v161, v202, v203
  v_mul_f32 v201, s40, v169
  v_mfma_f32_32x32x16_bf16 v[64:79], v[192:195], a[180:183], v[64:79]
  ds_read_b64_tr_b16 v[192:193], v6 offset:20480
  buffer_load_dwordx4 v254, s[24:27], s49 offen offset:1024 sc1 lds
  v_exp_f32 v200, v200
  v_add_f32 v207, 1.0, v207
  v_mfma_f32_32x32x16_bf16 v[48:63], v[196:199], a[184:187], v[48:63]
  ds_read_b64_tr_b16 v[194:195], v6 offset:20992
  v_rcp_f32 v206, v206
  v_mul_f32 v205, v205, v165
  v_mul_f32 v202, s40, v170
  v_mfma_f32_32x32x16_bf16 v[64:79], v[196:199], a[188:191], v[64:79]
  ds_read_b64_tr_b16 v[196:197], v6 offset:22528
  buffer_load_dwordx4 v255, s[24:27], s49 offen offset:2048 sc1 lds
  s_add_u32 s49, s49, s50
  s_waitcnt lgkmcnt(7)
  v_mfma_f32_32x32x16_bf16 v[48:63], v[176:179], a[192:195], v[48:63]
  ds_read_b64_tr_b16 v[198:199], v6 offset:23040
  ds_read_b128 a[48:51], v251 offset:12288
  ds_read_b128 a[52:55], v251 offset:13312
  v_exp_f32 v201, v201
  v_mfma_f32_32x32x16_bf16 v[64:79], v[176:179], a[196:199], v[64:79]
  ds_read_b64_tr_b16 v[176:177], v6 offset:24576
  ds_read_b128 a[56:59], v251 offset:14336
  v_add_f32 v200, 1.0, v200
  v_rcp_f32 v207, v207
  v_mul_f32 v206, v206, v166
  v_mfma_f32_32x32x16_bf16 v[48:63], v[180:183], a[200:203], v[48:63]
  ds_read_b64_tr_b16 v[178:179], v6 offset:25088
  v_cvt_pk_bf16_f32 v162, v204, v205
  v_mul_f32 v203, s40, v171
  v_exp_f32 v202, v202
  v_add_f32 v201, 1.0, v201
  v_mfma_f32_32x32x16_bf16 v[64:79], v[180:183], a[204:207], v[64:79]
  ds_read_b64_tr_b16 v[180:181], v6 offset:26624
  v_rcp_f32 v200, v200
  v_mul_f32 v207, v207, v167
  v_mul_f32 v204, s40, v172
  s_waitcnt lgkmcnt(10)
  v_mfma_f32_32x32x16_bf16 v[48:63], v[184:187], a[208:211], v[48:63]
  ds_read_b64_tr_b16 v[182:183], v6 offset:27136
  s_waitcnt lgkmcnt(3)
  s_add_u32 m0, s51, 86016
  v_exp_f32 v203, v203
  v_add_f32 v202, 1.0, v202
  v_mfma_f32_32x32x16_bf16 v[64:79], v[184:187], a[212:215], v[64:79]
  ds_read_b64_tr_b16 v[184:185], v6 offset:28672
  v_rcp_f32 v201, v201
  v_mul_f32 v200, v200, v168
  v_cvt_pk_bf16_f32 v163, v206, v207
  v_mfma_f32_32x32x16_bf16 v[48:63], v[188:191], a[216:219], v[48:63]
  ds_read_b64_tr_b16 v[186:187], v6 offset:29184
  buffer_load_dwordx4 v253, s[24:27], s49 offen offset:0 sc1 lds
  buffer_store_dwordx4 v[160:163], v12, s[8:11], s38 offen offset:2048 sc1
  v_mfma_f32_32x32x16_bf16 v[64:79], v[188:191], a[220:223], v[64:79]
  ds_read_b64_tr_b16 v[188:189], v6 offset:30720
  v_mul_f32 v205, s40, v173
  v_exp_f32 v204, v204
  v_add_f32 v203, 1.0, v203
  v_mfma_f32_32x32x16_bf16 v[48:63], v[192:195], a[224:227], v[48:63]
  ds_read_b64_tr_b16 v[190:191], v6 offset:31232
  buffer_load_dwordx4 v254, s[24:27], s49 offen offset:1024 sc1 lds
  v_rcp_f32 v202, v202
  v_mul_f32 v201, v201, v169
  v_mfma_f32_32x32x16_bf16 v[64:79], v[192:195], a[228:231], v[64:79]
  ds_read_b64_tr_b16 v[192:193], v6 offset:32768
  v_mul_f32 v206, s40, v174
  v_exp_f32 v205, v205
  v_add_f32 v204, 1.0, v204
  v_mfma_f32_32x32x16_bf16 v[48:63], v[196:199], a[232:235], v[48:63]
  ds_read_b64_tr_b16 v[194:195], v6 offset:33280
  buffer_load_dwordx4 v255, s[24:27], s49 offen offset:2048 sc1 lds
  s_add_u32 s49, s49, s50
  v_rcp_f32 v203, v203
  v_mfma_f32_32x32x16_bf16 v[64:79], v[196:199], a[236:239], v[64:79]
  ds_read_b64_tr_b16 v[196:197], v6 offset:34816
  ds_read_b128 a[60:63], v251 offset:15360
  ds_read_b128 a[64:67], v251 offset:16384
  v_mul_f32 v202, v202, v170
  s_waitcnt lgkmcnt(9)
  v_mfma_f32_32x32x16_bf16 v[48:63], v[176:179], a[240:243], v[48:63]
  ds_read_b64_tr_b16 v[198:199], v6 offset:35328
  ds_read_b128 a[68:71], v251 offset:17408
  v_cvt_pk_bf16_f32 v168, v200, v201
  v_mul_f32 v207, s40, v175
  v_exp_f32 v206, v206
  v_mfma_f32_32x32x16_bf16 v[64:79], v[176:179], a[244:247], v[64:79]
  v_add_f32 v205, 1.0, v205
  v_rcp_f32 v204, v204
  v_mul_f32 v203, v203, v171
  v_exp_f32 v207, v207
  v_mfma_f32_32x32x16_bf16 v[48:63], v[180:183], a[248:251], v[48:63]
  v_add_f32 v206, 1.0, v206
  v_rcp_f32 v205, v205
  v_mul_f32 v204, v204, v172
  v_cvt_pk_bf16_f32 v169, v202, v203
  v_add_f32 v207, 1.0, v207
  v_mfma_f32_32x32x16_bf16 v[64:79], v[180:183], a[252:255], v[64:79]
  s_waitcnt lgkmcnt(0)
  s_add_u32 m0, s51, 89088
  v_rcp_f32 v206, v206
  v_mul_f32 v205, v205, v173
  v_mfma_f32_32x32x16_bf16 v[48:63], v[184:187], v[16:19], v[48:63]
  v_rcp_f32 v207, v207
  v_mul_f32 v206, v206, v174
  v_cvt_pk_bf16_f32 v170, v204, v205
  v_mul_f32 v207, v207, v175
  v_cvt_pk_bf16_f32 v171, v206, v207
  v_mfma_f32_32x32x16_bf16 v[64:79], v[184:187], v[20:23], v[64:79]
  buffer_load_dwordx4 v253, s[24:27], s49 offen offset:0 sc1 lds
  buffer_store_dwordx4 v[168:171], v12, s[8:11], s38 offen offset:3072 sc1
  s_lshl_b32 s38, s36, 5
  v_mfma_f32_32x32x16_bf16 v[48:63], v[188:191], v[24:27], v[48:63]
  s_add_u32 s38, s38, s37
  s_add_u32 s38, s38, s34
  v_mul_f32 v200, s40, v112
  v_mul_f32 v201, s40, v113
  v_exp_f32 v200, v200
  v_mfma_f32_32x32x16_bf16 v[64:79], v[188:191], v[28:31], v[64:79]
  buffer_load_dwordx4 v254, s[24:27], s49 offen offset:1024 sc1 lds
  v_mul_f32 v202, s40, v114
  v_exp_f32 v201, v201
  v_add_f32 v200, 1.0, v200
  v_mfma_f32_32x32x16_bf16 v[48:63], v[192:195], v[32:35], v[48:63]
  v_mul_f32 v203, s40, v115
  v_exp_f32 v202, v202
  v_add_f32 v201, 1.0, v201
  v_rcp_f32 v200, v200
  v_mfma_f32_32x32x16_bf16 v[64:79], v[192:195], v[36:39], v[64:79]
  buffer_load_dwordx4 v255, s[24:27], s49 offen offset:2048 sc1 lds
  s_add_u32 s49, s49, s50
  v_mul_f32 v204, s40, v116
  v_exp_f32 v203, v203
  v_mfma_f32_32x32x16_bf16 v[48:63], v[196:199], v[40:43], v[48:63]
  v_add_f32 v202, 1.0, v202
  v_rcp_f32 v201, v201
  v_mul_f32 v200, v200, v112
  v_mul_f32 v205, s40, v117
  v_mfma_f32_32x32x16_bf16 v[64:79], v[196:199], v[44:47], v[64:79]
  s_barrier
  v_exp_f32 v204, v204
  v_add_f32 v203, 1.0, v203
  v_rcp_f32 v202, v202
  v_mul_f32 v201, v201, v113
  v_mul_f32 v206, s40, v118
  v_exp_f32 v205, v205
  v_add_f32 v204, 1.0, v204
  v_rcp_f32 v203, v203
  v_mul_f32 v202, v202, v114
  v_cvt_pk_bf16_f32 v112, v200, v201
  v_mul_f32 v207, s40, v119
  v_exp_f32 v206, v206
  v_add_f32 v205, 1.0, v205
  v_rcp_f32 v204, v204
  v_mul_f32 v203, v203, v115
  v_mul_f32 v200, s40, v120
  v_exp_f32 v207, v207
  v_add_f32 v206, 1.0, v206
  v_rcp_f32 v205, v205
  v_mul_f32 v204, v204, v116
  v_cvt_pk_bf16_f32 v113, v202, v203
  v_mul_f32 v201, s40, v121
  v_exp_f32 v200, v200
  v_add_f32 v207, 1.0, v207
  v_rcp_f32 v206, v206
  v_mul_f32 v205, v205, v117
  v_mul_f32 v202, s40, v122
  v_exp_f32 v201, v201
  v_add_f32 v200, 1.0, v200
  v_rcp_f32 v207, v207
  v_mul_f32 v206, v206, v118
  v_cvt_pk_bf16_f32 v114, v204, v205
  v_mul_f32 v203, s40, v123
  v_exp_f32 v202, v202
  v_add_f32 v201, 1.0, v201
  v_rcp_f32 v200, v200
  v_mul_f32 v207, v207, v119
  v_mul_f32 v204, s40, v124
  v_exp_f32 v203, v203
  v_add_f32 v202, 1.0, v202
  v_rcp_f32 v201, v201
  v_mul_f32 v200, v200, v120
  v_cvt_pk_bf16_f32 v115, v206, v207
  buffer_store_dwordx4 v[112:115], v11, s[8:11], s38 offen offset:0 sc1
  v_mul_f32 v205, s40, v125
  v_exp_f32 v204, v204
  v_add_f32 v203, 1.0, v203
  v_rcp_f32 v202, v202
  v_mul_f32 v201, v201, v121
  v_mul_f32 v206, s40, v126
  v_exp_f32 v205, v205
  v_add_f32 v204, 1.0, v204
  v_rcp_f32 v203, v203
  v_mul_f32 v202, v202, v122
  v_cvt_pk_bf16_f32 v120, v200, v201
  v_mul_f32 v207, s40, v127
  v_exp_f32 v206, v206
  v_add_f32 v205, 1.0, v205
  v_rcp_f32 v204, v204
  v_mul_f32 v203, v203, v123
  v_mul_f32 v200, s40, v128
  v_exp_f32 v207, v207
  v_add_f32 v206, 1.0, v206
  v_rcp_f32 v205, v205
  v_mul_f32 v204, v204, v124
  v_cvt_pk_bf16_f32 v121, v202, v203
  v_mul_f32 v201, s40, v129
  v_exp_f32 v200, v200
  v_add_f32 v207, 1.0, v207
  v_rcp_f32 v206, v206
  v_mul_f32 v205, v205, v125
  v_mul_f32 v202, s40, v130
  v_exp_f32 v201, v201
  v_add_f32 v200, 1.0, v200
  v_rcp_f32 v207, v207
  v_mul_f32 v206, v206, v126
  v_cvt_pk_bf16_f32 v122, v204, v205
  v_mul_f32 v203, s40, v131
  v_exp_f32 v202, v202
  v_add_f32 v201, 1.0, v201
  v_rcp_f32 v200, v200
  v_mul_f32 v207, v207, v127
  v_mul_f32 v204, s40, v132
  v_exp_f32 v203, v203
  v_add_f32 v202, 1.0, v202
  v_rcp_f32 v201, v201
  v_mul_f32 v200, v200, v128
  v_cvt_pk_bf16_f32 v123, v206, v207
  buffer_store_dwordx4 v[120:123], v11, s[8:11], s38 offen offset:1024 sc1
  v_mul_f32 v205, s40, v133
  v_exp_f32 v204, v204
  v_add_f32 v203, 1.0, v203
  v_rcp_f32 v202, v202
  v_mul_f32 v201, v201, v129
  v_mul_f32 v206, s40, v134
  v_exp_f32 v205, v205
  v_add_f32 v204, 1.0, v204
  v_rcp_f32 v203, v203
  v_mul_f32 v202, v202, v130
  v_cvt_pk_bf16_f32 v128, v200, v201
  v_mul_f32 v207, s40, v135
  v_exp_f32 v206, v206
  v_add_f32 v205, 1.0, v205
  v_rcp_f32 v204, v204
  v_mul_f32 v203, v203, v131
  v_mul_f32 v200, s40, v136
  v_exp_f32 v207, v207
  v_add_f32 v206, 1.0, v206
  v_rcp_f32 v205, v205
  v_mul_f32 v204, v204, v132
  v_cvt_pk_bf16_f32 v129, v202, v203
  v_mul_f32 v201, s40, v137
  v_exp_f32 v200, v200
  v_add_f32 v207, 1.0, v207
  v_rcp_f32 v206, v206
  v_mul_f32 v205, v205, v133
  v_mul_f32 v202, s40, v138
  v_exp_f32 v201, v201
  v_add_f32 v200, 1.0, v200
  v_rcp_f32 v207, v207
  v_mul_f32 v206, v206, v134
  v_cvt_pk_bf16_f32 v130, v204, v205
  v_mul_f32 v203, s40, v139
  v_exp_f32 v202, v202
  v_add_f32 v201, 1.0, v201
  v_rcp_f32 v200, v200
  v_mul_f32 v207, v207, v135
  v_mul_f32 v204, s40, v140
  v_exp_f32 v203, v203
  v_add_f32 v202, 1.0, v202
  v_rcp_f32 v201, v201
  v_mul_f32 v200, v200, v136
  v_cvt_pk_bf16_f32 v131, v206, v207
  buffer_store_dwordx4 v[128:131], v12, s[8:11], s38 offen offset:0 sc1
  v_mul_f32 v205, s40, v141
  v_exp_f32 v204, v204
  v_add_f32 v203, 1.0, v203
  v_rcp_f32 v202, v202
  v_mul_f32 v201, v201, v137
  v_mul_f32 v206, s40, v142
  v_exp_f32 v205, v205
  v_add_f32 v204, 1.0, v204
  v_rcp_f32 v203, v203
  v_mul_f32 v202, v202, v138
  v_cvt_pk_bf16_f32 v136, v200, v201
  v_mul_f32 v207, s40, v143
  v_exp_f32 v206, v206
  v_add_f32 v205, 1.0, v205
  v_rcp_f32 v204, v204
  v_mul_f32 v203, v203, v139
  v_exp_f32 v207, v207
  v_add_f32 v206, 1.0, v206
  v_rcp_f32 v205, v205
  v_mul_f32 v204, v204, v140
  v_cvt_pk_bf16_f32 v137, v202, v203
  v_add_f32 v207, 1.0, v207
  v_rcp_f32 v206, v206
  v_mul_f32 v205, v205, v141
  v_rcp_f32 v207, v207
  v_mul_f32 v206, v206, v142
  v_cvt_pk_bf16_f32 v138, v204, v205
  v_mul_f32 v207, v207, v143
  v_cvt_pk_bf16_f32 v139, v206, v207
  buffer_store_dwordx4 v[136:139], v12, s[8:11], s38 offen offset:1024 sc1
  s_lshl_b32 s38, s36, 5
  s_add_u32 s38, s38, s37
  s_sub_u32 s38, s38, s34
  v_mul_f32 v200, s40, v48
  v_mul_f32 v201, s40, v49
  v_exp_f32 v200, v200
  v_mul_f32 v202, s40, v50
  v_exp_f32 v201, v201
  v_add_f32 v200, 1.0, v200
  v_mul_f32 v203, s40, v51
  v_exp_f32 v202, v202
  v_add_f32 v201, 1.0, v201
  v_rcp_f32 v200, v200
  v_mul_f32 v204, s40, v52
  v_exp_f32 v203, v203
  v_add_f32 v202, 1.0, v202
  v_rcp_f32 v201, v201
  v_mul_f32 v200, v200, v48
  v_mul_f32 v205, s40, v53
  v_exp_f32 v204, v204
  v_add_f32 v203, 1.0, v203
  v_rcp_f32 v202, v202
  v_mul_f32 v201, v201, v49
  v_mul_f32 v206, s40, v54
  v_exp_f32 v205, v205
  v_add_f32 v204, 1.0, v204
  v_rcp_f32 v203, v203
  v_mul_f32 v202, v202, v50
  v_cvt_pk_bf16_f32 v48, v200, v201
  v_mul_f32 v207, s40, v55
  v_exp_f32 v206, v206
  v_add_f32 v205, 1.0, v205
  v_rcp_f32 v204, v204
  buffer_load_dword v8, v9, s[8:11], s12 offen sc1
  v_mul_f32 v203, v203, v51
  v_mul_f32 v200, s40, v56
  v_exp_f32 v207, v207
  v_add_f32 v206, 1.0, v206
  v_rcp_f32 v205, v205
  v_mul_f32 v204, v204, v52
  v_cvt_pk_bf16_f32 v49, v202, v203
  v_mul_f32 v201, s40, v57
  v_exp_f32 v200, v200
  v_add_f32 v207, 1.0, v207
  v_rcp_f32 v206, v206
  v_mul_f32 v205, v205, v53
  v_mul_f32 v202, s40, v58
  v_exp_f32 v201, v201
  v_add_f32 v200, 1.0, v200
  v_rcp_f32 v207, v207
  v_mul_f32 v206, v206, v54
  v_cvt_pk_bf16_f32 v50, v204, v205
  v_mul_f32 v203, s40, v59
  v_exp_f32 v202, v202
  v_add_f32 v201, 1.0, v201
  v_rcp_f32 v200, v200
  v_mul_f32 v207, v207, v55
  v_mul_f32 v204, s40, v60
  v_exp_f32 v203, v203
  v_add_f32 v202, 1.0, v202
  v_rcp_f32 v201, v201
  v_mul_f32 v200, v200, v56
  v_cvt_pk_bf16_f32 v51, v206, v207
  buffer_store_dwordx4 v[48:51], v11, s[8:11], s38 offen offset:2048 sc1
  v_mul_f32 v205, s40, v61
  v_exp_f32 v204, v204
  v_add_f32 v203, 1.0, v203
  v_rcp_f32 v202, v202
  v_mul_f32 v201, v201, v57
  v_mul_f32 v206, s40, v62
  v_exp_f32 v205, v205
  v_add_f32 v204, 1.0, v204
  v_rcp_f32 v203, v203
  v_mul_f32 v202, v202, v58
  v_cvt_pk_bf16_f32 v56, v200, v201
  v_mul_f32 v207, s40, v63
  v_exp_f32 v206, v206
  v_add_f32 v205, 1.0, v205
  v_rcp_f32 v204, v204
  v_mul_f32 v203, v203, v59
  v_mul_f32 v200, s40, v64
  v_exp_f32 v207, v207
  v_add_f32 v206, 1.0, v206
  v_rcp_f32 v205, v205
  v_mul_f32 v204, v204, v60
  v_cvt_pk_bf16_f32 v57, v202, v203
  v_mul_f32 v201, s40, v65
  v_exp_f32 v200, v200
  v_add_f32 v207, 1.0, v207
  v_rcp_f32 v206, v206
  v_mul_f32 v205, v205, v61
  v_mul_f32 v202, s40, v66
  v_exp_f32 v201, v201
  v_add_f32 v200, 1.0, v200
  v_rcp_f32 v207, v207
  v_mul_f32 v206, v206, v62
  v_cvt_pk_bf16_f32 v58, v204, v205
  v_mul_f32 v203, s40, v67
  v_exp_f32 v202, v202
  v_add_f32 v201, 1.0, v201
  v_rcp_f32 v200, v200
  v_mul_f32 v207, v207, v63
  v_mul_f32 v204, s40, v68
  v_exp_f32 v203, v203
  v_add_f32 v202, 1.0, v202
  v_rcp_f32 v201, v201
  v_mul_f32 v200, v200, v64
  v_cvt_pk_bf16_f32 v59, v206, v207
  buffer_store_dwordx4 v[56:59], v11, s[8:11], s38 offen offset:3072 sc1
  v_mul_f32 v205, s40, v69
  v_exp_f32 v204, v204
  v_add_f32 v203, 1.0, v203
  v_rcp_f32 v202, v202
  v_mul_f32 v201, v201, v65
  v_mul_f32 v206, s40, v70
  v_exp_f32 v205, v205
  v_add_f32 v204, 1.0, v204
  v_rcp_f32 v203, v203
  v_mul_f32 v202, v202, v66
  v_cvt_pk_bf16_f32 v64, v200, v201
  v_mul_f32 v207, s40, v71
  v_exp_f32 v206, v206
  v_add_f32 v205, 1.0, v205
  v_rcp_f32 v204, v204
  v_mul_f32 v203, v203, v67
  v_mul_f32 v200, s40, v72
  v_exp_f32 v207, v207
  v_add_f32 v206, 1.0, v206
  v_rcp_f32 v205, v205
  v_mul_f32 v204, v204, v68
  v_cvt_pk_bf16_f32 v65, v202, v203
  v_mul_f32 v201, s40, v73
  v_exp_f32 v200, v200
  v_add_f32 v207, 1.0, v207
  v_rcp_f32 v206, v206
  v_mul_f32 v205, v205, v69
  v_mul_f32 v202, s40, v74
  v_exp_f32 v201, v201
  v_add_f32 v200, 1.0, v200
  v_rcp_f32 v207, v207
  v_mul_f32 v206, v206, v70
  v_cvt_pk_bf16_f32 v66, v204, v205
  v_mul_f32 v203, s40, v75
  v_exp_f32 v202, v202
  v_add_f32 v201, 1.0, v201
  v_rcp_f32 v200, v200
  v_mul_f32 v207, v207, v71
  v_mul_f32 v204, s40, v76
  v_exp_f32 v203, v203
  v_add_f32 v202, 1.0, v202
  v_rcp_f32 v201, v201
  v_mul_f32 v200, v200, v72
  v_cvt_pk_bf16_f32 v67, v206, v207
  buffer_store_dwordx4 v[64:67], v12, s[8:11], s38 offen offset:2048 sc1
  v_mul_f32 v205, s40, v77
  v_exp_f32 v204, v204
  v_add_f32 v203, 1.0, v203
  v_rcp_f32 v202, v202
  v_mul_f32 v201, v201, v73
  v_mul_f32 v206, s40, v78
  v_exp_f32 v205, v205
  v_add_f32 v204, 1.0, v204
  v_rcp_f32 v203, v203
  v_mul_f32 v202, v202, v74
  v_cvt_pk_bf16_f32 v72, v200, v201
  v_mul_f32 v207, s40, v79
  v_exp_f32 v206, v206
  v_add_f32 v205, 1.0, v205
  v_rcp_f32 v204, v204
  v_mul_f32 v203, v203, v75
  v_exp_f32 v207, v207
  v_add_f32 v206, 1.0, v206
  v_rcp_f32 v205, v205
  v_mul_f32 v204, v204, v76
  v_cvt_pk_bf16_f32 v73, v202, v203
  v_add_f32 v207, 1.0, v207
  v_rcp_f32 v206, v206
  v_mul_f32 v205, v205, v77
  v_rcp_f32 v207, v207
  v_mul_f32 v206, v206, v78
  v_cvt_pk_bf16_f32 v74, v204, v205
  v_mul_f32 v207, v207, v79
  v_cvt_pk_bf16_f32 v75, v206, v207
  buffer_store_dwordx4 v[72:75], v12, s[8:11], s38 offen offset:3072 sc1
  s_waitcnt vmcnt(9)
  s_nop 3
  s_branch B_SSM
A_DONE:
B_FFN:
  s_add_u32 s42, s53, 393216
  s_add_u32 s3, s48, 1
  s_and_b32 s3, s3, 3
  s_lshl_b32 s56, s3, 1
  s_add_u32 s59, s56, 1
  s_add_u32 s3, s48, 2
  s_and_b32 s3, s3, 3
  s_lshl_b32 s57, s3, 1
  s_add_u32 s60, s57, 1
  s_add_u32 s3, s48, 3
  s_and_b32 s3, s3, 3
  s_lshl_b32 s58, s3, 1
  s_add_u32 s61, s58, 1
  s_mul_i32 s37, s46, 2949120
  s_mul_i32 s3, s48, 73728
  s_add_u32 s37, s37, s3
  s_add_u32 s37, s37, 8388608
  s_lshl_b32 s4, s30, 3
  v_add_u32 v14, s4, v0
  v_and_b32 v14, 31, v14
  v_and_b32 v15, 32, v0
  v_add_u32 v14, v14, v15
  s_mul_i32 s3, s30, 18432
  v_lshl_add_u32 v1, v14, 4, s3
  s_mul_i32 s41, s56, 368640
  s_add_u32 s41, s41, s37
  buffer_load_dwordx4 v[152:155], v1, s[8:11], s41 offen offset:0 sc1
  buffer_load_dwordx4 v[156:159], v1, s[8:11], s41 offen offset:1024 sc1
  buffer_load_dwordx4 v[160:163], v1, s[8:11], s41 offen offset:2048 sc1
  buffer_load_dwordx4 v[164:167], v1, s[8:11], s41 offen offset:3072 sc1
  s_add_u32 s41, s41, 4096
  buffer_load_dwordx4 v[168:171], v1, s[8:11], s41 offen offset:0 sc1
  buffer_load_dwordx4 v[172:175], v1, s[8:11], s41 offen offset:1024 sc1
  buffer_load_dwordx4 v[176:179], v1, s[8:11], s41 offen offset:2048 sc1
  buffer_load_dwordx4 v[180:183], v1, s[8:11], s41 offen offset:3072 sc1
  s_mul_i32 s41, s57, 368640
  s_add_u32 s41, s41, s37
  buffer_load_dwordx4 v[184:187], v1, s[8:11], s41 offen offset:0 sc1
  buffer_load_dwordx4 v[188:191], v1, s[8:11], s41 offen offset:1024 sc1
  s_lshl_b32 s62, s48, 1
  s_add_u32 s63, s62, 1
  s_load_dwordx2 s[96:97], s[0:1], 0
  s_load_dwordx2 s[98:99], s[0:1], 96
  s_load_dwordx2 s[100:101], s[0:1], 64
  v_mov_b32 v5, v251
  ds_read_b64_tr_b16 a[72:73], v5 offset:0
  ds_read_b64_tr_b16 a[74:75], v5 offset:1536
  ds_read_b64_tr_b16 a[76:77], v5 offset:64
  ds_read_b64_tr_b16 a[78:79], v5 offset:1600
  ds_read_b64_tr_b16 a[80:81], v5 offset:128
  ds_read_b64_tr_b16 a[82:83], v5 offset:1664
  s_waitcnt vmcnt(10)
  s_barrier
  buffer_store_dword v250, v252, s[8:11], s42 offen sc1
  ds_read_b64_tr_b16 a[84:85], v5 offset:3072
  ds_read_b64_tr_b16 a[86:87], v5 offset:4608
  ds_read_b64_tr_b16 a[88:89], v5 offset:3136
  ds_read_b64_tr_b16 a[90:91], v5 offset:4672
  ds_read_b64_tr_b16 a[92:93], v5 offset:3200
  ds_read_b64_tr_b16 a[94:95], v5 offset:4736
  ds_read_b64_tr_b16 a[96:97], v5 offset:6144
  ds_read_b64_tr_b16 a[98:99], v5 offset:7680
  ds_read_b64_tr_b16 a[100:101], v5 offset:6208
  ds_read_b64_tr_b16 a[102:103], v5 offset:7744
  ds_read_b64_tr_b16 a[104:105], v5 offset:6272
  ds_read_b64_tr_b16 a[106:107], v5 offset:7808
  ds_read_b64_tr_b16 a[108:109], v5 offset:9216
  ds_read_b64_tr_b16 a[110:111], v5 offset:10752
  ds_read_b64_tr_b16 a[112:113], v5 offset:9280
  ds_read_b64_tr_b16 a[114:115], v5 offset:10816
  ds_read_b64_tr_b16 a[116:117], v5 offset:9344
  ds_read_b64_tr_b16 a[118:119], v5 offset:10880
  ds_read_b64_tr_b16 a[120:121], v5 offset:12288
  ds_read_b64_tr_b16 a[122:123], v5 offset:13824
  ds_read_b64_tr_b16 a[124:125], v5 offset:12352
  ds_read_b64_tr_b16 a[126:127], v5 offset:13888
  ds_read_b64_tr_b16 a[128:129], v5 offset:12416
  ds_read_b64_tr_b16 a[130:131], v5 offset:13952
  ds_read_b64_tr_b16 a[132:133], v5 offset:15360
  ds_read_b64_tr_b16 a[134:135], v5 offset:16896
  ds_read_b64_tr_b16 a[136:137], v5 offset:15424
  ds_read_b64_tr_b16 a[138:139], v5 offset:16960
  ds_read_b64_tr_b16 a[140:141], v5 offset:15488
  ds_read_b64_tr_b16 a[142:143], v5 offset:17024
  s_mul_i32 s55, s46, 48
  s_add_u32 s55, s55, s47
  s_lshl_b32 s3, s55, 13
  s_mul_i32 s4, s48, 3145728
  s_add_u32 s3, s3, s4
  s_add_u32 s39, s3, 33554432
  s_lshl_b32 s3, s30, 11
  v_lshl_add_u32 v13, v0, 4, s3
  s_sub_u32 s3, s30, 1
  s_and_b32 s3, s3, 3
  s_mul_i32 s3, s3, 9216
  s_add_u32 s3, s3, 73728
  v_lshl_add_u32 v10, v0, 4, s3
  s_sub_u32 s3, s30, 2
  s_and_b32 s3, s3, 3
  s_mul_i32 s3, s3, 9216
  s_add_u32 s3, s3, 76800
  v_lshl_add_u32 v11, v0, 4, s3
  s_sub_u32 s3, s30, 3
  s_and_b32 s3, s3, 3
  s_mul_i32 s3, s3, 9216
  s_add_u32 s3, s3, 79872
  v_lshl_add_u32 v12, v0, 4, s3
  s_mul_i32 s3, s30, 9216
  s_add_u32 s3, s3, 73728
  v_lshl_add_u32 v6, v0, 4, s3
  v_subrev_u32 v5, 73728, v251
  s_waitcnt lgkmcnt(0)
  s_lshl_b32 s3, s48, 3
  s_lshl_b32 s3, 0xff, s3
  s_lshl_b32 s5, s48, 2
  s_lshl_b32 s5, 0x3f, s5
  s_or_b32 s3, s3, s5
  s_waitcnt vmcnt(10)
  v_mfma_f32_32x32x16_bf16 v[16:31], v[152:155], a[0:3], 0
  buffer_load_dwordx4 v[192:195], v1, s[8:11], s41 offen offset:2048 sc1
  s_and_b32 s54, s54, s3
  s_add_u32 s12, s12, 65536
  v_mfma_f32_32x32x16_bf16 v[32:47], v[152:155], a[4:7], 0
  buffer_load_dwordx4 v[196:199], v1, s[8:11], s41 offen offset:3072 sc1
  v_mfma_f32_32x32x16_bf16 v[48:63], v[152:155], a[8:11], 0
  s_add_u32 s41, s41, 4096
  buffer_load_dwordx4 v[200:203], v1, s[8:11], s41 offen offset:0 sc1
  s_waitcnt vmcnt(12)
  v_mfma_f32_32x32x16_bf16 v[16:31], v[156:159], a[12:15], v[16:31]
  buffer_load_dwordx4 v[204:207], v1, s[8:11], s41 offen offset:1024 sc1
  v_mfma_f32_32x32x16_bf16 v[32:47], v[156:159], a[16:19], v[32:47]
  buffer_load_dwordx4 v[208:211], v1, s[8:11], s41 offen offset:2048 sc1
  v_mfma_f32_32x32x16_bf16 v[48:63], v[156:159], a[20:23], v[48:63]
  buffer_load_dwordx4 v[212:215], v1, s[8:11], s41 offen offset:3072 sc1
  s_add_u32 m0, s51, 0
  s_nop 0
  buffer_load_dwordx4 v253, s[24:27], s49 offen offset:0 sc1 lds
  s_waitcnt vmcnt(15)
  v_mfma_f32_32x32x16_bf16 v[16:31], v[160:163], a[24:27], v[16:31]
  buffer_load_dwordx4 v254, s[24:27], s49 offen offset:1024 sc1 lds
  buffer_load_dwordx4 v255, s[24:27], s49 offen offset:2048 sc1 lds
  s_add_u32 s49, s49, s50
  v_mfma_f32_32x32x16_bf16 v[32:47], v[160:163], a[28:31], v[32:47]
  s_add_u32 m0, s51, 3072
  s_nop 0
  buffer_load_dwordx4 v253, s[24:27], s49 offen offset:0 sc1 lds
  buffer_load_dwordx4 v254, s[24:27], s49 offen offset:1024 sc1 lds
  v_mfma_f32_32x32x16_bf16 v[48:63], v[160:163], a[32:35], v[48:63]
  buffer_load_dwordx4 v255, s[24:27], s49 offen offset:2048 sc1 lds
  s_add_u32 s49, s49, s50
  s_waitcnt vmcnt(19)
  v_mfma_f32_32x32x16_bf16 v[16:31], v[164:167], a[36:39], v[16:31]
  s_add_u32 m0, s51, 6144
  s_nop 0
  buffer_load_dwordx4 v253, s[24:27], s49 offen offset:0 sc1 lds
  buffer_load_dwordx4 v254, s[24:27], s49 offen offset:1024 sc1 lds
  v_mfma_f32_32x32x16_bf16 v[32:47], v[164:167], a[40:43], v[32:47]
  buffer_load_dwordx4 v255, s[24:27], s49 offen offset:2048 sc1 lds
  s_add_u32 s49, s49, s50
  v_mfma_f32_32x32x16_bf16 v[48:63], v[164:167], a[44:47], v[48:63]
  s_barrier
  s_add_u32 m0, s51, 9216
  s_nop 0
  buffer_load_dwordx4 v253, s[24:27], s49 offen offset:0 sc1 lds
  s_waitcnt vmcnt(22)
  v_mfma_f32_32x32x16_bf16 v[16:31], v[168:171], a[48:51], v[16:31]
  buffer_load_dwordx4 v254, s[24:27], s49 offen offset:1024 sc1 lds
  buffer_load_dwordx4 v255, s[24:27], s49 offen offset:2048 sc1 lds
  s_add_u32 s49, s49, s50
  v_mfma_f32_32x32x16_bf16 v[32:47], v[168:171], a[52:55], v[32:47]
  s_add_u32 m0, s51, 12288
  s_nop 0
  buffer_load_dwordx4 v253, s[24:27], s49 offen offset:0 sc1 lds
  buffer_load_dwordx4 v254, s[24:27], s49 offen offset:1024 sc1 lds
  v_mfma_f32_32x32x16_bf16 v[48:63], v[168:171], a[56:59], v[48:63]
  buffer_load_dwordx4 v255, s[24:27], s49 offen offset:2048 sc1 lds
  s_add_u32 s49, s49, s50
  s_waitcnt vmcnt(26)
  v_mfma_f32_32x32x16_bf16 v[16:31], v[172:175], a[60:63], v[16:31]
  buffer_load_dword v8, v9, s[8:11], s12 offen sc1
  s_add_u32 m0, s51, 15360
  s_nop 0
  buffer_load_dwordx4 v253, s[24:27], s49 offen offset:0 sc1 lds
  v_mfma_f32_32x32x16_bf16 v[32:47], v[172:175], a[64:67], v[32:47]
  buffer_load_dwordx4 v254, s[24:27], s49 offen offset:1024 sc1 lds
  buffer_load_dwordx4 v255, s[24:27], s49 offen offset:2048 sc1 lds
  s_add_u32 s49, s49, s50
  s_mul_i32 s5, s48, 12
  v_mfma_f32_32x32x16_bf16 v[48:63], v[172:175], a[68:71], v[48:63]
  s_add_u32 s5, s5, s55
  s_lshl_b32 s5, s5, 13
  s_sub_u32 s3, s48, 1
  s_and_b32 s3, s3, 3
  s_mul_i32 s3, s3, 3145728
  s_waitcnt vmcnt(29)
  v_mfma_f32_32x32x16_bf16 v[16:31], v[176:179], a[72:75], v[16:31]
  s_add_u32 s3, s3, s5
  s_add_u32 s34, s3, 33554432
  s_sub_u32 s3, s48, 2
  s_and_b32 s3, s3, 3
  s_mul_i32 s3, s3, 3145728
  s_add_u32 s3, s3, s5
  v_mfma_f32_32x32x16_bf16 v[32:47], v[176:179], a[76:79], v[32:47]
  s_add_u32 s35, s3, 33554432
  s_sub_u32 s3, s48, 3
  s_and_b32 s3, s3, 3
  s_mul_i32 s3, s3, 3145728
  s_add_u32 s3, s3, s5
  s_add_u32 s36, s3, 33554432
  v_mfma_f32_32x32x16_bf16 v[48:63], v[176:179], a[80:83], v[48:63]
  s_mov_b32 s15, 0xffff0000
  s_add_u32 s38, s5, 46137344
  s_mov_b32 s52, 0
  s_waitcnt vmcnt(28)
  v_mfma_f32_32x32x16_bf16 v[16:31], v[180:183], a[84:87], v[16:31]
  v_mfma_f32_32x32x16_bf16 v[32:47], v[180:183], a[88:91], v[32:47]
  v_mfma_f32_32x32x16_bf16 v[48:63], v[180:183], a[92:95], v[48:63]
  s_waitcnt vmcnt(27)
  v_mfma_f32_32x32x16_bf16 v[64:79], v[184:187], a[0:3], 0
  v_mfma_f32_32x32x16_bf16 v[80:95], v[184:187], a[4:7], 0
  v_mfma_f32_32x32x16_bf16 v[96:111], v[184:187], a[8:11], 0
  s_waitcnt vmcnt(26)
  v_mfma_f32_32x32x16_bf16 v[64:79], v[188:191], a[12:15], v[64:79]
  v_mfma_f32_32x32x16_bf16 v[80:95], v[188:191], a[16:19], v[80:95]
  v_mfma_f32_32x32x16_bf16 v[96:111], v[188:191], a[20:23], v[96:111]
  s_waitcnt vmcnt(24)
  v_mfma_f32_32x32x16_bf16 v[64:79], v[192:195], a[24:27], v[64:79]
  v_mfma_f32_32x32x16_bf16 v[80:95], v[192:195], a[28:31], v[80:95]
  v_mfma_f32_32x32x16_bf16 v[96:111], v[192:195], a[32:35], v[96:111]
  s_waitcnt vmcnt(3)
  v_cmp_ne_u32 vcc, s45, v8
  s_nop 1
  s_or_b32 s4, vcc_lo, vcc_hi
  s_and_b32 s4, s4, s54
  s_cmp_eq_u32 s4, 0
  s_cbranch_scc0 POLL8
POLL8_OK:
  s_mul_i32 s41, s56, 368640
  s_add_u32 s41, s41, s37
  s_add_u32 s41, s41, 8192
  buffer_load_dwordx4 v[216:219], v1, s[8:11], s41 offen offset:0 sc1
  buffer_load_dwordx4 v[220:223], v1, s[8:11], s41 offen offset:1024 sc1
  buffer_load_dwordx4 v[152:155], v1, s[8:11], s41 offen offset:2048 sc1
  buffer_load_dwordx4 v[156:159], v1, s[8:11], s41 offen offset:3072 sc1
  s_add_u32 s41, s41, 4096
  buffer_load_dwordx4 v[160:163], v1, s[8:11], s41 offen offset:0 sc1
  buffer_load_dwordx4 v[164:167], v1, s[8:11], s41 offen offset:1024 sc1
  v_mfma_f32_32x32x16_bf16 v[64:79], v[196:199], a[36:39], v[64:79]
  buffer_load_dwordx4 v[168:171], v1, s[8:11], s41 offen offset:2048 sc1
  v_mfma_f32_32x32x16_bf16 v[80:95], v[196:199], a[40:43], v[80:95]
  buffer_load_dwordx4 v[172:175], v1, s[8:11], s41 offen offset:3072 sc1
  v_mfma_f32_32x32x16_bf16 v[96:111], v[196:199], a[44:47], v[96:111]
  s_add_u32 s41, s41, 4096
  buffer_load_dwordx4 v[176:179], v1, s[8:11], s41 offen offset:0 sc1
  v_mfma_f32_32x32x16_bf16 v[64:79], v[200:203], a[48:51], v[64:79]
  buffer_load_dwordx4 v[180:183], v1, s[8:11], s41 offen offset:1024 sc1
  v_mfma_f32_32x32x16_bf16 v[80:95], v[200:203], a[52:55], v[80:95]
  s_mul_i32 s41, s57, 368640
  s_add_u32 s41, s41, s37
  s_add_u32 s41, s41, 8192
  buffer_load_dwordx4 v[184:187], v1, s[8:11], s41 offen offset:0 sc1
  v_mfma_f32_32x32x16_bf16 v[96:111], v[200:203], a[56:59], v[96:111]
  buffer_load_dwordx4 v[188:191], v1, s[8:11], s41 offen offset:1024 sc1
  v_mfma_f32_32x32x16_bf16 v[64:79], v[204:207], a[60:63], v[64:79]
  buffer_load_dwordx4 v[192:195], v1, s[8:11], s41 offen offset:2048 sc1
  ds_read_b64_tr_b16 a[144:145], v5 offset:0
  ds_read_b64_tr_b16 a[146:147], v5 offset:1536
  ds_read_b64_tr_b16 a[148:149], v5 offset:64
  v_mfma_f32_32x32x16_bf16 v[80:95], v[204:207], a[64:67], v[80:95]
  buffer_load_dwordx4 v[196:199], v1, s[8:11], s41 offen offset:3072 sc1
  ds_read_b64_tr_b16 a[150:151], v5 offset:1600
  ds_read_b64_tr_b16 a[152:153], v5 offset:128
  ds_read_b64_tr_b16 a[154:155], v5 offset:1664
  v_mfma_f32_32x32x16_bf16 v[96:111], v[204:207], a[68:71], v[96:111]
  s_add_u32 s41, s41, 4096
  buffer_load_dwordx4 v[200:203], v1, s[8:11], s41 offen offset:0 sc1
  v_mfma_f32_32x32x16_bf16 v[64:79], v[208:211], a[72:75], v[64:79]
  buffer_load_dwordx4 v[204:207], v1, s[8:11], s41 offen offset:1024 sc1
  ds_read_b64_tr_b16 a[156:157], v5 offset:3072
  ds_read_b64_tr_b16 a[158:159], v5 offset:4608
  ds_read_b64_tr_b16 a[160:161], v5 offset:3136
  v_mfma_f32_32x32x16_bf16 v[80:95], v[208:211], a[76:79], v[80:95]
  ds_read_b64_tr_b16 a[162:163], v5 offset:4672
  ds_read_b64_tr_b16 a[164:165], v5 offset:3200
  ds_read_b64_tr_b16 a[166:167], v5 offset:4736
  v_mfma_f32_32x32x16_bf16 v[96:111], v[208:211], a[80:83], v[96:111]
  buffer_load_dwordx4 v[208:211], v1, s[8:11], s41 offen offset:2048 sc1
  v_mfma_f32_32x32x16_bf16 v[64:79], v[212:215], a[84:87], v[64:79]
  ds_read_b64_tr_b16 a[168:169], v5 offset:6144
  ds_read_b64_tr_b16 a[170:171], v5 offset:7680
  ds_read_b64_tr_b16 a[172:173], v5 offset:6208
  ds_read_b64_tr_b16 a[174:175], v5 offset:7744
  ds_read_b64_tr_b16 a[176:177], v5 offset:6272
  v_mfma_f32_32x32x16_bf16 v[80:95], v[212:215], a[88:91], v[80:95]
  ds_read_b64_tr_b16 a[178:179], v5 offset:7808
  v_mfma_f32_32x32x16_bf16 v[96:111], v[212:215], a[92:95], v[96:111]
  buffer_load_dwordx4 v[212:215], v1, s[8:11], s41 offen offset:3072 sc1
  s_waitcnt vmcnt(17)
  v_mfma_f32_32x32x16_bf16 v[16:31], v[216:219], a[96:99], v[16:31]
  ds_read_b64_tr_b16 a[180:181], v5 offset:9216
  ds_read_b64_tr_b16 a[182:183], v5 offset:10752
  ds_read_b64_tr_b16 a[184:185], v5 offset:9280
  ds_read_b64_tr_b16 a[186:187], v5 offset:10816
  ds_read_b64_tr_b16 a[188:189], v5 offset:9344
  v_mfma_f32_32x32x16_bf16 v[32:47], v[216:219], a[100:103], v[32:47]
  ds_read_b64_tr_b16 a[190:191], v5 offset:10880
  v_mfma_f32_32x32x16_bf16 v[48:63], v[216:219], a[104:107], v[48:63]
  s_add_u32 s41, s41, 4096
  buffer_load_dwordx4 v[216:219], v1, s[8:11], s41 offen offset:0 sc1
  s_waitcnt vmcnt(17)
  v_mfma_f32_32x32x16_bf16 v[16:31], v[220:223], a[108:111], v[16:31]
  ds_read_b64_tr_b16 a[192:193], v5 offset:12288
  ds_read_b64_tr_b16 a[194:195], v5 offset:13824
  ds_read_b64_tr_b16 a[196:197], v5 offset:12352
  ds_read_b64_tr_b16 a[198:199], v5 offset:13888
  ds_read_b64_tr_b16 a[200:201], v5 offset:12416
  v_mfma_f32_32x32x16_bf16 v[32:47], v[220:223], a[112:115], v[32:47]
  ds_read_b64_tr_b16 a[202:203], v5 offset:13952
  v_mfma_f32_32x32x16_bf16 v[48:63], v[220:223], a[116:119], v[48:63]
  buffer_load_dwordx4 v[220:223], v1, s[8:11], s41 offen offset:1024 sc1
  s_waitcnt vmcnt(17)
  v_mfma_f32_32x32x16_bf16 v[16:31], v[152:155], a[120:123], v[16:31]
  ds_read_b64_tr_b16 a[204:205], v5 offset:15360
  ds_read_b64_tr_b16 a[206:207], v5 offset:16896
  ds_read_b64_tr_b16 a[208:209], v5 offset:15424
  ds_read_b64_tr_b16 a[210:211], v5 offset:16960
  ds_read_b64_tr_b16 a[212:213], v5 offset:15488
  v_mfma_f32_32x32x16_bf16 v[32:47], v[152:155], a[124:127], v[32:47]
  ds_read_b64_tr_b16 a[214:215], v5 offset:17024
  s_lshl_b32 s3, s46, 8
  s_lshl_b32 s4, s48, 6
  s_add_u32 s3, s3, s4
  s_lshl_b32 s4, s30, 2
  s_add_u32 s3, s3, s4
  v_mfma_f32_32x32x16_bf16 v[48:63], v[152:155], a[128:131], v[48:63]
  s_mul_i32 s41, s58, 368640
  s_add_u32 s41, s41, s37
  buffer_load_dwordx4 v[152:155], v1, s[8:11], s41 offen offset:0 sc1
  v_and_b32 v2, 32, v0
  s_waitcnt vmcnt(17)
  v_mfma_f32_32x32x16_bf16 v[16:31], v[156:159], a[132:135], v[16:31]
  v_add_u32 v2, s3, v2
  v_lshlrev_b32 v253, 3, v2
  v_mul_u32_u24 v2, 576, v2
  v_and_b32 v3, 31, v0
  s_mul_i32 s4, s47, 96
  v_add_u32 v254, s4, v3
  v_mfma_f32_32x32x16_bf16 v[32:47], v[156:159], a[136:139], v[32:47]
  v_add_u32 v2, v2, v254
  v_lshlrev_b32 v254, 1, v254
  v_lshlrev_b32 v3, 2, v2
  v_add_u32 v4, 4608, v3
  v_lshlrev_b32 v2, 1, v2
  v_and_b32 v5, 3, v0
  v_mfma_f32_32x32x16_bf16 v[48:63], v[156:159], a[140:143], v[48:63]
  buffer_load_dwordx4 v[156:159], v1, s[8:11], s41 offen offset:1024 sc1
  v_mul_u32_u24 v5, 2300, v5
  v_add_u32 v5, v3, v5
  s_mov_b32 s24, 0x55555555
  s_waitcnt vmcnt(17)
  s_waitcnt lgkmcnt(15)
  v_mfma_f32_32x32x16_bf16 v[16:31], v[160:163], a[144:147], v[16:31]
  s_mov_b32 s25, s24
  s_mov_b32 s26, 0xaaaaaaaa
  s_mov_b32 s27, s26
  s_mov_b32 s28, 0x33333333
  s_mov_b32 s29, s28
  s_mov_b32 s50, 0xcccccccc
  v_mfma_f32_32x32x16_bf16 v[32:47], v[160:163], a[148:151], v[32:47]
  s_mov_b32 s51, s50
  s_mov_b32 s16, s96
  s_and_b32 s17, s97, 0xffff
  s_mov_b32 s18, 0x240000
  s_mov_b32 s19, 0x00020000
  v_mfma_f32_32x32x16_bf16 v[48:63], v[160:163], a[152:155], v[48:63]
  buffer_load_dwordx4 v[160:163], v1, s[8:11], s41 offen offset:2048 sc1
  s_waitcnt vmcnt(17)
  v_mfma_f32_32x32x16_bf16 v[16:31], v[164:167], a[156:159], v[16:31]
  s_mov_b32 s20, s98
  s_and_b32 s21, s99, 0xffff
  s_mov_b32 s22, 0x480000
  s_mov_b32 s23, 0x00020000
  s_movk_i32 s7, 18432
  s_mov_b32 s6, 16384
  v_mfma_f32_32x32x16_bf16 v[32:47], v[164:167], a[160:163], v[32:47]
  global_load_ushort v248, v254, s[100:101] offset:0
  global_load_ushort v249, v254, s[100:101] offset:64
  global_load_ushort v250, v254, s[100:101] offset:128
  v_mfma_f32_32x32x16_bf16 v[48:63], v[164:167], a[164:167], v[48:63]
  buffer_load_dwordx4 v[164:167], v1, s[8:11], s41 offen offset:3072 sc1
  buffer_load_dwordx4 v[232:235], v253, s[8:11], s6 offen offset:0 sc1
  s_waitcnt vmcnt(21)
  v_mfma_f32_32x32x16_bf16 v[16:31], v[168:171], a[168:171], v[16:31]
  buffer_load_dwordx4 v[236:239], v253, s[8:11], s6 offen offset:16 sc1
  v_mfma_f32_32x32x16_bf16 v[32:47], v[168:171], a[172:175], v[32:47]
  buffer_load_dwordx4 v[240:243], v253, s[8:11], s6 offen offset:128 sc1
  v_mfma_f32_32x32x16_bf16 v[48:63], v[168:171], a[176:179], v[48:63]
  s_add_u32 s41, s41, 4096
  buffer_load_dwordx4 v[168:171], v1, s[8:11], s41 offen offset:0 sc1
  buffer_load_dwordx4 v[244:247], v253, s[8:11], s6 offen offset:144 sc1
  s_waitcnt vmcnt(24)
  s_waitcnt lgkmcnt(12)
  v_mfma_f32_32x32x16_bf16 v[16:31], v[172:175], a[180:183], v[16:31]
  v_mfma_f32_32x32x16_bf16 v[32:47], v[172:175], a[184:187], v[32:47]
  buffer_load_ushort a216, v2, s[16:19], 0 offen offset:0
  v_mfma_f32_32x32x16_bf16 v[48:63], v[172:175], a[188:191], v[48:63]
  buffer_load_dwordx4 v[172:175], v1, s[8:11], s41 offen offset:1024 sc1
  s_waitcnt vmcnt(25)
  s_waitcnt lgkmcnt(6)
  v_mfma_f32_32x32x16_bf16 v[16:31], v[176:179], a[192:195], v[16:31]
  buffer_load_ushort a217, v2, s[16:19], 0 offen offset:1152
  v_mfma_f32_32x32x16_bf16 v[32:47], v[176:179], a[196:199], v[32:47]
  v_mfma_f32_32x32x16_bf16 v[48:63], v[176:179], a[200:203], v[48:63]
  buffer_load_dwordx4 v[176:179], v1, s[8:11], s41 offen offset:2048 sc1
  buffer_load_ushort a218, v2, s[16:19], 0 offen offset:2304
  s_waitcnt vmcnt(27)
  s_waitcnt lgkmcnt(0)
  v_mfma_f32_32x32x16_bf16 v[16:31], v[180:183], a[204:207], v[16:31]
  v_mfma_f32_32x32x16_bf16 v[32:47], v[180:183], a[208:211], v[32:47]
  buffer_load_ushort a219, v2, s[16:19], 0 offen offset:3456
  v_mfma_f32_32x32x16_bf16 v[48:63], v[180:183], a[212:215], v[48:63]
  buffer_load_dwordx4 v[180:183], v1, s[8:11], s41 offen offset:3072 sc1
  s_waitcnt vmcnt(28)
  v_mfma_f32_32x32x16_bf16 v[64:79], v[184:187], a[96:99], v[64:79]
  buffer_load_ushort a220, v2, s[16:19], 0 offen offset:64
  v_mfma_f32_32x32x16_bf16 v[80:95], v[184:187], a[100:103], v[80:95]
  s_nop 3
  ds_write_b128 v6, v[20:23] offset:0
  v_mfma_f32_32x32x16_bf16 v[96:111], v[184:187], a[104:107], v[96:111]
  s_add_u32 s41, s41, 4096
  buffer_load_dwordx4 v[184:187], v1, s[8:11], s41 offen offset:0 sc1
  buffer_load_ushort a221, v2, s[16:19], 0 offen offset:1216
  s_waitcnt vmcnt(30)
  v_mfma_f32_32x32x16_bf16 v[64:79], v[188:191], a[108:111], v[64:79]
  ds_write_b128 v6, v[36:39] offset:1024
  v_mfma_f32_32x32x16_bf16 v[80:95], v[188:191], a[112:115], v[80:95]
  ds_write_b128 v6, v[52:55] offset:2048
  v_mfma_f32_32x32x16_bf16 v[96:111], v[188:191], a[116:119], v[96:111]
  buffer_load_dwordx4 v[188:191], v1, s[8:11], s41 offen offset:1024 sc1
  buffer_load_ushort a222, v2, s[16:19], 0 offen offset:2368
  s_waitcnt vmcnt(31)
  v_mfma_f32_32x32x16_bf16 v[64:79], v[192:195], a[120:123], v[64:79]
  ds_write_b128 v6, v[24:27] offset:3072
  v_mfma_f32_32x32x16_bf16 v[80:95], v[192:195], a[124:127], v[80:95]
  ds_write_b128 v6, v[40:43] offset:4096
  v_mfma_f32_32x32x16_bf16 v[96:111], v[192:195], a[128:131], v[96:111]
  buffer_load_dwordx4 v[192:195], v1, s[8:11], s41 offen offset:2048 sc1
  buffer_load_ushort a223, v2, s[16:19], 0 offen offset:3520
  s_waitcnt vmcnt(32)
  v_mfma_f32_32x32x16_bf16 v[64:79], v[196:199], a[132:135], v[64:79]
  ds_write_b128 v6, v[56:59] offset:5120
  v_mfma_f32_32x32x16_bf16 v[80:95], v[196:199], a[136:139], v[80:95]
  ds_write_b128 v6, v[28:31] offset:6144
  v_mfma_f32_32x32x16_bf16 v[96:111], v[196:199], a[140:143], v[96:111]
  buffer_load_dwordx4 v[196:199], v1, s[8:11], s41 offen offset:3072 sc1
  buffer_load_ushort a224, v2, s[16:19], 0 offen offset:128
  s_waitcnt vmcnt(33)
  v_mfma_f32_32x32x16_bf16 v[64:79], v[200:203], a[144:147], v[64:79]
  ds_write_b128 v6, v[44:47] offset:7168
  v_mfma_f32_32x32x16_bf16 v[80:95], v[200:203], a[148:151], v[80:95]
  ds_write_b128 v6, v[60:63] offset:8192
  v_mfma_f32_32x32x16_bf16 v[96:111], v[200:203], a[152:155], v[96:111]
  s_add_u32 s41, s41, 4096
  buffer_load_dwordx4 v[200:203], v1, s[8:11], s41 offen offset:0 sc1
  buffer_load_ushort a225, v2, s[16:19], 0 offen offset:1280
  s_waitcnt vmcnt(34)
  v_mfma_f32_32x32x16_bf16 v[64:79], v[204:207], a[156:159], v[64:79]
  s_waitcnt lgkmcnt(0)
  s_barrier
  ds_read_b128 v[112:115], v10 offset:0
  ds_read_b128 v[116:119], v10 offset:1024
  ds_read_b128 v[120:123], v10 offset:2048
  ds_read_b128 v[124:127], v11 offset:0
  v_mfma_f32_32x32x16_bf16 v[80:95], v[204:207], a[160:163], v[80:95]
  ds_read_b128 v[128:131], v11 offset:1024
  ds_read_b128 v[132:135], v11 offset:2048
  ds_read_b128 v[136:139], v12 offset:0
  ds_read_b128 v[140:143], v12 offset:1024
  ds_read_b128 v[144:147], v12 offset:2048
  v_mfma_f32_32x32x16_bf16 v[96:111], v[204:207], a[164:167], v[96:111]
  buffer_load_dwordx4 v[204:207], v1, s[8:11], s41 offen offset:1024 sc1
  buffer_load_ushort a226, v2, s[16:19], 0 offen offset:2432
  s_waitcnt vmcnt(35)
  v_mfma_f32_32x32x16_bf16 v[64:79], v[208:211], a[168:171], v[64:79]
  v_mfma_f32_32x32x16_bf16 v[80:95], v[208:211], a[172:175], v[80:95]
  buffer_load_ushort a227, v2, s[16:19], 0 offen offset:3584
  v_mfma_f32_32x32x16_bf16 v[96:111], v[208:211], a[176:179], v[96:111]
  buffer_load_dwordx4 v[208:211], v1, s[8:11], s41 offen offset:2048 sc1
  s_waitcnt lgkmcnt(0)
  v_add_f32 v112, v112, v16
  v_add_f32 v124, v124, v136
  s_waitcnt vmcnt(36)
  v_mfma_f32_32x32x16_bf16 v[64:79], v[212:215], a[180:183], v[64:79]
  v_add_f32 v113, v113, v17
  v_add_f32 v125, v125, v137
  v_add_f32 v114, v114, v18
  v_add_f32 v126, v126, v138
  v_add_f32 v115, v115, v19
  v_add_f32 v127, v127, v139
  v_mfma_f32_32x32x16_bf16 v[80:95], v[212:215], a[184:187], v[80:95]
  v_add_f32 v116, v116, v32
  v_add_f32 v128, v128, v140
  v_add_f32 v117, v117, v33
  v_add_f32 v129, v129, v141
  v_add_f32 v118, v118, v34
  v_add_f32 v130, v130, v142
  v_mfma_f32_32x32x16_bf16 v[96:111], v[212:215], a[188:191], v[96:111]
  buffer_load_dwordx4 v[212:215], v1, s[8:11], s41 offen offset:3072 sc1
  v_add_f32 v119, v119, v35
  v_add_f32 v131, v131, v143
  v_add_f32 v120, v120, v48
  s_waitcnt vmcnt(36)
  v_mfma_f32_32x32x16_bf16 v[64:79], v[216:219], a[192:195], v[64:79]
  v_add_f32 v132, v132, v144
  v_add_f32 v121, v121, v49
  v_add_f32 v133, v133, v145
  v_add_f32 v122, v122, v50
  v_add_f32 v134, v134, v146
  v_add_f32 v123, v123, v51
  v_mfma_f32_32x32x16_bf16 v[80:95], v[216:219], a[196:199], v[80:95]
  v_add_f32 v135, v135, v147
  v_add_f32 v112, v112, v124
  v_add_f32 v113, v113, v125
  v_add_f32 v114, v114, v126
  v_add_f32 v115, v115, v127
  v_add_f32 v116, v116, v128
  v_mfma_f32_32x32x16_bf16 v[96:111], v[216:219], a[200:203], v[96:111]
  s_add_u32 s41, s41, 4096
  buffer_load_dwordx4 v[216:219], v1, s[8:11], s41 offen offset:0 sc1
  v_add_f32 v117, v117, v129
  v_add_f32 v118, v118, v130
  s_waitcnt vmcnt(36)
  v_mfma_f32_32x32x16_bf16 v[64:79], v[220:223], a[204:207], v[64:79]
  v_add_f32 v119, v119, v131
  v_add_f32 v120, v120, v132
  v_add_f32 v121, v121, v133
  v_add_f32 v122, v122, v134
  v_add_f32 v123, v123, v135
  v_cvt_pk_bf16_f32 v136, v112, v113
  v_mfma_f32_32x32x16_bf16 v[80:95], v[220:223], a[208:211], v[80:95]
  v_cvt_pk_bf16_f32 v137, v114, v115
  v_cvt_pk_bf16_f32 v138, v116, v117
  v_cvt_pk_bf16_f32 v140, v118, v119
  v_cvt_pk_bf16_f32 v141, v120, v121
  v_cvt_pk_bf16_f32 v142, v122, v123
  v_mov_b32 v139, s45
  v_mfma_f32_32x32x16_bf16 v[96:111], v[220:223], a[212:215], v[96:111]
  buffer_load_dwordx4 v[220:223], v1, s[8:11], s41 offen offset:1024 sc1
  v_mov_b32 v143, s45
  s_mul_i32 s42, s56, 49152
  s_add_u32 s42, s42, s39
  s_waitcnt vmcnt(36)
  v_mfma_f32_32x32x16_bf16 v[16:31], v[152:155], a[0:3], 0
  buffer_store_dwordx4 v[136:139], v13, s[8:11], s42 offen offset:0 sc1
  buffer_load_ushort a228, v2, s[16:19], s7 offen offset:0
  v_mfma_f32_32x32x16_bf16 v[32:47], v[152:155], a[4:7], 0
  v_mfma_f32_32x32x16_bf16 v[48:63], v[152:155], a[8:11], 0
  s_mul_i32 s41, s59, 368640
  s_add_u32 s41, s41, s37
  buffer_load_dwordx4 v[152:155], v1, s[8:11], s41 offen offset:0 sc1
  s_waitcnt vmcnt(38)
  v_mfma_f32_32x32x16_bf16 v[16:31], v[156:159], a[12:15], v[16:31]
  buffer_store_dwordx4 v[140:143], v13, s[8:11], s42 offen offset:1024 sc1
  buffer_load_ushort a229, v2, s[16:19], s7 offen offset:1152
  v_mfma_f32_32x32x16_bf16 v[32:47], v[156:159], a[16:19], v[32:47]
  v_mfma_f32_32x32x16_bf16 v[48:63], v[156:159], a[20:23], v[48:63]
  buffer_load_dwordx4 v[156:159], v1, s[8:11], s41 offen offset:1024 sc1
  buffer_load_ushort a230, v2, s[16:19], s7 offen offset:2304
  s_waitcnt vmcnt(41)
  v_mfma_f32_32x32x16_bf16 v[16:31], v[160:163], a[24:27], v[16:31]
  ds_write_b128 v6, v[68:71] offset:36864
  v_mfma_f32_32x32x16_bf16 v[32:47], v[160:163], a[28:31], v[32:47]
  buffer_load_ushort a231, v2, s[16:19], s7 offen offset:3456
  v_mfma_f32_32x32x16_bf16 v[48:63], v[160:163], a[32:35], v[48:63]
  buffer_load_dwordx4 v[160:163], v1, s[8:11], s41 offen offset:2048 sc1
  s_waitcnt vmcnt(39)
  v_mfma_f32_32x32x16_bf16 v[16:31], v[164:167], a[36:39], v[16:31]
  ds_write_b128 v6, v[84:87] offset:37888
  v_mfma_f32_32x32x16_bf16 v[32:47], v[164:167], a[40:43], v[32:47]
  buffer_load_ushort a232, v2, s[16:19], s7 offen offset:64
  v_mfma_f32_32x32x16_bf16 v[48:63], v[164:167], a[44:47], v[48:63]
  buffer_load_dwordx4 v[164:167], v1, s[8:11], s41 offen offset:3072 sc1
  s_waitcnt vmcnt(37)
  v_mfma_f32_32x32x16_bf16 v[16:31], v[168:171], a[48:51], v[16:31]
  ds_write_b128 v6, v[100:103] offset:38912
  v_mfma_f32_32x32x16_bf16 v[32:47], v[168:171], a[52:55], v[32:47]
  buffer_load_ushort a233, v2, s[16:19], s7 offen offset:1216
  v_mfma_f32_32x32x16_bf16 v[48:63], v[168:171], a[56:59], v[48:63]
  s_add_u32 s41, s41, 4096
  buffer_load_dwordx4 v[168:171], v1, s[8:11], s41 offen offset:0 sc1
  s_waitcnt vmcnt(36)
  v_mfma_f32_32x32x16_bf16 v[16:31], v[172:175], a[60:63], v[16:31]
  ds_write_b128 v6, v[72:75] offset:39936
  v_mfma_f32_32x32x16_bf16 v[32:47], v[172:175], a[64:67], v[32:47]
  buffer_load_ushort a234, v2, s[16:19], s7 offen offset:2368
  v_mfma_f32_32x32x16_bf16 v[48:63], v[172:175], a[68:71], v[48:63]
  buffer_load_dwordx4 v[172:175], v1, s[8:11], s41 offen offset:1024 sc1
  s_waitcnt vmcnt(36)
  v_mfma_f32_32x32x16_bf16 v[16:31], v[176:179], a[72:75], v[16:31]
  ds_write_b128 v6, v[88:91] offset:40960
  v_mfma_f32_32x32x16_bf16 v[32:47], v[176:179], a[76:79], v[32:47]
  buffer_load_ushort a235, v2, s[16:19], s7 offen offset:3520
  v_mfma_f32_32x32x16_bf16 v[48:63], v[176:179], a[80:83], v[48:63]
  buffer_load_dwordx4 v[176:179], v1, s[8:11], s41 offen offset:2048 sc1
  s_waitcnt vmcnt(35)
  v_mfma_f32_32x32x16_bf16 v[16:31], v[180:183], a[84:87], v[16:31]
  ds_write_b128 v6, v[104:107] offset:41984
  v_mfma_f32_32x32x16_bf16 v[32:47], v[180:183], a[88:91], v[32:47]
  buffer_load_ushort a236, v2, s[16:19], s7 offen offset:128
  v_mfma_f32_32x32x16_bf16 v[48:63], v[180:183], a[92:95], v[48:63]
  buffer_load_dwordx4 v[180:183], v1, s[8:11], s41 offen offset:3072 sc1
  s_waitcnt vmcnt(35)
  v_mfma_f32_32x32x16_bf16 v[16:31], v[184:187], a[96:99], v[16:31]
  ds_write_b128 v6, v[76:79] offset:43008
  v_mfma_f32_32x32x16_bf16 v[32:47], v[184:187], a[100:103], v[32:47]
  buffer_load_ushort a237, v2, s[16:19], s7 offen offset:1280
  v_mfma_f32_32x32x16_bf16 v[48:63], v[184:187], a[104:107], v[48:63]
  s_add_u32 s41, s41, 4096
  buffer_load_dwordx4 v[184:187], v1, s[8:11], s41 offen offset:0 sc1
  s_waitcnt vmcnt(35)
  v_mfma_f32_32x32x16_bf16 v[16:31], v[188:191], a[108:111], v[16:31]
  ds_write_b128 v6, v[92:95] offset:44032
  v_mfma_f32_32x32x16_bf16 v[32:47], v[188:191], a[112:115], v[32:47]
  buffer_load_ushort a238, v2, s[16:19], s7 offen offset:2432
  v_mfma_f32_32x32x16_bf16 v[48:63], v[188:191], a[116:119], v[48:63]
  buffer_load_dwordx4 v[188:191], v1, s[8:11], s41 offen offset:1024 sc1
  s_waitcnt vmcnt(35)
  v_mfma_f32_32x32x16_bf16 v[16:31], v[192:195], a[120:123], v[16:31]
  ds_write_b128 v6, v[108:111] offset:45056
  v_mfma_f32_32x32x16_bf16 v[32:47], v[192:195], a[124:127], v[32:47]
  buffer_load_ushort a239, v2, s[16:19], s7 offen offset:3584
  v_mfma_f32_32x32x16_bf16 v[48:63], v[192:195], a[128:131], v[48:63]
  buffer_load_dwordx4 v[192:195], v1, s[8:11], s41 offen offset:2048 sc1
  s_waitcnt lgkmcnt(0)
  s_barrier
  ds_read_b128 v[112:115], v10 offset:36864
  s_waitcnt vmcnt(35)
  v_mfma_f32_32x32x16_bf16 v[16:31], v[196:199], a[132:135], v[16:31]
  ds_read_b128 v[116:119], v10 offset:37888
  ds_read_b128 v[120:123], v10 offset:38912
  ds_read_b128 v[124:127], v11 offset:36864
  ds_read_b128 v[128:131], v11 offset:37888
  ds_read_b128 v[132:135], v11 offset:38912
  ds_read_b128 v[136:139], v12 offset:36864
  v_mfma_f32_32x32x16_bf16 v[32:47], v[196:199], a[136:139], v[32:47]
  ds_read_b128 v[140:143], v12 offset:37888
  ds_read_b128 v[144:147], v12 offset:38912
  v_mfma_f32_32x32x16_bf16 v[48:63], v[196:199], a[140:143], v[48:63]
  buffer_load_dwordx4 v[196:199], v1, s[8:11], s41 offen offset:3072 sc1
  s_waitcnt vmcnt(34)
  v_mfma_f32_32x32x16_bf16 v[16:31], v[200:203], a[144:147], v[16:31]
  v_mfma_f32_32x32x16_bf16 v[32:47], v[200:203], a[148:151], v[32:47]
  s_waitcnt vmcnt(30)
  v_lshlrev_b32 v248, 16, v248
  v_lshlrev_b32 v249, 16, v249
  v_lshlrev_b32 v250, 16, v250
  v_accvgpr_read_b32 v14, a216
  v_accvgpr_read_b32 v15, a217
  v_mfma_f32_32x32x16_bf16 v[48:63], v[200:203], a[152:155], v[48:63]
  s_add_u32 s41, s41, 4096
  buffer_load_dwordx4 v[200:203], v1, s[8:11], s41 offen offset:0 sc1
  s_waitcnt lgkmcnt(0)
  v_add_f32 v112, v112, v64
  v_add_f32 v124, v124, v136
  v_mfma_f32_32x32x16_bf16 v[16:31], v[204:207], a[156:159], v[16:31]
  v_add_f32 v113, v113, v65
  v_add_f32 v125, v125, v137
  v_add_f32 v114, v114, v66
  v_add_f32 v126, v126, v138
  v_add_f32 v115, v115, v67
  v_add_f32 v127, v127, v139
  v_mfma_f32_32x32x16_bf16 v[32:47], v[204:207], a[160:163], v[32:47]
  v_add_f32 v116, v116, v80
  v_add_f32 v128, v128, v140
  v_add_f32 v117, v117, v81
  v_add_f32 v129, v129, v141
  v_add_f32 v118, v118, v82
  v_add_f32 v130, v130, v142
  v_mfma_f32_32x32x16_bf16 v[48:63], v[204:207], a[164:167], v[48:63]
  buffer_load_dwordx4 v[204:207], v1, s[8:11], s41 offen offset:1024 sc1
  v_add_f32 v119, v119, v83
  v_add_f32 v131, v131, v143
  v_add_f32 v120, v120, v96
  s_waitcnt vmcnt(31)
  v_mfma_f32_32x32x16_bf16 v[16:31], v[208:211], a[168:171], v[16:31]
  v_add_f32 v132, v132, v144
  v_add_f32 v121, v121, v97
  v_add_f32 v133, v133, v145
  v_add_f32 v122, v122, v98
  v_add_f32 v134, v134, v146
  v_add_f32 v123, v123, v99
  v_mfma_f32_32x32x16_bf16 v[32:47], v[208:211], a[172:175], v[32:47]
  v_add_f32 v135, v135, v147
  v_add_f32 v112, v112, v124
  v_add_f32 v113, v113, v125
  v_add_f32 v114, v114, v126
  v_add_f32 v115, v115, v127
  v_add_f32 v116, v116, v128
  v_mfma_f32_32x32x16_bf16 v[48:63], v[208:211], a[176:179], v[48:63]
  buffer_load_dwordx4 v[208:211], v1, s[8:11], s41 offen offset:2048 sc1
  v_add_f32 v117, v117, v129
  v_add_f32 v118, v118, v130
  v_add_f32 v119, v119, v131
  s_waitcnt vmcnt(31)
  v_mfma_f32_32x32x16_bf16 v[16:31], v[212:215], a[180:183], v[16:31]
  v_add_f32 v120, v120, v132
  v_add_f32 v121, v121, v133
  v_add_f32 v122, v122, v134
  v_add_f32 v123, v123, v135
  v_cvt_pk_bf16_f32 v136, v112, v113
  v_cvt_pk_bf16_f32 v137, v114, v115
  v_mfma_f32_32x32x16_bf16 v[32:47], v[212:215], a[184:187], v[32:47]
  v_cvt_pk_bf16_f32 v138, v116, v117
  v_cvt_pk_bf16_f32 v140, v118, v119
  v_cvt_pk_bf16_f32 v141, v120, v121
  v_cvt_pk_bf16_f32 v142, v122, v123
  v_mov_b32 v139, s45
  v_mov_b32 v143, s45
  v_mfma_f32_32x32x16_bf16 v[48:63], v[212:215], a[188:191], v[48:63]
  buffer_load_dwordx4 v[212:215], v1, s[8:11], s41 offen offset:3072 sc1
  s_mul_i32 s42, s57, 49152
  s_add_u32 s42, s42, s39
  v_lshlrev_b32 v14, 16, v14
  s_waitcnt vmcnt(31)
  v_mfma_f32_32x32x16_bf16 v[16:31], v[216:219], a[192:195], v[16:31]
  buffer_store_dwordx4 v[136:139], v13, s[8:11], s42 offen offset:0 sc1
  v_lshlrev_b32 v15, 16, v15
  v_sub_f32 v251, v14, v232
  v_sub_f32 v252, v15, v234
  v_mfma_f32_32x32x16_bf16 v[32:47], v[216:219], a[196:199], v[32:47]
  v_mul_f32 v251, v251, v233
  v_mul_f32 v252, v252, v235
  v_mul_f32 v251, v251, v248
  v_mul_f32 v252, v252, v248
  v_cvt_pk_bf16_f32 v251, v14, v251
  v_cvt_pk_bf16_f32 v252, v15, v252
  v_mfma_f32_32x32x16_bf16 v[48:63], v[216:219], a[200:203], v[48:63]
  s_add_u32 s41, s41, 4096
  buffer_load_dwordx4 v[216:219], v1, s[8:11], s41 offen offset:0 sc1
  v_accvgpr_write_b32 a216, v251
  v_accvgpr_write_b32 a217, v252
  s_waitcnt vmcnt(32)
  v_mfma_f32_32x32x16_bf16 v[16:31], v[220:223], a[204:207], v[16:31]
  buffer_store_dwordx4 v[140:143], v13, s[8:11], s42 offen offset:1024 sc1
  v_accvgpr_read_b32 v14, a218
  v_accvgpr_read_b32 v15, a219
  v_lshlrev_b32 v14, 16, v14
  v_mfma_f32_32x32x16_bf16 v[32:47], v[220:223], a[208:211], v[32:47]
  v_lshlrev_b32 v15, 16, v15
  v_sub_f32 v251, v14, v236
  v_sub_f32 v252, v15, v238
  v_mul_f32 v251, v251, v237
  v_mul_f32 v252, v252, v239
  v_mul_f32 v251, v251, v248
  v_mfma_f32_32x32x16_bf16 v[48:63], v[220:223], a[212:215], v[48:63]
  buffer_load_dwordx4 v[220:223], v1, s[8:11], s41 offen offset:1024 sc1
  v_mul_f32 v252, v252, v248
  v_cvt_pk_bf16_f32 v251, v14, v251
  v_cvt_pk_bf16_f32 v252, v15, v252
  s_waitcnt vmcnt(31)
  v_mfma_f32_32x32x16_bf16 v[64:79], v[152:155], a[0:3], 0
  v_accvgpr_write_b32 a218, v251
  v_accvgpr_write_b32 a219, v252
  v_accvgpr_read_b32 v14, a220
  v_accvgpr_read_b32 v15, a221
  v_lshlrev_b32 v14, 16, v14
  v_lshlrev_b32 v15, 16, v15
  v_mfma_f32_32x32x16_bf16 v[80:95], v[152:155], a[4:7], 0
  ds_write_b128 v6, v[20:23] offset:0
  v_sub_f32 v251, v14, v232
  v_mfma_f32_32x32x16_bf16 v[96:111], v[152:155], a[8:11], 0
  s_mul_i32 s41, s60, 368640
  s_add_u32 s41, s41, s37
  buffer_load_dwordx4 v[152:155], v1, s[8:11], s41 offen offset:0 sc1
  v_sub_f32 v252, v15, v234
  s_waitcnt vmcnt(29)
  v_mfma_f32_32x32x16_bf16 v[64:79], v[156:159], a[12:15], v[64:79]
  ds_write_b128 v6, v[36:39] offset:1024
  v_mul_f32 v251, v251, v233
  v_mfma_f32_32x32x16_bf16 v[80:95], v[156:159], a[16:19], v[80:95]
  v_mul_f32 v252, v252, v235
  v_mul_f32 v251, v251, v249
  v_mul_f32 v252, v252, v249
  v_cvt_pk_bf16_f32 v251, v14, v251
  v_cvt_pk_bf16_f32 v252, v15, v252
  v_accvgpr_write_b32 a220, v251
  v_mfma_f32_32x32x16_bf16 v[96:111], v[156:159], a[20:23], v[96:111]
  buffer_load_dwordx4 v[156:159], v1, s[8:11], s41 offen offset:1024 sc1
  buffer_load_dwordx4 v[224:227], v13, s[8:11], s34 offen offset:0 sc1
  v_accvgpr_write_b32 a221, v252
  s_waitcnt vmcnt(28)
  v_mfma_f32_32x32x16_bf16 v[64:79], v[160:163], a[24:27], v[64:79]
  buffer_load_dwordx4 v[228:231], v13, s[8:11], s34 offen offset:1024 sc1
  v_accvgpr_read_b32 v14, a222
  v_accvgpr_read_b32 v15, a223
  v_lshlrev_b32 v14, 16, v14
  v_lshlrev_b32 v15, 16, v15
  v_mfma_f32_32x32x16_bf16 v[80:95], v[160:163], a[28:31], v[80:95]
  ds_write_b128 v6, v[52:55] offset:2048
  v_sub_f32 v251, v14, v236
  v_mfma_f32_32x32x16_bf16 v[96:111], v[160:163], a[32:35], v[96:111]
  buffer_load_dwordx4 v[160:163], v1, s[8:11], s41 offen offset:2048 sc1
  v_sub_f32 v252, v15, v238
  v_mul_f32 v251, v251, v237
  v_mul_f32 v252, v252, v239
  s_waitcnt vmcnt(28)
  v_mfma_f32_32x32x16_bf16 v[64:79], v[164:167], a[36:39], v[64:79]
  ds_write_b128 v6, v[24:27] offset:3072
  v_mul_f32 v251, v251, v249
  v_mfma_f32_32x32x16_bf16 v[80:95], v[164:167], a[40:43], v[80:95]
  v_mul_f32 v252, v252, v249
  v_cvt_pk_bf16_f32 v251, v14, v251
  v_cvt_pk_bf16_f32 v252, v15, v252
  v_accvgpr_write_b32 a222, v251
  v_accvgpr_write_b32 a223, v252
  v_accvgpr_read_b32 v14, a224
  v_mfma_f32_32x32x16_bf16 v[96:111], v[164:167], a[44:47], v[96:111]
  buffer_load_dwordx4 v[164:167], v1, s[8:11], s41 offen offset:3072 sc1
  v_accvgpr_read_b32 v15, a225
  v_lshlrev_b32 v14, 16, v14
  v_lshlrev_b32 v15, 16, v15
  s_waitcnt vmcnt(27)
  v_mfma_f32_32x32x16_bf16 v[64:79], v[168:171], a[48:51], v[64:79]
  ds_write_b128 v6, v[40:43] offset:4096
  v_sub_f32 v251, v14, v232
  v_mfma_f32_32x32x16_bf16 v[80:95], v[168:171], a[52:55], v[80:95]
  v_sub_f32 v252, v15, v234
  v_mul_f32 v251, v251, v233
  v_mul_f32 v252, v252, v235
  v_mul_f32 v251, v251, v250
  v_mul_f32 v252, v252, v250
  v_cvt_pk_bf16_f32 v251, v14, v251
  v_mfma_f32_32x32x16_bf16 v[96:111], v[168:171], a[56:59], v[96:111]
  s_add_u32 s41, s41, 4096
  buffer_load_dwordx4 v[168:171], v1, s[8:11], s41 offen offset:0 sc1
  v_cvt_pk_bf16_f32 v252, v15, v252
  v_accvgpr_write_b32 a224, v251
  s_waitcnt vmcnt(26)
  v_mfma_f32_32x32x16_bf16 v[64:79], v[172:175], a[60:63], v[64:79]
  ds_write_b128 v6, v[56:59] offset:5120
  v_accvgpr_write_b32 a225, v252
  v_mfma_f32_32x32x16_bf16 v[80:95], v[172:175], a[64:67], v[80:95]
  v_accvgpr_read_b32 v14, a226
  v_accvgpr_read_b32 v15, a227
  v_lshlrev_b32 v14, 16, v14
  v_lshlrev_b32 v15, 16, v15
  v_sub_f32 v251, v14, v236
  v_sub_f32 v252, v15, v238
  v_mfma_f32_32x32x16_bf16 v[96:111], v[172:175], a[68:71], v[96:111]
  buffer_load_dwordx4 v[172:175], v1, s[8:11], s41 offen offset:1024 sc1
  v_mul_f32 v251, v251, v237
  v_mul_f32 v252, v252, v239
  v_mul_f32 v251, v251, v250
  s_waitcnt vmcnt(25)
  v_mfma_f32_32x32x16_bf16 v[64:79], v[176:179], a[72:75], v[64:79]
  ds_write_b128 v6, v[28:31] offset:6144
  v_mul_f32 v252, v252, v250
  v_mfma_f32_32x32x16_bf16 v[80:95], v[176:179], a[76:79], v[80:95]
  v_cvt_pk_bf16_f32 v251, v14, v251
  v_cvt_pk_bf16_f32 v252, v15, v252
  v_accvgpr_write_b32 a226, v251
  v_accvgpr_write_b32 a227, v252
  s_waitcnt vmcnt(18)
  v_accvgpr_read_b32 v14, a228
  v_mfma_f32_32x32x16_bf16 v[96:111], v[176:179], a[80:83], v[96:111]
  buffer_load_dwordx4 v[176:179], v1, s[8:11], s41 offen offset:2048 sc1
  v_accvgpr_read_b32 v15, a229
  v_lshlrev_b32 v14, 16, v14
  v_lshlrev_b32 v15, 16, v15
  v_sub_f32 v251, v14, v240
  v_mfma_f32_32x32x16_bf16 v[64:79], v[180:183], a[84:87], v[64:79]
  ds_write_b128 v6, v[44:47] offset:7168
  v_sub_f32 v252, v15, v242
  v_mfma_f32_32x32x16_bf16 v[80:95], v[180:183], a[88:91], v[80:95]
  v_mul_f32 v251, v251, v241
  v_mul_f32 v252, v252, v243
  v_mul_f32 v251, v251, v248
  v_mul_f32 v252, v252, v248
  v_cvt_pk_bf16_f32 v251, v14, v251
  v_cvt_pk_bf16_f32 v252, v15, v252
  v_mfma_f32_32x32x16_bf16 v[96:111], v[180:183], a[92:95], v[96:111]
  buffer_load_dwordx4 v[180:183], v1, s[8:11], s41 offen offset:3072 sc1
  v_accvgpr_write_b32 a228, v251
  v_accvgpr_write_b32 a229, v252
  v_accvgpr_read_b32 v14, a230
  v_accvgpr_read_b32 v15, a231
  v_mfma_f32_32x32x16_bf16 v[64:79], v[184:187], a[96:99], v[64:79]
  ds_write_b128 v6, v[60:63] offset:8192
  v_lshlrev_b32 v14, 16, v14
  v_mfma_f32_32x32x16_bf16 v[80:95], v[184:187], a[100:103], v[80:95]
  v_lshlrev_b32 v15, 16, v15
  v_sub_f32 v251, v14, v244
  v_sub_f32 v252, v15, v246
  v_mul_f32 v251, v251, v245
  v_mul_f32 v252, v252, v247
  v_mul_f32 v251, v251, v248
  v_mfma_f32_32x32x16_bf16 v[96:111], v[184:187], a[104:107], v[96:111]
  s_add_u32 s41, s41, 4096
  buffer_load_dwordx4 v[184:187], v1, s[8:11], s41 offen offset:0 sc1
  s_waitcnt lgkmcnt(0)
  s_barrier
  ds_read_b128 v[112:115], v10 offset:0
  v_mfma_f32_32x32x16_bf16 v[64:79], v[188:191], a[108:111], v[64:79]
  ds_read_b128 v[116:119], v10 offset:1024
  ds_read_b128 v[120:123], v10 offset:2048
  ds_read_b128 v[124:127], v11 offset:0
  ds_read_b128 v[128:131], v11 offset:1024
  ds_read_b128 v[132:135], v11 offset:2048
  ds_read_b128 v[136:139], v12 offset:0
  v_mfma_f32_32x32x16_bf16 v[80:95], v[188:191], a[112:115], v[80:95]
  ds_read_b128 v[140:143], v12 offset:1024
  ds_read_b128 v[144:147], v12 offset:2048
  v_mul_f32 v252, v252, v248
  v_cvt_pk_bf16_f32 v251, v14, v251
  v_cvt_pk_bf16_f32 v252, v15, v252
  v_accvgpr_write_b32 a230, v251
  v_mfma_f32_32x32x16_bf16 v[96:111], v[188:191], a[116:119], v[96:111]
  buffer_load_dwordx4 v[188:191], v1, s[8:11], s41 offen offset:1024 sc1
  v_accvgpr_write_b32 a231, v252
  v_accvgpr_read_b32 v14, a232
  v_accvgpr_read_b32 v15, a233
  s_waitcnt vmcnt(21)
  v_mfma_f32_32x32x16_bf16 v[64:79], v[192:195], a[120:123], v[64:79]
  v_lshlrev_b32 v14, 16, v14
  v_lshlrev_b32 v15, 16, v15
  v_sub_f32 v251, v14, v240
  v_sub_f32 v252, v15, v242
  v_mul_f32 v251, v251, v241
  v_mul_f32 v252, v252, v243
  v_mfma_f32_32x32x16_bf16 v[80:95], v[192:195], a[124:127], v[80:95]
  v_mul_f32 v251, v251, v249
  v_mul_f32 v252, v252, v249
  v_cvt_pk_bf16_f32 v251, v14, v251
  v_cvt_pk_bf16_f32 v252, v15, v252
  v_accvgpr_write_b32 a232, v251
  v_accvgpr_write_b32 a233, v252
  v_mfma_f32_32x32x16_bf16 v[96:111], v[192:195], a[128:131], v[96:111]
  buffer_load_dwordx4 v[192:195], v1, s[8:11], s41 offen offset:2048 sc1
  s_waitcnt lgkmcnt(0)
  v_add_f32 v112, v112, v16
  v_add_f32 v124, v124, v136
  s_waitcnt vmcnt(21)
  v_mfma_f32_32x32x16_bf16 v[64:79], v[196:199], a[132:135], v[64:79]
  v_add_f32 v113, v113, v17
  v_add_f32 v125, v125, v137
  v_add_f32 v114, v114, v18
  v_add_f32 v126, v126, v138
  v_add_f32 v115, v115, v19
  v_add_f32 v127, v127, v139
  v_mfma_f32_32x32x16_bf16 v[80:95], v[196:199], a[136:139], v[80:95]
  v_add_f32 v116, v116, v32
  v_add_f32 v128, v128, v140
  v_add_f32 v117, v117, v33
  v_add_f32 v129, v129, v141
  v_add_f32 v118, v118, v34
  v_add_f32 v130, v130, v142
  v_mfma_f32_32x32x16_bf16 v[96:111], v[196:199], a[140:143], v[96:111]
  buffer_load_dwordx4 v[196:199], v1, s[8:11], s41 offen offset:3072 sc1
  v_add_f32 v119, v119, v35
  v_add_f32 v131, v131, v143
  v_add_f32 v120, v120, v48
  s_waitcnt vmcnt(21)
  v_mfma_f32_32x32x16_bf16 v[64:79], v[200:203], a[144:147], v[64:79]
  v_add_f32 v132, v132, v144
  v_add_f32 v121, v121, v49
  v_add_f32 v133, v133, v145
  v_add_f32 v122, v122, v50
  v_add_f32 v134, v134, v146
  v_add_f32 v123, v123, v51
  v_mfma_f32_32x32x16_bf16 v[80:95], v[200:203], a[148:151], v[80:95]
  v_add_f32 v135, v135, v147
  v_add_f32 v112, v112, v124
  v_add_f32 v113, v113, v125
  v_add_f32 v114, v114, v126
  v_add_f32 v115, v115, v127
  v_add_f32 v116, v116, v128
  v_mfma_f32_32x32x16_bf16 v[96:111], v[200:203], a[152:155], v[96:111]
  s_add_u32 s41, s41, 4096
  buffer_load_dwordx4 v[200:203], v1, s[8:11], s41 offen offset:0 sc1
  v_add_f32 v117, v117, v129
  v_add_f32 v118, v118, v130
  s_waitcnt vmcnt(21)
  v_mfma_f32_32x32x16_bf16 v[64:79], v[204:207], a[156:159], v[64:79]
  v_add_f32 v119, v119, v131
  v_add_f32 v120, v120, v132
  v_add_f32 v121, v121, v133
  v_add_f32 v122, v122, v134
  v_add_f32 v123, v123, v135
  v_cvt_pk_bf16_f32 v136, v112, v113
  v_mfma_f32_32x32x16_bf16 v[80:95], v[204:207], a[160:163], v[80:95]
  v_cvt_pk_bf16_f32 v137, v114, v115
  v_cvt_pk_bf16_f32 v138, v116, v117
  v_cvt_pk_bf16_f32 v140, v118, v119
  v_cvt_pk_bf16_f32 v141, v120, v121
  v_cvt_pk_bf16_f32 v142, v122, v123
  v_mov_b32 v139, s45
  v_mfma_f32_32x32x16_bf16 v[96:111], v[204:207], a[164:167], v[96:111]
  buffer_load_dwordx4 v[204:207], v1, s[8:11], s41 offen offset:1024 sc1
  v_mov_b32 v143, s45
  s_mul_i32 s42, s58, 49152
  s_add_u32 s42, s42, s39
  s_waitcnt vmcnt(21)
  v_mfma_f32_32x32x16_bf16 v[64:79], v[208:211], a[168:171], v[64:79]
  buffer_store_dwordx4 v[136:139], v13, s[8:11], s42 offen offset:0 sc1
  v_accvgpr_read_b32 v14, a234
  v_accvgpr_read_b32 v15, a235
  v_lshlrev_b32 v14, 16, v14
  v_mfma_f32_32x32x16_bf16 v[80:95], v[208:211], a[172:175], v[80:95]
  v_lshlrev_b32 v15, 16, v15
  v_sub_f32 v251, v14, v244
  v_sub_f32 v252, v15, v246
  v_mul_f32 v251, v251, v245
  v_mul_f32 v252, v252, v247
  v_mul_f32 v251, v251, v249
  v_mfma_f32_32x32x16_bf16 v[96:111], v[208:211], a[176:179], v[96:111]
  buffer_load_dwordx4 v[208:211], v1, s[8:11], s41 offen offset:2048 sc1
  buffer_store_dwordx4 v[140:143], v13, s[8:11], s42 offen offset:1024 sc1
  s_waitcnt vmcnt(23)
  v_mfma_f32_32x32x16_bf16 v[64:79], v[212:215], a[180:183], v[64:79]
  v_mul_f32 v252, v252, v249
  v_cvt_pk_bf16_f32 v251, v14, v251
  v_cvt_pk_bf16_f32 v252, v15, v252
  v_accvgpr_write_b32 a234, v251
  v_accvgpr_write_b32 a235, v252
  v_accvgpr_read_b32 v14, a236
  v_mfma_f32_32x32x16_bf16 v[80:95], v[212:215], a[184:187], v[80:95]
  v_accvgpr_read_b32 v15, a237
  v_lshlrev_b32 v14, 16, v14
  v_lshlrev_b32 v15, 16, v15
  v_sub_f32 v251, v14, v240
  v_sub_f32 v252, v15, v242
  v_mul_f32 v251, v251, v241
  v_mfma_f32_32x32x16_bf16 v[96:111], v[212:215], a[188:191], v[96:111]
  buffer_load_dwordx4 v[212:215], v1, s[8:11], s41 offen offset:3072 sc1
  v_mul_f32 v252, v252, v243
  v_mul_f32 v251, v251, v250
  v_mul_f32 v252, v252, v250
  s_waitcnt vmcnt(22)
  v_mfma_f32_32x32x16_bf16 v[64:79], v[216:219], a[192:195], v[64:79]
  v_cvt_pk_bf16_f32 v251, v14, v251
  v_cvt_pk_bf16_f32 v252, v15, v252
  v_accvgpr_write_b32 a236, v251
  v_accvgpr_write_b32 a237, v252
  v_accvgpr_read_b32 v14, a238
  v_accvgpr_read_b32 v15, a239
  v_mfma_f32_32x32x16_bf16 v[80:95], v[216:219], a[196:199], v[80:95]
  v_lshlrev_b32 v14, 16, v14
  v_lshlrev_b32 v15, 16, v15
  v_sub_f32 v251, v14, v244
  v_sub_f32 v252, v15, v246
  v_mul_f32 v251, v251, v245
  v_mul_f32 v252, v252, v247
  v_mfma_f32_32x32x16_bf16 v[96:111], v[216:219], a[200:203], v[96:111]
  s_add_u32 s41, s41, 4096
  buffer_load_dwordx4 v[216:219], v1, s[8:11], s41 offen offset:0 sc1
  v_mul_f32 v251, v251, v250
  v_mul_f32 v252, v252, v250
  s_waitcnt vmcnt(21)
  v_mfma_f32_32x32x16_bf16 v[64:79], v[220:223], a[204:207], v[64:79]
  v_cvt_pk_bf16_f32 v251, v14, v251
  v_cvt_pk_bf16_f32 v252, v15, v252
  v_accvgpr_write_b32 a238, v251
  v_accvgpr_write_b32 a239, v252
  v_mfma_f32_32x32x16_bf16 v[80:95], v[220:223], a[208:211], v[80:95]
  v_mfma_f32_32x32x16_bf16 v[96:111], v[220:223], a[212:215], v[96:111]
  buffer_load_dwordx4 v[220:223], v1, s[8:11], s41 offen offset:1024 sc1
  s_waitcnt vmcnt(21)
  v_mfma_f32_32x32x16_bf16 v[16:31], v[152:155], a[0:3], 0
  v_mfma_f32_32x32x16_bf16 v[32:47], v[152:155], a[4:7], 0
  s_nop 1
  ds_write_b128 v6, v[68:71] offset:36864
  v_mfma_f32_32x32x16_bf16 v[48:63], v[152:155], a[8:11], 0
  s_mul_i32 s41, s61, 368640
  s_add_u32 s41, s41, s37
  buffer_load_dwordx4 v[152:155], v1, s[8:11], s41 offen offset:0 sc1
  s_waitcnt vmcnt(21)
  v_mfma_f32_32x32x16_bf16 v[16:31], v[156:159], a[12:15], v[16:31]
  ds_write_b128 v6, v[84:87] offset:37888
  v_mfma_f32_32x32x16_bf16 v[32:47], v[156:159], a[16:19], v[32:47]
  v_mfma_f32_32x32x16_bf16 v[48:63], v[156:159], a[20:23], v[48:63]
  buffer_load_dwordx4 v[156:159], v1, s[8:11], s41 offen offset:1024 sc1
  buffer_load_dwordx4 v[232:235], v13, s[8:11], s35 offen offset:0 sc1
  s_waitcnt vmcnt(20)
  v_mfma_f32_32x32x16_bf16 v[16:31], v[160:163], a[24:27], v[16:31]
  ds_write_b128 v6, v[100:103] offset:38912
  v_mfma_f32_32x32x16_bf16 v[32:47], v[160:163], a[28:31], v[32:47]
  buffer_load_dwordx4 v[236:239], v13, s[8:11], s35 offen offset:1024 sc1
  v_mfma_f32_32x32x16_bf16 v[48:63], v[160:163], a[32:35], v[48:63]
  buffer_load_dwordx4 v[160:163], v1, s[8:11], s41 offen offset:2048 sc1
  s_waitcnt vmcnt(21)
  v_mfma_f32_32x32x16_bf16 v[16:31], v[164:167], a[36:39], v[16:31]
  ds_write_b128 v6, v[72:75] offset:39936
  v_mfma_f32_32x32x16_bf16 v[32:47], v[164:167], a[40:43], v[32:47]
  v_mfma_f32_32x32x16_bf16 v[48:63], v[164:167], a[44:47], v[48:63]
  buffer_load_dwordx4 v[164:167], v1, s[8:11], s41 offen offset:3072 sc1
  s_waitcnt vmcnt(21)
  v_mfma_f32_32x32x16_bf16 v[16:31], v[168:171], a[48:51], v[16:31]
  ds_write_b128 v6, v[88:91] offset:40960
  v_mfma_f32_32x32x16_bf16 v[32:47], v[168:171], a[52:55], v[32:47]
  v_mfma_f32_32x32x16_bf16 v[48:63], v[168:171], a[56:59], v[48:63]
  s_add_u32 s41, s41, 4096
  buffer_load_dwordx4 v[168:171], v1, s[8:11], s41 offen offset:0 sc1
  s_waitcnt vmcnt(21)
  v_mfma_f32_32x32x16_bf16 v[16:31], v[172:175], a[60:63], v[16:31]
  ds_write_b128 v6, v[104:107] offset:41984
  v_mfma_f32_32x32x16_bf16 v[32:47], v[172:175], a[64:67], v[32:47]
  v_mfma_f32_32x32x16_bf16 v[48:63], v[172:175], a[68:71], v[48:63]
  buffer_load_dwordx4 v[172:175], v1, s[8:11], s41 offen offset:1024 sc1
  s_waitcnt vmcnt(21)
  v_mfma_f32_32x32x16_bf16 v[16:31], v[176:179], a[72:75], v[16:31]
  ds_write_b128 v6, v[76:79] offset:43008
  v_mfma_f32_32x32x16_bf16 v[32:47], v[176:179], a[76:79], v[32:47]
  v_mfma_f32_32x32x16_bf16 v[48:63], v[176:179], a[80:83], v[48:63]
  buffer_load_dwordx4 v[176:179], v1, s[8:11], s41 offen offset:2048 sc1
  s_waitcnt vmcnt(21)
  v_mfma_f32_32x32x16_bf16 v[16:31], v[180:183], a[84:87], v[16:31]
  ds_write_b128 v6, v[92:95] offset:44032
  v_mfma_f32_32x32x16_bf16 v[32:47], v[180:183], a[88:91], v[32:47]
  v_mfma_f32_32x32x16_bf16 v[48:63], v[180:183], a[92:95], v[48:63]
  buffer_load_dwordx4 v[180:183], v1, s[8:11], s41 offen offset:3072 sc1
  s_waitcnt vmcnt(21)
  v_mfma_f32_32x32x16_bf16 v[16:31], v[184:187], a[96:99], v[16:31]
  ds_write_b128 v6, v[108:111] offset:45056
  v_mfma_f32_32x32x16_bf16 v[32:47], v[184:187], a[100:103], v[32:47]
  v_mfma_f32_32x32x16_bf16 v[48:63], v[184:187], a[104:107], v[48:63]
  s_add_u32 s41, s41, 4096
  buffer_load_dwordx4 v[184:187], v1, s[8:11], s41 offen offset:0 sc1
  s_waitcnt lgkmcnt(0)
  s_barrier
  s_waitcnt vmcnt(21)
  v_mfma_f32_32x32x16_bf16 v[16:31], v[188:191], a[108:111], v[16:31]
  ds_read_b128 v[112:115], v10 offset:36864
  ds_read_b128 v[116:119], v10 offset:37888
  ds_read_b128 v[120:123], v10 offset:38912
  ds_read_b128 v[124:127], v11 offset:36864
  ds_read_b128 v[128:131], v11 offset:37888
  ds_read_b128 v[132:135], v11 offset:38912
  v_mfma_f32_32x32x16_bf16 v[32:47], v[188:191], a[112:115], v[32:47]
  ds_read_b128 v[136:139], v12 offset:36864
  ds_read_b128 v[140:143], v12 offset:37888
  ds_read_b128 v[144:147], v12 offset:38912
  v_mfma_f32_32x32x16_bf16 v[48:63], v[188:191], a[116:119], v[48:63]
  buffer_load_dwordx4 v[188:191], v1, s[8:11], s41 offen offset:1024 sc1
  s_waitcnt vmcnt(21)
  v_mfma_f32_32x32x16_bf16 v[16:31], v[192:195], a[120:123], v[16:31]
  v_mfma_f32_32x32x16_bf16 v[32:47], v[192:195], a[124:127], v[32:47]
  v_mfma_f32_32x32x16_bf16 v[48:63], v[192:195], a[128:131], v[48:63]
  buffer_load_dwordx4 v[192:195], v1, s[8:11], s41 offen offset:2048 sc1
  s_waitcnt lgkmcnt(0)
  v_add_f32 v112, v112, v64
  v_add_f32 v124, v124, v136
  s_waitcnt vmcnt(21)
  v_mfma_f32_32x32x16_bf16 v[16:31], v[196:199], a[132:135], v[16:31]
  v_add_f32 v113, v113, v65
  v_add_f32 v125, v125, v137
  v_add_f32 v114, v114, v66
  v_add_f32 v126, v126, v138
  v_add_f32 v115, v115, v67
  v_add_f32 v127, v127, v139
  v_mfma_f32_32x32x16_bf16 v[32:47], v[196:199], a[136:139], v[32:47]
  v_add_f32 v116, v116, v80
  v_add_f32 v128, v128, v140
  v_add_f32 v117, v117, v81
  v_add_f32 v129, v129, v141
  v_add_f32 v118, v118, v82
  v_add_f32 v130, v130, v142
  v_mfma_f32_32x32x16_bf16 v[48:63], v[196:199], a[140:143], v[48:63]
  buffer_load_dwordx4 v[196:199], v1, s[8:11], s41 offen offset:3072 sc1
  v_add_f32 v119, v119, v83
  v_add_f32 v131, v131, v143
  v_add_f32 v120, v120, v96
  s_waitcnt vmcnt(21)
  v_mfma_f32_32x32x16_bf16 v[16:31], v[200:203], a[144:147], v[16:31]
  v_add_f32 v132, v132, v144
  v_add_f32 v121, v121, v97
  v_add_f32 v133, v133, v145
  v_add_f32 v122, v122, v98
  v_add_f32 v134, v134, v146
  v_add_f32 v123, v123, v99
  v_mfma_f32_32x32x16_bf16 v[32:47], v[200:203], a[148:151], v[32:47]
  v_add_f32 v135, v135, v147
  v_add_f32 v112, v112, v124
  v_add_f32 v113, v113, v125
  v_add_f32 v114, v114, v126
  v_add_f32 v115, v115, v127
  v_add_f32 v116, v116, v128
  v_mfma_f32_32x32x16_bf16 v[48:63], v[200:203], a[152:155], v[48:63]
  s_add_u32 s41, s41, 4096
  buffer_load_dwordx4 v[200:203], v1, s[8:11], s41 offen offset:0 sc1
  v_add_f32 v117, v117, v129
  v_add_f32 v118, v118, v130
  s_waitcnt vmcnt(21)
  v_mfma_f32_32x32x16_bf16 v[16:31], v[204:207], a[156:159], v[16:31]
  v_add_f32 v119, v119, v131
  v_add_f32 v120, v120, v132
  v_add_f32 v121, v121, v133
  v_add_f32 v122, v122, v134
  v_add_f32 v123, v123, v135
  v_cvt_pk_bf16_f32 v136, v112, v113
  v_mfma_f32_32x32x16_bf16 v[32:47], v[204:207], a[160:163], v[32:47]
  v_cvt_pk_bf16_f32 v137, v114, v115
  v_cvt_pk_bf16_f32 v138, v116, v117
  v_cvt_pk_bf16_f32 v140, v118, v119
  v_cvt_pk_bf16_f32 v141, v120, v121
  v_cvt_pk_bf16_f32 v142, v122, v123
  v_mov_b32 v139, s45
  v_mfma_f32_32x32x16_bf16 v[48:63], v[204:207], a[164:167], v[48:63]
  buffer_load_dwordx4 v[204:207], v1, s[8:11], s41 offen offset:1024 sc1
  v_mov_b32 v143, s45
  s_mul_i32 s42, s59, 49152
  s_add_u32 s42, s42, s39
  s_waitcnt vmcnt(20)
  v_mfma_f32_32x32x16_bf16 v[16:31], v[208:211], a[168:171], v[16:31]
  buffer_store_dwordx4 v[136:139], v13, s[8:11], s42 offen offset:0 sc1
  v_mfma_f32_32x32x16_bf16 v[32:47], v[208:211], a[172:175], v[32:47]
  v_mfma_f32_32x32x16_bf16 v[48:63], v[208:211], a[176:179], v[48:63]
  buffer_load_dwordx4 v[208:211], v1, s[8:11], s41 offen offset:2048 sc1
  buffer_store_dwordx4 v[140:143], v13, s[8:11], s42 offen offset:1024 sc1
  s_waitcnt vmcnt(21)
  v_mfma_f32_32x32x16_bf16 v[16:31], v[212:215], a[180:183], v[16:31]
  v_mfma_f32_32x32x16_bf16 v[32:47], v[212:215], a[184:187], v[32:47]
  v_mfma_f32_32x32x16_bf16 v[48:63], v[212:215], a[188:191], v[48:63]
  buffer_load_dwordx4 v[212:215], v1, s[8:11], s41 offen offset:3072 sc1
  s_waitcnt vmcnt(21)
  v_mfma_f32_32x32x16_bf16 v[16:31], v[216:219], a[192:195], v[16:31]
  v_mfma_f32_32x32x16_bf16 v[32:47], v[216:219], a[196:199], v[32:47]
  v_mfma_f32_32x32x16_bf16 v[48:63], v[216:219], a[200:203], v[48:63]
  s_add_u32 s41, s41, 4096
  buffer_load_dwordx4 v[216:219], v1, s[8:11], s41 offen offset:0 sc1
  s_waitcnt vmcnt(21)
  v_mfma_f32_32x32x16_bf16 v[16:31], v[220:223], a[204:207], v[16:31]
  buffer_load_dwordx4 v[240:243], v13, s[8:11], s36 offen offset:0 sc1
  buffer_load_dwordx4 v[244:247], v13, s[8:11], s36 offen offset:1024 sc1
  v_mfma_f32_32x32x16_bf16 v[32:47], v[220:223], a[208:211], v[32:47]
  v_mfma_f32_32x32x16_bf16 v[48:63], v[220:223], a[212:215], v[48:63]
  buffer_load_dwordx4 v[220:223], v1, s[8:11], s41 offen offset:1024 sc1
  s_waitcnt vmcnt(23)
  v_mfma_f32_32x32x16_bf16 v[64:79], v[152:155], a[0:3], 0
  v_mfma_f32_32x32x16_bf16 v[80:95], v[152:155], a[4:7], 0
  s_nop 3
  ds_write_b128 v6, v[20:23] offset:0
  v_mfma_f32_32x32x16_bf16 v[96:111], v[152:155], a[8:11], 0
  s_mul_i32 s41, s62, 368640
  s_add_u32 s41, s41, s37
  buffer_load_dwordx4 v[152:155], v1, s[8:11], s41 offen offset:0 sc1
  s_waitcnt vmcnt(23)
  v_mfma_f32_32x32x16_bf16 v[64:79], v[156:159], a[12:15], v[64:79]
  ds_write_b128 v6, v[36:39] offset:1024
  v_mfma_f32_32x32x16_bf16 v[80:95], v[156:159], a[16:19], v[80:95]
  v_mfma_f32_32x32x16_bf16 v[96:111], v[156:159], a[20:23], v[96:111]
  buffer_load_dwordx4 v[156:159], v1, s[8:11], s41 offen offset:1024 sc1
  s_waitcnt vmcnt(21)
  v_mfma_f32_32x32x16_bf16 v[64:79], v[160:163], a[24:27], v[64:79]
  ds_write_b128 v6, v[52:55] offset:2048
  v_mfma_f32_32x32x16_bf16 v[80:95], v[160:163], a[28:31], v[80:95]
  v_mfma_f32_32x32x16_bf16 v[96:111], v[160:163], a[32:35], v[96:111]
  buffer_load_dwordx4 v[160:163], v1, s[8:11], s41 offen offset:2048 sc1
  s_waitcnt vmcnt(21)
  v_mfma_f32_32x32x16_bf16 v[64:79], v[164:167], a[36:39], v[64:79]
  ds_write_b128 v6, v[24:27] offset:3072
  v_mfma_f32_32x32x16_bf16 v[80:95], v[164:167], a[40:43], v[80:95]
  v_mfma_f32_32x32x16_bf16 v[96:111], v[164:167], a[44:47], v[96:111]
  buffer_load_dwordx4 v[164:167], v1, s[8:11], s41 offen offset:3072 sc1
  s_waitcnt vmcnt(21)
  v_mfma_f32_32x32x16_bf16 v[64:79], v[168:171], a[48:51], v[64:79]
  ds_write_b128 v6, v[40:43] offset:4096
  v_mfma_f32_32x32x16_bf16 v[80:95], v[168:171], a[52:55], v[80:95]
  v_mfma_f32_32x32x16_bf16 v[96:111], v[168:171], a[56:59], v[96:111]
  s_add_u32 s41, s41, 4096
  buffer_load_dwordx4 v[168:171], v1, s[8:11], s41 offen offset:0 sc1
  s_waitcnt vmcnt(21)
  v_mfma_f32_32x32x16_bf16 v[64:79], v[172:175], a[60:63], v[64:79]
  ds_write_b128 v6, v[56:59] offset:5120
  v_mfma_f32_32x32x16_bf16 v[80:95], v[172:175], a[64:67], v[80:95]
  v_mfma_f32_32x32x16_bf16 v[96:111], v[172:175], a[68:71], v[96:111]
  buffer_load_dwordx4 v[172:175], v1, s[8:11], s41 offen offset:1024 sc1
  s_waitcnt vmcnt(21)
  v_mfma_f32_32x32x16_bf16 v[64:79], v[176:179], a[72:75], v[64:79]
  ds_write_b128 v6, v[28:31] offset:6144
  v_mfma_f32_32x32x16_bf16 v[80:95], v[176:179], a[76:79], v[80:95]
  v_mfma_f32_32x32x16_bf16 v[96:111], v[176:179], a[80:83], v[96:111]
  buffer_load_dwordx4 v[176:179], v1, s[8:11], s41 offen offset:2048 sc1
  s_waitcnt vmcnt(21)
  v_mfma_f32_32x32x16_bf16 v[64:79], v[180:183], a[84:87], v[64:79]
  ds_write_b128 v6, v[44:47] offset:7168
  v_mfma_f32_32x32x16_bf16 v[80:95], v[180:183], a[88:91], v[80:95]
  v_mfma_f32_32x32x16_bf16 v[96:111], v[180:183], a[92:95], v[96:111]
  buffer_load_dwordx4 v[180:183], v1, s[8:11], s41 offen offset:3072 sc1
  s_waitcnt vmcnt(21)
  v_mfma_f32_32x32x16_bf16 v[64:79], v[184:187], a[96:99], v[64:79]
  ds_write_b128 v6, v[60:63] offset:8192
  v_mfma_f32_32x32x16_bf16 v[80:95], v[184:187], a[100:103], v[80:95]
  v_mfma_f32_32x32x16_bf16 v[96:111], v[184:187], a[104:107], v[96:111]
  s_add_u32 s41, s41, 4096
  buffer_load_dwordx4 v[184:187], v1, s[8:11], s41 offen offset:0 sc1
  s_waitcnt lgkmcnt(0)
  s_barrier
  s_waitcnt vmcnt(21)
  v_mfma_f32_32x32x16_bf16 v[64:79], v[188:191], a[108:111], v[64:79]
  ds_read_b128 v[112:115], v10 offset:0
  ds_read_b128 v[116:119], v10 offset:1024
  ds_read_b128 v[120:123], v10 offset:2048
  ds_read_b128 v[124:127], v11 offset:0
  ds_read_b128 v[128:131], v11 offset:1024
  ds_read_b128 v[132:135], v11 offset:2048
  v_mfma_f32_32x32x16_bf16 v[80:95], v[188:191], a[112:115], v[80:95]
  ds_read_b128 v[136:139], v12 offset:0
  ds_read_b128 v[140:143], v12 offset:1024
  ds_read_b128 v[144:147], v12 offset:2048
  s_waitcnt vmcnt(10)
  v_min3_u32 v7, v227, v231, v235
  v_min3_u32 v7, v7, v239, v243
  v_mfma_f32_32x32x16_bf16 v[96:111], v[188:191], a[116:119], v[96:111]
  buffer_load_dwordx4 v[188:191], v1, s[8:11], s41 offen offset:1024 sc1
  v_min3_u32 v7, v7, v247, v247
  v_max3_u32 v8, v227, v231, v235
  v_max3_u32 v8, v8, v239, v243
  v_max3_u32 v8, v8, v247, v247
  v_mfma_f32_32x32x16_bf16 v[64:79], v[192:195], a[120:123], v[64:79]
  v_xor_b32 v7, s45, v7
  v_xor_b32 v8, s45, v8
  v_or_b32 v7, v7, v8
  v_mfma_f32_32x32x16_bf16 v[80:95], v[192:195], a[124:127], v[80:95]
  v_cmp_ne_u32 vcc, 0, v7
  s_nop 1
  s_cmp_eq_u64 vcc, 0
  s_cbranch_scc0 POLL9
POLL9_OK:
  v_lshlrev_b32 v248, 16, v224
  v_lshlrev_b32 v7, 16, v232
  v_mfma_f32_32x32x16_bf16 v[96:111], v[192:195], a[128:131], v[96:111]
  buffer_load_dwordx4 v[192:195], v1, s[8:11], s41 offen offset:2048 sc1
  s_waitcnt lgkmcnt(0)
  v_add_f32 v112, v112, v16
  v_add_f32 v124, v124, v136
  v_add_f32 v113, v113, v17
  v_mfma_f32_32x32x16_bf16 v[64:79], v[196:199], a[132:135], v[64:79]
  v_add_f32 v125, v125, v137
  v_add_f32 v114, v114, v18
  v_add_f32 v126, v126, v138
  v_add_f32 v115, v115, v19
  v_add_f32 v127, v127, v139
  v_add_f32 v116, v116, v32
  v_mfma_f32_32x32x16_bf16 v[80:95], v[196:199], a[136:139], v[80:95]
  v_add_f32 v128, v128, v140
  v_add_f32 v117, v117, v33
  v_add_f32 v129, v129, v141
  v_add_f32 v118, v118, v34
  v_add_f32 v130, v130, v142
  v_add_f32 v119, v119, v35
  v_mfma_f32_32x32x16_bf16 v[96:111], v[196:199], a[140:143], v[96:111]
  buffer_load_dwordx4 v[196:199], v1, s[8:11], s41 offen offset:3072 sc1
  v_add_f32 v131, v131, v143
  v_add_f32 v120, v120, v48
  v_add_f32 v132, v132, v144
  v_add_f32 v121, v121, v49
  v_mfma_f32_32x32x16_bf16 v[64:79], v[200:203], a[144:147], v[64:79]
  v_add_f32 v133, v133, v145
  v_add_f32 v122, v122, v50
  v_add_f32 v134, v134, v146
  v_add_f32 v123, v123, v51
  v_add_f32 v135, v135, v147
  v_add_f32 v112, v112, v124
  v_mfma_f32_32x32x16_bf16 v[80:95], v[200:203], a[148:151], v[80:95]
  v_add_f32 v113, v113, v125
  v_add_f32 v114, v114, v126
  v_add_f32 v115, v115, v127
  v_add_f32 v116, v116, v128
  v_add_f32 v117, v117, v129
  v_add_f32 v118, v118, v130
  v_mfma_f32_32x32x16_bf16 v[96:111], v[200:203], a[152:155], v[96:111]
  s_add_u32 s41, s41, 4096
  buffer_load_dwordx4 v[200:203], v1, s[8:11], s41 offen offset:0 sc1
  v_add_f32 v119, v119, v131
  v_add_f32 v120, v120, v132
  v_add_f32 v121, v121, v133
  v_mfma_f32_32x32x16_bf16 v[64:79], v[204:207], a[156:159], v[64:79]
  v_add_f32 v122, v122, v134
  v_add_f32 v123, v123, v135
  v_cvt_pk_bf16_f32 v136, v112, v113
  v_cvt_pk_bf16_f32 v137, v114, v115
  v_cvt_pk_bf16_f32 v138, v116, v117
  v_cvt_pk_bf16_f32 v140, v118, v119
  v_mfma_f32_32x32x16_bf16 v[80:95], v[204:207], a[160:163], v[80:95]
  v_cvt_pk_bf16_f32 v141, v120, v121
  v_cvt_pk_bf16_f32 v142, v122, v123
  v_mov_b32 v139, s45
  v_mov_b32 v143, s45
  s_mul_i32 s42, s60, 49152
  s_add_u32 s42, s42, s39
  v_mfma_f32_32x32x16_bf16 v[96:111], v[204:207], a[164:167], v[96:111]
  buffer_load_dwordx4 v[204:207], v1, s[8:11], s41 offen offset:1024 sc1
  buffer_store_dwordx4 v[136:139], v13, s[8:11], s42 offen offset:0 sc1
  v_lshlrev_b32 v8, 16, v240
  v_mfma_f32_32x32x16_bf16 v[64:79], v[208:211], a[168:171], v[64:79]
  v_add_f32 v248, v248, v7
  v_add_f32 v248, v248, v8
  v_and_b32 v249, s15, v224
  v_and_b32 v7, s15, v232
  v_and_b32 v8, s15, v240
  v_add_f32 v249, v249, v7
  v_mfma_f32_32x32x16_bf16 v[80:95], v[208:211], a[172:175], v[80:95]
  buffer_store_dwordx4 v[140:143], v13, s[8:11], s42 offen offset:1024 sc1
  v_add_f32 v249, v249, v8
  v_lshlrev_b32 v250, 16, v225
  v_lshlrev_b32 v7, 16, v233
  v_mfma_f32_32x32x16_bf16 v[96:111], v[208:211], a[176:179], v[96:111]
  buffer_load_dwordx4 v[208:211], v1, s[8:11], s41 offen offset:2048 sc1
  v_lshlrev_b32 v8, 16, v241
  v_add_f32 v250, v250, v7
  v_add_f32 v250, v250, v8
  v_and_b32 v251, s15, v225
  v_mfma_f32_32x32x16_bf16 v[64:79], v[212:215], a[180:183], v[64:79]
  v_and_b32 v7, s15, v233
  v_and_b32 v8, s15, v241
  v_add_f32 v251, v251, v7
  v_add_f32 v251, v251, v8
  v_lshlrev_b32 v252, 16, v226
  v_lshlrev_b32 v7, 16, v234
  v_mfma_f32_32x32x16_bf16 v[80:95], v[212:215], a[184:187], v[80:95]
  v_lshlrev_b32 v8, 16, v242
  v_add_f32 v252, v252, v7
  v_add_f32 v252, v252, v8
  v_and_b32 v253, s15, v226
  v_and_b32 v7, s15, v234
  v_and_b32 v8, s15, v242
  v_mfma_f32_32x32x16_bf16 v[96:111], v[212:215], a[188:191], v[96:111]
  buffer_load_dwordx4 v[212:215], v1, s[8:11], s41 offen offset:3072 sc1
  v_add_f32 v253, v253, v7
  v_add_f32 v253, v253, v8
  v_lshlrev_b32 v254, 16, v228
  v_lshlrev_b32 v7, 16, v236
  v_mfma_f32_32x32x16_bf16 v[64:79], v[216:219], a[192:195], v[64:79]
  v_lshlrev_b32 v8, 16, v244
  v_add_f32 v254, v254, v7
  v_add_f32 v254, v254, v8
  v_and_b32 v255, s15, v228
  v_and_b32 v7, s15, v236
  v_and_b32 v8, s15, v244
  v_mfma_f32_32x32x16_bf16 v[80:95], v[216:219], a[196:199], v[80:95]
  v_add_f32 v255, v255, v7
  v_add_f32 v255, v255, v8
  v_lshlrev_b32 v148, 16, v229
  v_lshlrev_b32 v7, 16, v237
  v_lshlrev_b32 v8, 16, v245
  v_add_f32 v148, v148, v7
  v_mfma_f32_32x32x16_bf16 v[96:111], v[216:219], a[200:203], v[96:111]
  s_add_u32 s41, s41, 4096
  buffer_load_dwordx4 v[216:219], v1, s[8:11], s41 offen offset:0 sc1
  v_add_f32 v148, v148, v8
  v_and_b32 v149, s15, v229
  s_waitcnt vmcnt(19)
  v_mfma_f32_32x32x16_bf16 v[64:79], v[220:223], a[204:207], v[64:79]
  v_and_b32 v7, s15, v237
  v_and_b32 v8, s15, v245
  v_add_f32 v149, v149, v7
  v_add_f32 v149, v149, v8
  v_lshlrev_b32 v150, 16, v230
  v_lshlrev_b32 v7, 16, v238
  v_mfma_f32_32x32x16_bf16 v[80:95], v[220:223], a[208:211], v[80:95]
  v_lshlrev_b32 v8, 16, v246
  v_add_f32 v150, v150, v7
  v_add_f32 v150, v150, v8
  v_and_b32 v151, s15, v230
  v_and_b32 v7, s15, v238
  v_and_b32 v8, s15, v246
  v_mfma_f32_32x32x16_bf16 v[96:111], v[220:223], a[212:215], v[96:111]
  buffer_load_dwordx4 v[220:223], v1, s[8:11], s41 offen offset:1024 sc1
  v_add_f32 v151, v151, v7
  v_add_f32 v151, v151, v8
  s_add_u32 s34, s34, 49152
  s_waitcnt vmcnt(19)
  v_mfma_f32_32x32x16_bf16 v[16:31], v[152:155], a[0:3], 0
  s_add_u32 s35, s35, 49152
  s_add_u32 s36, s36, 49152
  buffer_load_dwordx4 v[224:227], v13, s[8:11], s38 offen offset:0 sc1
  buffer_load_dwordx4 v[228:231], v13, s[8:11], s38 offen offset:1024 sc1
  v_mfma_f32_32x32x16_bf16 v[32:47], v[152:155], a[4:7], 0
  ds_write_b128 v6, v[68:71] offset:36864
  v_mfma_f32_32x32x16_bf16 v[48:63], v[152:155], a[8:11], 0
  s_mul_i32 s41, s63, 368640
  s_add_u32 s41, s41, s37
  buffer_load_dwordx4 v[152:155], v1, s[8:11], s41 offen offset:0 sc1
  s_waitcnt vmcnt(21)
  v_mfma_f32_32x32x16_bf16 v[16:31], v[156:159], a[12:15], v[16:31]
  ds_write_b128 v6, v[84:87] offset:37888
  v_mfma_f32_32x32x16_bf16 v[32:47], v[156:159], a[16:19], v[32:47]
  v_mfma_f32_32x32x16_bf16 v[48:63], v[156:159], a[20:23], v[48:63]
  buffer_load_dwordx4 v[156:159], v1, s[8:11], s41 offen offset:1024 sc1
  s_waitcnt vmcnt(21)
  v_mfma_f32_32x32x16_bf16 v[16:31], v[160:163], a[24:27], v[16:31]
  ds_write_b128 v6, v[100:103] offset:38912
  v_mfma_f32_32x32x16_bf16 v[32:47], v[160:163], a[28:31], v[32:47]
  v_mfma_f32_32x32x16_bf16 v[48:63], v[160:163], a[32:35], v[48:63]
  buffer_load_dwordx4 v[160:163], v1, s[8:11], s41 offen offset:2048 sc1
  s_waitcnt vmcnt(21)
  v_mfma_f32_32x32x16_bf16 v[16:31], v[164:167], a[36:39], v[16:31]
  ds_write_b128 v6, v[72:75] offset:39936
  v_mfma_f32_32x32x16_bf16 v[32:47], v[164:167], a[40:43], v[32:47]
  v_mfma_f32_32x32x16_bf16 v[48:63], v[164:167], a[44:47], v[48:63]
  buffer_load_dwordx4 v[164:167], v1, s[8:11], s41 offen offset:3072 sc1
  s_waitcnt vmcnt(21)
  v_mfma_f32_32x32x16_bf16 v[16:31], v[168:171], a[48:51], v[16:31]
  ds_write_b128 v6, v[88:91] offset:40960
  v_mfma_f32_32x32x16_bf16 v[32:47], v[168:171], a[52:55], v[32:47]
  v_mfma_f32_32x32x16_bf16 v[48:63], v[168:171], a[56:59], v[48:63]
  s_add_u32 s41, s41, 4096
  buffer_load_dwordx4 v[168:171], v1, s[8:11], s41 offen offset:0 sc1
  s_waitcnt vmcnt(21)
  v_mfma_f32_32x32x16_bf16 v[16:31], v[172:175], a[60:63], v[16:31]
  ds_write_b128 v6, v[104:107] offset:41984
  v_mfma_f32_32x32x16_bf16 v[32:47], v[172:175], a[64:67], v[32:47]
  v_mfma_f32_32x32x16_bf16 v[48:63], v[172:175], a[68:71], v[48:63]
  buffer_load_dwordx4 v[172:175], v1, s[8:11], s41 offen offset:1024 sc1
  s_waitcnt vmcnt(21)
  v_mfma_f32_32x32x16_bf16 v[16:31], v[176:179], a[72:75], v[16:31]
  ds_write_b128 v6, v[76:79] offset:43008
  v_mfma_f32_32x32x16_bf16 v[32:47], v[176:179], a[76:79], v[32:47]
  v_mfma_f32_32x32x16_bf16 v[48:63], v[176:179], a[80:83], v[48:63]
  buffer_load_dwordx4 v[176:179], v1, s[8:11], s41 offen offset:2048 sc1
  s_waitcnt vmcnt(21)
  v_mfma_f32_32x32x16_bf16 v[16:31], v[180:183], a[84:87], v[16:31]
  ds_write_b128 v6, v[92:95] offset:44032
  v_mfma_f32_32x32x16_bf16 v[32:47], v[180:183], a[88:91], v[32:47]
  v_mfma_f32_32x32x16_bf16 v[48:63], v[180:183], a[92:95], v[48:63]
  buffer_load_dwordx4 v[180:183], v1, s[8:11], s41 offen offset:3072 sc1
  s_waitcnt vmcnt(21)
  v_mfma_f32_32x32x16_bf16 v[16:31], v[184:187], a[96:99], v[16:31]
  ds_write_b128 v6, v[108:111] offset:45056
  v_mfma_f32_32x32x16_bf16 v[32:47], v[184:187], a[100:103], v[32:47]
  v_mfma_f32_32x32x16_bf16 v[48:63], v[184:187], a[104:107], v[48:63]
  s_add_u32 s41, s41, 4096
  buffer_load_dwordx4 v[184:187], v1, s[8:11], s41 offen offset:0 sc1
  s_waitcnt lgkmcnt(0)
  s_barrier
  s_waitcnt vmcnt(21)
  v_mfma_f32_32x32x16_bf16 v[16:31], v[188:191], a[108:111], v[16:31]
  ds_read_b128 v[112:115], v10 offset:36864
  ds_read_b128 v[116:119], v10 offset:37888
  ds_read_b128 v[120:123], v10 offset:38912
  ds_read_b128 v[124:127], v11 offset:36864
  ds_read_b128 v[128:131], v11 offset:37888
  ds_read_b128 v[132:135], v11 offset:38912
  v_mfma_f32_32x32x16_bf16 v[32:47], v[188:191], a[112:115], v[32:47]
  ds_read_b128 v[136:139], v12 offset:36864
  ds_read_b128 v[140:143], v12 offset:37888
  ds_read_b128 v[144:147], v12 offset:38912
  v_mfma_f32_32x32x16_bf16 v[48:63], v[188:191], a[116:119], v[48:63]
  buffer_load_dwordx4 v[188:191], v1, s[8:11], s41 offen offset:1024 sc1
  s_waitcnt vmcnt(21)
  v_mfma_f32_32x32x16_bf16 v[16:31], v[192:195], a[120:123], v[16:31]
  s_waitcnt vmcnt(10)
  v_min3_u32 v7, v227, v231, v227
  v_max3_u32 v8, v227, v231, v227
  v_xor_b32 v7, s45, v7
  v_xor_b32 v8, s45, v8
  v_or_b32 v7, v7, v8
  v_mfma_f32_32x32x16_bf16 v[32:47], v[192:195], a[124:127], v[32:47]
  v_cmp_ne_u32 vcc, 0, v7
  s_nop 1
  s_cmp_eq_u64 vcc, 0
  s_cbranch_scc0 POLL10
POLL10_OK:
  v_accvgpr_read_b32 v7, a216
  v_lshlrev_b32 v232, 16, v224
  v_mfma_f32_32x32x16_bf16 v[48:63], v[192:195], a[128:131], v[48:63]
  buffer_load_dwordx4 v[192:195], v1, s[8:11], s41 offen offset:2048 sc1
  s_waitcnt lgkmcnt(0)
  v_add_f32 v112, v112, v64
  v_add_f32 v124, v124, v136
  v_add_f32 v113, v113, v65
  v_mfma_f32_32x32x16_bf16 v[16:31], v[196:199], a[132:135], v[16:31]
  v_add_f32 v125, v125, v137
  v_add_f32 v114, v114, v66
  v_add_f32 v126, v126, v138
  v_add_f32 v115, v115, v67
  v_add_f32 v127, v127, v139
  v_add_f32 v116, v116, v80
  v_mfma_f32_32x32x16_bf16 v[32:47], v[196:199], a[136:139], v[32:47]
  v_add_f32 v128, v128, v140
  v_add_f32 v117, v117, v81
  v_add_f32 v129, v129, v141
  v_add_f32 v118, v118, v82
  v_add_f32 v130, v130, v142
  v_add_f32 v119, v119, v83
  v_mfma_f32_32x32x16_bf16 v[48:63], v[196:199], a[140:143], v[48:63]
  buffer_load_dwordx4 v[196:199], v1, s[8:11], s41 offen offset:3072 sc1
  v_add_f32 v131, v131, v143
  v_add_f32 v120, v120, v96
  v_add_f32 v132, v132, v144
  v_add_f32 v121, v121, v97
  v_mfma_f32_32x32x16_bf16 v[16:31], v[200:203], a[144:147], v[16:31]
  v_add_f32 v133, v133, v145
  v_add_f32 v122, v122, v98
  v_add_f32 v134, v134, v146
  v_add_f32 v123, v123, v99
  v_add_f32 v135, v135, v147
  v_add_f32 v112, v112, v124
  v_mfma_f32_32x32x16_bf16 v[32:47], v[200:203], a[148:151], v[32:47]
  v_add_f32 v113, v113, v125
  v_add_f32 v114, v114, v126
  v_add_f32 v115, v115, v127
  v_add_f32 v116, v116, v128
  v_add_f32 v117, v117, v129
  v_add_f32 v118, v118, v130
  v_mfma_f32_32x32x16_bf16 v[48:63], v[200:203], a[152:155], v[48:63]
  s_add_u32 s41, s41, 4096
  buffer_load_dwordx4 v[200:203], v1, s[8:11], s41 offen offset:0 sc1
  v_add_f32 v119, v119, v131
  v_add_f32 v120, v120, v132
  v_add_f32 v121, v121, v133
  v_mfma_f32_32x32x16_bf16 v[16:31], v[204:207], a[156:159], v[16:31]
  v_add_f32 v122, v122, v134
  v_add_f32 v123, v123, v135
  v_cvt_pk_bf16_f32 v136, v112, v113
  v_cvt_pk_bf16_f32 v137, v114, v115
  v_cvt_pk_bf16_f32 v138, v116, v117
  v_cvt_pk_bf16_f32 v140, v118, v119
  v_mfma_f32_32x32x16_bf16 v[32:47], v[204:207], a[160:163], v[32:47]
  v_cvt_pk_bf16_f32 v141, v120, v121
  v_cvt_pk_bf16_f32 v142, v122, v123
  v_mov_b32 v139, s45
  v_mov_b32 v143, s45
  s_mul_i32 s42, s61, 49152
  s_add_u32 s42, s42, s39
  v_mfma_f32_32x32x16_bf16 v[48:63], v[204:207], a[164:167], v[48:63]
  buffer_load_dwordx4 v[204:207], v1, s[8:11], s41 offen offset:1024 sc1
  buffer_store_dwordx4 v[136:139], v13, s[8:11], s42 offen offset:0 sc1
  v_and_b32 v7, s15, v7
  v_mfma_f32_32x32x16_bf16 v[16:31], v[208:211], a[168:171], v[16:31]
  v_fma_f32 v232, 2.0, v232, v7
  v_accvgpr_read_b32 v8, a217
  v_and_b32 v233, s15, v224
  v_and_b32 v8, s15, v8
  v_fma_f32 v233, 2.0, v233, v8
  v_accvgpr_read_b32 v7, a218
  v_mfma_f32_32x32x16_bf16 v[32:47], v[208:211], a[172:175], v[32:47]
  buffer_store_dwordx4 v[140:143], v13, s[8:11], s42 offen offset:1024 sc1
  v_lshlrev_b32 v234, 16, v225
  v_and_b32 v7, s15, v7
  v_fma_f32 v234, 2.0, v234, v7
  v_mfma_f32_32x32x16_bf16 v[48:63], v[208:211], a[176:179], v[48:63]
  buffer_load_dwordx4 v[208:211], v1, s[8:11], s41 offen offset:2048 sc1
  v_accvgpr_read_b32 v8, a219
  v_and_b32 v235, s15, v225
  v_and_b32 v8, s15, v8
  v_fma_f32 v235, 2.0, v235, v8
  v_mfma_f32_32x32x16_bf16 v[16:31], v[212:215], a[180:183], v[16:31]
  v_accvgpr_read_b32 v7, a220
  v_lshlrev_b32 v236, 16, v226
  v_and_b32 v7, s15, v7
  v_fma_f32 v236, 2.0, v236, v7
  v_accvgpr_read_b32 v8, a221
  v_and_b32 v237, s15, v226
  v_mfma_f32_32x32x16_bf16 v[32:47], v[212:215], a[184:187], v[32:47]
  v_and_b32 v8, s15, v8
  v_fma_f32 v237, 2.0, v237, v8
  v_accvgpr_read_b32 v7, a222
  v_lshlrev_b32 v238, 16, v228
  v_and_b32 v7, s15, v7
  v_fma_f32 v238, 2.0, v238, v7
  v_mfma_f32_32x32x16_bf16 v[48:63], v[212:215], a[188:191], v[48:63]
  buffer_load_dwordx4 v[212:215], v1, s[8:11], s41 offen offset:3072 sc1
  v_accvgpr_read_b32 v8, a223
  v_and_b32 v239, s15, v228
  v_and_b32 v8, s15, v8
  v_fma_f32 v239, 2.0, v239, v8
  v_mfma_f32_32x32x16_bf16 v[16:31], v[216:219], a[192:195], v[16:31]
  v_accvgpr_read_b32 v7, a224
  v_lshlrev_b32 v240, 16, v229
  v_and_b32 v7, s15, v7
  v_fma_f32 v240, 2.0, v240, v7
  v_accvgpr_read_b32 v8, a225
  v_and_b32 v241, s15, v229
  v_mfma_f32_32x32x16_bf16 v[32:47], v[216:219], a[196:199], v[32:47]
  v_and_b32 v8, s15, v8
  v_fma_f32 v241, 2.0, v241, v8
  v_accvgpr_read_b32 v7, a226
  v_lshlrev_b32 v242, 16, v230
  v_and_b32 v7, s15, v7
  v_fma_f32 v242, 2.0, v242, v7
  v_mfma_f32_32x32x16_bf16 v[48:63], v[216:219], a[200:203], v[48:63]
  s_add_u32 s41, s41, 4096
  buffer_load_dwordx4 v[216:219], v1, s[8:11], s41 offen offset:0 sc1
  v_accvgpr_read_b32 v8, a227
  v_and_b32 v243, s15, v230
  v_and_b32 v8, s15, v8
  v_mfma_f32_32x32x16_bf16 v[16:31], v[220:223], a[204:207], v[16:31]
  v_fma_f32 v243, 2.0, v243, v8
  v_mfma_f32_32x32x16_bf16 v[32:47], v[220:223], a[208:211], v[32:47]
  v_mfma_f32_32x32x16_bf16 v[48:63], v[220:223], a[212:215], v[48:63]
  buffer_load_dwordx4 v[220:223], v1, s[8:11], s41 offen offset:1024 sc1
  s_waitcnt vmcnt(19)
  v_mfma_f32_32x32x16_bf16 v[64:79], v[152:155], a[0:3], 0
  buffer_load_dwordx4 v[224:227], v13, s[8:11], s34 offen offset:0 sc1
  v_mfma_f32_32x32x16_bf16 v[80:95], v[152:155], a[4:7], 0
  s_nop 3
  ds_write_b128 v6, v[20:23] offset:0
  v_mfma_f32_32x32x16_bf16 v[96:111], v[152:155], a[8:11], 0
  s_waitcnt vmcnt(19)
  v_mfma_f32_32x32x16_bf16 v[64:79], v[156:159], a[12:15], v[64:79]
  buffer_load_dwordx4 v[228:231], v13, s[8:11], s34 offen offset:1024 sc1
  s_add_u32 s38, s38, 49152
  v_mfma_f32_32x32x16_bf16 v[80:95], v[156:159], a[16:19], v[80:95]
  ds_write_b128 v6, v[36:39] offset:1024
  v_mfma_f32_32x32x16_bf16 v[96:111], v[156:159], a[20:23], v[96:111]
  s_waitcnt vmcnt(19)
  v_mfma_f32_32x32x16_bf16 v[64:79], v[160:163], a[24:27], v[64:79]
  ds_write_b128 v6, v[52:55] offset:2048
  v_mfma_f32_32x32x16_bf16 v[80:95], v[160:163], a[28:31], v[80:95]
  v_mfma_f32_32x32x16_bf16 v[96:111], v[160:163], a[32:35], v[96:111]
  ds_write_b128 v6, v[24:27] offset:3072
  s_waitcnt vmcnt(18)
  v_mfma_f32_32x32x16_bf16 v[64:79], v[164:167], a[36:39], v[64:79]
  v_mfma_f32_32x32x16_bf16 v[80:95], v[164:167], a[40:43], v[80:95]
  ds_write_b128 v6, v[40:43] offset:4096
  v_mfma_f32_32x32x16_bf16 v[96:111], v[164:167], a[44:47], v[96:111]
  s_waitcnt vmcnt(17)
  v_mfma_f32_32x32x16_bf16 v[64:79], v[168:171], a[48:51], v[64:79]
  ds_write_b128 v6, v[56:59] offset:5120
  v_mfma_f32_32x32x16_bf16 v[80:95], v[168:171], a[52:55], v[80:95]
  v_mfma_f32_32x32x16_bf16 v[96:111], v[168:171], a[56:59], v[96:111]
  ds_write_b128 v6, v[28:31] offset:6144
  s_waitcnt vmcnt(16)
  v_mfma_f32_32x32x16_bf16 v[64:79], v[172:175], a[60:63], v[64:79]
  v_mfma_f32_32x32x16_bf16 v[80:95], v[172:175], a[64:67], v[80:95]
  ds_write_b128 v6, v[44:47] offset:7168
  v_mfma_f32_32x32x16_bf16 v[96:111], v[172:175], a[68:71], v[96:111]
  s_waitcnt vmcnt(15)
  v_mfma_f32_32x32x16_bf16 v[64:79], v[176:179], a[72:75], v[64:79]
  ds_write_b128 v6, v[60:63] offset:8192
  v_mfma_f32_32x32x16_bf16 v[80:95], v[176:179], a[76:79], v[80:95]
  v_mfma_f32_32x32x16_bf16 v[96:111], v[176:179], a[80:83], v[96:111]
  s_waitcnt lgkmcnt(0)
  s_barrier
  ds_read_b128 v[112:115], v10 offset:0
  ds_read_b128 v[116:119], v10 offset:1024
  ds_read_b128 v[120:123], v10 offset:2048
  s_waitcnt vmcnt(14)
  v_mfma_f32_32x32x16_bf16 v[64:79], v[180:183], a[84:87], v[64:79]
  ds_read_b128 v[124:127], v11 offset:0
  ds_read_b128 v[128:131], v11 offset:1024
  ds_read_b128 v[132:135], v11 offset:2048
  ds_read_b128 v[136:139], v12 offset:0
  ds_read_b128 v[140:143], v12 offset:1024
  ds_read_b128 v[144:147], v12 offset:2048
  v_mfma_f32_32x32x16_bf16 v[80:95], v[180:183], a[88:91], v[80:95]
  v_mfma_f32_32x32x16_bf16 v[96:111], v[180:183], a[92:95], v[96:111]
  s_waitcnt vmcnt(13)
  v_mfma_f32_32x32x16_bf16 v[64:79], v[184:187], a[96:99], v[64:79]
  v_mfma_f32_32x32x16_bf16 v[80:95], v[184:187], a[100:103], v[80:95]
  s_waitcnt lgkmcnt(0)
  v_add_f32 v112, v112, v16
  v_add_f32 v124, v124, v136
  v_add_f32 v113, v113, v17
  v_add_f32 v125, v125, v137
  v_add_f32 v114, v114, v18
  v_mfma_f32_32x32x16_bf16 v[96:111], v[184:187], a[104:107], v[96:111]
  buffer_load_dwordx4 v[20:23], v13, s[8:11], s35 offen offset:0 sc1
  v_add_f32 v126, v126, v138
  v_add_f32 v115, v115, v19
  v_add_f32 v127, v127, v139
  s_waitcnt vmcnt(13)
  v_mfma_f32_32x32x16_bf16 v[64:79], v[188:191], a[108:111], v[64:79]
  v_add_f32 v116, v116, v32
  v_add_f32 v128, v128, v140
  v_add_f32 v117, v117, v33
  v_add_f32 v129, v129, v141
  v_add_f32 v118, v118, v34
  v_add_f32 v130, v130, v142
  v_mfma_f32_32x32x16_bf16 v[80:95], v[188:191], a[112:115], v[80:95]
  v_add_f32 v119, v119, v35
  v_add_f32 v131, v131, v143
  v_add_f32 v120, v120, v48
  v_add_f32 v132, v132, v144
  v_add_f32 v121, v121, v49
  v_add_f32 v133, v133, v145
  v_mfma_f32_32x32x16_bf16 v[96:111], v[188:191], a[116:119], v[96:111]
  buffer_load_dwordx4 v[36:39], v13, s[8:11], s35 offen offset:1024 sc1
  v_add_f32 v122, v122, v50
  v_add_f32 v134, v134, v146
  v_add_f32 v123, v123, v51
  s_waitcnt vmcnt(13)
  v_mfma_f32_32x32x16_bf16 v[64:79], v[192:195], a[120:123], v[64:79]
  v_add_f32 v135, v135, v147
  v_add_f32 v112, v112, v124
  v_add_f32 v113, v113, v125
  v_add_f32 v114, v114, v126
  v_add_f32 v115, v115, v127
  v_add_f32 v116, v116, v128
  v_mfma_f32_32x32x16_bf16 v[80:95], v[192:195], a[124:127], v[80:95]
  v_add_f32 v117, v117, v129
  v_add_f32 v118, v118, v130
  v_add_f32 v119, v119, v131
  v_add_f32 v120, v120, v132
  v_add_f32 v121, v121, v133
  v_add_f32 v122, v122, v134
  v_mfma_f32_32x32x16_bf16 v[96:111], v[192:195], a[128:131], v[96:111]
  buffer_load_dwordx4 v[152:155], v13, s[8:11], s38 offen offset:0 sc1
  v_add_f32 v123, v123, v135
  v_add_f32 v112, v112, v248
  v_add_f32 v113, v113, v249
  s_waitcnt vmcnt(13)
  v_mfma_f32_32x32x16_bf16 v[64:79], v[196:199], a[132:135], v[64:79]
  v_add_f32 v114, v114, v250
  v_add_f32 v115, v115, v251
  v_mul_f32 v124, s40, v112
  v_mul_f32 v125, s40, v113
  v_mul_f32 v126, s40, v114
  v_mul_f32 v127, s40, v115
  v_mfma_f32_32x32x16_bf16 v[80:95], v[196:199], a[136:139], v[80:95]
  v_exp_f32 v124, v124
  v_exp_f32 v125, v125
  v_exp_f32 v126, v126
  v_mfma_f32_32x32x16_bf16 v[96:111], v[196:199], a[140:143], v[96:111]
  buffer_load_dwordx4 v[156:159], v13, s[8:11], s38 offen offset:1024 sc1
  v_exp_f32 v127, v127
  v_accvgpr_read_b32 v136, a216
  s_waitcnt vmcnt(13)
  v_mfma_f32_32x32x16_bf16 v[64:79], v[200:203], a[144:147], v[64:79]
  v_accvgpr_read_b32 v137, a217
  v_accvgpr_read_b32 v138, a218
  v_accvgpr_read_b32 v139, a219
  v_add_f32 v124, 1.0, v124
  v_add_f32 v125, 1.0, v125
  v_add_f32 v126, 1.0, v126
  v_mfma_f32_32x32x16_bf16 v[80:95], v[200:203], a[148:151], v[80:95]
  v_add_f32 v127, 1.0, v127
  v_rcp_f32 v124, v124
  v_rcp_f32 v125, v125
  v_mfma_f32_32x32x16_bf16 v[96:111], v[200:203], a[152:155], v[96:111]
  buffer_load_dwordx4 v[52:55], v13, s[8:11], s36 offen offset:0 sc1
  v_rcp_f32 v126, v126
  s_waitcnt vmcnt(13)
  v_mfma_f32_32x32x16_bf16 v[64:79], v[204:207], a[156:159], v[64:79]
  v_rcp_f32 v127, v127
  v_lshlrev_b32 v136, 16, v136
  v_lshlrev_b32 v137, 16, v137
  v_lshlrev_b32 v138, 16, v138
  v_lshlrev_b32 v139, 16, v139
  v_mfma_f32_32x32x16_bf16 v[80:95], v[204:207], a[160:163], v[80:95]
  v_mul_f32 v112, v112, v124
  v_mul_f32 v113, v113, v125
  v_mul_f32 v114, v114, v126
  v_mul_f32 v115, v115, v127
  v_fma_f32 v136, v232, v112, v136
  v_fma_f32 v137, v233, v113, v137
  v_mfma_f32_32x32x16_bf16 v[96:111], v[204:207], a[164:167], v[96:111]
  buffer_load_dwordx4 v[24:27], v13, s[8:11], s36 offen offset:1024 sc1
  v_fma_f32 v138, v234, v114, v138
  v_fma_f32 v139, v235, v115, v139
  s_waitcnt vmcnt(11)
  v_mfma_f32_32x32x16_bf16 v[64:79], v[208:211], a[168:171], v[64:79]
  s_mov_b64 vcc, s[26:27]
  v_cndmask_b32_dpp v125, v136, v137, vcc quad_perm:[1,0,3,2] row_mask:0xf bank_mask:0xf
  v_cndmask_b32_dpp v127, v138, v139, vcc quad_perm:[1,0,3,2] row_mask:0xf bank_mask:0xf
  s_mov_b64 vcc, s[24:25]
  v_cndmask_b32_dpp v124, v137, v136, vcc quad_perm:[1,0,3,2] row_mask:0xf bank_mask:0xf
  v_cndmask_b32_dpp v126, v139, v138, vcc quad_perm:[1,0,3,2] row_mask:0xf bank_mask:0xf
  v_mfma_f32_32x32x16_bf16 v[80:95], v[208:211], a[172:175], v[80:95]
  s_mov_b64 vcc, s[50:51]
  v_cndmask_b32_dpp v114, v124, v126, vcc quad_perm:[2,3,0,1] row_mask:0xf bank_mask:0xf
  v_cndmask_b32_dpp v115, v125, v127, vcc quad_perm:[2,3,0,1] row_mask:0xf bank_mask:0xf
  s_mov_b64 vcc, s[28:29]
  v_cndmask_b32_dpp v112, v126, v124, vcc quad_perm:[2,3,0,1] row_mask:0xf bank_mask:0xf
  v_cndmask_b32_dpp v113, v127, v125, vcc quad_perm:[2,3,0,1] row_mask:0xf bank_mask:0xf
  v_mfma_f32_32x32x16_bf16 v[96:111], v[208:211], a[176:179], v[96:111]
  buffer_store_dwordx4 v[112:115], v5, s[20:23], s52 offen offset:0 sc1
  v_add_f32 v116, v116, v252
  v_add_f32 v117, v117, v253
  s_waitcnt vmcnt(11)
  v_mfma_f32_32x32x16_bf16 v[64:79], v[212:215], a[180:183], v[64:79]
  v_add_f32 v118, v118, v254
  v_add_f32 v119, v119, v255
  v_mul_f32 v128, s40, v116
  v_mul_f32 v129, s40, v117
  v_mul_f32 v130, s40, v118
  v_mul_f32 v131, s40, v119
  v_mfma_f32_32x32x16_bf16 v[80:95], v[212:215], a[184:187], v[80:95]
  v_exp_f32 v128, v128
  v_exp_f32 v129, v129
  v_exp_f32 v130, v130
  v_mfma_f32_32x32x16_bf16 v[96:111], v[212:215], a[188:191], v[96:111]
  v_exp_f32 v131, v131
  v_accvgpr_read_b32 v140, a220
  v_accvgpr_read_b32 v141, a221
  v_accvgpr_read_b32 v142, a222
  s_waitcnt vmcnt(10)
  v_mfma_f32_32x32x16_bf16 v[64:79], v[216:219], a[192:195], v[64:79]
  v_accvgpr_read_b32 v143, a223
  v_add_f32 v128, 1.0, v128
  v_add_f32 v129, 1.0, v129
  v_add_f32 v130, 1.0, v130
  v_add_f32 v131, 1.0, v131
  v_mfma_f32_32x32x16_bf16 v[80:95], v[216:219], a[196:199], v[80:95]
  v_rcp_f32 v128, v128
  v_rcp_f32 v129, v129
  v_rcp_f32 v130, v130
  v_mfma_f32_32x32x16_bf16 v[96:111], v[216:219], a[200:203], v[96:111]
  v_rcp_f32 v131, v131
  v_lshlrev_b32 v140, 16, v140
  v_lshlrev_b32 v141, 16, v141
  v_lshlrev_b32 v142, 16, v142
  s_waitcnt vmcnt(9)
  v_mfma_f32_32x32x16_bf16 v[64:79], v[220:223], a[204:207], v[64:79]
  v_lshlrev_b32 v143, 16, v143
  v_mul_f32 v116, v116, v128
  v_mul_f32 v117, v117, v129
  v_mul_f32 v118, v118, v130
  v_mul_f32 v119, v119, v131
  v_fma_f32 v140, v236, v116, v140
  v_mfma_f32_32x32x16_bf16 v[80:95], v[220:223], a[208:211], v[80:95]
  v_fma_f32 v141, v237, v117, v141
  v_fma_f32 v142, v238, v118, v142
  v_fma_f32 v143, v239, v119, v143
  s_mov_b64 vcc, s[26:27]
  v_cndmask_b32_dpp v129, v140, v141, vcc quad_perm:[1,0,3,2] row_mask:0xf bank_mask:0xf
  v_cndmask_b32_dpp v131, v142, v143, vcc quad_perm:[1,0,3,2] row_mask:0xf bank_mask:0xf
  v_mfma_f32_32x32x16_bf16 v[96:111], v[220:223], a[212:215], v[96:111]
  ds_write_b128 v6, v[68:71] offset:36864
  s_mov_b64 vcc, s[24:25]
  v_cndmask_b32_dpp v128, v141, v140, vcc quad_perm:[1,0,3,2] row_mask:0xf bank_mask:0xf
  v_cndmask_b32_dpp v130, v143, v142, vcc quad_perm:[1,0,3,2] row_mask:0xf bank_mask:0xf
  s_mov_b64 vcc, s[50:51]
  s_nop 0
  v_cndmask_b32_dpp v118, v128, v130, vcc quad_perm:[2,3,0,1] row_mask:0xf bank_mask:0xf
  v_cndmask_b32_dpp v119, v129, v131, vcc quad_perm:[2,3,0,1] row_mask:0xf bank_mask:0xf
  s_mov_b64 vcc, s[28:29]
  v_cndmask_b32_dpp v116, v130, v128, vcc quad_perm:[2,3,0,1] row_mask:0xf bank_mask:0xf
  v_cndmask_b32_dpp v117, v131, v129, vcc quad_perm:[2,3,0,1] row_mask:0xf bank_mask:0xf
  buffer_store_dwordx4 v[116:119], v5, s[20:23], s52 offen offset:128 sc1
  v_add_f32 v120, v120, v148
  v_add_f32 v121, v121, v149
  ds_write_b128 v6, v[84:87] offset:37888
  v_add_f32 v122, v122, v150
  v_add_f32 v123, v123, v151
  v_mul_f32 v132, s40, v120
  v_mul_f32 v133, s40, v121
  v_mul_f32 v134, s40, v122
  v_mul_f32 v135, s40, v123
  ds_write_b128 v6, v[100:103] offset:38912
  v_exp_f32 v132, v132
  v_exp_f32 v133, v133
  v_exp_f32 v134, v134
  v_exp_f32 v135, v135
  v_accvgpr_read_b32 v144, a224
  v_accvgpr_read_b32 v145, a225
  ds_write_b128 v6, v[72:75] offset:39936
  v_accvgpr_read_b32 v146, a226
  v_accvgpr_read_b32 v147, a227
  v_add_f32 v132, 1.0, v132
  v_add_f32 v133, 1.0, v133
  v_add_f32 v134, 1.0, v134
  v_add_f32 v135, 1.0, v135
  ds_write_b128 v6, v[88:91] offset:40960
  v_rcp_f32 v132, v132
  v_rcp_f32 v133, v133
  v_rcp_f32 v134, v134
  v_rcp_f32 v135, v135
  v_lshlrev_b32 v144, 16, v144
  v_lshlrev_b32 v145, 16, v145
  ds_write_b128 v6, v[104:107] offset:41984
  v_lshlrev_b32 v146, 16, v146
  v_lshlrev_b32 v147, 16, v147
  v_mul_f32 v120, v120, v132
  v_mul_f32 v121, v121, v133
  v_mul_f32 v122, v122, v134
  v_mul_f32 v123, v123, v135
  ds_write_b128 v6, v[76:79] offset:43008
  v_fma_f32 v144, v240, v120, v144
  v_fma_f32 v145, v241, v121, v145
  v_fma_f32 v146, v242, v122, v146
  v_fma_f32 v147, v243, v123, v147
  s_mov_b64 vcc, s[26:27]
  v_cndmask_b32_dpp v133, v144, v145, vcc quad_perm:[1,0,3,2] row_mask:0xf bank_mask:0xf
  v_cndmask_b32_dpp v135, v146, v147, vcc quad_perm:[1,0,3,2] row_mask:0xf bank_mask:0xf
  s_mov_b64 vcc, s[24:25]
  v_cndmask_b32_dpp v132, v145, v144, vcc quad_perm:[1,0,3,2] row_mask:0xf bank_mask:0xf
  v_cndmask_b32_dpp v134, v147, v146, vcc quad_perm:[1,0,3,2] row_mask:0xf bank_mask:0xf
  ds_write_b128 v6, v[92:95] offset:44032
  s_mov_b64 vcc, s[50:51]
  v_cndmask_b32_dpp v122, v132, v134, vcc quad_perm:[2,3,0,1] row_mask:0xf bank_mask:0xf
  v_cndmask_b32_dpp v123, v133, v135, vcc quad_perm:[2,3,0,1] row_mask:0xf bank_mask:0xf
  s_mov_b64 vcc, s[28:29]
  v_cndmask_b32_dpp v120, v134, v132, vcc quad_perm:[2,3,0,1] row_mask:0xf bank_mask:0xf
  v_cndmask_b32_dpp v121, v135, v133, vcc quad_perm:[2,3,0,1] row_mask:0xf bank_mask:0xf
  buffer_store_dwordx4 v[120:123], v5, s[20:23], s52 offen offset:256 sc1
  ds_write_b128 v6, v[108:111] offset:45056
  s_waitcnt lgkmcnt(0)
  s_barrier
  ds_read_b128 v[112:115], v10 offset:36864
  ds_read_b128 v[116:119], v10 offset:37888
  ds_read_b128 v[120:123], v10 offset:38912
  ds_read_b128 v[124:127], v11 offset:36864
  ds_read_b128 v[128:131], v11 offset:37888
  ds_read_b128 v[132:135], v11 offset:38912
  ds_read_b128 v[136:139], v12 offset:36864
  ds_read_b128 v[140:143], v12 offset:37888
  ds_read_b128 v[144:147], v12 offset:38912
  s_waitcnt vmcnt(5)
  v_min3_u32 v7, v155, v159, v155
  v_max3_u32 v8, v155, v159, v155
  v_xor_b32 v7, s45, v7
  v_xor_b32 v8, s45, v8
  v_or_b32 v7, v7, v8
  v_cmp_ne_u32 vcc, 0, v7
  s_nop 1
  s_cmp_eq_u64 vcc, 0
  s_cbranch_scc0 POLL11
POLL11_OK:
  v_accvgpr_read_b32 v7, a228
  v_lshlrev_b32 v160, 16, v152
  v_and_b32 v7, s15, v7
  v_fma_f32 v160, 2.0, v160, v7
  v_accvgpr_read_b32 v8, a229
  v_and_b32 v161, s15, v152
  v_and_b32 v8, s15, v8
  v_fma_f32 v161, 2.0, v161, v8
  v_accvgpr_read_b32 v7, a230
  v_lshlrev_b32 v162, 16, v153
  v_and_b32 v7, s15, v7
  v_fma_f32 v162, 2.0, v162, v7
  v_accvgpr_read_b32 v8, a231
  v_and_b32 v163, s15, v153
  v_and_b32 v8, s15, v8
  v_fma_f32 v163, 2.0, v163, v8
  v_accvgpr_read_b32 v7, a232
  v_lshlrev_b32 v164, 16, v154
  v_and_b32 v7, s15, v7
  v_fma_f32 v164, 2.0, v164, v7
  v_accvgpr_read_b32 v8, a233
  v_and_b32 v165, s15, v154
  v_and_b32 v8, s15, v8
  v_fma_f32 v165, 2.0, v165, v8
  v_accvgpr_read_b32 v7, a234
  v_lshlrev_b32 v166, 16, v156
  v_and_b32 v7, s15, v7
  v_fma_f32 v166, 2.0, v166, v7
  v_accvgpr_read_b32 v8, a235
  v_and_b32 v167, s15, v156
  v_and_b32 v8, s15, v8
  v_fma_f32 v167, 2.0, v167, v8
  v_accvgpr_read_b32 v7, a236
  v_lshlrev_b32 v168, 16, v157
  v_and_b32 v7, s15, v7
  v_fma_f32 v168, 2.0, v168, v7
  v_accvgpr_read_b32 v8, a237
  v_and_b32 v169, s15, v157
  v_and_b32 v8, s15, v8
  v_fma_f32 v169, 2.0, v169, v8
  v_accvgpr_read_b32 v7, a238
  v_lshlrev_b32 v170, 16, v158
  v_and_b32 v7, s15, v7
  v_fma_f32 v170, 2.0, v170, v7
  v_accvgpr_read_b32 v8, a239
  v_and_b32 v171, s15, v158
  v_and_b32 v8, s15, v8
  v_fma_f32 v171, 2.0, v171, v8
  s_waitcnt lgkmcnt(0)
  v_add_f32 v112, v112, v64
  v_add_f32 v124, v124, v136
  v_add_f32 v113, v113, v65
  v_add_f32 v125, v125, v137
  v_add_f32 v114, v114, v66
  v_add_f32 v126, v126, v138
  v_add_f32 v115, v115, v67
  v_add_f32 v127, v127, v139
  v_add_f32 v116, v116, v80
  v_add_f32 v128, v128, v140
  v_add_f32 v117, v117, v81
  v_add_f32 v129, v129, v141
  v_add_f32 v118, v118, v82
  v_add_f32 v130, v130, v142
  v_add_f32 v119, v119, v83
  v_add_f32 v131, v131, v143
  v_add_f32 v120, v120, v96
  v_add_f32 v132, v132, v144
  v_add_f32 v121, v121, v97
  v_add_f32 v133, v133, v145
  v_add_f32 v122, v122, v98
  v_add_f32 v134, v134, v146
  v_add_f32 v123, v123, v99
  v_add_f32 v135, v135, v147
  v_add_f32 v112, v112, v124
  v_add_f32 v113, v113, v125
  v_add_f32 v114, v114, v126
  v_add_f32 v115, v115, v127
  v_add_f32 v116, v116, v128
  v_add_f32 v117, v117, v129
  v_add_f32 v118, v118, v130
  v_add_f32 v119, v119, v131
  v_add_f32 v120, v120, v132
  v_add_f32 v121, v121, v133
  v_add_f32 v122, v122, v134
  v_add_f32 v123, v123, v135
  s_waitcnt vmcnt(3)
  v_min3_u32 v7, v227, v231, v23
  v_min3_u32 v7, v7, v39, v55
  v_min3_u32 v7, v7, v27, v27
  v_max3_u32 v8, v227, v231, v23
  v_max3_u32 v8, v8, v39, v55
  v_max3_u32 v8, v8, v27, v27
  v_xor_b32 v7, s45, v7
  v_xor_b32 v8, s45, v8
  v_or_b32 v7, v7, v8
  v_cmp_ne_u32 vcc, 0, v7
  s_nop 1
  s_cmp_eq_u64 vcc, 0
  s_cbranch_scc0 POLL12
POLL12_OK:
  v_lshlrev_b32 v28, 16, v224
  v_lshlrev_b32 v7, 16, v20
  v_lshlrev_b32 v8, 16, v52
  v_add_f32 v28, v28, v7
  v_add_f32 v28, v28, v8
  v_and_b32 v29, s15, v224
  v_and_b32 v7, s15, v20
  v_and_b32 v8, s15, v52
  v_add_f32 v29, v29, v7
  v_add_f32 v29, v29, v8
  v_lshlrev_b32 v30, 16, v225
  v_lshlrev_b32 v7, 16, v21
  v_lshlrev_b32 v8, 16, v53
  v_add_f32 v30, v30, v7
  v_add_f32 v30, v30, v8
  v_and_b32 v31, s15, v225
  v_and_b32 v7, s15, v21
  v_and_b32 v8, s15, v53
  v_add_f32 v31, v31, v7
  v_add_f32 v31, v31, v8
  v_lshlrev_b32 v44, 16, v226
  v_lshlrev_b32 v7, 16, v22
  v_lshlrev_b32 v8, 16, v54
  v_add_f32 v44, v44, v7
  v_add_f32 v44, v44, v8
  v_and_b32 v45, s15, v226
  v_and_b32 v7, s15, v22
  v_and_b32 v8, s15, v54
  v_add_f32 v45, v45, v7
  v_add_f32 v45, v45, v8
  v_lshlrev_b32 v46, 16, v228
  v_lshlrev_b32 v7, 16, v36
  v_lshlrev_b32 v8, 16, v24
  v_add_f32 v46, v46, v7
  v_add_f32 v46, v46, v8
  v_and_b32 v47, s15, v228
  v_and_b32 v7, s15, v36
  v_and_b32 v8, s15, v24
  v_add_f32 v47, v47, v7
  v_add_f32 v47, v47, v8
  v_lshlrev_b32 v60, 16, v229
  v_lshlrev_b32 v7, 16, v37
  v_lshlrev_b32 v8, 16, v25
  v_add_f32 v60, v60, v7
  v_add_f32 v60, v60, v8
  v_and_b32 v61, s15, v229
  v_and_b32 v7, s15, v37
  v_and_b32 v8, s15, v25
  v_add_f32 v61, v61, v7
  v_add_f32 v61, v61, v8
  v_lshlrev_b32 v62, 16, v230
  v_lshlrev_b32 v7, 16, v38
  v_lshlrev_b32 v8, 16, v26
  v_add_f32 v62, v62, v7
  v_add_f32 v62, v62, v8
  v_and_b32 v63, s15, v230
  v_and_b32 v7, s15, v38
  v_and_b32 v8, s15, v26
  v_add_f32 v63, v63, v7
  v_add_f32 v63, v63, v8
  s_mov_b32 s52, 36864
  v_add_f32 v112, v112, v28
  v_add_f32 v113, v113, v29
  v_add_f32 v114, v114, v30
  v_add_f32 v115, v115, v31
  v_mul_f32 v124, s40, v112
  v_mul_f32 v125, s40, v113
  v_mul_f32 v126, s40, v114
  v_mul_f32 v127, s40, v115
  v_exp_f32 v124, v124
  v_exp_f32 v125, v125
  v_exp_f32 v126, v126
  v_exp_f32 v127, v127
  v_accvgpr_read_b32 v136, a228
  v_accvgpr_read_b32 v137, a229
  v_accvgpr_read_b32 v138, a230
  v_accvgpr_read_b32 v139, a231
  v_add_f32 v124, 1.0, v124
  v_add_f32 v125, 1.0, v125
  v_add_f32 v126, 1.0, v126
  v_add_f32 v127, 1.0, v127
  v_rcp_f32 v124, v124
  v_rcp_f32 v125, v125
  v_rcp_f32 v126, v126
  v_rcp_f32 v127, v127
  v_lshlrev_b32 v136, 16, v136
  v_lshlrev_b32 v137, 16, v137
  v_lshlrev_b32 v138, 16, v138
  v_lshlrev_b32 v139, 16, v139
  v_mul_f32 v112, v112, v124
  v_mul_f32 v113, v113, v125
  v_mul_f32 v114, v114, v126
  v_mul_f32 v115, v115, v127
  v_fma_f32 v136, v160, v112, v136
  v_fma_f32 v137, v161, v113, v137
  v_fma_f32 v138, v162, v114, v138
  v_fma_f32 v139, v163, v115, v139
  buffer_store_dword v136, v3, s[20:23], s52 offen offset:0
  buffer_store_dword v137, v3, s[20:23], s52 offen offset:2304
  buffer_store_dword v138, v4, s[20:23], s52 offen offset:0
  buffer_store_dword v139, v4, s[20:23], s52 offen offset:2304
  v_add_f32 v116, v116, v44
  v_add_f32 v117, v117, v45
  v_add_f32 v118, v118, v46
  v_add_f32 v119, v119, v47
  v_mul_f32 v128, s40, v116
  v_mul_f32 v129, s40, v117
  v_mul_f32 v130, s40, v118
  v_mul_f32 v131, s40, v119
  v_exp_f32 v128, v128
  v_exp_f32 v129, v129
  v_exp_f32 v130, v130
  v_exp_f32 v131, v131
  v_accvgpr_read_b32 v140, a232
  v_accvgpr_read_b32 v141, a233
  v_accvgpr_read_b32 v142, a234
  v_accvgpr_read_b32 v143, a235
  v_add_f32 v128, 1.0, v128
  v_add_f32 v129, 1.0, v129
  v_add_f32 v130, 1.0, v130
  v_add_f32 v131, 1.0, v131
  v_rcp_f32 v128, v128
  v_rcp_f32 v129, v129
  v_rcp_f32 v130, v130
  v_rcp_f32 v131, v131
  v_lshlrev_b32 v140, 16, v140
  v_lshlrev_b32 v141, 16, v141
  v_lshlrev_b32 v142, 16, v142
  v_lshlrev_b32 v143, 16, v143
  v_mul_f32 v116, v116, v128
  v_mul_f32 v117, v117, v129
  v_mul_f32 v118, v118, v130
  v_mul_f32 v119, v119, v131
  v_fma_f32 v140, v164, v116, v140
  v_fma_f32 v141, v165, v117, v141
  v_fma_f32 v142, v166, v118, v142
  v_fma_f32 v143, v167, v119, v143
  buffer_store_dword v140, v3, s[20:23], s52 offen offset:128
  buffer_store_dword v141, v3, s[20:23], s52 offen offset:2432
  buffer_store_dword v142, v4, s[20:23], s52 offen offset:128
  buffer_store_dword v143, v4, s[20:23], s52 offen offset:2432
  v_add_f32 v120, v120, v60
  v_add_f32 v121, v121, v61
  v_add_f32 v122, v122, v62
  v_add_f32 v123, v123, v63
  v_mul_f32 v132, s40, v120
  v_mul_f32 v133, s40, v121
  v_mul_f32 v134, s40, v122
  v_mul_f32 v135, s40, v123
  v_exp_f32 v132, v132
  v_exp_f32 v133, v133
  v_exp_f32 v134, v134
  v_exp_f32 v135, v135
  v_accvgpr_read_b32 v144, a236
  v_accvgpr_read_b32 v145, a237
  v_accvgpr_read_b32 v146, a238
  v_accvgpr_read_b32 v147, a239
  v_add_f32 v132, 1.0, v132
  v_add_f32 v133, 1.0, v133
  v_add_f32 v134, 1.0, v134
  v_add_f32 v135, 1.0, v135
  v_rcp_f32 v132, v132
  v_rcp_f32 v133, v133
  v_rcp_f32 v134, v134
  v_rcp_f32 v135, v135
  v_lshlrev_b32 v144, 16, v144
  v_lshlrev_b32 v145, 16, v145
  v_lshlrev_b32 v146, 16, v146
  v_lshlrev_b32 v147, 16, v147
  v_mul_f32 v120, v120, v132
  v_mul_f32 v121, v121, v133
  v_mul_f32 v122, v122, v134
  v_mul_f32 v123, v123, v135
  v_fma_f32 v144, v168, v120, v144
  v_fma_f32 v145, v169, v121, v145
  v_fma_f32 v146, v170, v122, v146
  v_fma_f32 v147, v171, v123, v147
  buffer_store_dword v144, v3, s[20:23], s52 offen offset:256
  buffer_store_dword v145, v3, s[20:23], s52 offen offset:2560
  buffer_store_dword v146, v4, s[20:23], s52 offen offset:256
  buffer_store_dword v147, v4, s[20:23], s52 offen offset:2560
  s_lshl_b32 s3, s48, 9
  s_add_u32 s3, s3, s55
  s_lshl_b32 s4, s30, 12
  s_add_u32 s3, s3, s4
  s_cmp_eq_u32 s3, 336
  s_cbranch_scc0 NOBUMP
  v_mov_b32 v14, 0
  v_mov_b32 v15, s45
  s_mov_b64 exec, 1
  buffer_store_dword v15, v14, s[8:11], 0 offen sc1
NOBUMP:
  s_endpgm
B_SSM:
  s_add_u32 s42, s53, 393216
  s_mov_b32 s56, 0
  s_mov_b32 s57, 2
  s_mov_b32 s58, 4
  s_mov_b32 s59, 6
  s_mov_b32 s60, 1
  s_mov_b32 s61, 3
  s_mov_b32 s62, 3
  s_mov_b32 s63, 3
  s_mov_b32 s31, 1
  s_mov_b32 s52, 0
  s_add_u32 m0, s51, 0
  s_nop 0
  buffer_load_dwordx4 v253, s[24:27], s49 offen offset:0 sc1 lds
  buffer_load_dwordx4 v254, s[24:27], s49 offen offset:1024 sc1 lds
  buffer_load_dwordx4 v255, s[24:27], s49 offen offset:2048 sc1 lds
  s_add_u32 s49, s49, s50
  s_add_u32 m0, s51, 3072
  s_nop 0
  buffer_load_dwordx4 v253, s[24:27], s49 offen offset:0 sc1 lds
  buffer_load_dwordx4 v254, s[24:27], s49 offen offset:1024 sc1 lds
  buffer_load_dwordx4 v255, s[24:27], s49 offen offset:2048 sc1 lds
  s_add_u32 s49, s49, s50
  s_add_u32 m0, s51, 6144
  s_nop 0
  buffer_load_dwordx4 v253, s[24:27], s49 offen offset:0 sc1 lds
  buffer_load_dwordx4 v254, s[24:27], s49 offen offset:1024 sc1 lds
  buffer_load_dwordx4 v255, s[24:27], s49 offen offset:2048 sc1 lds
  s_add_u32 s49, s49, s50
  s_mul_i32 s37, s46, 2949120
  s_mul_i32 s3, s48, 73728
  s_add_u32 s37, s37, s3
  s_add_u32 s37, s37, 8388608
  s_lshl_b32 s4, s30, 3
  v_add_u32 v14, s4, v0
  v_and_b32 v14, 31, v14
  v_and_b32 v15, 32, v0
  v_add_u32 v14, v14, v15
  s_mul_i32 s3, s30, 18432
  v_lshl_add_u32 v1, v14, 4, s3
  s_mul_i32 s55, s46, 48
  s_add_u32 s55, s55, s47
  s_lshl_b32 s3, s55, 13
  s_mul_i32 s4, s48, 3145728
  s_add_u32 s3, s3, s4
  s_add_u32 s39, s3, 33554432
  s_lshl_b32 s3, s30, 11
  v_lshl_add_u32 v13, v0, 4, s3
  s_sub_u32 s3, s30, 1
  s_and_b32 s3, s3, 3
  s_mul_i32 s3, s3, 9216
  s_add_u32 s3, s3, 73728
  v_lshl_add_u32 v10, v0, 4, s3
  s_sub_u32 s3, s30, 2
  s_and_b32 s3, s3, 3
  s_mul_i32 s3, s3, 9216
  s_add_u32 s3, s3, 76800
  v_lshl_add_u32 v11, v0, 4, s3
  s_sub_u32 s3, s30, 3
  s_and_b32 s3, s3, 3
  s_mul_i32 s3, s3, 9216
  s_add_u32 s3, s3, 79872
  v_lshl_add_u32 v12, v0, 4, s3
  s_mul_i32 s3, s30, 9216
  s_add_u32 s3, s3, 73728
  v_lshl_add_u32 v6, v0, 4, s3
  v_mov_b32 v5, v251
  ds_read_b128 a[72:75], v5 offset:0
  ds_read_b128 a[76:79], v5 offset:1024
  ds_read_b128 a[80:83], v5 offset:2048
  s_waitcnt vmcnt(9)
  s_barrier
  buffer_store_dword v250, v252, s[8:11], s42 offen sc1
  s_add_u32 m0, s51, 9216
  s_nop 0
  buffer_load_dwordx4 v253, s[24:27], s49 offen offset:0 sc1 lds
  buffer_load_dwordx4 v254, s[24:27], s49 offen offset:1024 sc1 lds
  buffer_load_dwordx4 v255, s[24:27], s49 offen offset:2048 sc1 lds
  s_add_u32 s49, s49, s50
  s_add_u32 m0, s51, 12288
  s_nop 0
  buffer_load_dwordx4 v253, s[24:27], s49 offen offset:0 sc1 lds
  buffer_load_dwordx4 v254, s[24:27], s49 offen offset:1024 sc1 lds
  buffer_load_dwordx4 v255, s[24:27], s49 offen offset:2048 sc1 lds
  s_add_u32 s49, s49, s50
  s_add_u32 m0, s51, 15360
  s_nop 0
  buffer_load_dwordx4 v253, s[24:27], s49 offen offset:0 sc1 lds
  buffer_load_dwordx4 v254, s[24:27], s49 offen offset:1024 sc1 lds
  buffer_load_dwordx4 v255, s[24:27], s49 offen offset:2048 sc1 lds
  s_add_u32 s49, s49, s50
  ds_read_b128 a[84:87], v5 offset:3072
  ds_read_b128 a[88:91], v5 offset:4096
  ds_read_b128 a[92:95], v5 offset:5120
  ds_read_b128 a[96:99], v5 offset:6144
  ds_read_b128 a[100:103], v5 offset:7168
  ds_read_b128 a[104:107], v5 offset:8192
  ds_read_b128 a[108:111], v5 offset:9216
  ds_read_b128 a[112:115], v5 offset:10240
  ds_read_b128 a[116:119], v5 offset:11264
  ds_read_b128 a[120:123], v5 offset:12288
  ds_read_b128 a[124:127], v5 offset:13312
  ds_read_b128 a[128:131], v5 offset:14336
  ds_read_b128 a[132:135], v5 offset:15360
  ds_read_b128 a[136:139], v5 offset:16384
  ds_read_b128 a[140:143], v5 offset:17408
  v_subrev_u32 v5, 73728, v251
  s_waitcnt lgkmcnt(0)
  v_cmp_ne_u32 vcc, s45, v8
  s_nop 1
  s_or_b32 s4, vcc_lo, vcc_hi
  s_and_b32 s4, s4, s54
  s_cmp_eq_u32 s4, 0
  s_cbranch_scc0 POLL13
POLL13_OK:
  s_waitcnt vmcnt(0)
  ds_read_b128 a[144:147], v5 offset:0
  ds_read_b128 a[148:151], v5 offset:1024
  ds_read_b128 a[152:155], v5 offset:2048
  ds_read_b128 a[156:159], v5 offset:3072
  ds_read_b128 a[160:163], v5 offset:4096
  ds_read_b128 a[164:167], v5 offset:5120
  ds_read_b128 a[168:171], v5 offset:6144
  ds_read_b128 a[172:175], v5 offset:7168
  ds_read_b128 a[176:179], v5 offset:8192
  ds_read_b128 a[180:183], v5 offset:9216
  ds_read_b128 a[184:187], v5 offset:10240
  ds_read_b128 a[188:191], v5 offset:11264
  ds_read_b128 a[192:195], v5 offset:12288
  ds_read_b128 a[196:199], v5 offset:13312
  ds_read_b128 a[200:203], v5 offset:14336
  ds_read_b128 a[204:207], v5 offset:15360
  ds_read_b128 a[208:211], v5 offset:16384
  ds_read_b128 a[212:215], v5 offset:17408
  s_waitcnt lgkmcnt(0)
B_SSM2:
  s_mul_i32 s41, s56, 368640
  s_add_u32 s41, s41, s37
  buffer_load_dwordx4 v[152:155], v1, s[8:11], s41 offen offset:0 sc1
  buffer_load_dwordx4 v[156:159], v1, s[8:11], s41 offen offset:1024 sc1
  buffer_load_dwordx4 v[160:163], v1, s[8:11], s41 offen offset:2048 sc1
  buffer_load_dwordx4 v[164:167], v1, s[8:11], s41 offen offset:3072 sc1
  s_add_u32 s41, s41, 4096
  buffer_load_dwordx4 v[168:171], v1, s[8:11], s41 offen offset:0 sc1
  buffer_load_dwordx4 v[172:175], v1, s[8:11], s41 offen offset:1024 sc1
  buffer_load_dwordx4 v[176:179], v1, s[8:11], s41 offen offset:2048 sc1
  buffer_load_dwordx4 v[180:183], v1, s[8:11], s41 offen offset:3072 sc1
  s_add_u32 s41, s41, 4096
  buffer_load_dwordx4 v[184:187], v1, s[8:11], s41 offen offset:0 sc1
  buffer_load_dwordx4 v[188:191], v1, s[8:11], s41 offen offset:1024 sc1
  s_add_u32 s12, s12, s52
  buffer_load_dword v8, v9, s[8:11], s12 offen sc1
  s_waitcnt vmcnt(10)
  v_mfma_f32_32x32x16_bf16 v[16:31], v[152:155], a[0:3], 0
  buffer_load_dwordx4 v[192:195], v1, s[8:11], s41 offen offset:2048 sc1
  v_mfma_f32_32x32x16_bf16 v[32:47], v[152:155], a[4:7], 0
  buffer_load_dwordx4 v[196:199], v1, s[8:11], s41 offen offset:3072 sc1
  v_mfma_f32_32x32x16_bf16 v[48:63], v[152:155], a[8:11], 0
  s_add_u32 s41, s41, 4096
  buffer_load_dwordx4 v[200:203], v1, s[8:11], s41 offen offset:0 sc1
  s_waitcnt vmcnt(12)
  v_mfma_f32_32x32x16_bf16 v[16:31], v[156:159], a[12:15], v[16:31]
  buffer_load_dwordx4 v[204:207], v1, s[8:11], s41 offen offset:1024 sc1
  v_mfma_f32_32x32x16_bf16 v[32:47], v[156:159], a[16:19], v[32:47]
  buffer_load_dwordx4 v[208:211], v1, s[8:11], s41 offen offset:2048 sc1
  v_mfma_f32_32x32x16_bf16 v[48:63], v[156:159], a[20:23], v[48:63]
  buffer_load_dwordx4 v[212:215], v1, s[8:11], s41 offen offset:3072 sc1
  s_waitcnt vmcnt(14)
  v_mfma_f32_32x32x16_bf16 v[16:31], v[160:163], a[24:27], v[16:31]
  s_add_u32 s41, s41, 4096
  buffer_load_dwordx4 v[216:219], v1, s[8:11], s41 offen offset:0 sc1
  v_mfma_f32_32x32x16_bf16 v[32:47], v[160:163], a[28:31], v[32:47]
  buffer_load_dwordx4 v[220:223], v1, s[8:11], s41 offen offset:1024 sc1
  v_mfma_f32_32x32x16_bf16 v[48:63], v[160:163], a[32:35], v[48:63]
  s_mul_i32 s41, s57, 368640
  s_add_u32 s41, s41, s37
  buffer_load_dwordx4 v[224:227], v1, s[8:11], s41 offen offset:0 sc1
  s_waitcnt vmcnt(16)
  v_mfma_f32_32x32x16_bf16 v[16:31], v[164:167], a[36:39], v[16:31]
  buffer_load_dwordx4 v[228:231], v1, s[8:11], s41 offen offset:1024 sc1
  v_mfma_f32_32x32x16_bf16 v[32:47], v[164:167], a[40:43], v[32:47]
  buffer_load_dwordx4 v[232:235], v1, s[8:11], s41 offen offset:2048 sc1
  v_mfma_f32_32x32x16_bf16 v[48:63], v[164:167], a[44:47], v[48:63]
  buffer_load_dwordx4 v[236:239], v1, s[8:11], s41 offen offset:3072 sc1
  s_barrier
  s_waitcnt vmcnt(18)
  v_mfma_f32_32x32x16_bf16 v[16:31], v[168:171], a[48:51], v[16:31]
  s_add_u32 s41, s41, 4096
  buffer_load_dwordx4 v[240:243], v1, s[8:11], s41 offen offset:0 sc1
  v_mfma_f32_32x32x16_bf16 v[32:47], v[168:171], a[52:55], v[32:47]
  buffer_load_dwordx4 v[244:247], v1, s[8:11], s41 offen offset:1024 sc1
  v_mfma_f32_32x32x16_bf16 v[48:63], v[168:171], a[56:59], v[48:63]
  buffer_load_dwordx4 v[152:155], v1, s[8:11], s41 offen offset:2048 sc1
  s_waitcnt vmcnt(20)
  v_mfma_f32_32x32x16_bf16 v[16:31], v[172:175], a[60:63], v[16:31]
  buffer_load_dwordx4 v[156:159], v1, s[8:11], s41 offen offset:3072 sc1
  v_mfma_f32_32x32x16_bf16 v[32:47], v[172:175], a[64:67], v[32:47]
  s_add_u32 s41, s41, 4096
  buffer_load_dwordx4 v[160:163], v1, s[8:11], s41 offen offset:0 sc1
  v_mfma_f32_32x32x16_bf16 v[48:63], v[172:175], a[68:71], v[48:63]
  buffer_load_dwordx4 v[164:167], v1, s[8:11], s41 offen offset:1024 sc1
  s_waitcnt vmcnt(22)
  v_mfma_f32_32x32x16_bf16 v[16:31], v[176:179], a[72:75], v[16:31]
  buffer_load_dwordx4 v[168:171], v1, s[8:11], s41 offen offset:2048 sc1
  v_mfma_f32_32x32x16_bf16 v[32:47], v[176:179], a[76:79], v[32:47]
  buffer_load_dwordx4 v[172:175], v1, s[8:11], s41 offen offset:3072 sc1
  v_mfma_f32_32x32x16_bf16 v[48:63], v[176:179], a[80:83], v[48:63]
  s_add_u32 s41, s41, 4096
  buffer_load_dwordx4 v[176:179], v1, s[8:11], s41 offen offset:0 sc1
  s_waitcnt vmcnt(24)
  v_mfma_f32_32x32x16_bf16 v[16:31], v[180:183], a[84:87], v[16:31]
  v_mfma_f32_32x32x16_bf16 v[32:47], v[180:183], a[88:91], v[32:47]
  v_mfma_f32_32x32x16_bf16 v[48:63], v[180:183], a[92:95], v[48:63]
  buffer_load_dwordx4 v[180:183], v1, s[8:11], s41 offen offset:1024 sc1
  s_waitcnt vmcnt(24)
  v_mfma_f32_32x32x16_bf16 v[16:31], v[184:187], a[96:99], v[16:31]
  v_mfma_f32_32x32x16_bf16 v[32:47], v[184:187], a[100:103], v[32:47]
  v_mfma_f32_32x32x16_bf16 v[48:63], v[184:187], a[104:107], v[48:63]
  buffer_load_dwordx4 v[184:187], v1, s[8:11], s41 offen offset:2048 sc1
  s_waitcnt vmcnt(24)
  v_mfma_f32_32x32x16_bf16 v[16:31], v[188:191], a[108:111], v[16:31]
  v_mfma_f32_32x32x16_bf16 v[32:47], v[188:191], a[112:115], v[32:47]
  v_mfma_f32_32x32x16_bf16 v[48:63], v[188:191], a[116:119], v[48:63]
  buffer_load_dwordx4 v[188:191], v1, s[8:11], s41 offen offset:3072 sc1
  s_waitcnt vmcnt(23)
  v_mfma_f32_32x32x16_bf16 v[16:31], v[192:195], a[120:123], v[16:31]
  v_mfma_f32_32x32x16_bf16 v[32:47], v[192:195], a[124:127], v[32:47]
  v_mfma_f32_32x32x16_bf16 v[48:63], v[192:195], a[128:131], v[48:63]
  s_add_u32 s41, s41, 4096
  buffer_load_dwordx4 v[192:195], v1, s[8:11], s41 offen offset:0 sc1
  v_cmp_ne_u32 vcc, s45, v8
  s_nop 1
  s_or_b32 s4, vcc_lo, vcc_hi
  s_and_b32 s4, s4, s54
  s_cmp_eq_u32 s4, 0
  s_cbranch_scc0 POLL14
POLL14_OK:
  s_waitcnt vmcnt(23)
  v_mfma_f32_32x32x16_bf16 v[16:31], v[196:199], a[132:135], v[16:31]
  v_mfma_f32_32x32x16_bf16 v[32:47], v[196:199], a[136:139], v[32:47]
  v_mfma_f32_32x32x16_bf16 v[48:63], v[196:199], a[140:143], v[48:63]
  buffer_load_dwordx4 v[196:199], v1, s[8:11], s41 offen offset:1024 sc1
  s_waitcnt vmcnt(23)
  v_mfma_f32_32x32x16_bf16 v[16:31], v[200:203], a[144:147], v[16:31]
  v_mfma_f32_32x32x16_bf16 v[32:47], v[200:203], a[148:151], v[32:47]
  v_mfma_f32_32x32x16_bf16 v[48:63], v[200:203], a[152:155], v[48:63]
  s_mul_i32 s41, s58, 368640
  s_add_u32 s41, s41, s37
  buffer_load_dwordx4 v[200:203], v1, s[8:11], s41 offen offset:0 sc1
  s_waitcnt vmcnt(23)
  v_mfma_f32_32x32x16_bf16 v[16:31], v[204:207], a[156:159], v[16:31]
  v_mfma_f32_32x32x16_bf16 v[32:47], v[204:207], a[160:163], v[32:47]
  v_mfma_f32_32x32x16_bf16 v[48:63], v[204:207], a[164:167], v[48:63]
  buffer_load_dwordx4 v[204:207], v1, s[8:11], s41 offen offset:1024 sc1
  s_waitcnt vmcnt(23)
  v_mfma_f32_32x32x16_bf16 v[16:31], v[208:211], a[168:171], v[16:31]
  v_mfma_f32_32x32x16_bf16 v[32:47], v[208:211], a[172:175], v[32:47]
  v_mfma_f32_32x32x16_bf16 v[48:63], v[208:211], a[176:179], v[48:63]
  buffer_load_dwordx4 v[208:211], v1, s[8:11], s41 offen offset:2048 sc1
  s_waitcnt vmcnt(23)
  v_mfma_f32_32x32x16_bf16 v[16:31], v[212:215], a[180:183], v[16:31]
  v_mfma_f32_32x32x16_bf16 v[32:47], v[212:215], a[184:187], v[32:47]
  v_mfma_f32_32x32x16_bf16 v[48:63], v[212:215], a[188:191], v[48:63]
  buffer_load_dwordx4 v[212:215], v1, s[8:11], s41 offen offset:3072 sc1
  s_waitcnt vmcnt(23)
  v_mfma_f32_32x32x16_bf16 v[16:31], v[216:219], a[192:195], v[16:31]
  v_mfma_f32_32x32x16_bf16 v[32:47], v[216:219], a[196:199], v[32:47]
  v_mfma_f32_32x32x16_bf16 v[48:63], v[216:219], a[200:203], v[48:63]
  s_add_u32 s41, s41, 4096
  buffer_load_dwordx4 v[216:219], v1, s[8:11], s41 offen offset:0 sc1
  s_waitcnt vmcnt(23)
  v_mfma_f32_32x32x16_bf16 v[16:31], v[220:223], a[204:207], v[16:31]
  v_mfma_f32_32x32x16_bf16 v[32:47], v[220:223], a[208:211], v[32:47]
  v_mfma_f32_32x32x16_bf16 v[48:63], v[220:223], a[212:215], v[48:63]
  buffer_load_dwordx4 v[220:223], v1, s[8:11], s41 offen offset:1024 sc1
  s_waitcnt vmcnt(23)
  v_mfma_f32_32x32x16_bf16 v[64:79], v[224:227], a[0:3], 0
  v_mfma_f32_32x32x16_bf16 v[80:95], v[224:227], a[4:7], 0
  s_nop 5
  ds_write_b128 v6, v[20:23] offset:0
  v_mfma_f32_32x32x16_bf16 v[96:111], v[224:227], a[8:11], 0
  buffer_load_dwordx4 v[224:227], v1, s[8:11], s41 offen offset:2048 sc1
  s_waitcnt vmcnt(23)
  v_mfma_f32_32x32x16_bf16 v[64:79], v[228:231], a[12:15], v[64:79]
  ds_write_b128 v6, v[36:39] offset:1024
  v_mfma_f32_32x32x16_bf16 v[80:95], v[228:231], a[16:19], v[80:95]
  v_mfma_f32_32x32x16_bf16 v[96:111], v[228:231], a[20:23], v[96:111]
  buffer_load_dwordx4 v[228:231], v1, s[8:11], s41 offen offset:3072 sc1
  s_waitcnt vmcnt(23)
  v_mfma_f32_32x32x16_bf16 v[64:79], v[232:235], a[24:27], v[64:79]
  ds_write_b128 v6, v[52:55] offset:2048
  v_mfma_f32_32x32x16_bf16 v[80:95], v[232:235], a[28:31], v[80:95]
  v_mfma_f32_32x32x16_bf16 v[96:111], v[232:235], a[32:35], v[96:111]
  s_add_u32 s41, s41, 4096
  buffer_load_dwordx4 v[232:235], v1, s[8:11], s41 offen offset:0 sc1
  s_waitcnt vmcnt(23)
  v_mfma_f32_32x32x16_bf16 v[64:79], v[236:239], a[36:39], v[64:79]
  ds_write_b128 v6, v[24:27] offset:3072
  v_mfma_f32_32x32x16_bf16 v[80:95], v[236:239], a[40:43], v[80:95]
  v_mfma_f32_32x32x16_bf16 v[96:111], v[236:239], a[44:47], v[96:111]
  buffer_load_dwordx4 v[236:239], v1, s[8:11], s41 offen offset:1024 sc1
  s_waitcnt vmcnt(23)
  v_mfma_f32_32x32x16_bf16 v[64:79], v[240:243], a[48:51], v[64:79]
  ds_write_b128 v6, v[40:43] offset:4096
  v_mfma_f32_32x32x16_bf16 v[80:95], v[240:243], a[52:55], v[80:95]
  v_mfma_f32_32x32x16_bf16 v[96:111], v[240:243], a[56:59], v[96:111]
  buffer_load_dwordx4 v[240:243], v1, s[8:11], s41 offen offset:2048 sc1
  s_waitcnt vmcnt(23)
  v_mfma_f32_32x32x16_bf16 v[64:79], v[244:247], a[60:63], v[64:79]
  ds_write_b128 v6, v[56:59] offset:5120
  v_mfma_f32_32x32x16_bf16 v[80:95], v[244:247], a[64:67], v[80:95]
  v_mfma_f32_32x32x16_bf16 v[96:111], v[244:247], a[68:71], v[96:111]
  buffer_load_dwordx4 v[244:247], v1, s[8:11], s41 offen offset:3072 sc1
  s_waitcnt vmcnt(23)
  v_mfma_f32_32x32x16_bf16 v[64:79], v[152:155], a[72:75], v[64:79]
  ds_write_b128 v6, v[28:31] offset:6144
  v_mfma_f32_32x32x16_bf16 v[80:95], v[152:155], a[76:79], v[80:95]
  v_mfma_f32_32x32x16_bf16 v[96:111], v[152:155], a[80:83], v[96:111]
  s_add_u32 s41, s41, 4096
  buffer_load_dwordx4 v[152:155], v1, s[8:11], s41 offen offset:0 sc1
  s_waitcnt vmcnt(23)
  v_mfma_f32_32x32x16_bf16 v[64:79], v[156:159], a[84:87], v[64:79]
  ds_write_b128 v6, v[44:47] offset:7168
  v_mfma_f32_32x32x16_bf16 v[80:95], v[156:159], a[88:91], v[80:95]
  v_mfma_f32_32x32x16_bf16 v[96:111], v[156:159], a[92:95], v[96:111]
  buffer_load_dwordx4 v[156:159], v1, s[8:11], s41 offen offset:1024 sc1
  s_waitcnt vmcnt(23)
  v_mfma_f32_32x32x16_bf16 v[64:79], v[160:163], a[96:99], v[64:79]
  ds_write_b128 v6, v[60:63] offset:8192
  v_mfma_f32_32x32x16_bf16 v[80:95], v[160:163], a[100:103], v[80:95]
  v_mfma_f32_32x32x16_bf16 v[96:111], v[160:163], a[104:107], v[96:111]
  buffer_load_dwordx4 v[160:163], v1, s[8:11], s41 offen offset:2048 sc1
  s_waitcnt lgkmcnt(0)
  s_barrier
  ds_read_b128 v[112:115], v10 offset:0
  s_waitcnt vmcnt(23)
  v_mfma_f32_32x32x16_bf16 v[64:79], v[164:167], a[108:111], v[64:79]
  ds_read_b128 v[116:119], v10 offset:1024
  ds_read_b128 v[120:123], v10 offset:2048
  ds_read_b128 v[124:127], v11 offset:0
  ds_read_b128 v[128:131], v11 offset:1024
  ds_read_b128 v[132:135], v11 offset:2048
  ds_read_b128 v[136:139], v12 offset:0
  v_mfma_f32_32x32x16_bf16 v[80:95], v[164:167], a[112:115], v[80:95]
  ds_read_b128 v[140:143], v12 offset:1024
  ds_read_b128 v[144:147], v12 offset:2048
  v_mfma_f32_32x32x16_bf16 v[96:111], v[164:167], a[116:119], v[96:111]
  buffer_load_dwordx4 v[164:167], v1, s[8:11], s41 offen offset:3072 sc1
  s_waitcnt vmcnt(23)
  v_mfma_f32_32x32x16_bf16 v[64:79], v[168:171], a[120:123], v[64:79]
  v_mfma_f32_32x32x16_bf16 v[80:95], v[168:171], a[124:127], v[80:95]
  v_mfma_f32_32x32x16_bf16 v[96:111], v[168:171], a[128:131], v[96:111]
  s_add_u32 s41, s41, 4096
  buffer_load_dwordx4 v[168:171], v1, s[8:11], s41 offen offset:0 sc1
  s_waitcnt lgkmcnt(0)
  v_add_f32 v112, v112, v16
  s_waitcnt vmcnt(23)
  v_mfma_f32_32x32x16_bf16 v[64:79], v[172:175], a[132:135], v[64:79]
  v_add_f32 v124, v124, v136
  v_add_f32 v113, v113, v17
  v_add_f32 v125, v125, v137
  v_add_f32 v114, v114, v18
  v_add_f32 v126, v126, v138
  v_add_f32 v115, v115, v19
  v_mfma_f32_32x32x16_bf16 v[80:95], v[172:175], a[136:139], v[80:95]
  v_add_f32 v127, v127, v139
  v_add_f32 v116, v116, v32
  v_add_f32 v128, v128, v140
  v_add_f32 v117, v117, v33
  v_add_f32 v129, v129, v141
  v_add_f32 v118, v118, v34
  v_mfma_f32_32x32x16_bf16 v[96:111], v[172:175], a[140:143], v[96:111]
  buffer_load_dwordx4 v[172:175], v1, s[8:11], s41 offen offset:1024 sc1
  v_add_f32 v130, v130, v142
  v_add_f32 v119, v119, v35
  v_add_f32 v131, v131, v143
  s_waitcnt vmcnt(23)
  v_mfma_f32_32x32x16_bf16 v[64:79], v[176:179], a[144:147], v[64:79]
  v_add_f32 v120, v120, v48
  v_add_f32 v132, v132, v144
  v_add_f32 v121, v121, v49
  v_add_f32 v133, v133, v145
  v_add_f32 v122, v122, v50
  v_add_f32 v134, v134, v146
  v_mfma_f32_32x32x16_bf16 v[80:95], v[176:179], a[148:151], v[80:95]
  v_add_f32 v123, v123, v51
  v_add_f32 v135, v135, v147
  v_add_f32 v112, v112, v124
  v_add_f32 v113, v113, v125
  v_add_f32 v114, v114, v126
  v_add_f32 v115, v115, v127
  v_mfma_f32_32x32x16_bf16 v[96:111], v[176:179], a[152:155], v[96:111]
  s_mul_i32 s41, s59, 368640
  s_add_u32 s41, s41, s37
  buffer_load_dwordx4 v[176:179], v1, s[8:11], s41 offen offset:0 sc1
  v_add_f32 v116, v116, v128
  s_waitcnt vmcnt(23)
  v_mfma_f32_32x32x16_bf16 v[64:79], v[180:183], a[156:159], v[64:79]
  v_add_f32 v117, v117, v129
  v_add_f32 v118, v118, v130
  v_add_f32 v119, v119, v131
  v_add_f32 v120, v120, v132
  v_add_f32 v121, v121, v133
  v_add_f32 v122, v122, v134
  v_mfma_f32_32x32x16_bf16 v[80:95], v[180:183], a[160:163], v[80:95]
  v_add_f32 v123, v123, v135
  v_cvt_pk_bf16_f32 v136, v112, v113
  v_cvt_pk_bf16_f32 v137, v114, v115
  v_cvt_pk_bf16_f32 v138, v116, v117
  v_cvt_pk_bf16_f32 v140, v118, v119
  v_cvt_pk_bf16_f32 v141, v120, v121
  v_mfma_f32_32x32x16_bf16 v[96:111], v[180:183], a[164:167], v[96:111]
  buffer_load_dwordx4 v[180:183], v1, s[8:11], s41 offen offset:1024 sc1
  v_cvt_pk_bf16_f32 v142, v122, v123
  v_mov_b32 v139, s45
  v_mov_b32 v143, s45
  s_waitcnt vmcnt(23)
  v_mfma_f32_32x32x16_bf16 v[64:79], v[184:187], a[168:171], v[64:79]
  s_mul_i32 s42, s56, 49152
  s_add_u32 s42, s42, s39
  buffer_store_dwordx4 v[136:139], v13, s[8:11], s42 offen offset:0 sc1
  v_mfma_f32_32x32x16_bf16 v[80:95], v[184:187], a[172:175], v[80:95]
  v_mfma_f32_32x32x16_bf16 v[96:111], v[184:187], a[176:179], v[96:111]
  buffer_load_dwordx4 v[184:187], v1, s[8:11], s41 offen offset:2048 sc1
  buffer_store_dwordx4 v[140:143], v13, s[8:11], s42 offen offset:1024 sc1
  s_waitcnt vmcnt(25)
  v_mfma_f32_32x32x16_bf16 v[64:79], v[188:191], a[180:183], v[64:79]
  v_mfma_f32_32x32x16_bf16 v[80:95], v[188:191], a[184:187], v[80:95]
  v_mfma_f32_32x32x16_bf16 v[96:111], v[188:191], a[188:191], v[96:111]
  buffer_load_dwordx4 v[188:191], v1, s[8:11], s41 offen offset:3072 sc1
  s_waitcnt vmcnt(25)
  v_mfma_f32_32x32x16_bf16 v[64:79], v[192:195], a[192:195], v[64:79]
  v_mfma_f32_32x32x16_bf16 v[80:95], v[192:195], a[196:199], v[80:95]
  v_mfma_f32_32x32x16_bf16 v[96:111], v[192:195], a[200:203], v[96:111]
  s_add_u32 s41, s41, 4096
  buffer_load_dwordx4 v[192:195], v1, s[8:11], s41 offen offset:0 sc1
  s_waitcnt vmcnt(25)
  v_mfma_f32_32x32x16_bf16 v[64:79], v[196:199], a[204:207], v[64:79]
  v_mfma_f32_32x32x16_bf16 v[80:95], v[196:199], a[208:211], v[80:95]
  v_mfma_f32_32x32x16_bf16 v[96:111], v[196:199], a[212:215], v[96:111]
  buffer_load_dwordx4 v[196:199], v1, s[8:11], s41 offen offset:1024 sc1
  s_add_u32 s12, s12, s52
  buffer_load_dword v8, v9, s[8:11], s12 offen sc1
  s_waitcnt vmcnt(26)
  v_mfma_f32_32x32x16_bf16 v[16:31], v[200:203], a[0:3], 0
  v_mfma_f32_32x32x16_bf16 v[32:47], v[200:203], a[4:7], 0
  s_nop 3
  ds_write_b128 v6, v[68:71] offset:36864
  v_mfma_f32_32x32x16_bf16 v[48:63], v[200:203], a[8:11], 0
  buffer_load_dwordx4 v[200:203], v1, s[8:11], s41 offen offset:2048 sc1
  s_waitcnt vmcnt(26)
  v_mfma_f32_32x32x16_bf16 v[16:31], v[204:207], a[12:15], v[16:31]
  ds_write_b128 v6, v[84:87] offset:37888
  v_mfma_f32_32x32x16_bf16 v[32:47], v[204:207], a[16:19], v[32:47]
  v_mfma_f32_32x32x16_bf16 v[48:63], v[204:207], a[20:23], v[48:63]
  buffer_load_dwordx4 v[204:207], v1, s[8:11], s41 offen offset:3072 sc1
  s_waitcnt vmcnt(26)
  v_mfma_f32_32x32x16_bf16 v[16:31], v[208:211], a[24:27], v[16:31]
  ds_write_b128 v6, v[100:103] offset:38912
  v_mfma_f32_32x32x16_bf16 v[32:47], v[208:211], a[28:31], v[32:47]
  v_mfma_f32_32x32x16_bf16 v[48:63], v[208:211], a[32:35], v[48:63]
  s_add_u32 s41, s41, 4096
  buffer_load_dwordx4 v[208:211], v1, s[8:11], s41 offen offset:0 sc1
  s_waitcnt vmcnt(26)
  v_mfma_f32_32x32x16_bf16 v[16:31], v[212:215], a[36:39], v[16:31]
  ds_write_b128 v6, v[72:75] offset:39936
  v_mfma_f32_32x32x16_bf16 v[32:47], v[212:215], a[40:43], v[32:47]
  v_mfma_f32_32x32x16_bf16 v[48:63], v[212:215], a[44:47], v[48:63]
  buffer_load_dwordx4 v[212:215], v1, s[8:11], s41 offen offset:1024 sc1
  s_waitcnt vmcnt(26)
  v_mfma_f32_32x32x16_bf16 v[16:31], v[216:219], a[48:51], v[16:31]
  ds_write_b128 v6, v[88:91] offset:40960
  v_mfma_f32_32x32x16_bf16 v[32:47], v[216:219], a[52:55], v[32:47]
  v_mfma_f32_32x32x16_bf16 v[48:63], v[216:219], a[56:59], v[48:63]
  buffer_load_dwordx4 v[216:219], v1, s[8:11], s41 offen offset:2048 sc1
  s_waitcnt vmcnt(26)
  v_mfma_f32_32x32x16_bf16 v[16:31], v[220:223], a[60:63], v[16:31]
  ds_write_b128 v6, v[104:107] offset:41984
  v_mfma_f32_32x32x16_bf16 v[32:47], v[220:223], a[64:67], v[32:47]
  v_mfma_f32_32x32x16_bf16 v[48:63], v[220:223], a[68:71], v[48:63]
  buffer_load_dwordx4 v[220:223], v1, s[8:11], s41 offen offset:3072 sc1
  s_waitcnt vmcnt(26)
  v_mfma_f32_32x32x16_bf16 v[16:31], v[224:227], a[72:75], v[16:31]
  ds_write_b128 v6, v[76:79] offset:43008
  v_mfma_f32_32x32x16_bf16 v[32:47], v[224:227], a[76:79], v[32:47]
  v_mfma_f32_32x32x16_bf16 v[48:63], v[224:227], a[80:83], v[48:63]
  s_add_u32 s41, s41, 4096
  buffer_load_dwordx4 v[224:227], v1, s[8:11], s41 offen offset:0 sc1
  s_waitcnt vmcnt(26)
  v_mfma_f32_32x32x16_bf16 v[16:31], v[228:231], a[84:87], v[16:31]
  ds_write_b128 v6, v[92:95] offset:44032
  v_mfma_f32_32x32x16_bf16 v[32:47], v[228:231], a[88:91], v[32:47]
  v_mfma_f32_32x32x16_bf16 v[48:63], v[228:231], a[92:95], v[48:63]
  buffer_load_dwordx4 v[228:231], v1, s[8:11], s41 offen offset:1024 sc1
  s_waitcnt vmcnt(26)
  v_mfma_f32_32x32x16_bf16 v[16:31], v[232:235], a[96:99], v[16:31]
  ds_write_b128 v6, v[108:111] offset:45056
  v_mfma_f32_32x32x16_bf16 v[32:47], v[232:235], a[100:103], v[32:47]
  v_mfma_f32_32x32x16_bf16 v[48:63], v[232:235], a[104:107], v[48:63]
  buffer_load_dwordx4 v[232:235], v1, s[8:11], s41 offen offset:2048 sc1
  s_waitcnt lgkmcnt(0)
  s_barrier
  ds_read_b128 v[112:115], v10 offset:36864
  s_waitcnt vmcnt(26)
  v_mfma_f32_32x32x16_bf16 v[16:31], v[236:239], a[108:111], v[16:31]
  ds_read_b128 v[116:119], v10 offset:37888
  ds_read_b128 v[120:123], v10 offset:38912
  ds_read_b128 v[124:127], v11 offset:36864
  ds_read_b128 v[128:131], v11 offset:37888
  ds_read_b128 v[132:135], v11 offset:38912
  ds_read_b128 v[136:139], v12 offset:36864
  v_mfma_f32_32x32x16_bf16 v[32:47], v[236:239], a[112:115], v[32:47]
  ds_read_b128 v[140:143], v12 offset:37888
  ds_read_b128 v[144:147], v12 offset:38912
  v_mfma_f32_32x32x16_bf16 v[48:63], v[236:239], a[116:119], v[48:63]
  buffer_load_dwordx4 v[236:239], v1, s[8:11], s41 offen offset:3072 sc1
  s_waitcnt vmcnt(26)
  v_mfma_f32_32x32x16_bf16 v[16:31], v[240:243], a[120:123], v[16:31]
  v_mfma_f32_32x32x16_bf16 v[32:47], v[240:243], a[124:127], v[32:47]
  v_mfma_f32_32x32x16_bf16 v[48:63], v[240:243], a[128:131], v[48:63]
  s_add_u32 s41, s41, 4096
  buffer_load_dwordx4 v[240:243], v1, s[8:11], s41 offen offset:0 sc1
  s_waitcnt vmcnt(11)
  v_cmp_ne_u32 vcc, s45, v8
  s_nop 1
  s_or_b32 s4, vcc_lo, vcc_hi
  s_and_b32 s4, s4, s54
  s_cmp_eq_u32 s4, 0
  s_cbranch_scc0 POLL15
POLL15_OK:
  v_mfma_f32_32x32x16_bf16 v[16:31], v[244:247], a[132:135], v[16:31]
  s_waitcnt lgkmcnt(0)
  v_add_f32 v112, v112, v64
  v_add_f32 v124, v124, v136
  v_add_f32 v113, v113, v65
  v_add_f32 v125, v125, v137
  v_add_f32 v114, v114, v66
  v_mfma_f32_32x32x16_bf16 v[32:47], v[244:247], a[136:139], v[32:47]
  v_add_f32 v126, v126, v138
  v_add_f32 v115, v115, v67
  v_add_f32 v127, v127, v139
  v_add_f32 v116, v116, v80
  v_add_f32 v128, v128, v140
  v_add_f32 v117, v117, v81
  v_mfma_f32_32x32x16_bf16 v[48:63], v[244:247], a[140:143], v[48:63]
  buffer_load_dwordx4 v[244:247], v1, s[8:11], s41 offen offset:1024 sc1
  v_add_f32 v129, v129, v141
  v_add_f32 v118, v118, v82
  v_add_f32 v130, v130, v142
  v_add_f32 v119, v119, v83
  v_mfma_f32_32x32x16_bf16 v[16:31], v[152:155], a[144:147], v[16:31]
  v_add_f32 v131, v131, v143
  v_add_f32 v120, v120, v96
  v_add_f32 v132, v132, v144
  v_add_f32 v121, v121, v97
  v_add_f32 v133, v133, v145
  v_add_f32 v122, v122, v98
  v_mfma_f32_32x32x16_bf16 v[32:47], v[152:155], a[148:151], v[32:47]
  v_add_f32 v134, v134, v146
  v_add_f32 v123, v123, v99
  v_add_f32 v135, v135, v147
  v_add_f32 v112, v112, v124
  v_add_f32 v113, v113, v125
  v_add_f32 v114, v114, v126
  v_mfma_f32_32x32x16_bf16 v[48:63], v[152:155], a[152:155], v[48:63]
  s_mul_i32 s41, s60, 368640
  s_add_u32 s41, s41, s37
  buffer_load_dwordx4 v[152:155], v1, s[8:11], s41 offen offset:0 sc1
  v_add_f32 v115, v115, v127
  v_add_f32 v116, v116, v128
  v_mfma_f32_32x32x16_bf16 v[16:31], v[156:159], a[156:159], v[16:31]
  v_add_f32 v117, v117, v129
  v_add_f32 v118, v118, v130
  v_add_f32 v119, v119, v131
  v_add_f32 v120, v120, v132
  v_add_f32 v121, v121, v133
  v_add_f32 v122, v122, v134
  v_mfma_f32_32x32x16_bf16 v[32:47], v[156:159], a[160:163], v[32:47]
  v_add_f32 v123, v123, v135
  v_cvt_pk_bf16_f32 v136, v112, v113
  v_cvt_pk_bf16_f32 v137, v114, v115
  v_cvt_pk_bf16_f32 v138, v116, v117
  v_cvt_pk_bf16_f32 v140, v118, v119
  v_cvt_pk_bf16_f32 v141, v120, v121
  v_mfma_f32_32x32x16_bf16 v[48:63], v[156:159], a[164:167], v[48:63]
  buffer_load_dwordx4 v[156:159], v1, s[8:11], s41 offen offset:1024 sc1
  v_cvt_pk_bf16_f32 v142, v122, v123
  v_mov_b32 v139, s45
  v_mov_b32 v143, s45
  s_mul_i32 s42, s57, 49152
  v_mfma_f32_32x32x16_bf16 v[16:31], v[160:163], a[168:171], v[16:31]
  s_add_u32 s42, s42, s39
  buffer_store_dwordx4 v[136:139], v13, s[8:11], s42 offen offset:0 sc1
  v_mfma_f32_32x32x16_bf16 v[32:47], v[160:163], a[172:175], v[32:47]
  v_mfma_f32_32x32x16_bf16 v[48:63], v[160:163], a[176:179], v[48:63]
  buffer_load_dwordx4 v[160:163], v1, s[8:11], s41 offen offset:2048 sc1
  buffer_store_dwordx4 v[140:143], v13, s[8:11], s42 offen offset:1024 sc1
  v_mfma_f32_32x32x16_bf16 v[16:31], v[164:167], a[180:183], v[16:31]
  v_mfma_f32_32x32x16_bf16 v[32:47], v[164:167], a[184:187], v[32:47]
  v_mfma_f32_32x32x16_bf16 v[48:63], v[164:167], a[188:191], v[48:63]
  buffer_load_dwordx4 v[164:167], v1, s[8:11], s41 offen offset:3072 sc1
  v_mfma_f32_32x32x16_bf16 v[16:31], v[168:171], a[192:195], v[16:31]
  v_mfma_f32_32x32x16_bf16 v[32:47], v[168:171], a[196:199], v[32:47]
  v_mfma_f32_32x32x16_bf16 v[48:63], v[168:171], a[200:203], v[48:63]
  s_add_u32 s41, s41, 4096
  buffer_load_dwordx4 v[168:171], v1, s[8:11], s41 offen offset:0 sc1
  v_mfma_f32_32x32x16_bf16 v[16:31], v[172:175], a[204:207], v[16:31]
  v_mfma_f32_32x32x16_bf16 v[32:47], v[172:175], a[208:211], v[32:47]
  v_mfma_f32_32x32x16_bf16 v[48:63], v[172:175], a[212:215], v[48:63]
  buffer_load_dwordx4 v[172:175], v1, s[8:11], s41 offen offset:1024 sc1
  v_mfma_f32_32x32x16_bf16 v[64:79], v[176:179], a[0:3], 0
  v_mfma_f32_32x32x16_bf16 v[80:95], v[176:179], a[4:7], 0
  s_nop 6
  ds_write_b128 v6, v[20:23] offset:0
  v_mfma_f32_32x32x16_bf16 v[96:111], v[176:179], a[8:11], 0
  buffer_load_dwordx4 v[176:179], v1, s[8:11], s41 offen offset:2048 sc1
  v_mfma_f32_32x32x16_bf16 v[64:79], v[180:183], a[12:15], v[64:79]
  ds_write_b128 v6, v[36:39] offset:1024
  v_mfma_f32_32x32x16_bf16 v[80:95], v[180:183], a[16:19], v[80:95]
  v_mfma_f32_32x32x16_bf16 v[96:111], v[180:183], a[20:23], v[96:111]
  buffer_load_dwordx4 v[180:183], v1, s[8:11], s41 offen offset:3072 sc1
  v_mfma_f32_32x32x16_bf16 v[64:79], v[184:187], a[24:27], v[64:79]
  ds_write_b128 v6, v[52:55] offset:2048
  v_mfma_f32_32x32x16_bf16 v[80:95], v[184:187], a[28:31], v[80:95]
  v_mfma_f32_32x32x16_bf16 v[96:111], v[184:187], a[32:35], v[96:111]
  s_add_u32 s41, s41, 4096
  buffer_load_dwordx4 v[184:187], v1, s[8:11], s41 offen offset:0 sc1
  v_mfma_f32_32x32x16_bf16 v[64:79], v[188:191], a[36:39], v[64:79]
  ds_write_b128 v6, v[24:27] offset:3072
  v_mfma_f32_32x32x16_bf16 v[80:95], v[188:191], a[40:43], v[80:95]
  v_mfma_f32_32x32x16_bf16 v[96:111], v[188:191], a[44:47], v[96:111]
  buffer_load_dwordx4 v[188:191], v1, s[8:11], s41 offen offset:1024 sc1
  v_mfma_f32_32x32x16_bf16 v[64:79], v[192:195], a[48:51], v[64:79]
  ds_write_b128 v6, v[40:43] offset:4096
  v_mfma_f32_32x32x16_bf16 v[80:95], v[192:195], a[52:55], v[80:95]
  v_mfma_f32_32x32x16_bf16 v[96:111], v[192:195], a[56:59], v[96:111]
  buffer_load_dwordx4 v[192:195], v1, s[8:11], s41 offen offset:2048 sc1
  v_mfma_f32_32x32x16_bf16 v[64:79], v[196:199], a[60:63], v[64:79]
  ds_write_b128 v6, v[56:59] offset:5120
  v_mfma_f32_32x32x16_bf16 v[80:95], v[196:199], a[64:67], v[80:95]
  v_mfma_f32_32x32x16_bf16 v[96:111], v[196:199], a[68:71], v[96:111]
  buffer_load_dwordx4 v[196:199], v1, s[8:11], s41 offen offset:3072 sc1
  s_waitcnt vmcnt(25)
  v_mfma_f32_32x32x16_bf16 v[64:79], v[200:203], a[72:75], v[64:79]
  ds_write_b128 v6, v[28:31] offset:6144
  v_mfma_f32_32x32x16_bf16 v[80:95], v[200:203], a[76:79], v[80:95]
  v_mfma_f32_32x32x16_bf16 v[96:111], v[200:203], a[80:83], v[96:111]
  s_add_u32 s41, s41, 4096
  buffer_load_dwordx4 v[200:203], v1, s[8:11], s41 offen offset:0 sc1
  s_waitcnt vmcnt(25)
  v_mfma_f32_32x32x16_bf16 v[64:79], v[204:207], a[84:87], v[64:79]
  ds_write_b128 v6, v[44:47] offset:7168
  v_mfma_f32_32x32x16_bf16 v[80:95], v[204:207], a[88:91], v[80:95]
  v_mfma_f32_32x32x16_bf16 v[96:111], v[204:207], a[92:95], v[96:111]
  buffer_load_dwordx4 v[204:207], v1, s[8:11], s41 offen offset:1024 sc1
  s_waitcnt vmcnt(25)
  v_mfma_f32_32x32x16_bf16 v[64:79], v[208:211], a[96:99], v[64:79]
  ds_write_b128 v6, v[60:63] offset:8192
  v_mfma_f32_32x32x16_bf16 v[80:95], v[208:211], a[100:103], v[80:95]
  v_mfma_f32_32x32x16_bf16 v[96:111], v[208:211], a[104:107], v[96:111]
  buffer_load_dwordx4 v[208:211], v1, s[8:11], s41 offen offset:2048 sc1
  s_waitcnt lgkmcnt(0)
  s_barrier
  ds_read_b128 v[112:115], v10 offset:0
  s_waitcnt vmcnt(25)
  v_mfma_f32_32x32x16_bf16 v[64:79], v[212:215], a[108:111], v[64:79]
  ds_read_b128 v[116:119], v10 offset:1024
  ds_read_b128 v[120:123], v10 offset:2048
  ds_read_b128 v[124:127], v11 offset:0
  ds_read_b128 v[128:131], v11 offset:1024
  ds_read_b128 v[132:135], v11 offset:2048
  ds_read_b128 v[136:139], v12 offset:0
  v_mfma_f32_32x32x16_bf16 v[80:95], v[212:215], a[112:115], v[80:95]
  ds_read_b128 v[140:143], v12 offset:1024
  ds_read_b128 v[144:147], v12 offset:2048
  v_mfma_f32_32x32x16_bf16 v[96:111], v[212:215], a[116:119], v[96:111]
  buffer_load_dwordx4 v[212:215], v1, s[8:11], s41 offen offset:3072 sc1
  s_waitcnt vmcnt(25)
  v_mfma_f32_32x32x16_bf16 v[64:79], v[216:219], a[120:123], v[64:79]
  v_mfma_f32_32x32x16_bf16 v[80:95], v[216:219], a[124:127], v[80:95]
  v_mfma_f32_32x32x16_bf16 v[96:111], v[216:219], a[128:131], v[96:111]
  s_add_u32 s41, s41, 4096
  buffer_load_dwordx4 v[216:219], v1, s[8:11], s41 offen offset:0 sc1
  s_waitcnt lgkmcnt(0)
  v_add_f32 v112, v112, v16
  s_waitcnt vmcnt(25)
  v_mfma_f32_32x32x16_bf16 v[64:79], v[220:223], a[132:135], v[64:79]
  v_add_f32 v124, v124, v136
  v_add_f32 v113, v113, v17
  v_add_f32 v125, v125, v137
  v_add_f32 v114, v114, v18
  v_add_f32 v126, v126, v138
  v_add_f32 v115, v115, v19
  v_mfma_f32_32x32x16_bf16 v[80:95], v[220:223], a[136:139], v[80:95]
  v_add_f32 v127, v127, v139
  v_add_f32 v116, v116, v32
  v_add_f32 v128, v128, v140
  v_add_f32 v117, v117, v33
  v_add_f32 v129, v129, v141
  v_add_f32 v118, v118, v34
  v_mfma_f32_32x32x16_bf16 v[96:111], v[220:223], a[140:143], v[96:111]
  buffer_load_dwordx4 v[220:223], v1, s[8:11], s41 offen offset:1024 sc1
  v_add_f32 v130, v130, v142
  v_add_f32 v119, v119, v35
  v_add_f32 v131, v131, v143
  s_waitcnt vmcnt(25)
  v_mfma_f32_32x32x16_bf16 v[64:79], v[224:227], a[144:147], v[64:79]
  v_add_f32 v120, v120, v48
  v_add_f32 v132, v132, v144
  v_add_f32 v121, v121, v49
  v_add_f32 v133, v133, v145
  v_add_f32 v122, v122, v50
  v_add_f32 v134, v134, v146
  v_mfma_f32_32x32x16_bf16 v[80:95], v[224:227], a[148:151], v[80:95]
  v_add_f32 v123, v123, v51
  v_add_f32 v135, v135, v147
  v_add_f32 v112, v112, v124
  v_add_f32 v113, v113, v125
  v_add_f32 v114, v114, v126
  v_add_f32 v115, v115, v127
  v_mfma_f32_32x32x16_bf16 v[96:111], v[224:227], a[152:155], v[96:111]
  s_mul_i32 s41, s61, 368640
  s_add_u32 s41, s41, s37
  buffer_load_dwordx4 v[224:227], v1, s[8:11], s41 offen offset:0 sc1
  v_add_f32 v116, v116, v128
  s_waitcnt vmcnt(25)
  v_mfma_f32_32x32x16_bf16 v[64:79], v[228:231], a[156:159], v[64:79]
  v_add_f32 v117, v117, v129
  v_add_f32 v118, v118, v130
  v_add_f32 v119, v119, v131
  v_add_f32 v120, v120, v132
  v_add_f32 v121, v121, v133
  v_add_f32 v122, v122, v134
  v_mfma_f32_32x32x16_bf16 v[80:95], v[228:231], a[160:163], v[80:95]
  v_add_f32 v123, v123, v135
  v_cvt_pk_bf16_f32 v136, v112, v113
  v_cvt_pk_bf16_f32 v137, v114, v115
  v_cvt_pk_bf16_f32 v138, v116, v117
  v_cvt_pk_bf16_f32 v140, v118, v119
  v_cvt_pk_bf16_f32 v141, v120, v121
  v_mfma_f32_32x32x16_bf16 v[96:111], v[228:231], a[164:167], v[96:111]
  buffer_load_dwordx4 v[228:231], v1, s[8:11], s41 offen offset:1024 sc1
  v_cvt_pk_bf16_f32 v142, v122, v123
  v_mov_b32 v139, s45
  v_mov_b32 v143, s45
  s_waitcnt vmcnt(25)
  v_mfma_f32_32x32x16_bf16 v[64:79], v[232:235], a[168:171], v[64:79]
  s_mul_i32 s42, s58, 49152
  s_add_u32 s42, s42, s39
  buffer_store_dwordx4 v[136:139], v13, s[8:11], s42 offen offset:0 sc1
  v_mfma_f32_32x32x16_bf16 v[80:95], v[232:235], a[172:175], v[80:95]
  v_mfma_f32_32x32x16_bf16 v[96:111], v[232:235], a[176:179], v[96:111]
  buffer_load_dwordx4 v[232:235], v1, s[8:11], s41 offen offset:2048 sc1
  buffer_store_dwordx4 v[140:143], v13, s[8:11], s42 offen offset:1024 sc1
  s_waitcnt vmcnt(27)
  v_mfma_f32_32x32x16_bf16 v[64:79], v[236:239], a[180:183], v[64:79]
  v_mfma_f32_32x32x16_bf16 v[80:95], v[236:239], a[184:187], v[80:95]
  v_mfma_f32_32x32x16_bf16 v[96:111], v[236:239], a[188:191], v[96:111]
  buffer_load_dwordx4 v[236:239], v1, s[8:11], s41 offen offset:3072 sc1
  s_waitcnt vmcnt(27)
  v_mfma_f32_32x32x16_bf16 v[64:79], v[240:243], a[192:195], v[64:79]
  v_mfma_f32_32x32x16_bf16 v[80:95], v[240:243], a[196:199], v[80:95]
  v_mfma_f32_32x32x16_bf16 v[96:111], v[240:243], a[200:203], v[96:111]
  s_add_u32 s41, s41, 4096
  buffer_load_dwordx4 v[240:243], v1, s[8:11], s41 offen offset:0 sc1
  s_waitcnt vmcnt(27)
  v_mfma_f32_32x32x16_bf16 v[64:79], v[244:247], a[204:207], v[64:79]
  v_mfma_f32_32x32x16_bf16 v[80:95], v[244:247], a[208:211], v[80:95]
  v_mfma_f32_32x32x16_bf16 v[96:111], v[244:247], a[212:215], v[96:111]
  buffer_load_dwordx4 v[244:247], v1, s[8:11], s41 offen offset:1024 sc1
  s_add_u32 s12, s12, s52
  buffer_load_dword v8, v9, s[8:11], s12 offen sc1
  s_waitcnt vmcnt(28)
  v_mfma_f32_32x32x16_bf16 v[16:31], v[152:155], a[0:3], 0
  v_mfma_f32_32x32x16_bf16 v[32:47], v[152:155], a[4:7], 0
  s_nop 3
  ds_write_b128 v6, v[68:71] offset:36864
  v_mfma_f32_32x32x16_bf16 v[48:63], v[152:155], a[8:11], 0
  buffer_load_dwordx4 v[152:155], v1, s[8:11], s41 offen offset:2048 sc1
  s_waitcnt vmcnt(28)
  v_mfma_f32_32x32x16_bf16 v[16:31], v[156:159], a[12:15], v[16:31]
  ds_write_b128 v6, v[84:87] offset:37888
  v_mfma_f32_32x32x16_bf16 v[32:47], v[156:159], a[16:19], v[32:47]
  v_mfma_f32_32x32x16_bf16 v[48:63], v[156:159], a[20:23], v[48:63]
  buffer_load_dwordx4 v[156:159], v1, s[8:11], s41 offen offset:3072 sc1
  s_waitcnt vmcnt(27)
  v_mfma_f32_32x32x16_bf16 v[16:31], v[160:163], a[24:27], v[16:31]
  ds_write_b128 v6, v[100:103] offset:38912
  v_mfma_f32_32x32x16_bf16 v[32:47], v[160:163], a[28:31], v[32:47]
  v_mfma_f32_32x32x16_bf16 v[48:63], v[160:163], a[32:35], v[48:63]
  s_add_u32 s41, s41, 4096
  buffer_load_dwordx4 v[160:163], v1, s[8:11], s41 offen offset:0 sc1
  s_waitcnt vmcnt(26)
  v_mfma_f32_32x32x16_bf16 v[16:31], v[164:167], a[36:39], v[16:31]
  ds_write_b128 v6, v[72:75] offset:39936
  v_mfma_f32_32x32x16_bf16 v[32:47], v[164:167], a[40:43], v[32:47]
  v_mfma_f32_32x32x16_bf16 v[48:63], v[164:167], a[44:47], v[48:63]
  buffer_load_dwordx4 v[164:167], v1, s[8:11], s41 offen offset:1024 sc1
  s_waitcnt vmcnt(26)
  v_mfma_f32_32x32x16_bf16 v[16:31], v[168:171], a[48:51], v[16:31]
  ds_write_b128 v6, v[88:91] offset:40960
  v_mfma_f32_32x32x16_bf16 v[32:47], v[168:171], a[52:55], v[32:47]
  v_mfma_f32_32x32x16_bf16 v[48:63], v[168:171], a[56:59], v[48:63]
  buffer_load_dwordx4 v[168:171], v1, s[8:11], s41 offen offset:2048 sc1
  s_waitcnt vmcnt(26)
  v_mfma_f32_32x32x16_bf16 v[16:31], v[172:175], a[60:63], v[16:31]
  ds_write_b128 v6, v[104:107] offset:41984
  v_mfma_f32_32x32x16_bf16 v[32:47], v[172:175], a[64:67], v[32:47]
  v_mfma_f32_32x32x16_bf16 v[48:63], v[172:175], a[68:71], v[48:63]
  buffer_load_dwordx4 v[172:175], v1, s[8:11], s41 offen offset:3072 sc1
  s_waitcnt vmcnt(26)
  v_mfma_f32_32x32x16_bf16 v[16:31], v[176:179], a[72:75], v[16:31]
  ds_write_b128 v6, v[76:79] offset:43008
  v_mfma_f32_32x32x16_bf16 v[32:47], v[176:179], a[76:79], v[32:47]
  v_mfma_f32_32x32x16_bf16 v[48:63], v[176:179], a[80:83], v[48:63]
  s_add_u32 s41, s41, 4096
  buffer_load_dwordx4 v[176:179], v1, s[8:11], s41 offen offset:0 sc1
  s_waitcnt vmcnt(26)
  v_mfma_f32_32x32x16_bf16 v[16:31], v[180:183], a[84:87], v[16:31]
  ds_write_b128 v6, v[92:95] offset:44032
  v_mfma_f32_32x32x16_bf16 v[32:47], v[180:183], a[88:91], v[32:47]
  v_mfma_f32_32x32x16_bf16 v[48:63], v[180:183], a[92:95], v[48:63]
  buffer_load_dwordx4 v[180:183], v1, s[8:11], s41 offen offset:1024 sc1
  s_waitcnt vmcnt(26)
  v_mfma_f32_32x32x16_bf16 v[16:31], v[184:187], a[96:99], v[16:31]
  ds_write_b128 v6, v[108:111] offset:45056
  v_mfma_f32_32x32x16_bf16 v[32:47], v[184:187], a[100:103], v[32:47]
  v_mfma_f32_32x32x16_bf16 v[48:63], v[184:187], a[104:107], v[48:63]
  buffer_load_dwordx4 v[184:187], v1, s[8:11], s41 offen offset:2048 sc1
  s_waitcnt lgkmcnt(0)
  s_barrier
  ds_read_b128 v[112:115], v10 offset:36864
  s_waitcnt vmcnt(26)
  v_mfma_f32_32x32x16_bf16 v[16:31], v[188:191], a[108:111], v[16:31]
  ds_read_b128 v[116:119], v10 offset:37888
  ds_read_b128 v[120:123], v10 offset:38912
  ds_read_b128 v[124:127], v11 offset:36864
  ds_read_b128 v[128:131], v11 offset:37888
  ds_read_b128 v[132:135], v11 offset:38912
  ds_read_b128 v[136:139], v12 offset:36864
  v_mfma_f32_32x32x16_bf16 v[32:47], v[188:191], a[112:115], v[32:47]
  ds_read_b128 v[140:143], v12 offset:37888
  ds_read_b128 v[144:147], v12 offset:38912
  v_mfma_f32_32x32x16_bf16 v[48:63], v[188:191], a[116:119], v[48:63]
  buffer_load_dwordx4 v[188:191], v1, s[8:11], s41 offen offset:3072 sc1
  s_waitcnt vmcnt(26)
  v_mfma_f32_32x32x16_bf16 v[16:31], v[192:195], a[120:123], v[16:31]
  v_mfma_f32_32x32x16_bf16 v[32:47], v[192:195], a[124:127], v[32:47]
  v_mfma_f32_32x32x16_bf16 v[48:63], v[192:195], a[128:131], v[48:63]
  s_add_u32 s41, s41, 4096
  buffer_load_dwordx4 v[192:195], v1, s[8:11], s41 offen offset:0 sc1
  s_waitcnt vmcnt(11)
  v_cmp_ne_u32 vcc, s45, v8
  s_nop 1
  s_or_b32 s4, vcc_lo, vcc_hi
  s_and_b32 s4, s4, s54
  s_cmp_eq_u32 s4, 0
  s_cbranch_scc0 POLL16
POLL16_OK:
  v_mfma_f32_32x32x16_bf16 v[16:31], v[196:199], a[132:135], v[16:31]
  s_waitcnt lgkmcnt(0)
  v_add_f32 v112, v112, v64
  v_add_f32 v124, v124, v136
  v_add_f32 v113, v113, v65
  v_add_f32 v125, v125, v137
  v_add_f32 v114, v114, v66
  v_mfma_f32_32x32x16_bf16 v[32:47], v[196:199], a[136:139], v[32:47]
  v_add_f32 v126, v126, v138
  v_add_f32 v115, v115, v67
  v_add_f32 v127, v127, v139
  v_add_f32 v116, v116, v80
  v_add_f32 v128, v128, v140
  v_add_f32 v117, v117, v81
  v_mfma_f32_32x32x16_bf16 v[48:63], v[196:199], a[140:143], v[48:63]
  buffer_load_dwordx4 v[196:199], v1, s[8:11], s41 offen offset:1024 sc1
  v_add_f32 v129, v129, v141
  v_add_f32 v118, v118, v82
  v_add_f32 v130, v130, v142
  v_add_f32 v119, v119, v83
  v_mfma_f32_32x32x16_bf16 v[16:31], v[200:203], a[144:147], v[16:31]
  v_add_f32 v131, v131, v143
  v_add_f32 v120, v120, v96
  v_add_f32 v132, v132, v144
  v_add_f32 v121, v121, v97
  v_add_f32 v133, v133, v145
  v_add_f32 v122, v122, v98
  v_mfma_f32_32x32x16_bf16 v[32:47], v[200:203], a[148:151], v[32:47]
  v_add_f32 v134, v134, v146
  v_add_f32 v123, v123, v99
  v_add_f32 v135, v135, v147
  v_add_f32 v112, v112, v124
  v_add_f32 v113, v113, v125
  v_add_f32 v114, v114, v126
  v_mfma_f32_32x32x16_bf16 v[48:63], v[200:203], a[152:155], v[48:63]
  s_mul_i32 s41, s62, 368640
  s_add_u32 s41, s41, s37
  buffer_load_dwordx4 v[200:203], v1, s[8:11], s41 offen offset:0 sc1
  v_add_f32 v115, v115, v127
  v_add_f32 v116, v116, v128
  v_mfma_f32_32x32x16_bf16 v[16:31], v[204:207], a[156:159], v[16:31]
  v_add_f32 v117, v117, v129
  v_add_f32 v118, v118, v130
  v_add_f32 v119, v119, v131
  v_add_f32 v120, v120, v132
  v_add_f32 v121, v121, v133
  v_add_f32 v122, v122, v134
  v_mfma_f32_32x32x16_bf16 v[32:47], v[204:207], a[160:163], v[32:47]
  v_add_f32 v123, v123, v135
  v_cvt_pk_bf16_f32 v136, v112, v113
  v_cvt_pk_bf16_f32 v137, v114, v115
  v_cvt_pk_bf16_f32 v138, v116, v117
  v_cvt_pk_bf16_f32 v140, v118, v119
  v_cvt_pk_bf16_f32 v141, v120, v121
  v_mfma_f32_32x32x16_bf16 v[48:63], v[204:207], a[164:167], v[48:63]
  buffer_load_dwordx4 v[204:207], v1, s[8:11], s41 offen offset:1024 sc1
  v_cvt_pk_bf16_f32 v142, v122, v123
  v_mov_b32 v139, s45
  v_mov_b32 v143, s45
  s_mul_i32 s42, s59, 49152
  v_mfma_f32_32x32x16_bf16 v[16:31], v[208:211], a[168:171], v[16:31]
  s_add_u32 s42, s42, s39
  buffer_store_dwordx4 v[136:139], v13, s[8:11], s42 offen offset:0 sc1
  v_mfma_f32_32x32x16_bf16 v[32:47], v[208:211], a[172:175], v[32:47]
  v_mfma_f32_32x32x16_bf16 v[48:63], v[208:211], a[176:179], v[48:63]
  buffer_load_dwordx4 v[208:211], v1, s[8:11], s41 offen offset:2048 sc1
  buffer_store_dwordx4 v[140:143], v13, s[8:11], s42 offen offset:1024 sc1
  v_mfma_f32_32x32x16_bf16 v[16:31], v[212:215], a[180:183], v[16:31]
  v_mfma_f32_32x32x16_bf16 v[32:47], v[212:215], a[184:187], v[32:47]
  v_mfma_f32_32x32x16_bf16 v[48:63], v[212:215], a[188:191], v[48:63]
  buffer_load_dwordx4 v[212:215], v1, s[8:11], s41 offen offset:3072 sc1
  v_mfma_f32_32x32x16_bf16 v[16:31], v[216:219], a[192:195], v[16:31]
  v_mfma_f32_32x32x16_bf16 v[32:47], v[216:219], a[196:199], v[32:47]
  v_mfma_f32_32x32x16_bf16 v[48:63], v[216:219], a[200:203], v[48:63]
  s_add_u32 s41, s41, 4096
  buffer_load_dwordx4 v[216:219], v1, s[8:11], s41 offen offset:0 sc1
  v_mfma_f32_32x32x16_bf16 v[16:31], v[220:223], a[204:207], v[16:31]
  v_mfma_f32_32x32x16_bf16 v[32:47], v[220:223], a[208:211], v[32:47]
  v_mfma_f32_32x32x16_bf16 v[48:63], v[220:223], a[212:215], v[48:63]
  buffer_load_dwordx4 v[220:223], v1, s[8:11], s41 offen offset:1024 sc1
  v_mfma_f32_32x32x16_bf16 v[64:79], v[224:227], a[0:3], 0
  v_mfma_f32_32x32x16_bf16 v[80:95], v[224:227], a[4:7], 0
  s_nop 6
  ds_write_b128 v6, v[20:23] offset:0
  v_mfma_f32_32x32x16_bf16 v[96:111], v[224:227], a[8:11], 0
  buffer_load_dwordx4 v[224:227], v1, s[8:11], s41 offen offset:2048 sc1
  v_mfma_f32_32x32x16_bf16 v[64:79], v[228:231], a[12:15], v[64:79]
  ds_write_b128 v6, v[36:39] offset:1024
  v_mfma_f32_32x32x16_bf16 v[80:95], v[228:231], a[16:19], v[80:95]
  v_mfma_f32_32x32x16_bf16 v[96:111], v[228:231], a[20:23], v[96:111]
  buffer_load_dwordx4 v[228:231], v1, s[8:11], s41 offen offset:3072 sc1
  v_mfma_f32_32x32x16_bf16 v[64:79], v[232:235], a[24:27], v[64:79]
  ds_write_b128 v6, v[52:55] offset:2048
  v_mfma_f32_32x32x16_bf16 v[80:95], v[232:235], a[28:31], v[80:95]
  v_mfma_f32_32x32x16_bf16 v[96:111], v[232:235], a[32:35], v[96:111]
  s_add_u32 s41, s41, 4096
  buffer_load_dwordx4 v[232:235], v1, s[8:11], s41 offen offset:0 sc1
  v_mfma_f32_32x32x16_bf16 v[64:79], v[236:239], a[36:39], v[64:79]
  ds_write_b128 v6, v[24:27] offset:3072
  v_mfma_f32_32x32x16_bf16 v[80:95], v[236:239], a[40:43], v[80:95]
  v_mfma_f32_32x32x16_bf16 v[96:111], v[236:239], a[44:47], v[96:111]
  buffer_load_dwordx4 v[236:239], v1, s[8:11], s41 offen offset:1024 sc1
  v_mfma_f32_32x32x16_bf16 v[64:79], v[240:243], a[48:51], v[64:79]
  ds_write_b128 v6, v[40:43] offset:4096
  v_mfma_f32_32x32x16_bf16 v[80:95], v[240:243], a[52:55], v[80:95]
  v_mfma_f32_32x32x16_bf16 v[96:111], v[240:243], a[56:59], v[96:111]
  buffer_load_dwordx4 v[240:243], v1, s[8:11], s41 offen offset:2048 sc1
  v_mfma_f32_32x32x16_bf16 v[64:79], v[244:247], a[60:63], v[64:79]
  ds_write_b128 v6, v[56:59] offset:5120
  v_mfma_f32_32x32x16_bf16 v[80:95], v[244:247], a[64:67], v[80:95]
  v_mfma_f32_32x32x16_bf16 v[96:111], v[244:247], a[68:71], v[96:111]
  buffer_load_dwordx4 v[244:247], v1, s[8:11], s41 offen offset:3072 sc1
  s_waitcnt vmcnt(25)
  v_mfma_f32_32x32x16_bf16 v[64:79], v[152:155], a[72:75], v[64:79]
  ds_write_b128 v6, v[28:31] offset:6144
  v_mfma_f32_32x32x16_bf16 v[80:95], v[152:155], a[76:79], v[80:95]
  v_mfma_f32_32x32x16_bf16 v[96:111], v[152:155], a[80:83], v[96:111]
  s_add_u32 s41, s41, 4096
  buffer_load_dwordx4 v[152:155], v1, s[8:11], s41 offen offset:0 sc1
  s_waitcnt vmcnt(25)
  v_mfma_f32_32x32x16_bf16 v[64:79], v[156:159], a[84:87], v[64:79]
  ds_write_b128 v6, v[44:47] offset:7168
  v_mfma_f32_32x32x16_bf16 v[80:95], v[156:159], a[88:91], v[80:95]
  v_mfma_f32_32x32x16_bf16 v[96:111], v[156:159], a[92:95], v[96:111]
  buffer_load_dwordx4 v[156:159], v1, s[8:11], s41 offen offset:1024 sc1
  s_waitcnt vmcnt(25)
  v_mfma_f32_32x32x16_bf16 v[64:79], v[160:163], a[96:99], v[64:79]
  ds_write_b128 v6, v[60:63] offset:8192
  v_mfma_f32_32x32x16_bf16 v[80:95], v[160:163], a[100:103], v[80:95]
  v_mfma_f32_32x32x16_bf16 v[96:111], v[160:163], a[104:107], v[96:111]
  buffer_load_dwordx4 v[160:163], v1, s[8:11], s41 offen offset:2048 sc1
  s_waitcnt lgkmcnt(0)
  s_barrier
  ds_read_b128 v[112:115], v10 offset:0
  s_waitcnt vmcnt(25)
  v_mfma_f32_32x32x16_bf16 v[64:79], v[164:167], a[108:111], v[64:79]
  ds_read_b128 v[116:119], v10 offset:1024
  ds_read_b128 v[120:123], v10 offset:2048
  ds_read_b128 v[124:127], v11 offset:0
  ds_read_b128 v[128:131], v11 offset:1024
  ds_read_b128 v[132:135], v11 offset:2048
  ds_read_b128 v[136:139], v12 offset:0
  v_mfma_f32_32x32x16_bf16 v[80:95], v[164:167], a[112:115], v[80:95]
  ds_read_b128 v[140:143], v12 offset:1024
  ds_read_b128 v[144:147], v12 offset:2048
  v_mfma_f32_32x32x16_bf16 v[96:111], v[164:167], a[116:119], v[96:111]
  buffer_load_dwordx4 v[164:167], v1, s[8:11], s41 offen offset:3072 sc1
  s_waitcnt vmcnt(25)
  v_mfma_f32_32x32x16_bf16 v[64:79], v[168:171], a[120:123], v[64:79]
  v_mfma_f32_32x32x16_bf16 v[80:95], v[168:171], a[124:127], v[80:95]
  v_mfma_f32_32x32x16_bf16 v[96:111], v[168:171], a[128:131], v[96:111]
  s_add_u32 s41, s41, 4096
  buffer_load_dwordx4 v[168:171], v1, s[8:11], s41 offen offset:0 sc1
  s_waitcnt lgkmcnt(0)
  v_add_f32 v112, v112, v16
  s_waitcnt vmcnt(25)
  v_mfma_f32_32x32x16_bf16 v[64:79], v[172:175], a[132:135], v[64:79]
  v_add_f32 v124, v124, v136
  v_add_f32 v113, v113, v17
  v_add_f32 v125, v125, v137
  v_add_f32 v114, v114, v18
  v_add_f32 v126, v126, v138
  v_add_f32 v115, v115, v19
  v_mfma_f32_32x32x16_bf16 v[80:95], v[172:175], a[136:139], v[80:95]
  v_add_f32 v127, v127, v139
  v_add_f32 v116, v116, v32
  v_add_f32 v128, v128, v140
  v_add_f32 v117, v117, v33
  v_add_f32 v129, v129, v141
  v_add_f32 v118, v118, v34
  v_mfma_f32_32x32x16_bf16 v[96:111], v[172:175], a[140:143], v[96:111]
  buffer_load_dwordx4 v[172:175], v1, s[8:11], s41 offen offset:1024 sc1
  v_add_f32 v130, v130, v142
  v_add_f32 v119, v119, v35
  v_add_f32 v131, v131, v143
  s_waitcnt vmcnt(25)
  v_mfma_f32_32x32x16_bf16 v[64:79], v[176:179], a[144:147], v[64:79]
  v_add_f32 v120, v120, v48
  v_add_f32 v132, v132, v144
  v_add_f32 v121, v121, v49
  v_add_f32 v133, v133, v145
  v_add_f32 v122, v122, v50
  v_add_f32 v134, v134, v146
  v_mfma_f32_32x32x16_bf16 v[80:95], v[176:179], a[148:151], v[80:95]
  v_add_f32 v123, v123, v51
  v_add_f32 v135, v135, v147
  v_add_f32 v112, v112, v124
  v_add_f32 v113, v113, v125
  v_add_f32 v114, v114, v126
  v_add_f32 v115, v115, v127
  v_mfma_f32_32x32x16_bf16 v[96:111], v[176:179], a[152:155], v[96:111]
  s_mul_i32 s41, s63, 368640
  s_add_u32 s41, s41, s37
  buffer_load_dwordx4 v[176:179], v1, s[8:11], s41 offen offset:0 sc1
  v_add_f32 v116, v116, v128
  s_waitcnt vmcnt(25)
  v_mfma_f32_32x32x16_bf16 v[64:79], v[180:183], a[156:159], v[64:79]
  v_add_f32 v117, v117, v129
  v_add_f32 v118, v118, v130
  v_add_f32 v119, v119, v131
  v_add_f32 v120, v120, v132
  v_add_f32 v121, v121, v133
  v_add_f32 v122, v122, v134
  v_mfma_f32_32x32x16_bf16 v[80:95], v[180:183], a[160:163], v[80:95]
  v_add_f32 v123, v123, v135
  v_cvt_pk_bf16_f32 v136, v112, v113
  v_cvt_pk_bf16_f32 v137, v114, v115
  v_cvt_pk_bf16_f32 v138, v116, v117
  v_cvt_pk_bf16_f32 v140, v118, v119
  v_cvt_pk_bf16_f32 v141, v120, v121
  v_mfma_f32_32x32x16_bf16 v[96:111], v[180:183], a[164:167], v[96:111]
  buffer_load_dwordx4 v[180:183], v1, s[8:11], s41 offen offset:1024 sc1
  v_cvt_pk_bf16_f32 v142, v122, v123
  v_mov_b32 v139, s45
  v_mov_b32 v143, s45
  s_waitcnt vmcnt(25)
  v_mfma_f32_32x32x16_bf16 v[64:79], v[184:187], a[168:171], v[64:79]
  s_mul_i32 s42, s60, 49152
  s_add_u32 s42, s42, s39
  buffer_store_dwordx4 v[136:139], v13, s[8:11], s42 offen offset:0 sc1
  v_mfma_f32_32x32x16_bf16 v[80:95], v[184:187], a[172:175], v[80:95]
  v_mfma_f32_32x32x16_bf16 v[96:111], v[184:187], a[176:179], v[96:111]
  buffer_load_dwordx4 v[184:187], v1, s[8:11], s41 offen offset:2048 sc1
  buffer_store_dwordx4 v[140:143], v13, s[8:11], s42 offen offset:1024 sc1
  s_waitcnt vmcnt(27)
  v_mfma_f32_32x32x16_bf16 v[64:79], v[188:191], a[180:183], v[64:79]
  v_mfma_f32_32x32x16_bf16 v[80:95], v[188:191], a[184:187], v[80:95]
  v_mfma_f32_32x32x16_bf16 v[96:111], v[188:191], a[188:191], v[96:111]
  buffer_load_dwordx4 v[188:191], v1, s[8:11], s41 offen offset:3072 sc1
  s_waitcnt vmcnt(27)
  v_mfma_f32_32x32x16_bf16 v[64:79], v[192:195], a[192:195], v[64:79]
  v_mfma_f32_32x32x16_bf16 v[80:95], v[192:195], a[196:199], v[80:95]
  v_mfma_f32_32x32x16_bf16 v[96:111], v[192:195], a[200:203], v[96:111]
  s_add_u32 s41, s41, 4096
  buffer_load_dwordx4 v[192:195], v1, s[8:11], s41 offen offset:0 sc1
  s_waitcnt vmcnt(27)
  v_mfma_f32_32x32x16_bf16 v[64:79], v[196:199], a[204:207], v[64:79]
  v_mfma_f32_32x32x16_bf16 v[80:95], v[196:199], a[208:211], v[80:95]
  v_mfma_f32_32x32x16_bf16 v[96:111], v[196:199], a[212:215], v[96:111]
  buffer_load_dwordx4 v[196:199], v1, s[8:11], s41 offen offset:1024 sc1
  s_cmp_eq_u32 s31, 1
  s_cbranch_scc1 B_SSM_TAIL
  s_waitcnt vmcnt(27)
  v_mfma_f32_32x32x16_bf16 v[16:31], v[200:203], a[0:3], 0
  v_mfma_f32_32x32x16_bf16 v[32:47], v[200:203], a[4:7], 0
  s_nop 3
  ds_write_b128 v6, v[68:71] offset:36864
  v_mfma_f32_32x32x16_bf16 v[48:63], v[200:203], a[8:11], 0
  buffer_load_dwordx4 v[200:203], v1, s[8:11], s41 offen offset:2048 sc1
  s_waitcnt vmcnt(27)
  v_mfma_f32_32x32x16_bf16 v[16:31], v[204:207], a[12:15], v[16:31]
  ds_write_b128 v6, v[84:87] offset:37888
  v_mfma_f32_32x32x16_bf16 v[32:47], v[204:207], a[16:19], v[32:47]
  v_mfma_f32_32x32x16_bf16 v[48:63], v[204:207], a[20:23], v[48:63]
  buffer_load_dwordx4 v[204:207], v1, s[8:11], s41 offen offset:3072 sc1
  s_waitcnt vmcnt(26)
  v_mfma_f32_32x32x16_bf16 v[16:31], v[208:211], a[24:27], v[16:31]
  ds_write_b128 v6, v[100:103] offset:38912
  v_mfma_f32_32x32x16_bf16 v[32:47], v[208:211], a[28:31], v[32:47]
  v_mfma_f32_32x32x16_bf16 v[48:63], v[208:211], a[32:35], v[48:63]
  s_add_u32 s41, s41, 4096
  buffer_load_dwordx4 v[208:211], v1, s[8:11], s41 offen offset:0 sc1
  s_waitcnt vmcnt(25)
  v_mfma_f32_32x32x16_bf16 v[16:31], v[212:215], a[36:39], v[16:31]
  ds_write_b128 v6, v[72:75] offset:39936
  v_mfma_f32_32x32x16_bf16 v[32:47], v[212:215], a[40:43], v[32:47]
  v_mfma_f32_32x32x16_bf16 v[48:63], v[212:215], a[44:47], v[48:63]
  buffer_load_dwordx4 v[212:215], v1, s[8:11], s41 offen offset:1024 sc1
  s_waitcnt vmcnt(25)
  v_mfma_f32_32x32x16_bf16 v[16:31], v[216:219], a[48:51], v[16:31]
  ds_write_b128 v6, v[88:91] offset:40960
  v_mfma_f32_32x32x16_bf16 v[32:47], v[216:219], a[52:55], v[32:47]
  v_mfma_f32_32x32x16_bf16 v[48:63], v[216:219], a[56:59], v[48:63]
  buffer_load_dwordx4 v[216:219], v1, s[8:11], s41 offen offset:2048 sc1
  s_waitcnt vmcnt(25)
  v_mfma_f32_32x32x16_bf16 v[16:31], v[220:223], a[60:63], v[16:31]
  ds_write_b128 v6, v[104:107] offset:41984
  v_mfma_f32_32x32x16_bf16 v[32:47], v[220:223], a[64:67], v[32:47]
  v_mfma_f32_32x32x16_bf16 v[48:63], v[220:223], a[68:71], v[48:63]
  buffer_load_dwordx4 v[220:223], v1, s[8:11], s41 offen offset:3072 sc1
  s_waitcnt vmcnt(25)
  v_mfma_f32_32x32x16_bf16 v[16:31], v[224:227], a[72:75], v[16:31]
  ds_write_b128 v6, v[76:79] offset:43008
  v_mfma_f32_32x32x16_bf16 v[32:47], v[224:227], a[76:79], v[32:47]
  v_mfma_f32_32x32x16_bf16 v[48:63], v[224:227], a[80:83], v[48:63]
  s_add_u32 s41, s41, 4096
  buffer_load_dwordx4 v[224:227], v1, s[8:11], s41 offen offset:0 sc1
  s_waitcnt vmcnt(25)
  v_mfma_f32_32x32x16_bf16 v[16:31], v[228:231], a[84:87], v[16:31]
  ds_write_b128 v6, v[92:95] offset:44032
  v_mfma_f32_32x32x16_bf16 v[32:47], v[228:231], a[88:91], v[32:47]
  v_mfma_f32_32x32x16_bf16 v[48:63], v[228:231], a[92:95], v[48:63]
  buffer_load_dwordx4 v[228:231], v1, s[8:11], s41 offen offset:1024 sc1
  s_waitcnt vmcnt(25)
  v_mfma_f32_32x32x16_bf16 v[16:31], v[232:235], a[96:99], v[16:31]
  ds_write_b128 v6, v[108:111] offset:45056
  v_mfma_f32_32x32x16_bf16 v[32:47], v[232:235], a[100:103], v[32:47]
  v_mfma_f32_32x32x16_bf16 v[48:63], v[232:235], a[104:107], v[48:63]
  buffer_load_dwordx4 v[232:235], v1, s[8:11], s41 offen offset:2048 sc1
  s_waitcnt lgkmcnt(0)
  s_barrier
  ds_read_b128 v[112:115], v10 offset:36864
  s_waitcnt vmcnt(25)
  v_mfma_f32_32x32x16_bf16 v[16:31], v[236:239], a[108:111], v[16:31]
  ds_read_b128 v[116:119], v10 offset:37888
  ds_read_b128 v[120:123], v10 offset:38912
  ds_read_b128 v[124:127], v11 offset:36864
  ds_read_b128 v[128:131], v11 offset:37888
  ds_read_b128 v[132:135], v11 offset:38912
  ds_read_b128 v[136:139], v12 offset:36864
  v_mfma_f32_32x32x16_bf16 v[32:47], v[236:239], a[112:115], v[32:47]
  ds_read_b128 v[140:143], v12 offset:37888
  ds_read_b128 v[144:147], v12 offset:38912
  v_mfma_f32_32x32x16_bf16 v[48:63], v[236:239], a[116:119], v[48:63]
  buffer_load_dwordx4 v[236:239], v1, s[8:11], s41 offen offset:3072 sc1
  s_waitcnt vmcnt(25)
  v_mfma_f32_32x32x16_bf16 v[16:31], v[240:243], a[120:123], v[16:31]
  v_mfma_f32_32x32x16_bf16 v[32:47], v[240:243], a[124:127], v[32:47]
  v_mfma_f32_32x32x16_bf16 v[48:63], v[240:243], a[128:131], v[48:63]
  s_add_u32 s41, s41, 4096
  buffer_load_dwordx4 v[240:243], v1, s[8:11], s41 offen offset:0 sc1
  s_waitcnt lgkmcnt(0)
  v_add_f32 v112, v112, v64
  s_waitcnt vmcnt(25)
  v_mfma_f32_32x32x16_bf16 v[16:31], v[244:247], a[132:135], v[16:31]
  v_add_f32 v124, v124, v136
  v_add_f32 v113, v113, v65
  v_add_f32 v125, v125, v137
  v_add_f32 v114, v114, v66
  v_add_f32 v126, v126, v138
  v_add_f32 v115, v115, v67
  v_mfma_f32_32x32x16_bf16 v[32:47], v[244:247], a[136:139], v[32:47]
  v_add_f32 v127, v127, v139
  v_add_f32 v116, v116, v80
  v_add_f32 v128, v128, v140
  v_add_f32 v117, v117, v81
  v_add_f32 v129, v129, v141
  v_add_f32 v118, v118, v82
  v_mfma_f32_32x32x16_bf16 v[48:63], v[244:247], a[140:143], v[48:63]
  buffer_load_dwordx4 v[244:247], v1, s[8:11], s41 offen offset:1024 sc1
  v_add_f32 v130, v130, v142
  v_add_f32 v119, v119, v83
  v_add_f32 v131, v131, v143
  s_waitcnt vmcnt(25)
  v_mfma_f32_32x32x16_bf16 v[16:31], v[152:155], a[144:147], v[16:31]
  v_add_f32 v120, v120, v96
  v_add_f32 v132, v132, v144
  v_add_f32 v121, v121, v97
  v_add_f32 v133, v133, v145
  v_add_f32 v122, v122, v98
  v_add_f32 v134, v134, v146
  v_mfma_f32_32x32x16_bf16 v[32:47], v[152:155], a[148:151], v[32:47]
  v_add_f32 v123, v123, v99
  v_add_f32 v135, v135, v147
  v_add_f32 v112, v112, v124
  v_add_f32 v113, v113, v125
  v_add_f32 v114, v114, v126
  v_add_f32 v115, v115, v127
  v_mfma_f32_32x32x16_bf16 v[48:63], v[152:155], a[152:155], v[48:63]
  v_add_f32 v116, v116, v128
  v_add_f32 v117, v117, v129
  v_add_f32 v118, v118, v130
  v_add_f32 v119, v119, v131
  v_add_f32 v120, v120, v132
  s_waitcnt vmcnt(24)
  v_mfma_f32_32x32x16_bf16 v[16:31], v[156:159], a[156:159], v[16:31]
  v_add_f32 v121, v121, v133
  v_add_f32 v122, v122, v134
  v_add_f32 v123, v123, v135
  v_cvt_pk_bf16_f32 v136, v112, v113
  v_cvt_pk_bf16_f32 v137, v114, v115
  v_cvt_pk_bf16_f32 v138, v116, v117
  v_mfma_f32_32x32x16_bf16 v[32:47], v[156:159], a[160:163], v[32:47]
  v_cvt_pk_bf16_f32 v140, v118, v119
  v_cvt_pk_bf16_f32 v141, v120, v121
  v_cvt_pk_bf16_f32 v142, v122, v123
  v_mov_b32 v139, s45
  v_mov_b32 v143, s45
  s_mul_i32 s42, s61, 49152
  v_mfma_f32_32x32x16_bf16 v[48:63], v[156:159], a[164:167], v[48:63]
  s_add_u32 s42, s42, s39
  buffer_store_dwordx4 v[136:139], v13, s[8:11], s42 offen offset:0 sc1
  s_waitcnt vmcnt(24)
  v_mfma_f32_32x32x16_bf16 v[16:31], v[160:163], a[168:171], v[16:31]
  v_mfma_f32_32x32x16_bf16 v[32:47], v[160:163], a[172:175], v[32:47]
  buffer_store_dwordx4 v[140:143], v13, s[8:11], s42 offen offset:1024 sc1
  v_mfma_f32_32x32x16_bf16 v[48:63], v[160:163], a[176:179], v[48:63]
  s_waitcnt vmcnt(24)
  v_mfma_f32_32x32x16_bf16 v[16:31], v[164:167], a[180:183], v[16:31]
  v_mfma_f32_32x32x16_bf16 v[32:47], v[164:167], a[184:187], v[32:47]
  v_mfma_f32_32x32x16_bf16 v[48:63], v[164:167], a[188:191], v[48:63]
  s_waitcnt vmcnt(23)
  v_mfma_f32_32x32x16_bf16 v[16:31], v[168:171], a[192:195], v[16:31]
  v_mfma_f32_32x32x16_bf16 v[32:47], v[168:171], a[196:199], v[32:47]
  v_mfma_f32_32x32x16_bf16 v[48:63], v[168:171], a[200:203], v[48:63]
  s_waitcnt vmcnt(22)
  v_mfma_f32_32x32x16_bf16 v[16:31], v[172:175], a[204:207], v[16:31]
  v_mfma_f32_32x32x16_bf16 v[32:47], v[172:175], a[208:211], v[32:47]
  v_mfma_f32_32x32x16_bf16 v[48:63], v[172:175], a[212:215], v[48:63]
  s_waitcnt vmcnt(21)
  v_mfma_f32_32x32x16_bf16 v[64:79], v[176:179], a[0:3], 0
  v_mfma_f32_32x32x16_bf16 v[80:95], v[176:179], a[4:7], 0
  s_nop 6
  ds_write_b128 v6, v[20:23] offset:0
  v_mfma_f32_32x32x16_bf16 v[96:111], v[176:179], a[8:11], 0
  s_waitcnt vmcnt(20)
  v_mfma_f32_32x32x16_bf16 v[64:79], v[180:183], a[12:15], v[64:79]
  ds_write_b128 v6, v[36:39] offset:1024
  v_mfma_f32_32x32x16_bf16 v[80:95], v[180:183], a[16:19], v[80:95]
  v_mfma_f32_32x32x16_bf16 v[96:111], v[180:183], a[20:23], v[96:111]
  ds_write_b128 v6, v[52:55] offset:2048
  s_waitcnt vmcnt(18)
  v_mfma_f32_32x32x16_bf16 v[64:79], v[184:187], a[24:27], v[64:79]
  v_mfma_f32_32x32x16_bf16 v[80:95], v[184:187], a[28:31], v[80:95]
  ds_write_b128 v6, v[24:27] offset:3072
  v_mfma_f32_32x32x16_bf16 v[96:111], v[184:187], a[32:35], v[96:111]
  s_waitcnt vmcnt(16)
  v_mfma_f32_32x32x16_bf16 v[64:79], v[188:191], a[36:39], v[64:79]
  ds_write_b128 v6, v[40:43] offset:4096
  v_mfma_f32_32x32x16_bf16 v[80:95], v[188:191], a[40:43], v[80:95]
  v_mfma_f32_32x32x16_bf16 v[96:111], v[188:191], a[44:47], v[96:111]
  ds_write_b128 v6, v[56:59] offset:5120
  s_waitcnt vmcnt(15)
  v_mfma_f32_32x32x16_bf16 v[64:79], v[192:195], a[48:51], v[64:79]
  v_mfma_f32_32x32x16_bf16 v[80:95], v[192:195], a[52:55], v[80:95]
  ds_write_b128 v6, v[28:31] offset:6144
  v_mfma_f32_32x32x16_bf16 v[96:111], v[192:195], a[56:59], v[96:111]
  s_waitcnt vmcnt(14)
  v_mfma_f32_32x32x16_bf16 v[64:79], v[196:199], a[60:63], v[64:79]
  ds_write_b128 v6, v[44:47] offset:7168
  v_mfma_f32_32x32x16_bf16 v[80:95], v[196:199], a[64:67], v[80:95]
  v_mfma_f32_32x32x16_bf16 v[96:111], v[196:199], a[68:71], v[96:111]
  ds_write_b128 v6, v[60:63] offset:8192
  s_waitcnt vmcnt(13)
  v_mfma_f32_32x32x16_bf16 v[64:79], v[200:203], a[72:75], v[64:79]
  v_mfma_f32_32x32x16_bf16 v[80:95], v[200:203], a[76:79], v[80:95]
  s_waitcnt lgkmcnt(0)
  s_barrier
  ds_read_b128 v[112:115], v10 offset:0
  ds_read_b128 v[116:119], v10 offset:1024
  ds_read_b128 v[120:123], v10 offset:2048
  ds_read_b128 v[124:127], v11 offset:0
  v_mfma_f32_32x32x16_bf16 v[96:111], v[200:203], a[80:83], v[96:111]
  ds_read_b128 v[128:131], v11 offset:1024
  ds_read_b128 v[132:135], v11 offset:2048
  ds_read_b128 v[136:139], v12 offset:0
  ds_read_b128 v[140:143], v12 offset:1024
  ds_read_b128 v[144:147], v12 offset:2048
  s_waitcnt vmcnt(12)
  v_mfma_f32_32x32x16_bf16 v[64:79], v[204:207], a[84:87], v[64:79]
  v_mfma_f32_32x32x16_bf16 v[80:95], v[204:207], a[88:91], v[80:95]
  v_mfma_f32_32x32x16_bf16 v[96:111], v[204:207], a[92:95], v[96:111]
  s_waitcnt vmcnt(11)
  v_mfma_f32_32x32x16_bf16 v[64:79], v[208:211], a[96:99], v[64:79]
  s_waitcnt lgkmcnt(0)
  v_add_f32 v112, v112, v16
  v_add_f32 v124, v124, v136
  v_add_f32 v113, v113, v17
  v_add_f32 v125, v125, v137
  v_add_f32 v114, v114, v18
  v_mfma_f32_32x32x16_bf16 v[80:95], v[208:211], a[100:103], v[80:95]
  v_add_f32 v126, v126, v138
  v_add_f32 v115, v115, v19
  v_add_f32 v127, v127, v139
  v_add_f32 v116, v116, v32
  v_add_f32 v128, v128, v140
  v_add_f32 v117, v117, v33
  v_mfma_f32_32x32x16_bf16 v[96:111], v[208:211], a[104:107], v[96:111]
  v_add_f32 v129, v129, v141
  v_add_f32 v118, v118, v34
  v_add_f32 v130, v130, v142
  v_add_f32 v119, v119, v35
  v_add_f32 v131, v131, v143
  s_waitcnt vmcnt(10)
  v_mfma_f32_32x32x16_bf16 v[64:79], v[212:215], a[108:111], v[64:79]
  v_add_f32 v120, v120, v48
  v_add_f32 v132, v132, v144
  v_add_f32 v121, v121, v49
  v_add_f32 v133, v133, v145
  v_add_f32 v122, v122, v50
  v_add_f32 v134, v134, v146
  v_mfma_f32_32x32x16_bf16 v[80:95], v[212:215], a[112:115], v[80:95]
  v_add_f32 v123, v123, v51
  v_add_f32 v135, v135, v147
  v_add_f32 v112, v112, v124
  v_add_f32 v113, v113, v125
  v_add_f32 v114, v114, v126
  v_add_f32 v115, v115, v127
  v_mfma_f32_32x32x16_bf16 v[96:111], v[212:215], a[116:119], v[96:111]
  v_add_f32 v116, v116, v128
  v_add_f32 v117, v117, v129
  v_add_f32 v118, v118, v130
  v_add_f32 v119, v119, v131
  v_add_f32 v120, v120, v132
  s_waitcnt vmcnt(9)
  v_mfma_f32_32x32x16_bf16 v[64:79], v[216:219], a[120:123], v[64:79]
  v_add_f32 v121, v121, v133
  v_add_f32 v122, v122, v134
  v_add_f32 v123, v123, v135
  v_cvt_pk_bf16_f32 v136, v112, v113
  v_cvt_pk_bf16_f32 v137, v114, v115
  v_cvt_pk_bf16_f32 v138, v116, v117
  v_mfma_f32_32x32x16_bf16 v[80:95], v[216:219], a[124:127], v[80:95]
  v_cvt_pk_bf16_f32 v140, v118, v119
  v_cvt_pk_bf16_f32 v141, v120, v121
  v_cvt_pk_bf16_f32 v142, v122, v123
  v_mov_b32 v139, s45
  v_mov_b32 v143, s45
  s_mul_i32 s42, s62, 49152
  v_mfma_f32_32x32x16_bf16 v[96:111], v[216:219], a[128:131], v[96:111]
  s_add_u32 s42, s42, s39
  buffer_store_dwordx4 v[136:139], v13, s[8:11], s42 offen offset:0 sc1
  s_waitcnt vmcnt(9)
  v_mfma_f32_32x32x16_bf16 v[64:79], v[220:223], a[132:135], v[64:79]
  v_mfma_f32_32x32x16_bf16 v[80:95], v[220:223], a[136:139], v[80:95]
  buffer_store_dwordx4 v[140:143], v13, s[8:11], s42 offen offset:1024 sc1
  v_mfma_f32_32x32x16_bf16 v[96:111], v[220:223], a[140:143], v[96:111]
  s_waitcnt vmcnt(9)
  v_mfma_f32_32x32x16_bf16 v[64:79], v[224:227], a[144:147], v[64:79]
  v_mfma_f32_32x32x16_bf16 v[80:95], v[224:227], a[148:151], v[80:95]
  v_mfma_f32_32x32x16_bf16 v[96:111], v[224:227], a[152:155], v[96:111]
  s_waitcnt vmcnt(8)
  v_mfma_f32_32x32x16_bf16 v[64:79], v[228:231], a[156:159], v[64:79]
  v_mfma_f32_32x32x16_bf16 v[80:95], v[228:231], a[160:163], v[80:95]
  v_mfma_f32_32x32x16_bf16 v[96:111], v[228:231], a[164:167], v[96:111]
  s_waitcnt vmcnt(7)
  v_mfma_f32_32x32x16_bf16 v[64:79], v[232:235], a[168:171], v[64:79]
  v_mfma_f32_32x32x16_bf16 v[80:95], v[232:235], a[172:175], v[80:95]
  v_mfma_f32_32x32x16_bf16 v[96:111], v[232:235], a[176:179], v[96:111]
  s_waitcnt vmcnt(6)
  v_mfma_f32_32x32x16_bf16 v[64:79], v[236:239], a[180:183], v[64:79]
  v_mfma_f32_32x32x16_bf16 v[80:95], v[236:239], a[184:187], v[80:95]
  v_mfma_f32_32x32x16_bf16 v[96:111], v[236:239], a[188:191], v[96:111]
  s_waitcnt vmcnt(5)
  v_mfma_f32_32x32x16_bf16 v[64:79], v[240:243], a[192:195], v[64:79]
  v_mfma_f32_32x32x16_bf16 v[80:95], v[240:243], a[196:199], v[80:95]
  v_mfma_f32_32x32x16_bf16 v[96:111], v[240:243], a[200:203], v[96:111]
  s_waitcnt vmcnt(4)
  v_mfma_f32_32x32x16_bf16 v[64:79], v[244:247], a[204:207], v[64:79]
  v_mfma_f32_32x32x16_bf16 v[80:95], v[244:247], a[208:211], v[80:95]
  v_mfma_f32_32x32x16_bf16 v[96:111], v[244:247], a[212:215], v[96:111]
B_SSM_TAIL:
  s_nop 11
  ds_write_b128 v6, v[68:71] offset:36864
  ds_write_b128 v6, v[84:87] offset:37888
  ds_write_b128 v6, v[100:103] offset:38912
  ds_write_b128 v6, v[72:75] offset:39936
  ds_write_b128 v6, v[88:91] offset:40960
  ds_write_b128 v6, v[104:107] offset:41984
  ds_write_b128 v6, v[76:79] offset:43008
  ds_write_b128 v6, v[92:95] offset:44032
  ds_write_b128 v6, v[108:111] offset:45056
  s_waitcnt lgkmcnt(0)
  s_barrier
  ds_read_b128 v[112:115], v10 offset:36864
  ds_read_b128 v[116:119], v10 offset:37888
  ds_read_b128 v[120:123], v10 offset:38912
  ds_read_b128 v[124:127], v11 offset:36864
  ds_read_b128 v[128:131], v11 offset:37888
  ds_read_b128 v[132:135], v11 offset:38912
  ds_read_b128 v[136:139], v12 offset:36864
  ds_read_b128 v[140:143], v12 offset:37888
  ds_read_b128 v[144:147], v12 offset:38912
  s_waitcnt lgkmcnt(0)
  v_add_f32 v112, v112, v64
  v_add_f32 v124, v124, v136
  v_add_f32 v113, v113, v65
  v_add_f32 v125, v125, v137
  v_add_f32 v114, v114, v66
  v_add_f32 v126, v126, v138
  v_add_f32 v115, v115, v67
  v_add_f32 v127, v127, v139
  v_add_f32 v116, v116, v80
  v_add_f32 v128, v128, v140
  v_add_f32 v117, v117, v81
  v_add_f32 v129, v129, v141
  v_add_f32 v118, v118, v82
  v_add_f32 v130, v130, v142
  v_add_f32 v119, v119, v83
  v_add_f32 v131, v131, v143
  v_add_f32 v120, v120, v96
  v_add_f32 v132, v132, v144
  v_add_f32 v121, v121, v97
  v_add_f32 v133, v133, v145
  v_add_f32 v122, v122, v98
  v_add_f32 v134, v134, v146
  v_add_f32 v123, v123, v99
  v_add_f32 v135, v135, v147
  v_add_f32 v112, v112, v124
  v_add_f32 v113, v113, v125
  v_add_f32 v114, v114, v126
  v_add_f32 v115, v115, v127
  v_add_f32 v116, v116, v128
  v_add_f32 v117, v117, v129
  v_add_f32 v118, v118, v130
  v_add_f32 v119, v119, v131
  v_add_f32 v120, v120, v132
  v_add_f32 v121, v121, v133
  v_add_f32 v122, v122, v134
  v_add_f32 v123, v123, v135
  v_cvt_pk_bf16_f32 v136, v112, v113
  v_cvt_pk_bf16_f32 v137, v114, v115
  v_cvt_pk_bf16_f32 v138, v116, v117
  v_cvt_pk_bf16_f32 v140, v118, v119
  v_cvt_pk_bf16_f32 v141, v120, v121
  v_cvt_pk_bf16_f32 v142, v122, v123
  v_mov_b32 v139, s45
  v_mov_b32 v143, s45
  s_mul_i32 s42, s63, 49152
  s_add_u32 s42, s42, s39
  buffer_store_dwordx4 v[136:139], v13, s[8:11], s42 offen offset:0 sc1
  buffer_store_dwordx4 v[140:143], v13, s[8:11], s42 offen offset:1024 sc1
  s_endpgm
LIGHT:
  s_barrier
  s_cmp_eq_u32 s30, 0
  s_cbranch_scc1 LIGHT2
  s_load_dwordx4 s[96:99], s[0:1], 40
  s_sub_u32 s3, s2, 240
  s_mul_i32 s3, s3, 3
  s_add_u32 s3, s3, s30
  s_sub_u32 s3, s3, 1
  s_lshr_b32 s4, s3, 3
  s_mul_i32 s4, s4, 110592
  s_bfe_u32 s5, s3, 0x10001
  s_mul_i32 s5, s5, 576
  s_add_u32 s4, s4, s5
  s_and_b32 s5, s3, 1
  s_mul_i32 s5, s5, 288
  s_add_u32 s4, s4, s5
  v_and_b32 v1, 31, v0
  v_mul_u32_u24 v1, 1152, v1
  v_lshrrev_b32 v2, 5, v0
  v_lshl_add_u32 v1, v2, 4, v1
  v_add_u32 v1, s4, v1
  v_add_u32 v2, 36864, v1
  v_add_u32 v3, 73728, v1
  v_lshlrev_b32 v4, 4, v0
  s_mul_i32 s6, s3, 27648
  s_add_u32 s6, s6, 4194304
  s_waitcnt lgkmcnt(0)
  s_bitcmp1_b32 s3, 2
  s_cselect_b32 s96, s98, s96
  s_cselect_b32 s97, s99, s97
  global_load_dwordx4 v[16:19], v1, s[96:97] offset:0
  global_load_dwordx4 v[20:23], v2, s[96:97] offset:0
  global_load_dwordx4 v[24:27], v3, s[96:97] offset:0
  global_load_dwordx4 v[28:31], v1, s[96:97] offset:32
  global_load_dwordx4 v[32:35], v2, s[96:97] offset:32
  global_load_dwordx4 v[36:39], v3, s[96:97] offset:32
  global_load_dwordx4 v[40:43], v1, s[96:97] offset:64
  global_load_dwordx4 v[44:47], v2, s[96:97] offset:64
  global_load_dwordx4 v[48:51], v3, s[96:97] offset:64
  global_load_dwordx4 v[52:55], v1, s[96:97] offset:96
  global_load_dwordx4 v[56:59], v2, s[96:97] offset:96
  global_load_dwordx4 v[60:63], v3, s[96:97] offset:96
  global_load_dwordx4 v[64:67], v1, s[96:97] offset:128
  global_load_dwordx4 v[68:71], v2, s[96:97] offset:128
  global_load_dwordx4 v[72:75], v3, s[96:97] offset:128
  global_load_dwordx4 v[76:79], v1, s[96:97] offset:160
  global_load_dwordx4 v[80:83], v2, s[96:97] offset:160
  global_load_dwordx4 v[84:87], v3, s[96:97] offset:160
  global_load_dwordx4 v[88:91], v1, s[96:97] offset:192
  global_load_dwordx4 v[92:95], v2, s[96:97] offset:192
  global_load_dwordx4 v[96:99], v3, s[96:97] offset:192
  global_load_dwordx4 v[100:103], v1, s[96:97] offset:224
  global_load_dwordx4 v[104:107], v2, s[96:97] offset:224
  global_load_dwordx4 v[108:111], v3, s[96:97] offset:224
  global_load_dwordx4 v[112:115], v1, s[96:97] offset:256
  global_load_dwordx4 v[116:119], v2, s[96:97] offset:256
  global_load_dwordx4 v[120:123], v3, s[96:97] offset:256
  s_waitcnt vmcnt(26)
  buffer_store_dwordx4 v[16:19], v4, s[8:11], s6 offen offset:0 sc1
  s_waitcnt vmcnt(26)
  buffer_store_dwordx4 v[20:23], v4, s[8:11], s6 offen offset:1024 sc1
  s_waitcnt vmcnt(26)
  buffer_store_dwordx4 v[24:27], v4, s[8:11], s6 offen offset:2048 sc1
  s_waitcnt vmcnt(26)
  buffer_store_dwordx4 v[28:31], v4, s[8:11], s6 offen offset:3072 sc1
  s_add_u32 s6, s6, 4096
  s_waitcnt vmcnt(26)
  buffer_store_dwordx4 v[32:35], v4, s[8:11], s6 offen offset:0 sc1
  s_waitcnt vmcnt(26)
  buffer_store_dwordx4 v[36:39], v4, s[8:11], s6 offen offset:1024 sc1
  s_waitcnt vmcnt(26)
  buffer_store_dwordx4 v[40:43], v4, s[8:11], s6 offen offset:2048 sc1
  s_waitcnt vmcnt(26)
  buffer_store_dwordx4 v[44:47], v4, s[8:11], s6 offen offset:3072 sc1
  s_add_u32 s6, s6, 4096
  s_waitcnt vmcnt(26)
  buffer_store_dwordx4 v[48:51], v4, s[8:11], s6 offen offset:0 sc1
  s_waitcnt vmcnt(26)
  buffer_store_dwordx4 v[52:55], v4, s[8:11], s6 offen offset:1024 sc1
  s_waitcnt vmcnt(26)
  buffer_store_dwordx4 v[56:59], v4, s[8:11], s6 offen offset:2048 sc1
  s_waitcnt vmcnt(26)
  buffer_store_dwordx4 v[60:63], v4, s[8:11], s6 offen offset:3072 sc1
  s_add_u32 s6, s6, 4096
  s_waitcnt vmcnt(26)
  buffer_store_dwordx4 v[64:67], v4, s[8:11], s6 offen offset:0 sc1
  s_waitcnt vmcnt(26)
  buffer_store_dwordx4 v[68:71], v4, s[8:11], s6 offen offset:1024 sc1
  s_waitcnt vmcnt(26)
  buffer_store_dwordx4 v[72:75], v4, s[8:11], s6 offen offset:2048 sc1
  s_waitcnt vmcnt(26)
  buffer_store_dwordx4 v[76:79], v4, s[8:11], s6 offen offset:3072 sc1
  s_add_u32 s6, s6, 4096
  s_waitcnt vmcnt(26)
  buffer_store_dwordx4 v[80:83], v4, s[8:11], s6 offen offset:0 sc1
  s_waitcnt vmcnt(26)
  buffer_store_dwordx4 v[84:87], v4, s[8:11], s6 offen offset:1024 sc1
  s_waitcnt vmcnt(26)
  buffer_store_dwordx4 v[88:91], v4, s[8:11], s6 offen offset:2048 sc1
  s_waitcnt vmcnt(26)
  buffer_store_dwordx4 v[92:95], v4, s[8:11], s6 offen offset:3072 sc1
  s_add_u32 s6, s6, 4096
  s_waitcnt vmcnt(26)
  buffer_store_dwordx4 v[96:99], v4, s[8:11], s6 offen offset:0 sc1
  s_waitcnt vmcnt(26)
  buffer_store_dwordx4 v[100:103], v4, s[8:11], s6 offen offset:1024 sc1
  s_waitcnt vmcnt(26)
  buffer_store_dwordx4 v[104:107], v4, s[8:11], s6 offen offset:2048 sc1
  s_waitcnt vmcnt(26)
  buffer_store_dwordx4 v[108:111], v4, s[8:11], s6 offen offset:3072 sc1
  s_add_u32 s6, s6, 4096
  s_waitcnt vmcnt(26)
  buffer_store_dwordx4 v[112:115], v4, s[8:11], s6 offen offset:0 sc1
  s_waitcnt vmcnt(26)
  buffer_store_dwordx4 v[116:119], v4, s[8:11], s6 offen offset:1024 sc1
  s_waitcnt vmcnt(26)
  buffer_store_dwordx4 v[120:123], v4, s[8:11], s6 offen offset:2048 sc1
  s_lshl_b32 s3, s3, 7
  s_add_u32 s3, s3, 524288
  v_mov_b32 v1, 0
  v_mov_b32 v2, s45
  s_mov_b64 exec, 1
  s_waitcnt vmcnt(0)
  buffer_store_dword v2, v1, s[8:11], s3 offen sc1
  s_mov_b64 exec, -1
LIGHT2:
  s_and_b32 s3, s2, 7
  s_and_b32 s4, s3, 3
  s_cmp_eq_u32 s4, 3
  s_cbranch_scc1 KEND
  s_lshr_b32 s4, s3, 2
  s_sub_u32 s3, s3, s4
  s_and_b32 s4, s3, 6
  s_bfe_u32 s5, s2, 0x10003
  s_add_u32 s47, s4, s5
  s_and_b32 s3, s3, 1
  s_lshl_b32 s4, s3, 1
  s_add_u32 s4, s4, 5
  s_add_u32 s56, s4, 0
  s_add_u32 s57, s4, 8
  s_add_u32 s58, s4, 16
  s_add_u32 s59, s4, 24
  s_add_u32 s60, s4, 32
  s_add_u32 s61, s4, 40
  s_add_u32 s62, s4, 48
  s_add_u32 s63, s4, 56
  s_mov_b32 s46, 0
  s_mov_b32 s48, 4
  s_mov_b32 s31, 0
  s_mov_b32 s54, 0x3ffff
  s_mov_b32 s12, 458752
  v_min_u32 v1, 47, v0
  v_lshlrev_b32 v1, 7, v1
  s_mov_b32 s52, 524288
  buffer_load_dword v2, v1, s[8:11], s52 offen sc1
  s_waitcnt vmcnt(0)
  v_cmp_ne_u32 vcc, s45, v2
  s_nop 1
  s_cmp_eq_u64 vcc, 0
  s_cbranch_scc0 POLL17
POLL17_OK:
  s_lshl_b32 s4, s47, 2
  s_add_u32 s4, s4, s30
  s_mul_i32 s4, s4, 55296
  s_add_u32 s4, s4, 4194304
  v_lshlrev_b32 v4, 4, v0
  buffer_load_dwordx4 a[0:3], v4, s[8:11], s4 offen offset:0 sc1
  buffer_load_dwordx4 a[4:7], v4, s[8:11], s4 offen offset:1024 sc1
  buffer_load_dwordx4 a[8:11], v4, s[8:11], s4 offen offset:2048 sc1
  buffer_load_dwordx4 a[12:15], v4, s[8:11], s4 offen offset:3072 sc1
  s_add_u32 s4, s4, 4096
  buffer_load_dwordx4 a[16:19], v4, s[8:11], s4 offen offset:0 sc1
  buffer_load_dwordx4 a[20:23], v4, s[8:11], s4 offen offset:1024 sc1
  buffer_load_dwordx4 a[24:27], v4, s[8:11], s4 offen offset:2048 sc1
  buffer_load_dwordx4 a[28:31], v4, s[8:11], s4 offen offset:3072 sc1
  s_add_u32 s4, s4, 4096
  buffer_load_dwordx4 a[32:35], v4, s[8:11], s4 offen offset:0 sc1
  buffer_load_dwordx4 a[36:39], v4, s[8:11], s4 offen offset:1024 sc1
  buffer_load_dwordx4 a[40:43], v4, s[8:11], s4 offen offset:2048 sc1
  buffer_load_dwordx4 a[44:47], v4, s[8:11], s4 offen offset:3072 sc1
  s_add_u32 s4, s4, 4096
  buffer_load_dwordx4 a[48:51], v4, s[8:11], s4 offen offset:0 sc1
  buffer_load_dwordx4 a[52:55], v4, s[8:11], s4 offen offset:1024 sc1
  buffer_load_dwordx4 a[56:59], v4, s[8:11], s4 offen offset:2048 sc1
  buffer_load_dwordx4 a[60:63], v4, s[8:11], s4 offen offset:3072 sc1
  s_add_u32 s4, s4, 4096
  buffer_load_dwordx4 a[64:67], v4, s[8:11], s4 offen offset:0 sc1
  buffer_load_dwordx4 a[68:71], v4, s[8:11], s4 offen offset:1024 sc1
  buffer_load_dwordx4 a[72:75], v4, s[8:11], s4 offen offset:2048 sc1
  buffer_load_dwordx4 a[76:79], v4, s[8:11], s4 offen offset:3072 sc1
  s_add_u32 s4, s4, 4096
  buffer_load_dwordx4 a[80:83], v4, s[8:11], s4 offen offset:0 sc1
  buffer_load_dwordx4 a[84:87], v4, s[8:11], s4 offen offset:1024 sc1
  buffer_load_dwordx4 a[88:91], v4, s[8:11], s4 offen offset:2048 sc1
  buffer_load_dwordx4 a[92:95], v4, s[8:11], s4 offen offset:3072 sc1
  s_add_u32 s4, s4, 4096
  buffer_load_dwordx4 a[96:99], v4, s[8:11], s4 offen offset:0 sc1
  buffer_load_dwordx4 a[100:103], v4, s[8:11], s4 offen offset:1024 sc1
  buffer_load_dwordx4 a[104:107], v4, s[8:11], s4 offen offset:2048 sc1
  buffer_load_dwordx4 a[108:111], v4, s[8:11], s4 offen offset:3072 sc1
  s_add_u32 s4, s4, 4096
  buffer_load_dwordx4 a[112:115], v4, s[8:11], s4 offen offset:0 sc1
  buffer_load_dwordx4 a[116:119], v4, s[8:11], s4 offen offset:1024 sc1
  buffer_load_dwordx4 a[120:123], v4, s[8:11], s4 offen offset:2048 sc1
  buffer_load_dwordx4 a[124:127], v4, s[8:11], s4 offen offset:3072 sc1
  s_add_u32 s4, s4, 4096
  buffer_load_dwordx4 a[128:131], v4, s[8:11], s4 offen offset:0 sc1
  buffer_load_dwordx4 a[132:135], v4, s[8:11], s4 offen offset:1024 sc1
  buffer_load_dwordx4 a[136:139], v4, s[8:11], s4 offen offset:2048 sc1
  buffer_load_dwordx4 a[140:143], v4, s[8:11], s4 offen offset:3072 sc1
  s_add_u32 s4, s4, 4096
  buffer_load_dwordx4 a[144:147], v4, s[8:11], s4 offen offset:0 sc1
  buffer_load_dwordx4 a[148:151], v4, s[8:11], s4 offen offset:1024 sc1
  buffer_load_dwordx4 a[152:155], v4, s[8:11], s4 offen offset:2048 sc1
  buffer_load_dwordx4 a[156:159], v4, s[8:11], s4 offen offset:3072 sc1
  s_add_u32 s4, s4, 4096
  buffer_load_dwordx4 a[160:163], v4, s[8:11], s4 offen offset:0 sc1
  buffer_load_dwordx4 a[164:167], v4, s[8:11], s4 offen offset:1024 sc1
  buffer_load_dwordx4 a[168:171], v4, s[8:11], s4 offen offset:2048 sc1
  buffer_load_dwordx4 a[172:175], v4, s[8:11], s4 offen offset:3072 sc1
  s_add_u32 s4, s4, 4096
  buffer_load_dwordx4 a[176:179], v4, s[8:11], s4 offen offset:0 sc1
  buffer_load_dwordx4 a[180:183], v4, s[8:11], s4 offen offset:1024 sc1
  buffer_load_dwordx4 a[184:187], v4, s[8:11], s4 offen offset:2048 sc1
  buffer_load_dwordx4 a[188:191], v4, s[8:11], s4 offen offset:3072 sc1
  s_add_u32 s4, s4, 4096
  buffer_load_dwordx4 a[192:195], v4, s[8:11], s4 offen offset:0 sc1
  buffer_load_dwordx4 a[196:199], v4, s[8:11], s4 offen offset:1024 sc1
  buffer_load_dwordx4 a[200:203], v4, s[8:11], s4 offen offset:2048 sc1
  buffer_load_dwordx4 a[204:207], v4, s[8:11], s4 offen offset:3072 sc1
  s_add_u32 s4, s4, 4096
  buffer_load_dwordx4 a[208:211], v4, s[8:11], s4 offen offset:0 sc1
  buffer_load_dwordx4 a[212:215], v4, s[8:11], s4 offen offset:1024 sc1
  v_and_b32 v14, 31, v0
  v_lshrrev_b32 v15, v14, s54
  v_and_b32 v15, 1, v15
  v_xor_b32 v15, 1, v15
  v_lshlrev_b32 v9, 7, v0
  v_lshl_add_u32 v9, v15, 30, v9
  s_mov_b32 s52, 8192
  buffer_load_dword v8, v9, s[8:11], s12 offen sc1
  s_waitcnt vmcnt(0)
  s_mul_i32 s37, s46, 2949120
  s_mul_i32 s3, s48, 73728
  s_add_u32 s37, s37, s3
  s_add_u32 s37, s37, 8388608
  s_lshl_b32 s4, s30, 3
  v_add_u32 v14, s4, v0
  v_and_b32 v14, 31, v14
  v_and_b32 v15, 32, v0
  v_add_u32 v14, v14, v15
  s_mul_i32 s3, s30, 18432
  v_lshl_add_u32 v1, v14, 4, s3
  s_mul_i32 s55, s46, 48
  s_add_u32 s55, s55, s47
  s_lshl_b32 s3, s55, 13
  s_mul_i32 s4, s48, 3145728
  s_add_u32 s3, s3, s4
  s_add_u32 s39, s3, 33554432
  s_lshl_b32 s3, s30, 11
  v_lshl_add_u32 v13, v0, 4, s3
  s_sub_u32 s3, s30, 1
  s_and_b32 s3, s3, 3
  s_mul_i32 s3, s3, 9216
  s_add_u32 s3, s3, 73728
  v_lshl_add_u32 v10, v0, 4, s3
  s_sub_u32 s3, s30, 2
  s_and_b32 s3, s3, 3
  s_mul_i32 s3, s3, 9216
  s_add_u32 s3, s3, 76800
  v_lshl_add_u32 v11, v0, 4, s3
  s_sub_u32 s3, s30, 3
  s_and_b32 s3, s3, 3
  s_mul_i32 s3, s3, 9216
  s_add_u32 s3, s3, 79872
  v_lshl_add_u32 v12, v0, 4, s3
  s_mul_i32 s3, s30, 9216
  s_add_u32 s3, s3, 73728
  v_lshl_add_u32 v6, v0, 4, s3
  v_cmp_ne_u32 vcc, s45, v8
  s_nop 1
  s_or_b32 s4, vcc_lo, vcc_hi
  s_and_b32 s4, s4, s54
  s_cmp_eq_u32 s4, 0
  s_cbranch_scc0 POLL18
POLL18_OK:
  s_branch B_SSM2
POLL1:
  s_mov_b32 s43, 0
POLL1_R:
  s_add_u32 s43, s43, 1
  s_cmp_gt_u32 s43, 200000
  s_cbranch_scc1 POLL1_OK
  s_sleep 1
  buffer_load_dword v250, v252, s[8:11], s52 offen sc1
  s_waitcnt vmcnt(0)
  v_cmp_ne_u32 vcc, s45, v250
  s_nop 1
  s_cmp_eq_u64 vcc, 0
  s_cbranch_scc0 POLL1_R
  s_branch POLL1_OK
POLL2:
  s_mov_b32 s43, 0
POLL2_R:
  s_add_u32 s43, s43, 1
  s_cmp_gt_u32 s43, 200000
  s_cbranch_scc1 POLL2_OK
  s_sleep 1
  buffer_load_dword v8, v9, s[8:11], s12 offen sc1
  s_waitcnt vmcnt(0)
  v_cmp_ne_u32 vcc, s45, v8
  s_nop 1
  s_or_b32 s4, vcc_lo, vcc_hi
  s_and_b32 s4, s4, s54
  s_cmp_eq_u32 s4, 0
  s_cbranch_scc0 POLL2_R
  s_branch POLL2_OK
POLL3:
  s_mov_b32 s43, 0
POLL3_R:
  s_add_u32 s43, s43, 1
  s_cmp_gt_u32 s43, 200000
  s_cbranch_scc1 POLL3_OK
  s_sleep 1
  buffer_load_dword v10, v15, s[8:11], s52 offen sc1
  s_waitcnt vmcnt(0)
  v_cmp_ne_u32 vcc, s45, v10
  s_nop 1
  s_cmp_eq_u64 vcc, 0
  s_cbranch_scc0 POLL3_R
  s_branch POLL3_OK
POLL4:
  s_mov_b32 s43, 0
POLL4_R:
  s_add_u32 s43, s43, 1
  s_cmp_gt_u32 s43, 200000
  s_cbranch_scc1 POLL4_OK
  s_sleep 1
  buffer_load_dword v250, v252, s[8:11], s52 offen sc1
  s_waitcnt vmcnt(0)
  v_cmp_ne_u32 vcc, s45, v250
  s_nop 1
  s_cmp_eq_u64 vcc, 0
  s_cbranch_scc0 POLL4_R
  s_branch POLL4_OK
POLL5:
  s_mov_b32 s43, 0
POLL5_R:
  s_add_u32 s43, s43, 1
  s_cmp_gt_u32 s43, 200000
  s_cbranch_scc1 POLL5_OK
  s_sleep 1
  s_add_u32 s42, s39, 0
  buffer_load_dwordx4 v[228:231], v226, s[8:11], s42 offen sc1
  s_add_u32 s42, s39, 18432
  buffer_load_dwordx4 v[232:235], v226, s[8:11], s42 offen sc1
  s_add_u32 s42, s39, 36864
  buffer_load_dwordx4 v[236:239], v226, s[8:11], s42 offen sc1
  s_add_u32 s42, s39, 55296
  buffer_load_dwordx4 v[240:243], v226, s[8:11], s42 offen sc1
  s_waitcnt vmcnt(0)
  v_cmp_le_u32 s[60:61], 8, v248
  s_nop 1
  v_cndmask_b32 v231, v222, v230, s[60:61]
  v_cndmask_b32 v228, 0, v228, s[60:61]
  v_cndmask_b32 v229, 0, v229, s[60:61]
  v_cmp_le_u32 s[60:61], 6, v248
  s_nop 1
  v_cndmask_b32 v235, v222, v234, s[60:61]
  v_cndmask_b32 v232, 0, v232, s[60:61]
  v_cndmask_b32 v233, 0, v233, s[60:61]
  v_cmp_le_u32 s[60:61], 4, v248
  s_nop 1
  v_cndmask_b32 v239, v222, v238, s[60:61]
  v_cndmask_b32 v236, 0, v236, s[60:61]
  v_cndmask_b32 v237, 0, v237, s[60:61]
  v_cmp_le_u32 s[60:61], 2, v248
  s_nop 1
  v_cndmask_b32 v243, v222, v242, s[60:61]
  v_cndmask_b32 v240, 0, v240, s[60:61]
  v_cndmask_b32 v241, 0, v241, s[60:61]
  v_xor_b32 v216, v231, v235
  v_xor_b32 v217, v239, v243
  v_xor_b32 v218, v231, v222
  v_xor_b32 v211, v239, v222
  v_or3_b32 v216, v216, v217, v218
  v_or_b32 v216, v216, v211
  v_cmp_ne_u32 vcc, 0, v216
  s_nop 1
  s_cmp_eq_u64 vcc, 0
  s_cbranch_scc0 POLL5_R
  s_branch POLL5_OK
POLL6:
  s_mov_b32 s43, 0
POLL6_R:
  s_add_u32 s43, s43, 1
  s_cmp_gt_u32 s43, 200000
  s_cbranch_scc1 POLL6_OK
  s_sleep 1
  buffer_load_dword v8, v9, s[8:11], s12 offen sc1
  s_waitcnt vmcnt(0)
  v_cmp_ne_u32 vcc, s45, v8
  s_nop 1
  s_or_b32 s4, vcc_lo, vcc_hi
  s_and_b32 s4, s4, s54
  s_cmp_eq_u32 s4, 0
  s_cbranch_scc0 POLL6_R
  s_branch POLL6_OK
POLL7:
  s_mov_b32 s43, 0
POLL7_R:
  s_add_u32 s43, s43, 1
  s_cmp_gt_u32 s43, 200000
  s_cbranch_scc1 POLL7_OK
  s_sleep 1
  buffer_load_dword v10, v15, s[8:11], s52 offen sc1
  s_waitcnt vmcnt(0)
  v_cmp_ne_u32 vcc, s45, v10
  s_nop 1
  s_cmp_eq_u64 vcc, 0
  s_cbranch_scc0 POLL7_R
  s_branch POLL7_OK
POLL8:
  s_mov_b32 s43, 0
POLL8_R:
  s_add_u32 s43, s43, 1
  s_cmp_gt_u32 s43, 200000
  s_cbranch_scc1 POLL8_OK
  s_sleep 1
  buffer_load_dword v8, v9, s[8:11], s12 offen sc1
  s_waitcnt vmcnt(0)
  v_cmp_ne_u32 vcc, s45, v8
  s_nop 1
  s_or_b32 s4, vcc_lo, vcc_hi
  s_and_b32 s4, s4, s54
  s_cmp_eq_u32 s4, 0
  s_cbranch_scc0 POLL8_R
  s_branch POLL8_OK
POLL9:
  s_mov_b32 s43, 0
POLL9_R:
  s_add_u32 s43, s43, 1
  s_cmp_gt_u32 s43, 200000
  s_cbranch_scc1 POLL9_OK
  s_sleep 8
  buffer_load_dwordx4 v[224:227], v13, s[8:11], s34 offen offset:0 sc1
  buffer_load_dwordx4 v[228:231], v13, s[8:11], s34 offen offset:1024 sc1
  buffer_load_dwordx4 v[232:235], v13, s[8:11], s35 offen offset:0 sc1
  buffer_load_dwordx4 v[236:239], v13, s[8:11], s35 offen offset:1024 sc1
  buffer_load_dwordx4 v[240:243], v13, s[8:11], s36 offen offset:0 sc1
  buffer_load_dwordx4 v[244:247], v13, s[8:11], s36 offen offset:1024 sc1
  s_waitcnt vmcnt(0)
  v_min3_u32 v7, v227, v231, v235
  v_min3_u32 v7, v7, v239, v243
  v_min3_u32 v7, v7, v247, v247
  v_max3_u32 v8, v227, v231, v235
  v_max3_u32 v8, v8, v239, v243
  v_max3_u32 v8, v8, v247, v247
  v_xor_b32 v7, s45, v7
  v_xor_b32 v8, s45, v8
  v_or_b32 v7, v7, v8
  v_cmp_ne_u32 vcc, 0, v7
  s_nop 1
  s_cmp_eq_u64 vcc, 0
  s_cbranch_scc0 POLL9_R
  s_branch POLL9_OK
POLL10:
  s_mov_b32 s43, 0
POLL10_R:
  s_add_u32 s43, s43, 1
  s_cmp_gt_u32 s43, 200000
  s_cbranch_scc1 POLL10_OK
  s_sleep 8
  buffer_load_dwordx4 v[224:227], v13, s[8:11], s38 offen offset:0 sc1
  buffer_load_dwordx4 v[228:231], v13, s[8:11], s38 offen offset:1024 sc1
  s_waitcnt vmcnt(0)
  v_min3_u32 v7, v227, v231, v227
  v_max3_u32 v8, v227, v231, v227
  v_xor_b32 v7, s45, v7
  v_xor_b32 v8, s45, v8
  v_or_b32 v7, v7, v8
  v_cmp_ne_u32 vcc, 0, v7
  s_nop 1
  s_cmp_eq_u64 vcc, 0
  s_cbranch_scc0 POLL10_R
  s_branch POLL10_OK
POLL11:
  s_mov_b32 s43, 0
POLL11_R:
  s_add_u32 s43, s43, 1
  s_cmp_gt_u32 s43, 200000
  s_cbranch_scc1 POLL11_OK
  s_sleep 1
  buffer_load_dwordx4 v[152:155], v13, s[8:11], s38 offen offset:0 sc1
  buffer_load_dwordx4 v[156:159], v13, s[8:11], s38 offen offset:1024 sc1
  s_waitcnt vmcnt(0)
  v_min3_u32 v7, v155, v159, v155
  v_max3_u32 v8, v155, v159, v155
  v_xor_b32 v7, s45, v7
  v_xor_b32 v8, s45, v8
  v_or_b32 v7, v7, v8
  v_cmp_ne_u32 vcc, 0, v7
  s_nop 1
  s_cmp_eq_u64 vcc, 0
  s_cbranch_scc0 POLL11_R
  s_branch POLL11_OK
POLL12:
  s_mov_b32 s43, 0
POLL12_R:
  s_add_u32 s43, s43, 1
  s_cmp_gt_u32 s43, 200000
  s_cbranch_scc1 POLL12_OK
  s_sleep 1
  buffer_load_dwordx4 v[224:227], v13, s[8:11], s34 offen offset:0 sc1
  buffer_load_dwordx4 v[228:231], v13, s[8:11], s34 offen offset:1024 sc1
  buffer_load_dwordx4 v[20:23], v13, s[8:11], s35 offen offset:0 sc1
  buffer_load_dwordx4 v[36:39], v13, s[8:11], s35 offen offset:1024 sc1
  buffer_load_dwordx4 v[52:55], v13, s[8:11], s36 offen offset:0 sc1
  buffer_load_dwordx4 v[24:27], v13, s[8:11], s36 offen offset:1024 sc1
  s_waitcnt vmcnt(0)
  v_min3_u32 v7, v227, v231, v23
  v_min3_u32 v7, v7, v39, v55
  v_min3_u32 v7, v7, v27, v27
  v_max3_u32 v8, v227, v231, v23
  v_max3_u32 v8, v8, v39, v55
  v_max3_u32 v8, v8, v27, v27
  v_xor_b32 v7, s45, v7
  v_xor_b32 v8, s45, v8
  v_or_b32 v7, v7, v8
  v_cmp_ne_u32 vcc, 0, v7
  s_nop 1
  s_cmp_eq_u64 vcc, 0
  s_cbranch_scc0 POLL12_R
  s_branch POLL12_OK
POLL13:
  s_mov_b32 s43, 0
POLL13_R:
  s_add_u32 s43, s43, 1
  s_cmp_gt_u32 s43, 200000
  s_cbranch_scc1 POLL13_OK
  s_sleep 1
  buffer_load_dword v8, v9, s[8:11], s12 offen sc1
  s_waitcnt vmcnt(0)
  v_cmp_ne_u32 vcc, s45, v8
  s_nop 1
  s_or_b32 s4, vcc_lo, vcc_hi
  s_and_b32 s4, s4, s54
  s_cmp_eq_u32 s4, 0
  s_cbranch_scc0 POLL13_R
  s_branch POLL13_OK
POLL14:
  s_mov_b32 s43, 0
POLL14_R:
  s_add_u32 s43, s43, 1
  s_cmp_gt_u32 s43, 200000
  s_cbranch_scc1 POLL14_OK
  s_sleep 4
  buffer_load_dword v8, v9, s[8:11], s12 offen sc1
  s_waitcnt vmcnt(0)
  v_cmp_ne_u32 vcc, s45, v8
  s_nop 1
  s_or_b32 s4, vcc_lo, vcc_hi
  s_and_b32 s4, s4, s54
  s_cmp_eq_u32 s4, 0
  s_cbranch_scc0 POLL14_R
  s_branch POLL14_OK
POLL15:
  s_mov_b32 s43, 0
POLL15_R:
  s_add_u32 s43, s43, 1
  s_cmp_gt_u32 s43, 200000
  s_cbranch_scc1 POLL15_OK
  s_sleep 4
  buffer_load_dword v8, v9, s[8:11], s12 offen sc1
  s_waitcnt vmcnt(0)
  v_cmp_ne_u32 vcc, s45, v8
  s_nop 1
  s_or_b32 s4, vcc_lo, vcc_hi
  s_and_b32 s4, s4, s54
  s_cmp_eq_u32 s4, 0
  s_cbranch_scc0 POLL15_R
  s_branch POLL15_OK
POLL16:
  s_mov_b32 s43, 0
POLL16_R:
  s_add_u32 s43, s43, 1
  s_cmp_gt_u32 s43, 200000
  s_cbranch_scc1 POLL16_OK
  s_sleep 4
  buffer_load_dword v8, v9, s[8:11], s12 offen sc1
  s_waitcnt vmcnt(0)
  v_cmp_ne_u32 vcc, s45, v8
  s_nop 1
  s_or_b32 s4, vcc_lo, vcc_hi
  s_and_b32 s4, s4, s54
  s_cmp_eq_u32 s4, 0
  s_cbranch_scc0 POLL16_R
  s_branch POLL16_OK
POLL17:
  s_mov_b32 s43, 0
POLL17_R:
  s_add_u32 s43, s43, 1
  s_cmp_gt_u32 s43, 200000
  s_cbranch_scc1 POLL17_OK
  s_sleep 8
  buffer_load_dword v2, v1, s[8:11], s52 offen sc1
  s_waitcnt vmcnt(0)
  v_cmp_ne_u32 vcc, s45, v2
  s_nop 1
  s_cmp_eq_u64 vcc, 0
  s_cbranch_scc0 POLL17_R
  s_branch POLL17_OK
POLL18:
  s_mov_b32 s43, 0
POLL18_R:
  s_add_u32 s43, s43, 1
  s_cmp_gt_u32 s43, 200000
  s_cbranch_scc1 POLL18_OK
  s_sleep 3
  buffer_load_dword v8, v9, s[8:11], s12 offen sc1
  s_waitcnt vmcnt(0)
  v_cmp_ne_u32 vcc, s45, v8
  s_nop 1
  s_or_b32 s4, vcc_lo, vcc_hi
  s_and_b32 s4, s4, s54
  s_cmp_eq_u32 s4, 0
  s_cbranch_scc0 POLL18_R
  s_branch POLL18_OK
KEND:
KLAST:
  s_endpgm
.section .rodata,"a"
.p2align 6
.amdhsa_kernel recurrent_scan__ssm_conv_s5__dense_activation_silu__prompt_kernel
  .amdhsa_next_free_vgpr 512
  .amdhsa_next_free_sgpr 102
  .amdhsa_accum_offset 256
  .amdhsa_group_segment_fixed_size 0
  .amdhsa_kernarg_size 120
  .amdhsa_user_sgpr_count 2
  .amdhsa_user_sgpr_kernarg_segment_ptr 1
  .amdhsa_system_sgpr_workgroup_id_x 1
  .amdhsa_float_denorm_mode_32 3
  .amdhsa_float_denorm_mode_16_64 3
.end_amdhsa_kernel
```
